```python
import torch

def _softmax(x, axis=-1):
    return torch.softmax(x, dim=axis)

def _gelu(x):
    return torch.nn.functional.gelu(x, approximate='tanh')

def _silu(x):
    return torch.nn.functional.silu(x)

def _sigmoid(x):
    return torch.sigmoid(x)

def _layernorm(x, axis=-1, eps=1e-05):
    m = x.mean(dim=axis, keepdim=True)
    v = x.var(dim=axis, keepdim=True, unbiased=False)
    return (x - m) / torch.sqrt(v + eps)

def _scatter_add(tgt, idx, src, axis=0):
    return tgt.clone().index_add_(axis, idx, src)

def _segment_sum(src, seg, n):
    out = torch.zeros((n,) + src.shape[1:], dtype=src.dtype)
    return out.index_add_(0, seg, src)

def _pad(x, pw):
    flat = tuple((v for pair in reversed(pw) for v in pair))
    return torch.nn.functional.pad(x, flat)
kernel_name = 'standalone__mm_dit__diffusion'

def setup_inputs():

    _w = lambda a: (lambda t: t.to(torch.bfloat16) if t.is_floating_point() else t)(torch.as_tensor(a))
    B, Ni, Nt, D = (2, 1024, 32, 1152)
    return {'x_img': _w((lambda *s: torch.randn(*s, dtype=torch.bfloat16) * 0.05)(B, Ni, D)), 'x_txt': _w((lambda *s: torch.randn(*s, dtype=torch.bfloat16) * 0.05)(B, Nt, D)), 'c': _w((lambda *s: torch.randn(*s, dtype=torch.bfloat16) * 0.05)(B, D)), 'wqkv_img': _w((lambda *s: torch.randn(*s, dtype=torch.bfloat16) * 0.05)(D, 3 * D)), 'wqkv_txt': _w((lambda *s: torch.randn(*s, dtype=torch.bfloat16) * 0.05)(D, 3 * D)), 'wo_img': _w((lambda *s: torch.randn(*s, dtype=torch.bfloat16) * 0.05)(D, D)), 'wo_txt': _w((lambda *s: torch.randn(*s, dtype=torch.bfloat16) * 0.05)(D, D)), 'wmod_img': _w((lambda *s: torch.randn(*s, dtype=torch.bfloat16) * 0.05)(D, 6 * D)), 'wmod_txt': _w((lambda *s: torch.randn(*s, dtype=torch.bfloat16) * 0.05)(D, 6 * D))}

def reference(x_img, x_txt, c, wqkv_img, wqkv_txt, wo_img, wo_txt, wmod_img, wmod_txt):
    B, Ni, D = x_img.shape
    Nt = x_txt.shape[1]
    mod_i = (_silu(c) @ wmod_img).reshape(B, 6, 1, D)
    mod_t = (_silu(c) @ wmod_txt).reshape(B, 6, 1, D)
    shi, sci, gai = (mod_i[:, 0].clone(), mod_i[:, 1].clone(), mod_i[:, 2].clone())
    sht, sct, gat = (mod_t[:, 0].clone(), mod_t[:, 1].clone(), mod_t[:, 2].clone())
    hi = _layernorm(x_img, axis=-1) * (1 + sci) + shi
    ht = _layernorm(x_txt, axis=-1) * (1 + sct) + sht
    qkvi = hi @ wqkv_img
    qkvt = ht @ wqkv_txt
    qi, ki, vi = (qkvi[..., :D].clone(), qkvi[..., D:2 * D].clone(), qkvi[..., 2 * D:].clone())
    qt, kt, vt = (qkvt[..., :D].clone(), qkvt[..., D:2 * D].clone(), qkvt[..., 2 * D:].clone())
    q = torch.concatenate([qt, qi], axis=1)
    k = torch.concatenate([kt, ki], axis=1)
    v = torch.concatenate([vt, vi], axis=1)
    scores = torch.einsum('bqd,bkd->bqk', q, k) * D ** (-0.5)
    p = _softmax(scores, axis=-1)
    a = torch.einsum('bqk,bkd->bqd', p, v)
    at, ai = (a[:, :Nt].clone(), a[:, Nt:].clone())
    out_i = x_img + gai * (ai @ wo_img)
    out_t = x_txt + gat * (at @ wo_txt)
    return (out_i, out_t)
```

```asm
; @launch grid=(256,1,1) block=(512,1,1) lds=147520
.amdgcn_target "amdgcn-amd-amdhsa--gfx950"
.text
.globl standalone__mm_dit__diffusion_kernel
.p2align 8
.type standalone__mm_dit__diffusion_kernel,@function
standalone__mm_dit__diffusion_kernel:
    s_cmp_ge_u32 s2, 256
    s_cbranch_scc1 K_exit
    s_load_dwordx16 s[48:63], s[0:1], 0
    s_cmp_lt_u32 s2, 248
    s_cbranch_scc1 P0_nc
    s_getpc_b64 s[4:5]
    s_add_u32 s4, s4, standalone__mm_dit__diffusion_kernel@rel32@lo+4
    s_addc_u32 s5, s5, standalone__mm_dit__diffusion_kernel@rel32@hi+12
    v_lshlrev_b32 v197, 7, v0
    v_min_u32 v197, 55040, v197
    global_load_dword v199, v197, s[4:5]
P0_nc:
    s_load_dwordx2 s[64:65], s[0:1], 64
    s_load_dwordx2 s[84:85], s[0:1], 88
    v_lshrrev_b32 v5, 6, v0
    v_lshrrev_b32 v1, 3, v0
    v_readfirstlane_b32 s87, v5
    v_mul_u32_u24 v1, 6, v1
    s_movk_i32 s17, 13824
    v_mul_lo_u32 v4, v1, s17
    v_and_b32 v5, 7, v0
    v_lshlrev_b32 v5, 4, v5
    v_add_u32 v4, v4, v5
    v_lshlrev_b32 v6, 1, v1
    v_and_b32 v2, 63, v0
    v_lshlrev_b32 v3, 4, v2
    s_mov_b32 s10, s87
    v_lshlrev_b32 v7, 2, v2
    s_mov_b32 s40, 0xffff0000
    s_mov_b32 s41, 0xbfb8aa3b
    s_min_u32 s75, s2, 216
    s_sub_u32 s74, s2, 128
    s_mul_i32 s13, s75, 21846
    s_lshr_b32 s13, s13, 16
    s_mul_i32 s12, s13, 3
    s_sub_u32 s12, s75, s12
    s_cmp_ge_u32 s13, 36
    s_cselect_b32 s14, 1, 0
    s_mul_i32 s15, s14, 36
    s_sub_u32 s13, s13, s15
    s_mul_i32 s16, s12, 5308416
    s_lshl_b32 s18, s13, 7
    s_add_u32 s16, s16, s18
    v_add_u32 v4, s16, v4
    s_mul_i32 s16, s12, 768
    v_add_u32 v6, s16, v6
    s_getpc_b64 s[16:17]
    s_add_u32 s16, s16, main_tab@rel32@lo+4
    s_addc_u32 s17, s17, main_tab@rel32@hi+12
    s_lshl_b32 s6, s2, 4
    s_waitcnt lgkmcnt(0)
    s_load_dwordx4 s[80:83], s[16:17], s6
    s_cmp_eq_u32 s14, 1
    s_cselect_b32 s8, s64, s62
    s_cselect_b32 s9, s65, s63
    s_add_u32 s4, s84, 0x98000
    s_addc_u32 s5, s85, 0
    s_load_dword s7, s[4:5], 0
    s_mov_b32 s20, s8
    s_mov_b32 s21, s9
    s_mov_b32 s22, 0xf30000
    s_mov_b32 s23, 0x20000
    s_mov_b32 s24, s52
    s_mov_b32 s25, s53
    s_mov_b32 s26, 0x1200
    s_mov_b32 s27, 0x20000
    s_cmp_ge_u32 s2, 128
    s_cbranch_scc1 P0_B
    buffer_load_dwordx3 v[8:10], v6, s[24:27], 0 offen
    buffer_load_dwordx3 v[12:14], v6, s[24:27], 0 offen offset:2304
    buffer_load_dwordx4 v[16:19], v4, s[20:23], 0 offen nt
    s_mov_b32 s3, 13824
    buffer_load_dwordx4 v[20:23], v4, s[20:23], s3 offen nt
    s_mov_b32 s3, 27648
    buffer_load_dwordx4 v[24:27], v4, s[20:23], s3 offen nt
    s_mov_b32 s3, 41472
    buffer_load_dwordx4 v[28:31], v4, s[20:23], s3 offen nt
    s_mov_b32 s3, 55296
    buffer_load_dwordx4 v[32:35], v4, s[20:23], s3 offen nt
    s_mov_b32 s3, 69120
    buffer_load_dwordx4 v[36:39], v4, s[20:23], s3 offen nt
    s_add_u32 s76, s84, 0x90000
    s_addc_u32 s77, s85, 0
    s_mov_b32 s78, 0x8080
    s_mov_b32 s79, 0x20000
    s_add_u32 s28, s84, 0xa0000
    s_addc_u32 s29, s85, 0
    s_mov_b32 s30, 0x36000
    s_mov_b32 s31, 0x20000
    s_add_u32 s32, s84, 0x100000
    s_addc_u32 s33, s85, 0
    s_mov_b32 s34, 0x4a4000
    s_mov_b32 s35, 0x20000
    v_mov_b32 v195, 147456
    v_mov_b32 v196, 0
    ds_write_b32 v195, v196
    ds_write_b32 v195, v196 offset:4
    ds_write_b32 v195, v196 offset:8
    ds_write_b32 v195, v196 offset:16
    ds_write_b32 v195, v196 offset:20
    ds_write_b32 v195, v196 offset:24
    ds_write_b32 v195, v196 offset:28
    s_waitcnt vmcnt(6)
    v_lshlrev_b32 v40, 16, v8
    v_and_b32 v41, s40, v8
    v_lshlrev_b32 v42, 16, v9
    v_and_b32 v43, s40, v9
    v_lshlrev_b32 v44, 16, v10
    v_and_b32 v45, s40, v10
    v_lshlrev_b32 v46, 16, v12
    v_and_b32 v47, s40, v12
    v_lshlrev_b32 v48, 16, v13
    v_and_b32 v49, s40, v13
    v_lshlrev_b32 v50, 16, v14
    v_and_b32 v51, s40, v14
    v_mul_f32 v52, s41, v40
    v_mul_f32 v53, s41, v41
    v_mul_f32 v54, s41, v42
    v_mul_f32 v55, s41, v43
    v_mul_f32 v56, s41, v44
    v_mul_f32 v57, s41, v45
    v_mul_f32 v58, s41, v46
    v_mul_f32 v59, s41, v47
    v_mul_f32 v60, s41, v48
    v_mul_f32 v61, s41, v49
    v_mul_f32 v62, s41, v50
    v_mul_f32 v63, s41, v51
    v_exp_f32 v52, v52
    v_exp_f32 v53, v53
    v_exp_f32 v54, v54
    v_exp_f32 v55, v55
    v_exp_f32 v56, v56
    v_exp_f32 v57, v57
    v_exp_f32 v58, v58
    v_exp_f32 v59, v59
    v_exp_f32 v60, v60
    v_exp_f32 v61, v61
    v_exp_f32 v62, v62
    v_exp_f32 v63, v63
    v_add_f32 v52, 1.0, v52
    v_add_f32 v53, 1.0, v53
    v_add_f32 v54, 1.0, v54
    v_add_f32 v55, 1.0, v55
    v_add_f32 v56, 1.0, v56
    v_add_f32 v57, 1.0, v57
    v_add_f32 v58, 1.0, v58
    v_add_f32 v59, 1.0, v59
    v_add_f32 v60, 1.0, v60
    v_add_f32 v61, 1.0, v61
    v_add_f32 v62, 1.0, v62
    v_add_f32 v63, 1.0, v63
    v_rcp_f32 v52, v52
    v_rcp_f32 v53, v53
    v_rcp_f32 v54, v54
    v_rcp_f32 v55, v55
    v_rcp_f32 v56, v56
    v_rcp_f32 v57, v57
    v_rcp_f32 v58, v58
    v_rcp_f32 v59, v59
    v_rcp_f32 v60, v60
    v_rcp_f32 v61, v61
    v_rcp_f32 v62, v62
    v_rcp_f32 v63, v63
    v_mul_f32 v40, v52, v40
    v_mul_f32 v41, v53, v41
    v_mul_f32 v42, v54, v42
    v_mul_f32 v43, v55, v43
    v_mul_f32 v44, v56, v44
    v_mul_f32 v45, v57, v45
    v_mul_f32 v46, v58, v46
    v_mul_f32 v47, v59, v47
    v_mul_f32 v48, v60, v48
    v_mul_f32 v49, v61, v49
    v_mul_f32 v50, v62, v50
    v_mul_f32 v51, v63, v51
    v_cvt_pk_bf16_f32 v52, v40, v41
    v_cvt_pk_bf16_f32 v53, v42, v43
    v_cvt_pk_bf16_f32 v54, v44, v45
    v_cvt_pk_bf16_f32 v55, v46, v47
    v_cvt_pk_bf16_f32 v56, v48, v49
    v_cvt_pk_bf16_f32 v57, v50, v51
    v_lshlrev_b32 v40, 16, v52
    v_and_b32 v41, s40, v52
    v_lshlrev_b32 v42, 16, v53
    v_and_b32 v43, s40, v53
    v_lshlrev_b32 v44, 16, v54
    v_and_b32 v45, s40, v54
    v_lshlrev_b32 v46, 16, v55
    v_and_b32 v47, s40, v55
    v_lshlrev_b32 v48, 16, v56
    v_and_b32 v49, s40, v56
    v_lshlrev_b32 v50, 16, v57
    v_and_b32 v51, s40, v57
    v_mov_b64 v[64:65], 0
    v_mov_b64 v[66:67], 0
    v_mov_b64 v[68:69], 0
    v_mov_b64 v[70:71], 0
    v_mov_b64 v[72:73], 0
    v_mov_b64 v[74:75], 0
    v_mov_b64 v[76:77], 0
    v_mov_b64 v[78:79], 0
    s_waitcnt vmcnt(5)
    v_lshlrev_b32 v52, 16, v16
    v_and_b32 v53, s40, v16
    v_lshlrev_b32 v54, 16, v17
    v_and_b32 v55, s40, v17
    v_lshlrev_b32 v56, 16, v18
    v_and_b32 v57, s40, v18
    v_lshlrev_b32 v58, 16, v19
    v_and_b32 v59, s40, v19
    v_pk_fma_f32 v[64:65], v[52:53], v[40:41], v[64:65] op_sel_hi:[1,0,1]
    v_pk_fma_f32 v[66:67], v[54:55], v[40:41], v[66:67] op_sel_hi:[1,0,1]
    v_pk_fma_f32 v[68:69], v[56:57], v[40:41], v[68:69] op_sel_hi:[1,0,1]
    v_pk_fma_f32 v[70:71], v[58:59], v[40:41], v[70:71] op_sel_hi:[1,0,1]
    v_pk_fma_f32 v[72:73], v[52:53], v[46:47], v[72:73] op_sel_hi:[1,0,1]
    v_pk_fma_f32 v[74:75], v[54:55], v[46:47], v[74:75] op_sel_hi:[1,0,1]
    v_pk_fma_f32 v[76:77], v[56:57], v[46:47], v[76:77] op_sel_hi:[1,0,1]
    v_pk_fma_f32 v[78:79], v[58:59], v[46:47], v[78:79] op_sel_hi:[1,0,1]
    s_waitcnt vmcnt(4)
    v_lshlrev_b32 v52, 16, v20
    v_and_b32 v53, s40, v20
    v_lshlrev_b32 v54, 16, v21
    v_and_b32 v55, s40, v21
    v_lshlrev_b32 v56, 16, v22
    v_and_b32 v57, s40, v22
    v_lshlrev_b32 v58, 16, v23
    v_and_b32 v59, s40, v23
    v_pk_fma_f32 v[64:65], v[52:53], v[40:41], v[64:65] op_sel:[0,1,0] op_sel_hi:[1,1,1]
    v_pk_fma_f32 v[66:67], v[54:55], v[40:41], v[66:67] op_sel:[0,1,0] op_sel_hi:[1,1,1]
    v_pk_fma_f32 v[68:69], v[56:57], v[40:41], v[68:69] op_sel:[0,1,0] op_sel_hi:[1,1,1]
    v_pk_fma_f32 v[70:71], v[58:59], v[40:41], v[70:71] op_sel:[0,1,0] op_sel_hi:[1,1,1]
    v_pk_fma_f32 v[72:73], v[52:53], v[46:47], v[72:73] op_sel:[0,1,0] op_sel_hi:[1,1,1]
    v_pk_fma_f32 v[74:75], v[54:55], v[46:47], v[74:75] op_sel:[0,1,0] op_sel_hi:[1,1,1]
    v_pk_fma_f32 v[76:77], v[56:57], v[46:47], v[76:77] op_sel:[0,1,0] op_sel_hi:[1,1,1]
    v_pk_fma_f32 v[78:79], v[58:59], v[46:47], v[78:79] op_sel:[0,1,0] op_sel_hi:[1,1,1]
    s_mov_b32 s44, s48
    s_mov_b32 s45, s49
    s_mov_b32 s46, 0x480000
    s_mov_b32 s47, 0x20000
    s_sub_u32 s3, s2, 0
    s_lshl_b32 s3, s3, 4
    s_add_u32 s3, s3, s10
    s_mul_i32 s3, s3, 2304
    v_add_u32 v195, s3, v3
    v_add_u32 v196, s3, v7
    s_movk_i32 s3, 18432
    buffer_load_dwordx4 v[170:173], v195, s[44:47], 0 offen
    buffer_load_dwordx4 v[174:177], v195, s[44:47], 0 offen offset:1024
    buffer_load_dword v178, v196, s[44:47], 0 offen offset:2048
    buffer_load_dwordx4 v[182:185], v195, s[44:47], s3 offen
    buffer_load_dwordx4 v[186:189], v195, s[44:47], s3 offen offset:1024
    buffer_load_dword v190, v196, s[44:47], s3 offen offset:2048
    s_getpc_b64 s[4:5]
    s_add_u32 s4, s4, dep_tab@rel32@lo+4
    s_addc_u32 s5, s5, dep_tab@rel32@hi+12
    s_mul_i32 s3, s2, 384
    v_lshl_add_u32 v195, v2, 1, s3
    global_load_ushort v250, v195, s[4:5] offset:0
    global_load_ushort v251, v195, s[4:5] offset:128
    global_load_ushort v252, v195, s[4:5] offset:256
    s_waitcnt vmcnt(12)
    v_lshlrev_b32 v52, 16, v24
    v_and_b32 v53, s40, v24
    v_lshlrev_b32 v54, 16, v25
    v_and_b32 v55, s40, v25
    v_lshlrev_b32 v56, 16, v26
    v_and_b32 v57, s40, v26
    v_lshlrev_b32 v58, 16, v27
    v_and_b32 v59, s40, v27
    v_pk_fma_f32 v[64:65], v[52:53], v[42:43], v[64:65] op_sel_hi:[1,0,1]
    v_pk_fma_f32 v[66:67], v[54:55], v[42:43], v[66:67] op_sel_hi:[1,0,1]
    v_pk_fma_f32 v[68:69], v[56:57], v[42:43], v[68:69] op_sel_hi:[1,0,1]
    v_pk_fma_f32 v[70:71], v[58:59], v[42:43], v[70:71] op_sel_hi:[1,0,1]
    v_pk_fma_f32 v[72:73], v[52:53], v[48:49], v[72:73] op_sel_hi:[1,0,1]
    v_pk_fma_f32 v[74:75], v[54:55], v[48:49], v[74:75] op_sel_hi:[1,0,1]
    v_pk_fma_f32 v[76:77], v[56:57], v[48:49], v[76:77] op_sel_hi:[1,0,1]
    v_pk_fma_f32 v[78:79], v[58:59], v[48:49], v[78:79] op_sel_hi:[1,0,1]
    s_waitcnt vmcnt(11)
    v_lshlrev_b32 v52, 16, v28
    v_and_b32 v53, s40, v28
    v_lshlrev_b32 v54, 16, v29
    v_and_b32 v55, s40, v29
    v_lshlrev_b32 v56, 16, v30
    v_and_b32 v57, s40, v30
    v_lshlrev_b32 v58, 16, v31
    v_and_b32 v59, s40, v31
    v_pk_fma_f32 v[64:65], v[52:53], v[42:43], v[64:65] op_sel:[0,1,0] op_sel_hi:[1,1,1]
    v_pk_fma_f32 v[66:67], v[54:55], v[42:43], v[66:67] op_sel:[0,1,0] op_sel_hi:[1,1,1]
    v_pk_fma_f32 v[68:69], v[56:57], v[42:43], v[68:69] op_sel:[0,1,0] op_sel_hi:[1,1,1]
    v_pk_fma_f32 v[70:71], v[58:59], v[42:43], v[70:71] op_sel:[0,1,0] op_sel_hi:[1,1,1]
    v_pk_fma_f32 v[72:73], v[52:53], v[48:49], v[72:73] op_sel:[0,1,0] op_sel_hi:[1,1,1]
    v_pk_fma_f32 v[74:75], v[54:55], v[48:49], v[74:75] op_sel:[0,1,0] op_sel_hi:[1,1,1]
    v_pk_fma_f32 v[76:77], v[56:57], v[48:49], v[76:77] op_sel:[0,1,0] op_sel_hi:[1,1,1]
    v_pk_fma_f32 v[78:79], v[58:59], v[48:49], v[78:79] op_sel:[0,1,0] op_sel_hi:[1,1,1]
    s_waitcnt vmcnt(10)
    v_lshlrev_b32 v52, 16, v32
    v_and_b32 v53, s40, v32
    v_lshlrev_b32 v54, 16, v33
    v_and_b32 v55, s40, v33
    v_lshlrev_b32 v56, 16, v34
    v_and_b32 v57, s40, v34
    v_lshlrev_b32 v58, 16, v35
    v_and_b32 v59, s40, v35
    v_pk_fma_f32 v[64:65], v[52:53], v[44:45], v[64:65] op_sel_hi:[1,0,1]
    v_pk_fma_f32 v[66:67], v[54:55], v[44:45], v[66:67] op_sel_hi:[1,0,1]
    v_pk_fma_f32 v[68:69], v[56:57], v[44:45], v[68:69] op_sel_hi:[1,0,1]
    v_pk_fma_f32 v[70:71], v[58:59], v[44:45], v[70:71] op_sel_hi:[1,0,1]
    v_pk_fma_f32 v[72:73], v[52:53], v[50:51], v[72:73] op_sel_hi:[1,0,1]
    v_pk_fma_f32 v[74:75], v[54:55], v[50:51], v[74:75] op_sel_hi:[1,0,1]
    v_pk_fma_f32 v[76:77], v[56:57], v[50:51], v[76:77] op_sel_hi:[1,0,1]
    v_pk_fma_f32 v[78:79], v[58:59], v[50:51], v[78:79] op_sel_hi:[1,0,1]
    s_waitcnt vmcnt(9)
    v_lshlrev_b32 v52, 16, v36
    v_and_b32 v53, s40, v36
    v_lshlrev_b32 v54, 16, v37
    v_and_b32 v55, s40, v37
    v_lshlrev_b32 v56, 16, v38
    v_and_b32 v57, s40, v38
    v_lshlrev_b32 v58, 16, v39
    v_and_b32 v59, s40, v39
    v_pk_fma_f32 v[64:65], v[52:53], v[44:45], v[64:65] op_sel:[0,1,0] op_sel_hi:[1,1,1]
    v_pk_fma_f32 v[66:67], v[54:55], v[44:45], v[66:67] op_sel:[0,1,0] op_sel_hi:[1,1,1]
    v_pk_fma_f32 v[68:69], v[56:57], v[44:45], v[68:69] op_sel:[0,1,0] op_sel_hi:[1,1,1]
    v_pk_fma_f32 v[70:71], v[58:59], v[44:45], v[70:71] op_sel:[0,1,0] op_sel_hi:[1,1,1]
    v_pk_fma_f32 v[72:73], v[52:53], v[50:51], v[72:73] op_sel:[0,1,0] op_sel_hi:[1,1,1]
    v_pk_fma_f32 v[74:75], v[54:55], v[50:51], v[74:75] op_sel:[0,1,0] op_sel_hi:[1,1,1]
    v_pk_fma_f32 v[76:77], v[56:57], v[50:51], v[76:77] op_sel:[0,1,0] op_sel_hi:[1,1,1]
    v_pk_fma_f32 v[78:79], v[58:59], v[50:51], v[78:79] op_sel:[0,1,0] op_sel_hi:[1,1,1]
    s_branch P0_red
P0_B:
    s_cmp_lt_u32 s75, 216
    s_cbranch_scc1 P0_B1
    s_add_u32 s76, s84, 0x90000
    s_addc_u32 s77, s85, 0
    s_mov_b32 s78, 0x8080
    s_mov_b32 s79, 0x20000
    s_add_u32 s28, s84, 0xa0000
    s_addc_u32 s29, s85, 0
    s_mov_b32 s30, 0x36000
    s_mov_b32 s31, 0x20000
    s_add_u32 s32, s84, 0x100000
    s_addc_u32 s33, s85, 0
    s_mov_b32 s34, 0x4a4000
    s_mov_b32 s35, 0x20000
    v_mov_b32 v195, 147456
    v_mov_b32 v196, 0
    ds_write_b32 v195, v196
    ds_write_b32 v195, v196 offset:4
    ds_write_b32 v195, v196 offset:8
    ds_write_b32 v195, v196 offset:16
    ds_write_b32 v195, v196 offset:20
    ds_write_b32 v195, v196 offset:24
    ds_write_b32 v195, v196 offset:28
    s_waitcnt lgkmcnt(0)
    s_and_b32 s83, s83, 0xff
    s_mul_i32 s86, s7, 0x9e3779b1
    s_add_u32 s86, s86, 0x7f4a7c15
    s_mov_b32 s44, s50
    s_mov_b32 s45, s51
    s_mov_b32 s46, 0x24000
    s_mov_b32 s47, 0x20000
    s_sub_u32 s3, s83, 128
    s_lshl_b32 s3, s3, 4
    s_add_u32 s3, s3, s10
    s_mul_i32 s3, s3, 2304
    v_add_u32 v195, s3, v3
    v_add_u32 v196, s3, v7
    s_movk_i32 s3, 18432
    buffer_load_dwordx4 v[170:173], v195, s[44:47], 0 offen
    buffer_load_dwordx4 v[174:177], v195, s[44:47], 0 offen offset:1024
    buffer_load_dword v178, v196, s[44:47], 0 offen offset:2048
    buffer_load_dwordx4 v[182:185], v195, s[44:47], s3 offen
    buffer_load_dwordx4 v[186:189], v195, s[44:47], s3 offen offset:1024
    buffer_load_dword v190, v196, s[44:47], s3 offen offset:2048
    s_getpc_b64 s[4:5]
    s_add_u32 s4, s4, dep_tab@rel32@lo+4
    s_addc_u32 s5, s5, dep_tab@rel32@hi+12
    s_mul_i32 s3, s2, 384
    v_lshl_add_u32 v195, v2, 1, s3
    global_load_ushort v250, v195, s[4:5] offset:0
    global_load_ushort v251, v195, s[4:5] offset:128
    global_load_ushort v252, v195, s[4:5] offset:256
    s_branch P0_nog
P0_B1:
    buffer_load_dwordx3 v[8:10], v6, s[24:27], 0 offen
    buffer_load_dwordx3 v[12:14], v6, s[24:27], 0 offen offset:2304
    buffer_load_dwordx4 v[16:19], v4, s[20:23], 0 offen nt
    s_mov_b32 s3, 13824
    buffer_load_dwordx4 v[20:23], v4, s[20:23], s3 offen nt
    s_mov_b32 s3, 27648
    buffer_load_dwordx4 v[24:27], v4, s[20:23], s3 offen nt
    s_mov_b32 s3, 41472
    buffer_load_dwordx4 v[28:31], v4, s[20:23], s3 offen nt
    s_mov_b32 s3, 55296
    buffer_load_dwordx4 v[32:35], v4, s[20:23], s3 offen nt
    s_mov_b32 s3, 69120
    buffer_load_dwordx4 v[36:39], v4, s[20:23], s3 offen nt
    s_add_u32 s76, s84, 0x90000
    s_addc_u32 s77, s85, 0
    s_mov_b32 s78, 0x8080
    s_mov_b32 s79, 0x20000
    s_add_u32 s28, s84, 0xa0000
    s_addc_u32 s29, s85, 0
    s_mov_b32 s30, 0x36000
    s_mov_b32 s31, 0x20000
    s_add_u32 s32, s84, 0x100000
    s_addc_u32 s33, s85, 0
    s_mov_b32 s34, 0x4a4000
    s_mov_b32 s35, 0x20000
    v_mov_b32 v195, 147456
    v_mov_b32 v196, 0
    ds_write_b32 v195, v196
    ds_write_b32 v195, v196 offset:4
    ds_write_b32 v195, v196 offset:8
    ds_write_b32 v195, v196 offset:16
    ds_write_b32 v195, v196 offset:20
    ds_write_b32 v195, v196 offset:24
    ds_write_b32 v195, v196 offset:28
    s_waitcnt vmcnt(6)
    v_lshlrev_b32 v40, 16, v8
    v_and_b32 v41, s40, v8
    v_lshlrev_b32 v42, 16, v9
    v_and_b32 v43, s40, v9
    v_lshlrev_b32 v44, 16, v10
    v_and_b32 v45, s40, v10
    v_lshlrev_b32 v46, 16, v12
    v_and_b32 v47, s40, v12
    v_lshlrev_b32 v48, 16, v13
    v_and_b32 v49, s40, v13
    v_lshlrev_b32 v50, 16, v14
    v_and_b32 v51, s40, v14
    v_mul_f32 v52, s41, v40
    v_mul_f32 v53, s41, v41
    v_mul_f32 v54, s41, v42
    v_mul_f32 v55, s41, v43
    v_mul_f32 v56, s41, v44
    v_mul_f32 v57, s41, v45
    v_mul_f32 v58, s41, v46
    v_mul_f32 v59, s41, v47
    v_mul_f32 v60, s41, v48
    v_mul_f32 v61, s41, v49
    v_mul_f32 v62, s41, v50
    v_mul_f32 v63, s41, v51
    v_exp_f32 v52, v52
    v_exp_f32 v53, v53
    v_exp_f32 v54, v54
    v_exp_f32 v55, v55
    v_exp_f32 v56, v56
    v_exp_f32 v57, v57
    v_exp_f32 v58, v58
    v_exp_f32 v59, v59
    v_exp_f32 v60, v60
    v_exp_f32 v61, v61
    v_exp_f32 v62, v62
    v_exp_f32 v63, v63
    v_add_f32 v52, 1.0, v52
    v_add_f32 v53, 1.0, v53
    v_add_f32 v54, 1.0, v54
    v_add_f32 v55, 1.0, v55
    v_add_f32 v56, 1.0, v56
    v_add_f32 v57, 1.0, v57
    v_add_f32 v58, 1.0, v58
    v_add_f32 v59, 1.0, v59
    v_add_f32 v60, 1.0, v60
    v_add_f32 v61, 1.0, v61
    v_add_f32 v62, 1.0, v62
    v_add_f32 v63, 1.0, v63
    v_rcp_f32 v52, v52
    v_rcp_f32 v53, v53
    v_rcp_f32 v54, v54
    v_rcp_f32 v55, v55
    v_rcp_f32 v56, v56
    v_rcp_f32 v57, v57
    v_rcp_f32 v58, v58
    v_rcp_f32 v59, v59
    v_rcp_f32 v60, v60
    v_rcp_f32 v61, v61
    v_rcp_f32 v62, v62
    v_rcp_f32 v63, v63
    v_mul_f32 v40, v52, v40
    v_mul_f32 v41, v53, v41
    v_mul_f32 v42, v54, v42
    v_mul_f32 v43, v55, v43
    v_mul_f32 v44, v56, v44
    v_mul_f32 v45, v57, v45
    v_mul_f32 v46, v58, v46
    v_mul_f32 v47, v59, v47
    v_mul_f32 v48, v60, v48
    v_mul_f32 v49, v61, v49
    v_mul_f32 v50, v62, v50
    v_mul_f32 v51, v63, v51
    v_cvt_pk_bf16_f32 v52, v40, v41
    v_cvt_pk_bf16_f32 v53, v42, v43
    v_cvt_pk_bf16_f32 v54, v44, v45
    v_cvt_pk_bf16_f32 v55, v46, v47
    v_cvt_pk_bf16_f32 v56, v48, v49
    v_cvt_pk_bf16_f32 v57, v50, v51
    v_lshlrev_b32 v40, 16, v52
    v_and_b32 v41, s40, v52
    v_lshlrev_b32 v42, 16, v53
    v_and_b32 v43, s40, v53
    v_lshlrev_b32 v44, 16, v54
    v_and_b32 v45, s40, v54
    v_lshlrev_b32 v46, 16, v55
    v_and_b32 v47, s40, v55
    v_lshlrev_b32 v48, 16, v56
    v_and_b32 v49, s40, v56
    v_lshlrev_b32 v50, 16, v57
    v_and_b32 v51, s40, v57
    v_mov_b64 v[64:65], 0
    v_mov_b64 v[66:67], 0
    v_mov_b64 v[68:69], 0
    v_mov_b64 v[70:71], 0
    v_mov_b64 v[72:73], 0
    v_mov_b64 v[74:75], 0
    v_mov_b64 v[76:77], 0
    v_mov_b64 v[78:79], 0
    s_waitcnt vmcnt(5)
    v_lshlrev_b32 v52, 16, v16
    v_and_b32 v53, s40, v16
    v_lshlrev_b32 v54, 16, v17
    v_and_b32 v55, s40, v17
    v_lshlrev_b32 v56, 16, v18
    v_and_b32 v57, s40, v18
    v_lshlrev_b32 v58, 16, v19
    v_and_b32 v59, s40, v19
    v_pk_fma_f32 v[64:65], v[52:53], v[40:41], v[64:65] op_sel_hi:[1,0,1]
    v_pk_fma_f32 v[66:67], v[54:55], v[40:41], v[66:67] op_sel_hi:[1,0,1]
    v_pk_fma_f32 v[68:69], v[56:57], v[40:41], v[68:69] op_sel_hi:[1,0,1]
    v_pk_fma_f32 v[70:71], v[58:59], v[40:41], v[70:71] op_sel_hi:[1,0,1]
    v_pk_fma_f32 v[72:73], v[52:53], v[46:47], v[72:73] op_sel_hi:[1,0,1]
    v_pk_fma_f32 v[74:75], v[54:55], v[46:47], v[74:75] op_sel_hi:[1,0,1]
    v_pk_fma_f32 v[76:77], v[56:57], v[46:47], v[76:77] op_sel_hi:[1,0,1]
    v_pk_fma_f32 v[78:79], v[58:59], v[46:47], v[78:79] op_sel_hi:[1,0,1]
    s_waitcnt vmcnt(4)
    v_lshlrev_b32 v52, 16, v20
    v_and_b32 v53, s40, v20
    v_lshlrev_b32 v54, 16, v21
    v_and_b32 v55, s40, v21
    v_lshlrev_b32 v56, 16, v22
    v_and_b32 v57, s40, v22
    v_lshlrev_b32 v58, 16, v23
    v_and_b32 v59, s40, v23
    v_pk_fma_f32 v[64:65], v[52:53], v[40:41], v[64:65] op_sel:[0,1,0] op_sel_hi:[1,1,1]
    v_pk_fma_f32 v[66:67], v[54:55], v[40:41], v[66:67] op_sel:[0,1,0] op_sel_hi:[1,1,1]
    v_pk_fma_f32 v[68:69], v[56:57], v[40:41], v[68:69] op_sel:[0,1,0] op_sel_hi:[1,1,1]
    v_pk_fma_f32 v[70:71], v[58:59], v[40:41], v[70:71] op_sel:[0,1,0] op_sel_hi:[1,1,1]
    v_pk_fma_f32 v[72:73], v[52:53], v[46:47], v[72:73] op_sel:[0,1,0] op_sel_hi:[1,1,1]
    v_pk_fma_f32 v[74:75], v[54:55], v[46:47], v[74:75] op_sel:[0,1,0] op_sel_hi:[1,1,1]
    v_pk_fma_f32 v[76:77], v[56:57], v[46:47], v[76:77] op_sel:[0,1,0] op_sel_hi:[1,1,1]
    v_pk_fma_f32 v[78:79], v[58:59], v[46:47], v[78:79] op_sel:[0,1,0] op_sel_hi:[1,1,1]
    s_getpc_b64 s[4:5]
    s_add_u32 s4, s4, dep_tab@rel32@lo+4
    s_addc_u32 s5, s5, dep_tab@rel32@hi+12
    s_mul_i32 s3, s2, 384
    v_lshl_add_u32 v195, v2, 1, s3
    global_load_ushort v250, v195, s[4:5] offset:0
    global_load_ushort v251, v195, s[4:5] offset:128
    global_load_ushort v252, v195, s[4:5] offset:256
    s_waitcnt vmcnt(6)
    v_lshlrev_b32 v52, 16, v24
    v_and_b32 v53, s40, v24
    v_lshlrev_b32 v54, 16, v25
    v_and_b32 v55, s40, v25
    v_lshlrev_b32 v56, 16, v26
    v_and_b32 v57, s40, v26
    v_lshlrev_b32 v58, 16, v27
    v_and_b32 v59, s40, v27
    v_pk_fma_f32 v[64:65], v[52:53], v[42:43], v[64:65] op_sel_hi:[1,0,1]
    v_pk_fma_f32 v[66:67], v[54:55], v[42:43], v[66:67] op_sel_hi:[1,0,1]
    v_pk_fma_f32 v[68:69], v[56:57], v[42:43], v[68:69] op_sel_hi:[1,0,1]
    v_pk_fma_f32 v[70:71], v[58:59], v[42:43], v[70:71] op_sel_hi:[1,0,1]
    v_pk_fma_f32 v[72:73], v[52:53], v[48:49], v[72:73] op_sel_hi:[1,0,1]
    v_pk_fma_f32 v[74:75], v[54:55], v[48:49], v[74:75] op_sel_hi:[1,0,1]
    v_pk_fma_f32 v[76:77], v[56:57], v[48:49], v[76:77] op_sel_hi:[1,0,1]
    v_pk_fma_f32 v[78:79], v[58:59], v[48:49], v[78:79] op_sel_hi:[1,0,1]
    s_waitcnt vmcnt(5)
    v_lshlrev_b32 v52, 16, v28
    v_and_b32 v53, s40, v28
    v_lshlrev_b32 v54, 16, v29
    v_and_b32 v55, s40, v29
    v_lshlrev_b32 v56, 16, v30
    v_and_b32 v57, s40, v30
    v_lshlrev_b32 v58, 16, v31
    v_and_b32 v59, s40, v31
    v_pk_fma_f32 v[64:65], v[52:53], v[42:43], v[64:65] op_sel:[0,1,0] op_sel_hi:[1,1,1]
    v_pk_fma_f32 v[66:67], v[54:55], v[42:43], v[66:67] op_sel:[0,1,0] op_sel_hi:[1,1,1]
    v_pk_fma_f32 v[68:69], v[56:57], v[42:43], v[68:69] op_sel:[0,1,0] op_sel_hi:[1,1,1]
    v_pk_fma_f32 v[70:71], v[58:59], v[42:43], v[70:71] op_sel:[0,1,0] op_sel_hi:[1,1,1]
    v_pk_fma_f32 v[72:73], v[52:53], v[48:49], v[72:73] op_sel:[0,1,0] op_sel_hi:[1,1,1]
    v_pk_fma_f32 v[74:75], v[54:55], v[48:49], v[74:75] op_sel:[0,1,0] op_sel_hi:[1,1,1]
    v_pk_fma_f32 v[76:77], v[56:57], v[48:49], v[76:77] op_sel:[0,1,0] op_sel_hi:[1,1,1]
    v_pk_fma_f32 v[78:79], v[58:59], v[48:49], v[78:79] op_sel:[0,1,0] op_sel_hi:[1,1,1]
    s_waitcnt vmcnt(4)
    v_lshlrev_b32 v52, 16, v32
    v_and_b32 v53, s40, v32
    v_lshlrev_b32 v54, 16, v33
    v_and_b32 v55, s40, v33
    v_lshlrev_b32 v56, 16, v34
    v_and_b32 v57, s40, v34
    v_lshlrev_b32 v58, 16, v35
    v_and_b32 v59, s40, v35
    v_pk_fma_f32 v[64:65], v[52:53], v[44:45], v[64:65] op_sel_hi:[1,0,1]
    v_pk_fma_f32 v[66:67], v[54:55], v[44:45], v[66:67] op_sel_hi:[1,0,1]
    v_pk_fma_f32 v[68:69], v[56:57], v[44:45], v[68:69] op_sel_hi:[1,0,1]
    v_pk_fma_f32 v[70:71], v[58:59], v[44:45], v[70:71] op_sel_hi:[1,0,1]
    v_pk_fma_f32 v[72:73], v[52:53], v[50:51], v[72:73] op_sel_hi:[1,0,1]
    v_pk_fma_f32 v[74:75], v[54:55], v[50:51], v[74:75] op_sel_hi:[1,0,1]
    v_pk_fma_f32 v[76:77], v[56:57], v[50:51], v[76:77] op_sel_hi:[1,0,1]
    v_pk_fma_f32 v[78:79], v[58:59], v[50:51], v[78:79] op_sel_hi:[1,0,1]
    s_waitcnt vmcnt(3)
    v_lshlrev_b32 v52, 16, v36
    v_and_b32 v53, s40, v36
    v_lshlrev_b32 v54, 16, v37
    v_and_b32 v55, s40, v37
    v_lshlrev_b32 v56, 16, v38
    v_and_b32 v57, s40, v38
    v_lshlrev_b32 v58, 16, v39
    v_and_b32 v59, s40, v39
    v_pk_fma_f32 v[64:65], v[52:53], v[44:45], v[64:65] op_sel:[0,1,0] op_sel_hi:[1,1,1]
    v_pk_fma_f32 v[66:67], v[54:55], v[44:45], v[66:67] op_sel:[0,1,0] op_sel_hi:[1,1,1]
    v_pk_fma_f32 v[68:69], v[56:57], v[44:45], v[68:69] op_sel:[0,1,0] op_sel_hi:[1,1,1]
    v_pk_fma_f32 v[70:71], v[58:59], v[44:45], v[70:71] op_sel:[0,1,0] op_sel_hi:[1,1,1]
    v_pk_fma_f32 v[72:73], v[52:53], v[50:51], v[72:73] op_sel:[0,1,0] op_sel_hi:[1,1,1]
    v_pk_fma_f32 v[74:75], v[54:55], v[50:51], v[74:75] op_sel:[0,1,0] op_sel_hi:[1,1,1]
    v_pk_fma_f32 v[76:77], v[56:57], v[50:51], v[76:77] op_sel:[0,1,0] op_sel_hi:[1,1,1]
    v_pk_fma_f32 v[78:79], v[58:59], v[50:51], v[78:79] op_sel:[0,1,0] op_sel_hi:[1,1,1]
P0_red:
    v_permlane32_swap_b32 v64, v72
    v_permlane32_swap_b32 v65, v73
    v_permlane32_swap_b32 v66, v74
    v_permlane32_swap_b32 v67, v75
    v_permlane32_swap_b32 v68, v76
    v_permlane32_swap_b32 v69, v77
    v_permlane32_swap_b32 v70, v78
    v_permlane32_swap_b32 v71, v79
    v_add_f32 v64, v64, v72
    v_add_f32 v65, v65, v73
    v_add_f32 v66, v66, v74
    v_add_f32 v67, v67, v75
    v_add_f32 v68, v68, v76
    v_add_f32 v69, v69, v77
    v_add_f32 v70, v70, v78
    v_add_f32 v71, v71, v79
    v_permlane16_swap_b32 v64, v68
    v_permlane16_swap_b32 v65, v69
    v_permlane16_swap_b32 v66, v70
    v_permlane16_swap_b32 v67, v71
    v_add_f32 v64, v64, v68
    v_add_f32 v65, v65, v69
    v_add_f32 v66, v66, v70
    v_add_f32 v67, v67, v71
    v_add_f32_dpp v68, v64, v64 row_ror:8 row_mask:0xf bank_mask:0xf
    v_add_f32_dpp v69, v65, v65 row_ror:8 row_mask:0xf bank_mask:0xf
    v_add_f32_dpp v70, v66, v66 row_ror:8 row_mask:0xf bank_mask:0xf
    v_add_f32_dpp v71, v67, v67 row_ror:8 row_mask:0xf bank_mask:0xf
    s_lshl_b32 s3, s10, 9
    s_add_u32 s3, s3, 98304
    v_and_b32 v1, 32, v2
    v_lshlrev_b32 v1, 3, v1
    v_lshl_add_u32 v1, v5, 1, v1
    v_and_b32 v4, 16, v2
    v_add3_u32 v1, v1, v4, s3
    ds_write_b128 v1, v[68:71]
    s_cmp_ge_u32 s75, 3
    s_cbranch_scc1 P0_nosc
    s_add_u32 s44, s84, 0x28000
    s_addc_u32 s45, s85, 0
    s_mov_b32 s46, 0x2400
    s_mov_b32 s47, 0x20000
    v_lshlrev_b32 v6, 1, v6
    s_movk_i32 s3, 4608
    buffer_store_dwordx4 v[40:43], v6, s[44:47], 0 offen sc1
    buffer_store_dwordx2 v[44:45], v6, s[44:47], 0 offen offset:16 sc1
    buffer_store_dwordx2 v[46:47], v6, s[44:47], s3 offen sc1
    buffer_store_dwordx4 v[48:51], v6, s[44:47], s3 offen offset:8 sc1
P0_nosc:
    s_waitcnt lgkmcnt(0)
    s_and_b32 s83, s83, 0xff
    s_mul_i32 s86, s7, 0x9e3779b1
    s_add_u32 s86, s86, 0x7f4a7c15
    s_barrier
    s_cmp_lg_u32 s10, 6
    s_cbranch_scc1 P0_stats
    v_lshlrev_b32 v1, 3, v2
    v_add_u32 v4, 98304, v1
    ds_read_b64 v[8:9], v4 offset:0
    ds_read_b64 v[10:11], v4 offset:512
    ds_read_b64 v[12:13], v4 offset:1024
    ds_read_b64 v[14:15], v4 offset:1536
    ds_read_b64 v[16:17], v4 offset:2048
    ds_read_b64 v[18:19], v4 offset:2560
    ds_read_b64 v[20:21], v4 offset:3072
    ds_read_b64 v[22:23], v4 offset:3584
    s_lshl_b32 s16, s12, 1
    s_add_u32 s16, s16, s14
    s_mul_i32 s16, s16, 36864
    s_lshl_b32 s17, s13, 9
    s_add_u32 s16, s16, s17
    v_lshrrev_b32 v4, 5, v2
    v_mul_u32_u24 v4, 17920, v4
    v_add_u32 v4, v4, v3
    v_mov_b32 v25, s86
    v_mov_b32 v27, s86
    s_waitcnt lgkmcnt(0)
    v_pk_add_f32 v[8:9], v[8:9], v[16:17]
    v_pk_add_f32 v[10:11], v[10:11], v[18:19]
    v_pk_add_f32 v[12:13], v[12:13], v[20:21]
    v_pk_add_f32 v[14:15], v[14:15], v[22:23]
    v_pk_add_f32 v[8:9], v[8:9], v[12:13]
    v_pk_add_f32 v[10:11], v[10:11], v[14:15]
    v_add_f32 v24, v8, v10
    v_add_f32 v26, v9, v11
    buffer_store_dwordx4 v[24:27], v4, s[28:31], s16 offen sc1
    s_branch P0_stats
P0_nog:
    s_barrier
P0_stats:
    s_cmp_ge_u32 s10, 4
    s_cbranch_scc1 P0_nopo
    s_and_b32 s3, s82, 15
    s_lshr_b32 s16, s82, 16
    v_mov_b32 v8, -1
    v_mov_b32 v9, -1
    v_mov_b32 v10, -1
    v_mov_b32 v11, -1
    s_cmp_eq_u32 s3, 2
    s_cbranch_scc1 P0_po2
    s_cmp_lg_u32 s3, 1
    s_cbranch_scc1 P0_nopo
    s_bfe_u32 s17, s82, 0x40004
    s_lshl_b32 s17, s17, 1
    s_and_b32 s3, s10, 1
    s_add_u32 s17, s17, s3
    s_mul_i32 s17, s17, 37888
    s_lshl_b32 s18, s16, 1
    s_lshr_b32 s3, s10, 1
    s_add_u32 s18, s18, s3
    s_lshl_b32 s18, s18, 10
    s_add_u32 s18, s18, s17
    s_add_u32 s17, s17, 36864
    s_cmp_eq_u32 s16, 0
    s_cselect_b32 s17, s17, s18
    s_add_u32 s44, s84, 0xd8000
    s_addc_u32 s45, s85, 0
    s_mov_b32 s46, 0x25000
    s_mov_b32 s47, 0x20000
    buffer_store_dwordx4 v[8:11], v3, s[44:47], s18 offen sc1
    buffer_store_dwordx4 v[8:11], v3, s[44:47], s17 offen sc1
    s_branch P0_nopo
P0_po2:
    s_mul_i32 s17, s16, 1536
    s_mul_i32 s3, s10, 36864
    s_add_u32 s17, s17, s3
    s_add_u32 s44, s84, 0x6c000
    s_addc_u32 s45, s85, 0
    s_mov_b32 s46, 0x24000
    s_mov_b32 s47, 0x20000
    buffer_store_dwordx4 v[8:11], v3, s[44:47], s17 offen sc1
    v_lshlrev_b32 v12, 3, v2
    buffer_store_dwordx2 v[8:9], v12, s[44:47], s17 offen offset:1024 sc1
P0_nopo:
    s_cmp_lt_u32 s2, 128
    s_cbranch_scc1 P0_nw
    s_mov_b32 s44, s54
    s_mov_b32 s45, s55
    s_mov_b32 s46, 0x798000
    s_mov_b32 s47, 0x20000
    s_lshl_b32 s3, s10, 7
    s_add_u32 s3, s3, s74
    s_mul_i32 s3, s3, 6912
    s_add_u32 s3, s3, 0
    v_mul_u32_u24 v197, 1821, v2
    v_lshrrev_b32 v197, 16, v197
    v_min_u32 v197, 0, v197
    v_mul_u32_u24 v198, 36, v197
    v_sub_u32 v198, v2, v198
    v_min_u32 v198, 35, v198
    v_mul_u32_u24 v197, 6912, v197
    v_lshl_add_u32 v198, v198, 7, v197
    v_add_u32 v198, s3, v198
    buffer_load_dword v199, v198, s[44:47], 0 offen
    v_add_u32 v198, 7077888, v198
    buffer_load_dword v199, v198, s[44:47], 0 offen
    s_mov_b32 s44, s54
    s_mov_b32 s45, s55
    s_mov_b32 s46, 0x798000
    s_mov_b32 s47, 0x20000
    s_lshl_b32 s3, s10, 7
    s_add_u32 s3, s3, s74
    s_mul_i32 s3, s3, 20736
    s_add_u32 s3, s3, 4608
    v_mul_u32_u24 v197, 3641, v2
    v_lshrrev_b32 v197, 16, v197
    v_min_u32 v197, 2, v197
    v_mul_u32_u24 v198, 18, v197
    v_sub_u32 v198, v2, v198
    v_min_u32 v198, 17, v198
    v_mul_u32_u24 v197, 6912, v197
    v_lshl_add_u32 v198, v198, 7, v197
    v_add_u32 v198, s3, v198
    buffer_load_dword v199, v198, s[44:47], 0 offen
    s_mov_b32 s44, s58
    s_mov_b32 s45, s59
    s_mov_b32 s46, 0x288000
    s_mov_b32 s47, 0x20000
    s_sub_u32 s3, s10, 3
    s_and_b32 s3, s3, 7
    s_lshl_b32 s3, s3, 7
    s_add_u32 s3, s3, s74
    s_lshl_b32 s3, s3, 13
    v_lshlrev_b32 v197, 7, v2
    v_add_u32 v198, s3, v197
    buffer_load_dword v199, v198, s[44:47], 0 offen
    s_mov_b32 s44, s54
    s_mov_b32 s45, s55
    s_mov_b32 s46, 0x798000
    s_mov_b32 s47, 0x20000
    s_lshl_b32 s3, s10, 7
    s_add_u32 s3, s3, s74
    s_lshl_b32 s3, s3, 13
    v_lshlrev_b32 v197, 7, v2
    v_add_u32 v198, s3, v197
    s_bfe_u32 s3, s80, 0x80008
    s_cmp_lg_u32 s3, 8
    s_cbranch_scc1 P0W_1
    s_mov_b32 s44, s56
    s_mov_b32 s45, s57
    s_mov_b32 s46, 0x798000
    s_mov_b32 s47, 0x20000
    v_lshrrev_b32 v197, 1, v0
    v_mul_u32_u24 v197, 6912, v197
    v_and_b32 v198, 1, v0
    v_lshl_add_u32 v197, v198, 7, v197
    s_and_b32 s3, s80, 0xff
    s_lshl_b32 s3, s3, 8
    buffer_load_dword v199, v197, s[44:47], s3 offen
    s_add_u32 s3, s3, 1769472
P0W_1:
P0_nw:
    s_mov_b32 s100, 0
    s_bfe_u32 s3, s80, 0x80010
    s_cbranch_scc1 FS_2
    s_sub_u32 s11, s10, 4
    s_and_b32 s16, s80, 0xff
    s_bfe_u32 s17, s80, 0x80008
    s_mov_b32 s71, 0x20000
    s_mov_b32 s75, 0x20000
    s_add_u32 s72, s84, 1048576
    s_addc_u32 s73, s85, 0
    s_mov_b32 s74, 4866048
    s_movk_i32 s7, 2304
    s_lshl_b32 s18, s17, 8
    s_lshl_b32 s19, s16, 8
    s_mov_b32 s14, 6
    s_add_u32 s4, s84, 31452672
    s_addc_u32 s5, s85, 0
    s_mov_b32 s70, 7962624
    s_movk_i32 s13, 6912
    s_cmp_ge_u32 s16, 18
    s_cselect_b32 s68, s4, s54
    s_cselect_b32 s69, s5, s55
    s_cselect_b32 s70, 2658816, s70
    s_cselect_b32 s13, 2304, s13
    s_cmp_eq_u32 s17, 8
    s_cselect_b32 s68, s56, s68
    s_cselect_b32 s69, s57, s69
    s_cselect_b32 s70, 7962624, s70
    s_cselect_b32 s13, 6912, s13
    s_cselect_b32 s14, 4, s14
    s_lshl_b32 s12, s11, s14
    s_add_u32 s18, s18, s12
    v_lshrrev_b32 v212, 3, v2
    v_add_u32 v213, s18, v212
    v_mul_lo_u32 v213, v213, s7
    v_lshrrev_b32 v212, 4, v2
    v_and_b32 v214, 7, v2
    v_xor_b32 v214, v214, v212
    v_lshl_add_u32 v200, v214, 4, v213
    v_xor_b32 v214, 4, v214
    v_lshl_add_u32 v201, v214, 4, v213
    s_lshl_b32 s3, s7, 3
    s_sub_u32 s3, s3, 1024
    v_add_u32 v201, s3, v201
    s_lshl_b32 s3, s3, 1
    v_add_u32 v202, s3, v200
    v_add_u32 v203, s3, v201
    s_lshl_b32 s3, s7, 5
    v_add_u32 v204, s3, v200
    v_add_u32 v205, s3, v201
    v_add_u32 v206, s3, v202
    v_add_u32 v207, s3, v203
    s_lshl_b32 s3, s11, 4
    v_add_u32 v213, s3, v212
    v_mul_lo_u32 v213, v213, s13
    v_add_u32 v213, s19, v213
    v_and_b32 v214, 1, v2
    v_lshl_add_u32 v213, v214, 4, v213
    v_bfe_u32 v214, v2, 1, 3
    v_xor_b32 v214, v214, v212
    v_lshl_add_u32 v208, v214, 5, v213
    s_lshl_b32 s3, s13, 2
    s_sub_u32 s3, s3, 1024
    v_add_u32 v209, s3, v208
    v_xor_b32 v214, 4, v214
    v_lshl_add_u32 v210, v214, 5, v213
    v_add_u32 v210, s3, v210
    v_add_u32 v210, s3, v210
    v_add_u32 v211, s3, v210
    s_lshl_b32 s101, s13, 6
    s_mov_b32 s62, 0
    s_mov_b32 s63, 0
    s_lshl_b32 s64, s12, 7
    s_lshl_b32 s65, s11, 12
    s_add_u32 s65, s65, 32768
    s_add_u32 s66, s64, 147456
    s_add_u32 s67, s65, 147456
    s_branch FSE_3
FS_2:
    s_sub_u32 s11, s10, 4
    s_and_b32 s16, s80, 0xff
    s_bfe_u32 s17, s80, 0x80008
    s_mov_b32 s71, 0x20000
    s_mov_b32 s75, 0x20000
    s_bfe_u32 s3, s80, 0x80010
    s_sub_u32 s3, s3, 1
    s_mul_i32 s18, s3, 7282
    s_lshr_b32 s18, s18, 16
    s_mul_i32 s19, s18, 9
    s_sub_u32 s19, s3, s19
    s_lshl_b32 s18, s18, 7
    s_lshl_b32 s19, s19, 8
    s_add_u32 s72, s54, 4608
    s_addc_u32 s73, s55, 0
    s_mov_b32 s74, 7958016
    s_movk_i32 s7, 6912
    s_mov_b32 s68, s58
    s_mov_b32 s69, s59
    s_mov_b32 s70, 2654208
    s_movk_i32 s13, 2304
    s_mov_b32 s14, 5
    s_lshl_b32 s12, s11, s14
    s_add_u32 s18, s18, s12
    v_lshrrev_b32 v212, 3, v2
    v_add_u32 v213, s18, v212
    v_mul_lo_u32 v213, v213, s7
    v_lshrrev_b32 v212, 4, v2
    v_and_b32 v214, 7, v2
    v_xor_b32 v214, v214, v212
    v_lshl_add_u32 v200, v214, 4, v213
    v_xor_b32 v214, 4, v214
    v_lshl_add_u32 v201, v214, 4, v213
    s_lshl_b32 s3, s7, 3
    s_sub_u32 s3, s3, 1024
    v_add_u32 v201, s3, v201
    s_lshl_b32 s3, s3, 1
    v_add_u32 v202, s3, v200
    v_add_u32 v203, s3, v201
    s_lshl_b32 s3, s7, 5
    v_add_u32 v204, s3, v200
    v_add_u32 v205, s3, v201
    v_add_u32 v206, s3, v202
    v_add_u32 v207, s3, v203
    s_lshl_b32 s3, s11, 4
    v_add_u32 v213, s3, v212
    v_mul_lo_u32 v213, v213, s13
    v_add_u32 v213, s19, v213
    v_and_b32 v214, 1, v2
    v_lshl_add_u32 v213, v214, 4, v213
    v_bfe_u32 v214, v2, 1, 3
    v_xor_b32 v214, v214, v212
    v_lshl_add_u32 v208, v214, 5, v213
    s_lshl_b32 s3, s13, 2
    s_sub_u32 s3, s3, 1024
    v_add_u32 v209, s3, v208
    v_xor_b32 v214, 4, v214
    v_lshl_add_u32 v210, v214, 5, v213
    v_add_u32 v210, s3, v210
    v_add_u32 v210, s3, v210
    v_add_u32 v211, s3, v210
    s_lshl_b32 s101, s13, 6
    s_mov_b32 s62, 0
    s_mov_b32 s63, 0
    s_lshl_b32 s64, s12, 7
    s_lshl_b32 s65, s11, 12
    s_add_u32 s65, s65, 32768
    s_add_u32 s66, s64, 147456
    s_add_u32 s67, s65, 147456
FSE_3:
    s_cmp_eq_u32 s83, 0xff
    s_cbranch_scc1 P1_end
    s_waitcnt vmcnt(3)
    v_lshlrev_b32 v40, 16, v170
    v_lshlrev_b32 v80, 16, v182
    v_and_b32 v41, s40, v170
    v_and_b32 v81, s40, v182
    v_lshlrev_b32 v42, 16, v171
    v_lshlrev_b32 v82, 16, v183
    v_and_b32 v43, s40, v171
    v_and_b32 v83, s40, v183
    v_lshlrev_b32 v44, 16, v172
    v_lshlrev_b32 v84, 16, v184
    v_and_b32 v45, s40, v172
    v_and_b32 v85, s40, v184
    v_lshlrev_b32 v46, 16, v173
    v_lshlrev_b32 v86, 16, v185
    v_and_b32 v47, s40, v173
    v_and_b32 v87, s40, v185
    v_lshlrev_b32 v48, 16, v174
    v_lshlrev_b32 v88, 16, v186
    v_and_b32 v49, s40, v174
    v_and_b32 v89, s40, v186
    v_lshlrev_b32 v50, 16, v175
    v_lshlrev_b32 v90, 16, v187
    v_and_b32 v51, s40, v175
    v_and_b32 v91, s40, v187
    v_lshlrev_b32 v52, 16, v176
    v_lshlrev_b32 v92, 16, v188
    v_and_b32 v53, s40, v176
    v_and_b32 v93, s40, v188
    v_lshlrev_b32 v54, 16, v177
    v_lshlrev_b32 v94, 16, v189
    v_and_b32 v55, s40, v177
    v_and_b32 v95, s40, v189
    v_lshlrev_b32 v56, 16, v178
    v_lshlrev_b32 v96, 16, v190
    v_and_b32 v57, s40, v178
    v_and_b32 v97, s40, v190
    v_pk_add_f32 v[130:131], v[40:41], v[48:49]
    v_pk_add_f32 v[150:151], v[80:81], v[88:89]
    v_pk_add_f32 v[132:133], v[42:43], v[50:51]
    v_pk_add_f32 v[152:153], v[82:83], v[90:91]
    v_pk_add_f32 v[134:135], v[44:45], v[52:53]
    v_pk_add_f32 v[154:155], v[84:85], v[92:93]
    v_pk_add_f32 v[136:137], v[46:47], v[54:55]
    v_pk_add_f32 v[156:157], v[86:87], v[94:95]
    v_pk_add_f32 v[130:131], v[130:131], v[56:57]
    v_pk_add_f32 v[150:151], v[150:151], v[96:97]
    v_pk_add_f32 v[132:133], v[132:133], v[134:135]
    v_pk_add_f32 v[152:153], v[152:153], v[154:155]
    v_pk_add_f32 v[130:131], v[130:131], v[136:137]
    v_pk_add_f32 v[150:151], v[150:151], v[156:157]
    v_pk_add_f32 v[130:131], v[130:131], v[132:133]
    v_pk_add_f32 v[150:151], v[150:151], v[152:153]
    v_add_f32 v4, v130, v131
    v_add_f32 v10, v150, v151
    s_nop 0
    v_add_f32_dpp v5, v4, v4 quad_perm:[1,0,3,2] row_mask:0xf bank_mask:0xf
    v_add_f32_dpp v11, v10, v10 quad_perm:[1,0,3,2] row_mask:0xf bank_mask:0xf
    s_nop 0
    v_add_f32_dpp v4, v5, v5 quad_perm:[2,3,0,1] row_mask:0xf bank_mask:0xf
    v_add_f32_dpp v10, v11, v11 quad_perm:[2,3,0,1] row_mask:0xf bank_mask:0xf
    s_nop 0
    v_add_f32_dpp v5, v4, v4 row_half_mirror row_mask:0xf bank_mask:0xf
    v_add_f32_dpp v11, v10, v10 row_half_mirror row_mask:0xf bank_mask:0xf
    s_nop 0
    v_add_f32_dpp v4, v5, v5 row_mirror row_mask:0xf bank_mask:0xf
    v_add_f32_dpp v10, v11, v11 row_mirror row_mask:0xf bank_mask:0xf
    v_mov_b32 v5, v4
    v_mov_b32 v11, v10
    s_nop 0
    v_permlane16_swap_b32 v4, v5
    v_permlane16_swap_b32 v10, v11
    v_add_f32 v4, v4, v5
    v_add_f32 v10, v10, v11
    v_mov_b32 v5, v4
    v_mov_b32 v11, v10
    s_nop 0
    v_permlane32_swap_b32 v4, v5
    v_permlane32_swap_b32 v10, v11
    v_add_f32 v4, v4, v5
    v_add_f32 v10, v10, v11
    v_mul_f32 v4, 0xba638e39, v4
    v_mul_f32 v10, 0xba638e39, v10
    v_pk_add_f32 v[130:131], v[40:41], v[4:5] op_sel_hi:[1,0]
    v_pk_add_f32 v[150:151], v[80:81], v[10:11] op_sel_hi:[1,0]
    v_pk_add_f32 v[132:133], v[42:43], v[4:5] op_sel_hi:[1,0]
    v_pk_add_f32 v[152:153], v[82:83], v[10:11] op_sel_hi:[1,0]
    v_pk_add_f32 v[134:135], v[44:45], v[4:5] op_sel_hi:[1,0]
    v_pk_add_f32 v[154:155], v[84:85], v[10:11] op_sel_hi:[1,0]
    v_pk_add_f32 v[136:137], v[46:47], v[4:5] op_sel_hi:[1,0]
    v_pk_add_f32 v[156:157], v[86:87], v[10:11] op_sel_hi:[1,0]
    v_pk_add_f32 v[138:139], v[48:49], v[4:5] op_sel_hi:[1,0]
    v_pk_add_f32 v[158:159], v[88:89], v[10:11] op_sel_hi:[1,0]
    v_pk_add_f32 v[140:141], v[50:51], v[4:5] op_sel_hi:[1,0]
    v_pk_add_f32 v[160:161], v[90:91], v[10:11] op_sel_hi:[1,0]
    v_pk_add_f32 v[142:143], v[52:53], v[4:5] op_sel_hi:[1,0]
    v_pk_add_f32 v[162:163], v[92:93], v[10:11] op_sel_hi:[1,0]
    v_pk_add_f32 v[144:145], v[54:55], v[4:5] op_sel_hi:[1,0]
    v_pk_add_f32 v[164:165], v[94:95], v[10:11] op_sel_hi:[1,0]
    v_pk_add_f32 v[146:147], v[56:57], v[4:5] op_sel_hi:[1,0]
    v_pk_add_f32 v[166:167], v[96:97], v[10:11] op_sel_hi:[1,0]
    v_pk_mul_f32 v[6:7], v[130:131], v[130:131]
    v_pk_mul_f32 v[12:13], v[150:151], v[150:151]
    v_pk_mul_f32 v[8:9], v[132:133], v[132:133]
    v_pk_mul_f32 v[14:15], v[152:153], v[152:153]
    v_pk_fma_f32 v[6:7], v[134:135], v[134:135], v[6:7]
    v_pk_fma_f32 v[12:13], v[154:155], v[154:155], v[12:13]
    v_pk_fma_f32 v[8:9], v[136:137], v[136:137], v[8:9]
    v_pk_fma_f32 v[14:15], v[156:157], v[156:157], v[14:15]
    v_pk_fma_f32 v[6:7], v[138:139], v[138:139], v[6:7]
    v_pk_fma_f32 v[12:13], v[158:159], v[158:159], v[12:13]
    v_pk_fma_f32 v[8:9], v[140:141], v[140:141], v[8:9]
    v_pk_fma_f32 v[14:15], v[160:161], v[160:161], v[14:15]
    v_pk_fma_f32 v[6:7], v[142:143], v[142:143], v[6:7]
    v_pk_fma_f32 v[12:13], v[162:163], v[162:163], v[12:13]
    v_pk_fma_f32 v[8:9], v[144:145], v[144:145], v[8:9]
    v_pk_fma_f32 v[14:15], v[164:165], v[164:165], v[14:15]
    v_pk_fma_f32 v[6:7], v[146:147], v[146:147], v[6:7]
    v_pk_fma_f32 v[12:13], v[166:167], v[166:167], v[12:13]
    v_pk_add_f32 v[6:7], v[6:7], v[8:9]
    v_pk_add_f32 v[12:13], v[12:13], v[14:15]
    v_add_f32 v6, v6, v7
    v_add_f32 v12, v12, v13
    s_nop 0
    v_add_f32_dpp v7, v6, v6 quad_perm:[1,0,3,2] row_mask:0xf bank_mask:0xf
    v_add_f32_dpp v13, v12, v12 quad_perm:[1,0,3,2] row_mask:0xf bank_mask:0xf
    s_nop 0
    v_add_f32_dpp v6, v7, v7 quad_perm:[2,3,0,1] row_mask:0xf bank_mask:0xf
    v_add_f32_dpp v12, v13, v13 quad_perm:[2,3,0,1] row_mask:0xf bank_mask:0xf
    s_nop 0
    v_add_f32_dpp v7, v6, v6 row_half_mirror row_mask:0xf bank_mask:0xf
    v_add_f32_dpp v13, v12, v12 row_half_mirror row_mask:0xf bank_mask:0xf
    s_nop 0
    v_add_f32_dpp v6, v7, v7 row_mirror row_mask:0xf bank_mask:0xf
    v_add_f32_dpp v12, v13, v13 row_mirror row_mask:0xf bank_mask:0xf
    v_mov_b32 v7, v6
    v_mov_b32 v13, v12
    s_nop 0
    v_permlane16_swap_b32 v6, v7
    v_permlane16_swap_b32 v12, v13
    v_add_f32 v6, v6, v7
    v_add_f32 v12, v12, v13
    v_mov_b32 v7, v6
    v_mov_b32 v13, v12
    s_nop 0
    v_permlane32_swap_b32 v6, v7
    v_permlane32_swap_b32 v12, v13
    v_add_f32 v6, v6, v7
    v_add_f32 v12, v12, v13
    v_mul_f32 v5, 0x3a638e39, v6
    v_mul_f32 v11, 0x3a638e39, v12
    v_cvt_pk_bf16_f32 v6, v4, v5
    v_cvt_pk_bf16_f32 v12, v10, v11
    v_lshlrev_b32 v4, 16, v6
    v_lshlrev_b32 v10, 16, v12
    v_and_b32 v5, s40, v6
    v_and_b32 v11, s40, v12
    v_add_f32 v6, 0x3727c5ac, v5
    v_add_f32 v12, 0x3727c5ac, v11
    v_cvt_pk_bf16_f32 v6, v6, v6
    v_cvt_pk_bf16_f32 v12, v12, v12
    v_lshlrev_b32 v6, 16, v6
    v_lshlrev_b32 v12, 16, v12
    v_sqrt_f32 v6, v6
    v_sqrt_f32 v12, v12
    v_pk_add_f32 v[40:41], v[40:41], v[4:5] op_sel_hi:[1,0]
    v_pk_add_f32 v[80:81], v[80:81], v[10:11] op_sel_hi:[1,0]
    v_pk_add_f32 v[42:43], v[42:43], v[4:5] op_sel_hi:[1,0]
    v_pk_add_f32 v[82:83], v[82:83], v[10:11] op_sel_hi:[1,0]
    v_pk_add_f32 v[44:45], v[44:45], v[4:5] op_sel_hi:[1,0]
    v_pk_add_f32 v[84:85], v[84:85], v[10:11] op_sel_hi:[1,0]
    v_pk_add_f32 v[46:47], v[46:47], v[4:5] op_sel_hi:[1,0]
    v_pk_add_f32 v[86:87], v[86:87], v[10:11] op_sel_hi:[1,0]
    v_pk_add_f32 v[48:49], v[48:49], v[4:5] op_sel_hi:[1,0]
    v_pk_add_f32 v[88:89], v[88:89], v[10:11] op_sel_hi:[1,0]
    v_pk_add_f32 v[50:51], v[50:51], v[4:5] op_sel_hi:[1,0]
    v_pk_add_f32 v[90:91], v[90:91], v[10:11] op_sel_hi:[1,0]
    v_pk_add_f32 v[52:53], v[52:53], v[4:5] op_sel_hi:[1,0]
    v_pk_add_f32 v[92:93], v[92:93], v[10:11] op_sel_hi:[1,0]
    v_pk_add_f32 v[54:55], v[54:55], v[4:5] op_sel_hi:[1,0]
    v_pk_add_f32 v[94:95], v[94:95], v[10:11] op_sel_hi:[1,0]
    v_pk_add_f32 v[56:57], v[56:57], v[4:5] op_sel_hi:[1,0]
    v_pk_add_f32 v[96:97], v[96:97], v[10:11] op_sel_hi:[1,0]
    v_cvt_pk_bf16_f32 v6, v6, v6
    v_cvt_pk_bf16_f32 v12, v12, v12
    v_lshlrev_b32 v6, 16, v6
    v_lshlrev_b32 v12, 16, v12
    v_rcp_f32 v6, v6
    v_rcp_f32 v12, v12
    v_cvt_pk_bf16_f32 v130, v40, v41
    v_cvt_pk_bf16_f32 v150, v80, v81
    v_cvt_pk_bf16_f32 v131, v42, v43
    v_cvt_pk_bf16_f32 v151, v82, v83
    v_cvt_pk_bf16_f32 v132, v44, v45
    v_cvt_pk_bf16_f32 v152, v84, v85
    v_cvt_pk_bf16_f32 v133, v46, v47
    v_cvt_pk_bf16_f32 v153, v86, v87
    v_cvt_pk_bf16_f32 v134, v48, v49
    v_cvt_pk_bf16_f32 v154, v88, v89
    v_cvt_pk_bf16_f32 v135, v50, v51
    v_cvt_pk_bf16_f32 v155, v90, v91
    v_cvt_pk_bf16_f32 v136, v52, v53
    v_cvt_pk_bf16_f32 v156, v92, v93
    v_cvt_pk_bf16_f32 v137, v54, v55
    v_cvt_pk_bf16_f32 v157, v94, v95
    v_cvt_pk_bf16_f32 v138, v56, v57
    v_cvt_pk_bf16_f32 v158, v96, v97
    v_lshlrev_b32 v40, 16, v130
    v_lshlrev_b32 v80, 16, v150
    v_and_b32 v41, s40, v130
    v_and_b32 v81, s40, v150
    v_lshlrev_b32 v42, 16, v131
    v_lshlrev_b32 v82, 16, v151
    v_and_b32 v43, s40, v131
    v_and_b32 v83, s40, v151
    v_lshlrev_b32 v44, 16, v132
    v_lshlrev_b32 v84, 16, v152
    v_and_b32 v45, s40, v132
    v_and_b32 v85, s40, v152
    v_lshlrev_b32 v46, 16, v133
    v_lshlrev_b32 v86, 16, v153
    v_and_b32 v47, s40, v133
    v_and_b32 v87, s40, v153
    v_lshlrev_b32 v48, 16, v134
    v_lshlrev_b32 v88, 16, v154
    v_and_b32 v49, s40, v134
    v_and_b32 v89, s40, v154
    v_lshlrev_b32 v50, 16, v135
    v_lshlrev_b32 v90, 16, v155
    v_and_b32 v51, s40, v135
    v_and_b32 v91, s40, v155
    v_lshlrev_b32 v52, 16, v136
    v_lshlrev_b32 v92, 16, v156
    v_and_b32 v53, s40, v136
    v_and_b32 v93, s40, v156
    v_lshlrev_b32 v54, 16, v137
    v_lshlrev_b32 v94, 16, v157
    v_and_b32 v55, s40, v137
    v_and_b32 v95, s40, v157
    v_lshlrev_b32 v56, 16, v138
    v_lshlrev_b32 v96, 16, v158
    v_and_b32 v57, s40, v138
    v_and_b32 v97, s40, v158
    v_pk_mul_f32 v[40:41], v[40:41], v[6:7] op_sel_hi:[1,0]
    v_pk_mul_f32 v[80:81], v[80:81], v[12:13] op_sel_hi:[1,0]
    v_pk_mul_f32 v[42:43], v[42:43], v[6:7] op_sel_hi:[1,0]
    v_pk_mul_f32 v[82:83], v[82:83], v[12:13] op_sel_hi:[1,0]
    v_pk_mul_f32 v[44:45], v[44:45], v[6:7] op_sel_hi:[1,0]
    v_pk_mul_f32 v[84:85], v[84:85], v[12:13] op_sel_hi:[1,0]
    v_pk_mul_f32 v[46:47], v[46:47], v[6:7] op_sel_hi:[1,0]
    v_pk_mul_f32 v[86:87], v[86:87], v[12:13] op_sel_hi:[1,0]
    v_pk_mul_f32 v[48:49], v[48:49], v[6:7] op_sel_hi:[1,0]
    v_pk_mul_f32 v[88:89], v[88:89], v[12:13] op_sel_hi:[1,0]
    v_pk_mul_f32 v[50:51], v[50:51], v[6:7] op_sel_hi:[1,0]
    v_pk_mul_f32 v[90:91], v[90:91], v[12:13] op_sel_hi:[1,0]
    v_pk_mul_f32 v[52:53], v[52:53], v[6:7] op_sel_hi:[1,0]
    v_pk_mul_f32 v[92:93], v[92:93], v[12:13] op_sel_hi:[1,0]
    v_pk_mul_f32 v[54:55], v[54:55], v[6:7] op_sel_hi:[1,0]
    v_pk_mul_f32 v[94:95], v[94:95], v[12:13] op_sel_hi:[1,0]
    v_pk_mul_f32 v[56:57], v[56:57], v[6:7] op_sel_hi:[1,0]
    v_pk_mul_f32 v[96:97], v[96:97], v[12:13] op_sel_hi:[1,0]
    v_cvt_pk_bf16_f32 v130, v40, v41
    v_cvt_pk_bf16_f32 v150, v80, v81
    v_cvt_pk_bf16_f32 v131, v42, v43
    v_cvt_pk_bf16_f32 v151, v82, v83
    v_cvt_pk_bf16_f32 v132, v44, v45
    v_cvt_pk_bf16_f32 v152, v84, v85
    v_cvt_pk_bf16_f32 v133, v46, v47
    v_cvt_pk_bf16_f32 v153, v86, v87
    v_cvt_pk_bf16_f32 v134, v48, v49
    v_cvt_pk_bf16_f32 v154, v88, v89
    v_cvt_pk_bf16_f32 v135, v50, v51
    v_cvt_pk_bf16_f32 v155, v90, v91
    v_cvt_pk_bf16_f32 v136, v52, v53
    v_cvt_pk_bf16_f32 v156, v92, v93
    v_cvt_pk_bf16_f32 v137, v54, v55
    v_cvt_pk_bf16_f32 v157, v94, v95
    v_cvt_pk_bf16_f32 v138, v56, v57
    v_cvt_pk_bf16_f32 v158, v96, v97
    v_lshlrev_b32 v40, 16, v130
    v_lshlrev_b32 v80, 16, v150
    v_and_b32 v41, s40, v130
    v_and_b32 v81, s40, v150
    v_lshlrev_b32 v42, 16, v131
    v_lshlrev_b32 v82, 16, v151
    v_and_b32 v43, s40, v131
    v_and_b32 v83, s40, v151
    v_lshlrev_b32 v44, 16, v132
    v_lshlrev_b32 v84, 16, v152
    v_and_b32 v45, s40, v132
    v_and_b32 v85, s40, v152
    v_lshlrev_b32 v46, 16, v133
    v_lshlrev_b32 v86, 16, v153
    v_and_b32 v47, s40, v133
    v_and_b32 v87, s40, v153
    v_lshlrev_b32 v48, 16, v134
    v_lshlrev_b32 v88, 16, v154
    v_and_b32 v49, s40, v134
    v_and_b32 v89, s40, v154
    v_lshlrev_b32 v50, 16, v135
    v_lshlrev_b32 v90, 16, v155
    v_and_b32 v51, s40, v135
    v_and_b32 v91, s40, v155
    v_lshlrev_b32 v52, 16, v136
    v_lshlrev_b32 v92, 16, v156
    v_and_b32 v53, s40, v136
    v_and_b32 v93, s40, v156
    v_lshlrev_b32 v54, 16, v137
    v_lshlrev_b32 v94, 16, v157
    v_and_b32 v55, s40, v137
    v_and_b32 v95, s40, v157
    v_lshlrev_b32 v56, 16, v138
    v_lshlrev_b32 v96, 16, v158
    v_and_b32 v57, s40, v138
    v_and_b32 v97, s40, v158
    s_lshr_b32 s14, s83, 6
    s_sub_u32 s15, s83, 124
    s_lshr_b32 s15, s15, 1
    s_cmp_ge_u32 s83, 128
    s_cselect_b32 s14, s15, s14
    s_mul_i32 s14, s14, 18432
    s_lshl_b32 s15, s83, 4
    v_lshlrev_b32 v99, 4, v0
    s_mov_b32 s38, 0x200000
    s_cmp_ge_u32 s10, 6
    s_cbranch_scc1 P1_nm
    s_mov_b32 s39, 511
P1_pl:
    s_bitcmp1_b32 s39, 0
    s_cbranch_scc0 P1_l0
    s_add_u32 s3, s14, 0
    buffer_load_dwordx4 v[100:103], v99, s[28:31], s3 offen sc1
P1_l0:
    s_bitcmp1_b32 s39, 1
    s_cbranch_scc0 P1_l1
    s_add_u32 s3, s14, 73728
    buffer_load_dwordx4 v[104:107], v99, s[28:31], s3 offen sc1
P1_l1:
    s_bitcmp1_b32 s39, 2
    s_cbranch_scc0 P1_l2
    s_add_u32 s3, s14, 147456
    buffer_load_dwordx4 v[108:111], v99, s[28:31], s3 offen sc1
P1_l2:
    s_bitcmp1_b32 s39, 3
    s_cbranch_scc0 P1_l3
    s_add_u32 s3, s14, 6144
    buffer_load_dwordx4 v[112:115], v99, s[28:31], s3 offen sc1
P1_l3:
    s_bitcmp1_b32 s39, 4
    s_cbranch_scc0 P1_l4
    s_add_u32 s3, s14, 79872
    buffer_load_dwordx4 v[116:119], v99, s[28:31], s3 offen sc1
P1_l4:
    s_bitcmp1_b32 s39, 5
    s_cbranch_scc0 P1_l5
    s_add_u32 s3, s14, 153600
    buffer_load_dwordx4 v[120:123], v99, s[28:31], s3 offen sc1
P1_l5:
    s_bitcmp1_b32 s39, 6
    s_cbranch_scc0 P1_l6
    s_add_u32 s3, s14, 12288
    buffer_load_dwordx4 v[124:127], v99, s[28:31], s3 offen sc1
P1_l6:
    s_bitcmp1_b32 s39, 7
    s_cbranch_scc0 P1_l7
    s_add_u32 s3, s14, 86016
    buffer_load_dwordx4 v[128:131], v99, s[28:31], s3 offen sc1
P1_l7:
    s_bitcmp1_b32 s39, 8
    s_cbranch_scc0 P1_l8
    s_add_u32 s3, s14, 159744
    buffer_load_dwordx4 v[132:135], v99, s[28:31], s3 offen sc1
P1_l8:
    s_sub_u32 s38, s38, 1
    s_mov_b32 s39, 0
    s_waitcnt vmcnt(0)
    v_xor_b32 v4, s86, v101
    v_bitop3_b32 v4, v103, s86, v4 bitop3:0xbe
    v_xor_b32 v5, s86, v105
    v_bitop3_b32 v5, v107, s86, v5 bitop3:0xbe
    v_xor_b32 v6, s86, v109
    v_bitop3_b32 v6, v111, s86, v6 bitop3:0xbe
    v_cmp_ne_u32 s[20:21], 0, v4
    v_cmp_ne_u32 s[22:23], 0, v5
    v_cmp_ne_u32 s[24:25], 0, v6
    s_cmp_lg_u64 s[20:21], 0
    s_cselect_b32 s3, 1, 0
    s_or_b32 s39, s39, s3
    s_cmp_lg_u64 s[22:23], 0
    s_cselect_b32 s3, 2, 0
    s_or_b32 s39, s39, s3
    s_cmp_lg_u64 s[24:25], 0
    s_cselect_b32 s3, 4, 0
    s_or_b32 s39, s39, s3
    v_xor_b32 v4, s86, v113
    v_bitop3_b32 v4, v115, s86, v4 bitop3:0xbe
    v_xor_b32 v5, s86, v117
    v_bitop3_b32 v5, v119, s86, v5 bitop3:0xbe
    v_xor_b32 v6, s86, v121
    v_bitop3_b32 v6, v123, s86, v6 bitop3:0xbe
    v_cmp_ne_u32 s[20:21], 0, v4
    v_cmp_ne_u32 s[22:23], 0, v5
    v_cmp_ne_u32 s[24:25], 0, v6
    s_cmp_lg_u64 s[20:21], 0
    s_cselect_b32 s3, 8, 0
    s_or_b32 s39, s39, s3
    s_cmp_lg_u64 s[22:23], 0
    s_cselect_b32 s3, 16, 0
    s_or_b32 s39, s39, s3
    s_cmp_lg_u64 s[24:25], 0
    s_cselect_b32 s3, 32, 0
    s_or_b32 s39, s39, s3
    v_xor_b32 v4, s86, v125
    v_bitop3_b32 v4, v127, s86, v4 bitop3:0xbe
    v_xor_b32 v5, s86, v129
    v_bitop3_b32 v5, v131, s86, v5 bitop3:0xbe
    v_xor_b32 v6, s86, v133
    v_bitop3_b32 v6, v135, s86, v6 bitop3:0xbe
    v_cmp_ne_u32 s[20:21], 0, v4
    v_cmp_ne_u32 s[22:23], 0, v5
    v_cmp_ne_u32 s[24:25], 0, v6
    s_cmp_lg_u64 s[20:21], 0
    s_cselect_b32 s3, 64, 0
    s_or_b32 s39, s39, s3
    s_cmp_lg_u64 s[22:23], 0
    s_cselect_b32 s3, 128, 0
    s_or_b32 s39, s39, s3
    s_cmp_lg_u64 s[24:25], 0
    s_cselect_b32 s3, 256, 0
    s_or_b32 s39, s39, s3
    s_cbranch_scc0 P1_pe
    s_cmp_eq_u32 s38, 0
    s_cbranch_scc1 P1_pe
    s_sleep 2
    s_branch P1_pl
P1_pe:
    s_cmp_ge_u32 s10, 3
    s_cselect_b32 s3, 1.0, 0
    v_lshlrev_b32 v13, 2, v0
    v_add_u32 v13, 102400, v13
    v_add_f32 v100, v100, v104
    v_add_f32 v102, v102, v106
    v_add_f32 v112, v112, v116
    v_add_f32 v114, v114, v118
    v_add_f32 v124, v124, v128
    v_add_f32 v126, v126, v130
    v_add_f32 v100, v100, v108
    v_add_f32 v102, v102, v110
    v_add_f32 v112, v112, v120
    v_add_f32 v114, v114, v122
    v_add_f32 v124, v124, v132
    v_add_f32 v126, v126, v134
    v_cvt_pk_bf16_f32 v101, v100, v102
    v_cvt_pk_bf16_f32 v113, v112, v114
    v_cvt_pk_bf16_f32 v125, v124, v126
    ds_write_b32 v13, v101 offset:0
    v_lshlrev_b32 v112, 16, v113
    v_and_b32 v114, s40, v113
    v_lshlrev_b32 v124, 16, v125
    v_and_b32 v126, s40, v125
    v_add_f32 v112, s3, v112
    v_add_f32 v114, s3, v114
    v_add_f32 v124, 1.0, v124
    v_add_f32 v126, 1.0, v126
    v_cvt_pk_bf16_f32 v113, v112, v114
    ds_write_b32 v13, v113 offset:1536
    v_cvt_pk_bf16_f32 v125, v124, v126
    ds_write_b32 v13, v125 offset:3072
    s_waitcnt lgkmcnt(0)
P1_nm:
    v_add_u32 v13, 102400, v3
    v_lshlrev_b32 v14, 2, v2
    v_add_u32 v14, 104448, v14
    v_lshlrev_b32 v10, 2, v2
    s_add_u32 s16, s15, s10
    s_mul_i32 s16, s16, 2304
    s_add_u32 s17, s16, 18432
    s_barrier
    ds_read_b128 v[100:103], v13 offset:2304
    ds_read_b128 v[104:107], v13 offset:3328
    ds_read_b32 v108, v14 offset:2304
    ds_read_b128 v[112:115], v13 offset:0
    ds_read_b128 v[116:119], v13 offset:1024
    ds_read_b32 v120, v14 offset:0
    s_waitcnt lgkmcnt(3)
    v_lshlrev_b32 v150, 16, v100
    v_and_b32 v151, s40, v100
    v_lshlrev_b32 v152, 16, v101
    v_and_b32 v153, s40, v101
    v_lshlrev_b32 v154, 16, v102
    v_and_b32 v155, s40, v102
    v_lshlrev_b32 v156, 16, v103
    v_and_b32 v157, s40, v103
    v_lshlrev_b32 v158, 16, v104
    v_and_b32 v159, s40, v104
    v_lshlrev_b32 v160, 16, v105
    v_and_b32 v161, s40, v105
    v_lshlrev_b32 v162, 16, v106
    v_and_b32 v163, s40, v106
    v_lshlrev_b32 v164, 16, v107
    v_and_b32 v165, s40, v107
    v_lshlrev_b32 v166, 16, v108
    v_and_b32 v167, s40, v108
    v_pk_mul_f32 v[40:41], v[40:41], v[150:151]
    v_pk_mul_f32 v[42:43], v[42:43], v[152:153]
    v_pk_mul_f32 v[44:45], v[44:45], v[154:155]
    v_pk_mul_f32 v[46:47], v[46:47], v[156:157]
    v_pk_mul_f32 v[48:49], v[48:49], v[158:159]
    v_pk_mul_f32 v[50:51], v[50:51], v[160:161]
    v_pk_mul_f32 v[52:53], v[52:53], v[162:163]
    v_pk_mul_f32 v[54:55], v[54:55], v[164:165]
    v_pk_mul_f32 v[56:57], v[56:57], v[166:167]
    v_cvt_pk_bf16_f32 v130, v40, v41
    v_cvt_pk_bf16_f32 v131, v42, v43
    v_cvt_pk_bf16_f32 v132, v44, v45
    v_cvt_pk_bf16_f32 v133, v46, v47
    v_cvt_pk_bf16_f32 v134, v48, v49
    v_cvt_pk_bf16_f32 v135, v50, v51
    v_cvt_pk_bf16_f32 v136, v52, v53
    v_cvt_pk_bf16_f32 v137, v54, v55
    v_cvt_pk_bf16_f32 v138, v56, v57
    v_lshlrev_b32 v40, 16, v130
    v_and_b32 v41, s40, v130
    v_lshlrev_b32 v42, 16, v131
    v_and_b32 v43, s40, v131
    v_lshlrev_b32 v44, 16, v132
    v_and_b32 v45, s40, v132
    v_lshlrev_b32 v46, 16, v133
    v_and_b32 v47, s40, v133
    v_lshlrev_b32 v48, 16, v134
    v_and_b32 v49, s40, v134
    v_lshlrev_b32 v50, 16, v135
    v_and_b32 v51, s40, v135
    v_lshlrev_b32 v52, 16, v136
    v_and_b32 v53, s40, v136
    v_lshlrev_b32 v54, 16, v137
    v_and_b32 v55, s40, v137
    v_lshlrev_b32 v56, 16, v138
    v_and_b32 v57, s40, v138
    s_waitcnt lgkmcnt(0)
    v_lshlrev_b32 v16, 16, v112
    v_and_b32 v17, s40, v112
    v_lshlrev_b32 v18, 16, v113
    v_and_b32 v19, s40, v113
    v_lshlrev_b32 v20, 16, v114
    v_and_b32 v21, s40, v114
    v_lshlrev_b32 v22, 16, v115
    v_and_b32 v23, s40, v115
    v_lshlrev_b32 v24, 16, v116
    v_and_b32 v25, s40, v116
    v_lshlrev_b32 v26, 16, v117
    v_and_b32 v27, s40, v117
    v_lshlrev_b32 v28, 16, v118
    v_and_b32 v29, s40, v118
    v_lshlrev_b32 v30, 16, v119
    v_and_b32 v31, s40, v119
    v_lshlrev_b32 v32, 16, v120
    v_and_b32 v33, s40, v120
    v_pk_add_f32 v[40:41], v[40:41], v[16:17]
    v_pk_add_f32 v[42:43], v[42:43], v[18:19]
    v_pk_add_f32 v[44:45], v[44:45], v[20:21]
    v_pk_add_f32 v[46:47], v[46:47], v[22:23]
    v_pk_add_f32 v[48:49], v[48:49], v[24:25]
    v_pk_add_f32 v[50:51], v[50:51], v[26:27]
    v_pk_add_f32 v[52:53], v[52:53], v[28:29]
    v_pk_add_f32 v[54:55], v[54:55], v[30:31]
    v_pk_add_f32 v[56:57], v[56:57], v[32:33]
    v_cvt_pk_bf16_f32 v100, v40, v41
    v_cvt_pk_bf16_f32 v101, v42, v43
    v_cvt_pk_bf16_f32 v102, v44, v45
    v_cvt_pk_bf16_f32 v103, v46, v47
    v_cvt_pk_bf16_f32 v104, v48, v49
    v_cvt_pk_bf16_f32 v105, v50, v51
    v_cvt_pk_bf16_f32 v106, v52, v53
    v_cvt_pk_bf16_f32 v107, v54, v55
    v_cvt_pk_bf16_f32 v108, v56, v57
    buffer_store_dwordx4 v[100:103], v3, s[32:35], s16 offen sc1
    buffer_store_dwordx4 v[104:107], v3, s[32:35], s16 offen offset:1024 sc1
    buffer_store_dword v108, v10, s[32:35], s16 offen offset:2048 sc1
    v_pk_mul_f32 v[80:81], v[80:81], v[150:151]
    v_pk_mul_f32 v[82:83], v[82:83], v[152:153]
    v_pk_mul_f32 v[84:85], v[84:85], v[154:155]
    v_pk_mul_f32 v[86:87], v[86:87], v[156:157]
    v_pk_mul_f32 v[88:89], v[88:89], v[158:159]
    v_pk_mul_f32 v[90:91], v[90:91], v[160:161]
    v_pk_mul_f32 v[92:93], v[92:93], v[162:163]
    v_pk_mul_f32 v[94:95], v[94:95], v[164:165]
    v_pk_mul_f32 v[96:97], v[96:97], v[166:167]
    v_cvt_pk_bf16_f32 v130, v80, v81
    v_cvt_pk_bf16_f32 v131, v82, v83
    v_cvt_pk_bf16_f32 v132, v84, v85
    v_cvt_pk_bf16_f32 v133, v86, v87
    v_cvt_pk_bf16_f32 v134, v88, v89
    v_cvt_pk_bf16_f32 v135, v90, v91
    v_cvt_pk_bf16_f32 v136, v92, v93
    v_cvt_pk_bf16_f32 v137, v94, v95
    v_cvt_pk_bf16_f32 v138, v96, v97
    v_lshlrev_b32 v80, 16, v130
    v_and_b32 v81, s40, v130
    v_lshlrev_b32 v82, 16, v131
    v_and_b32 v83, s40, v131
    v_lshlrev_b32 v84, 16, v132
    v_and_b32 v85, s40, v132
    v_lshlrev_b32 v86, 16, v133
    v_and_b32 v87, s40, v133
    v_lshlrev_b32 v88, 16, v134
    v_and_b32 v89, s40, v134
    v_lshlrev_b32 v90, 16, v135
    v_and_b32 v91, s40, v135
    v_lshlrev_b32 v92, 16, v136
    v_and_b32 v93, s40, v136
    v_lshlrev_b32 v94, 16, v137
    v_and_b32 v95, s40, v137
    v_lshlrev_b32 v96, 16, v138
    v_and_b32 v97, s40, v138
    v_pk_add_f32 v[80:81], v[80:81], v[16:17]
    v_pk_add_f32 v[82:83], v[82:83], v[18:19]
    v_pk_add_f32 v[84:85], v[84:85], v[20:21]
    v_pk_add_f32 v[86:87], v[86:87], v[22:23]
    v_pk_add_f32 v[88:89], v[88:89], v[24:25]
    v_pk_add_f32 v[90:91], v[90:91], v[26:27]
    v_pk_add_f32 v[92:93], v[92:93], v[28:29]
    v_pk_add_f32 v[94:95], v[94:95], v[30:31]
    v_pk_add_f32 v[96:97], v[96:97], v[32:33]
    v_cvt_pk_bf16_f32 v112, v80, v81
    v_cvt_pk_bf16_f32 v113, v82, v83
    v_cvt_pk_bf16_f32 v114, v84, v85
    v_cvt_pk_bf16_f32 v115, v86, v87
    v_cvt_pk_bf16_f32 v116, v88, v89
    v_cvt_pk_bf16_f32 v117, v90, v91
    v_cvt_pk_bf16_f32 v118, v92, v93
    v_cvt_pk_bf16_f32 v119, v94, v95
    v_cvt_pk_bf16_f32 v120, v96, v97
    buffer_store_dwordx4 v[112:115], v3, s[32:35], s17 offen sc1
    buffer_store_dwordx4 v[116:119], v3, s[32:35], s17 offen offset:1024 sc1
    buffer_store_dword v120, v10, s[32:35], s17 offen offset:2048 sc1
    s_waitcnt vmcnt(0)
    s_barrier
    s_cmp_lg_u32 s10, 0
    s_cbranch_scc1 P1_nf
    s_add_u32 s3, s86, 2
    v_mov_b32 v13, s3
    v_mov_b32 v14, 0
    s_lshl_b32 s3, s2, 7
    s_mov_b64 exec, 1
    buffer_store_dword v13, v14, s[76:79], s3 offen sc1
    s_mov_b64 exec, -1
P1_nf:
P1_end:
    s_waitcnt vmcnt(0)
    s_bfe_u32 s3, s80, 0x80010
    s_cbranch_scc0 P2
    s_cmp_lt_u32 s10, 4
    s_cbranch_scc1 PW_cons
    s_mov_b32 m0, s64
    s_add_u32 s64, s64, 49152
    buffer_load_dwordx4 v200, s[72:75], s62 offen offset:0 sc1 lds
    buffer_load_dwordx4 v201, s[72:75], s62 offen offset:1024 sc1 lds
    buffer_load_dwordx4 v202, s[72:75], s62 offen offset:2048 sc1 lds
    buffer_load_dwordx4 v203, s[72:75], s62 offen offset:3072 sc1 lds
    s_cmp_eq_u32 s64, s66
    s_cselect_b32 s3, 147456, 0
    s_sub_u32 s64, s64, s3
    s_add_u32 s62, s62, 128
    s_mov_b32 m0, s65
    s_add_u32 s65, s65, 49152
    buffer_load_dwordx4 v208, s[68:71], s63 offen offset:0 sc1 lds
    buffer_load_dwordx4 v209, s[68:71], s63 offen offset:1024 sc1 lds
    buffer_load_dwordx4 v210, s[68:71], s63 offen offset:2048 sc1 lds
    buffer_load_dwordx4 v211, s[68:71], s63 offen offset:3072 sc1 lds
    s_add_u32 s63, s63, s101
    s_cmp_eq_u32 s65, s67
    s_cselect_b32 s3, 147456, 0
    s_sub_u32 s65, s65, s3
    s_mov_b32 m0, s64
    s_add_u32 s64, s64, 49152
    buffer_load_dwordx4 v200, s[72:75], s62 offen offset:0 sc1 lds
    buffer_load_dwordx4 v201, s[72:75], s62 offen offset:1024 sc1 lds
    buffer_load_dwordx4 v202, s[72:75], s62 offen offset:2048 sc1 lds
    buffer_load_dwordx4 v203, s[72:75], s62 offen offset:3072 sc1 lds
    s_cmp_eq_u32 s64, s66
    s_cselect_b32 s3, 147456, 0
    s_sub_u32 s64, s64, s3
    s_add_u32 s62, s62, 128
    s_mov_b32 m0, s65
    s_add_u32 s65, s65, 49152
    buffer_load_dwordx4 v208, s[68:71], s63 offen offset:0 sc1 lds
    buffer_load_dwordx4 v209, s[68:71], s63 offen offset:1024 sc1 lds
    buffer_load_dwordx4 v210, s[68:71], s63 offen offset:2048 sc1 lds
    buffer_load_dwordx4 v211, s[68:71], s63 offen offset:3072 sc1 lds
    s_add_u32 s63, s63, s101
    s_cmp_eq_u32 s65, s67
    s_cselect_b32 s3, 147456, 0
    s_sub_u32 s65, s65, s3
    s_waitcnt vmcnt(8)
    s_barrier
    s_mov_b32 m0, s64
    s_add_u32 s64, s64, 49152
    buffer_load_dwordx4 v200, s[72:75], s62 offen offset:0 sc1 lds
    buffer_load_dwordx4 v201, s[72:75], s62 offen offset:1024 sc1 lds
    buffer_load_dwordx4 v202, s[72:75], s62 offen offset:2048 sc1 lds
    buffer_load_dwordx4 v203, s[72:75], s62 offen offset:3072 sc1 lds
    s_cmp_eq_u32 s64, s66
    s_cselect_b32 s3, 147456, 0
    s_sub_u32 s64, s64, s3
    s_add_u32 s62, s62, 128
    s_mov_b32 m0, s65
    s_add_u32 s65, s65, 49152
    buffer_load_dwordx4 v208, s[68:71], s63 offen offset:0 sc1 lds
    buffer_load_dwordx4 v209, s[68:71], s63 offen offset:1024 sc1 lds
    buffer_load_dwordx4 v210, s[68:71], s63 offen offset:2048 sc1 lds
    buffer_load_dwordx4 v211, s[68:71], s63 offen offset:3072 sc1 lds
    s_add_u32 s63, s63, s101
    s_cmp_eq_u32 s65, s67
    s_cselect_b32 s3, 147456, 0
    s_sub_u32 s65, s65, s3
    s_mov_b32 s60, 15
PW_lloop:
    s_waitcnt vmcnt(8)
    s_barrier
    s_mov_b32 m0, s64
    s_add_u32 s64, s64, 49152
    buffer_load_dwordx4 v200, s[72:75], s62 offen offset:0 sc1 lds
    buffer_load_dwordx4 v201, s[72:75], s62 offen offset:1024 sc1 lds
    buffer_load_dwordx4 v202, s[72:75], s62 offen offset:2048 sc1 lds
    buffer_load_dwordx4 v203, s[72:75], s62 offen offset:3072 sc1 lds
    s_cmp_eq_u32 s64, s66
    s_cselect_b32 s3, 147456, 0
    s_sub_u32 s64, s64, s3
    s_add_u32 s62, s62, 128
    s_mov_b32 m0, s65
    s_add_u32 s65, s65, 49152
    buffer_load_dwordx4 v208, s[68:71], s63 offen offset:0 sc1 lds
    buffer_load_dwordx4 v209, s[68:71], s63 offen offset:1024 sc1 lds
    buffer_load_dwordx4 v210, s[68:71], s63 offen offset:2048 sc1 lds
    buffer_load_dwordx4 v211, s[68:71], s63 offen offset:3072 sc1 lds
    s_add_u32 s63, s63, s101
    s_cmp_eq_u32 s65, s67
    s_cselect_b32 s3, 147456, 0
    s_sub_u32 s65, s65, s3
    s_sub_u32 s60, s60, 1
    s_cmp_lg_u32 s60, 0
    s_cbranch_scc1 PW_lloop
    s_waitcnt vmcnt(8)
    s_barrier
    s_waitcnt vmcnt(0)
    s_barrier
    s_barrier
    s_branch PW_next
PW_cons:
    s_lshr_b32 s18, s10, 1
    s_and_b32 s19, s10, 1
    s_lshl_b32 s42, s19, 13
    v_lshrrev_b32 v4, 4, v2
    v_bfe_u32 v5, v2, 1, 3
    v_xor_b32 v5, v5, v4
    v_and_b32 v6, 15, v2
    v_lshlrev_b32 v6, 7, v6
    v_lshl_add_u32 v6, v5, 4, v6
    v_add_u32 v112, s42, v6
    v_bfe_u32 v5, v2, 2, 2
    v_lshl_add_u32 v6, v4, 3, v5
    v_lshlrev_b32 v6, 8, v6
    v_add_u32 v6, 32768, v6
    v_and_b32 v4, 1, v4
    v_xor_b32 v4, s18, v4
    v_lshl_add_u32 v6, v4, 7, v6
    v_and_b32 v7, 2, v2
    v_lshl_add_u32 v6, v7, 2, v6
    v_and_b32 v7, 1, v2
    v_xor_b32 v5, v5, v7
    v_xor_b32 v7, 0, v5
    v_lshl_add_u32 v113, v7, 5, v6
    v_xor_b32 v7, 0, v5
    v_lshl_add_u32 v114, v7, 5, v6
    v_add_u32 v114, 16, v114
    v_xor_b32 v7, 2, v5
    v_lshl_add_u32 v115, v7, 5, v6
    v_xor_b32 v7, 2, v5
    v_lshl_add_u32 v116, v7, 5, v6
    v_add_u32 v116, 16, v116
    v_mov_b32 v117, v112
    v_xor_b32 v124, 64, v112
    v_mov_b32 v118, v113
    v_mov_b32 v119, v114
    v_mov_b32 v120, v115
    v_mov_b32 v121, v116
    v_mov_b64 v[128:129], 0
    v_mov_b64 v[130:131], 0
    v_mov_b64 v[132:133], 0
    v_mov_b64 v[134:135], 0
    v_mov_b64 v[136:137], 0
    v_mov_b64 v[138:139], 0
    v_mov_b64 v[140:141], 0
    v_mov_b64 v[142:143], 0
    v_mov_b64 v[144:145], 0
    v_mov_b64 v[146:147], 0
    v_mov_b64 v[148:149], 0
    v_mov_b64 v[150:151], 0
    v_mov_b64 v[152:153], 0
    v_mov_b64 v[154:155], 0
    v_mov_b64 v[156:157], 0
    v_mov_b64 v[158:159], 0
    v_mov_b64 v[160:161], 0
    v_mov_b64 v[162:163], 0
    v_mov_b64 v[164:165], 0
    v_mov_b64 v[166:167], 0
    v_mov_b64 v[168:169], 0
    v_mov_b64 v[170:171], 0
    v_mov_b64 v[172:173], 0
    v_mov_b64 v[174:175], 0
    v_mov_b64 v[176:177], 0
    v_mov_b64 v[178:179], 0
    v_mov_b64 v[180:181], 0
    v_mov_b64 v[182:183], 0
    v_mov_b64 v[184:185], 0
    v_mov_b64 v[186:187], 0
    v_mov_b64 v[188:189], 0
    v_mov_b64 v[190:191], 0
    v_mov_b64 v[192:193], 0
    v_mov_b64 v[194:195], 0
    v_mov_b64 v[196:197], 0
    v_mov_b64 v[198:199], 0
    v_mov_b64 v[200:201], 0
    v_mov_b64 v[202:203], 0
    v_mov_b64 v[204:205], 0
    v_mov_b64 v[206:207], 0
    v_mov_b64 v[208:209], 0
    v_mov_b64 v[210:211], 0
    v_mov_b64 v[212:213], 0
    v_mov_b64 v[214:215], 0
    v_mov_b64 v[216:217], 0
    v_mov_b64 v[218:219], 0
    v_mov_b64 v[220:221], 0
    v_mov_b64 v[222:223], 0
    v_mov_b64 v[224:225], 0
    v_mov_b64 v[226:227], 0
    v_mov_b64 v[228:229], 0
    v_mov_b64 v[230:231], 0
    v_mov_b64 v[232:233], 0
    v_mov_b64 v[234:235], 0
    v_mov_b64 v[236:237], 0
    v_mov_b64 v[238:239], 0
    v_mov_b64 v[240:241], 0
    v_mov_b64 v[242:243], 0
    v_mov_b64 v[244:245], 0
    v_mov_b64 v[246:247], 0
    v_mov_b64 v[248:249], 0
    v_mov_b64 v[250:251], 0
    v_mov_b64 v[252:253], 0
    v_mov_b64 v[254:255], 0
    s_mov_b32 s44, 0
    s_mov_b32 s45, 18
    s_add_u32 s28, s84, 0x1e00000
    s_addc_u32 s29, s85, 0
    s_mov_b32 s30, 0x288000
    s_mov_b32 s31, 0x20000
    s_bfe_u32 s3, s80, 0x80010
    s_sub_u32 s3, s3, 1
    s_mul_i32 s41, s3, 7282
    s_lshr_b32 s41, s41, 16
    s_mul_i32 s42, s41, 9
    s_sub_u32 s42, s3, s42
    s_lshl_b32 s41, s41, 1
    s_add_u32 s41, s41, s19
    s_mul_i32 s41, s41, 147456
    s_lshl_b32 s42, s42, 1
    s_add_u32 s42, s42, s18
    s_lshl_b32 s42, s42, 7
    s_add_u32 s41, s41, s42
    v_and_b32 v4, 15, v2
    v_mul_u32_u24 v4, 2304, v4
    v_lshrrev_b32 v5, 4, v2
    v_lshl_add_u32 v122, v5, 4, v4
    s_barrier
    ds_read_b64_tr_b16 v[16:17], v118 offset:0
    ds_read_b64_tr_b16 v[18:19], v118 offset:1024
    ds_read_b128 v[32:35], v117 offset:0
    ds_read_b128 v[36:39], v117 offset:2048
    ds_read_b128 v[40:43], v117 offset:4096
    ds_read_b64_tr_b16 v[20:21], v119 offset:0
    ds_read_b64_tr_b16 v[22:23], v119 offset:1024
    ds_read_b128 v[44:47], v117 offset:6144
    ds_read_b64_tr_b16 v[24:25], v120 offset:0
    ds_read_b64_tr_b16 v[26:27], v120 offset:1024
    ds_read_b64_tr_b16 v[28:29], v121 offset:0
    ds_read_b64_tr_b16 v[30:31], v121 offset:1024
    s_branch PW_mid
PW_loop:
    v_mfma_f32_16x16x32_bf16 v[128:131], v[64:67], v[80:83], v[128:131]
    v_mfma_f32_16x16x32_bf16 v[132:135], v[64:67], v[84:87], v[132:135]
    s_barrier
    v_mfma_f32_16x16x32_bf16 v[136:139], v[64:67], v[88:91], v[136:139]
    ds_read_b64_tr_b16 v[16:17], v118 offset:0
    ds_read_b64_tr_b16 v[18:19], v118 offset:1024
    v_mfma_f32_16x16x32_bf16 v[140:143], v[64:67], v[92:95], v[140:143]
    ds_read_b128 v[32:35], v117 offset:0
    ds_read_b128 v[36:39], v117 offset:2048
    v_mfma_f32_16x16x32_bf16 v[160:163], v[68:71], v[80:83], v[160:163]
    ds_read_b128 v[40:43], v117 offset:4096
    v_mfma_f32_16x16x32_bf16 v[164:167], v[68:71], v[84:87], v[164:167]
    ds_read_b64_tr_b16 v[20:21], v119 offset:0
    ds_read_b64_tr_b16 v[22:23], v119 offset:1024
    v_mfma_f32_16x16x32_bf16 v[168:171], v[68:71], v[88:91], v[168:171]
    ds_read_b128 v[44:47], v117 offset:6144
    v_mfma_f32_16x16x32_bf16 v[172:175], v[68:71], v[92:95], v[172:175]
    ds_read_b64_tr_b16 v[24:25], v120 offset:0
    ds_read_b64_tr_b16 v[26:27], v120 offset:1024
    v_mfma_f32_16x16x32_bf16 v[192:195], v[72:75], v[80:83], v[192:195]
    ds_read_b64_tr_b16 v[28:29], v121 offset:0
    v_mfma_f32_16x16x32_bf16 v[196:199], v[72:75], v[84:87], v[196:199]
    ds_read_b64_tr_b16 v[30:31], v121 offset:1024
    v_mfma_f32_16x16x32_bf16 v[200:203], v[72:75], v[88:91], v[200:203]
    v_mfma_f32_16x16x32_bf16 v[204:207], v[72:75], v[92:95], v[204:207]
    v_mfma_f32_16x16x32_bf16 v[224:227], v[76:79], v[80:83], v[224:227]
    v_mfma_f32_16x16x32_bf16 v[228:231], v[76:79], v[84:87], v[228:231]
    v_mfma_f32_16x16x32_bf16 v[232:235], v[76:79], v[88:91], v[232:235]
    v_mfma_f32_16x16x32_bf16 v[236:239], v[76:79], v[92:95], v[236:239]
PW_mid:
    s_waitcnt lgkmcnt(0)
    v_mfma_f32_16x16x32_bf16 v[128:131], v[16:19], v[32:35], v[128:131]
    ds_read_b64_tr_b16 v[64:65], v118 offset:8192
    ds_read_b64_tr_b16 v[66:67], v118 offset:9216
    v_mfma_f32_16x16x32_bf16 v[132:135], v[16:19], v[36:39], v[132:135]
    ds_read_b128 v[80:83], v124 offset:0
    ds_read_b128 v[84:87], v124 offset:2048
    v_mfma_f32_16x16x32_bf16 v[136:139], v[16:19], v[40:43], v[136:139]
    ds_read_b128 v[88:91], v124 offset:4096
    ds_read_b64_tr_b16 v[68:69], v119 offset:8192
    v_mfma_f32_16x16x32_bf16 v[140:143], v[16:19], v[44:47], v[140:143]
    ds_read_b64_tr_b16 v[70:71], v119 offset:9216
    v_mfma_f32_16x16x32_bf16 v[160:163], v[20:23], v[32:35], v[160:163]
    ds_read_b128 v[92:95], v124 offset:6144
    ds_read_b64_tr_b16 v[72:73], v120 offset:8192
    v_mfma_f32_16x16x32_bf16 v[164:167], v[20:23], v[36:39], v[164:167]
    ds_read_b64_tr_b16 v[74:75], v120 offset:9216
    ds_read_b64_tr_b16 v[76:77], v121 offset:8192
    v_mfma_f32_16x16x32_bf16 v[168:171], v[20:23], v[40:43], v[168:171]
    ds_read_b64_tr_b16 v[78:79], v121 offset:9216
    s_add_u32 s44, s44, 49152
    v_mfma_f32_16x16x32_bf16 v[172:175], v[20:23], v[44:47], v[172:175]
    s_cmp_eq_u32 s44, 147456
    v_mfma_f32_16x16x32_bf16 v[192:195], v[24:27], v[32:35], v[192:195]
    s_cselect_b32 s44, 0, s44
    v_add_u32 v117, s44, v112
    v_mfma_f32_16x16x32_bf16 v[196:199], v[24:27], v[36:39], v[196:199]
    v_xor_b32 v124, 64, v117
    v_add_u32 v118, s44, v113
    v_mfma_f32_16x16x32_bf16 v[200:203], v[24:27], v[40:43], v[200:203]
    v_add_u32 v119, s44, v114
    v_add_u32 v120, s44, v115
    v_mfma_f32_16x16x32_bf16 v[204:207], v[24:27], v[44:47], v[204:207]
    v_add_u32 v121, s44, v116
    v_mfma_f32_16x16x32_bf16 v[224:227], v[28:31], v[32:35], v[224:227]
    s_sub_u32 s45, s45, 1
    s_cmp_lg_u32 s45, 0
    v_mfma_f32_16x16x32_bf16 v[228:231], v[28:31], v[36:39], v[228:231]
    v_mfma_f32_16x16x32_bf16 v[232:235], v[28:31], v[40:43], v[232:235]
    v_mfma_f32_16x16x32_bf16 v[236:239], v[28:31], v[44:47], v[236:239]
    s_waitcnt lgkmcnt(0)
    s_cbranch_scc1 PW_loop
    s_barrier
    v_mfma_f32_16x16x32_bf16 v[128:131], v[64:67], v[80:83], v[128:131]
    v_mfma_f32_16x16x32_bf16 v[160:163], v[68:71], v[80:83], v[160:163]
    v_mfma_f32_16x16x32_bf16 v[192:195], v[72:75], v[80:83], v[192:195]
    v_mfma_f32_16x16x32_bf16 v[224:227], v[76:79], v[80:83], v[224:227]
    v_mfma_f32_16x16x32_bf16 v[132:135], v[64:67], v[84:87], v[132:135]
    v_mfma_f32_16x16x32_bf16 v[164:167], v[68:71], v[84:87], v[164:167]
    v_mfma_f32_16x16x32_bf16 v[196:199], v[72:75], v[84:87], v[196:199]
    v_mfma_f32_16x16x32_bf16 v[228:231], v[76:79], v[84:87], v[228:231]
    v_mfma_f32_16x16x32_bf16 v[136:139], v[64:67], v[88:91], v[136:139]
    v_cvt_pk_bf16_f32 v16, v128, v129
    v_cvt_pk_bf16_f32 v17, v130, v131
    v_cvt_pk_bf16_f32 v18, v160, v161
    v_mfma_f32_16x16x32_bf16 v[168:171], v[68:71], v[88:91], v[168:171]
    v_cvt_pk_bf16_f32 v19, v162, v163
    buffer_store_dwordx4 v[16:19], v122, s[28:31], s41 offen offset:0 sc1
    v_cvt_pk_bf16_f32 v20, v192, v193
    v_mfma_f32_16x16x32_bf16 v[200:203], v[72:75], v[88:91], v[200:203]
    v_cvt_pk_bf16_f32 v21, v194, v195
    v_cvt_pk_bf16_f32 v22, v224, v225
    v_cvt_pk_bf16_f32 v23, v226, v227
    v_mfma_f32_16x16x32_bf16 v[232:235], v[76:79], v[88:91], v[232:235]
    buffer_store_dwordx4 v[20:23], v122, s[28:31], s41 offen offset:64 sc1
    s_add_u32 s41, s41, 36864
    v_mfma_f32_16x16x32_bf16 v[140:143], v[64:67], v[92:95], v[140:143]
    v_cvt_pk_bf16_f32 v24, v132, v133
    v_cvt_pk_bf16_f32 v25, v134, v135
    v_cvt_pk_bf16_f32 v26, v164, v165
    v_mfma_f32_16x16x32_bf16 v[172:175], v[68:71], v[92:95], v[172:175]
    v_cvt_pk_bf16_f32 v27, v166, v167
    buffer_store_dwordx4 v[24:27], v122, s[28:31], s41 offen offset:0 sc1
    v_cvt_pk_bf16_f32 v28, v196, v197
    v_mfma_f32_16x16x32_bf16 v[204:207], v[72:75], v[92:95], v[204:207]
    v_cvt_pk_bf16_f32 v29, v198, v199
    v_cvt_pk_bf16_f32 v30, v228, v229
    v_cvt_pk_bf16_f32 v31, v230, v231
    v_mfma_f32_16x16x32_bf16 v[236:239], v[76:79], v[92:95], v[236:239]
    buffer_store_dwordx4 v[28:31], v122, s[28:31], s41 offen offset:64 sc1
    s_add_u32 s41, s41, 36864
    v_cvt_pk_bf16_f32 v32, v136, v137
    v_cvt_pk_bf16_f32 v33, v138, v139
    v_cvt_pk_bf16_f32 v34, v168, v169
    v_cvt_pk_bf16_f32 v35, v170, v171
    buffer_store_dwordx4 v[32:35], v122, s[28:31], s41 offen offset:0 sc1
    v_cvt_pk_bf16_f32 v36, v200, v201
    v_cvt_pk_bf16_f32 v37, v202, v203
    v_cvt_pk_bf16_f32 v38, v232, v233
    v_cvt_pk_bf16_f32 v39, v234, v235
    buffer_store_dwordx4 v[36:39], v122, s[28:31], s41 offen offset:64 sc1
    s_add_u32 s41, s41, 36864
    v_cvt_pk_bf16_f32 v40, v140, v141
    v_cvt_pk_bf16_f32 v41, v142, v143
    v_cvt_pk_bf16_f32 v42, v172, v173
    v_cvt_pk_bf16_f32 v43, v174, v175
    buffer_store_dwordx4 v[40:43], v122, s[28:31], s41 offen offset:0 sc1
    v_cvt_pk_bf16_f32 v44, v204, v205
    v_cvt_pk_bf16_f32 v45, v206, v207
    v_cvt_pk_bf16_f32 v46, v236, v237
    v_cvt_pk_bf16_f32 v47, v238, v239
    buffer_store_dwordx4 v[44:47], v122, s[28:31], s41 offen offset:64 sc1
    s_add_u32 s41, s41, 36864
    v_mov_b32 v8, 147456
    v_mov_b32 v9, 1
    s_add_u32 s100, s100, 4
    s_waitcnt vmcnt(0)
    s_mov_b64 exec, 1
    ds_add_rtn_u32 v10, v8, v9
    s_mov_b64 exec, -1
    s_waitcnt lgkmcnt(0)
    v_readfirstlane_b32 s3, v10
    s_nop 0
    s_add_u32 s3, s3, 1
    s_cmp_lg_u32 s3, s100
    s_cbranch_scc1 PB_4
    s_add_u32 s3, s86, 3
    v_mov_b32 v9, s3
    v_mov_b32 v10, 0
    s_lshl_b32 s3, s2, 7
    s_mov_b64 exec, 1
    buffer_store_dword v9, v10, s[76:79], s3 offen sc1
    s_mov_b64 exec, -1
    v_mov_b32 v11, 3
    ds_write_b32 v8, v11 offset:8
PB_4:
    s_branch P2
PW_next:
    s_sub_u32 s11, s10, 4
    s_and_b32 s16, s80, 0xff
    s_bfe_u32 s17, s80, 0x80008
    s_mov_b32 s71, 0x20000
    s_mov_b32 s75, 0x20000
    s_add_u32 s72, s84, 1048576
    s_addc_u32 s73, s85, 0
    s_mov_b32 s74, 4866048
    s_movk_i32 s7, 2304
    s_lshl_b32 s18, s17, 8
    s_lshl_b32 s19, s16, 8
    s_mov_b32 s14, 6
    s_add_u32 s4, s84, 31452672
    s_addc_u32 s5, s85, 0
    s_mov_b32 s70, 7962624
    s_movk_i32 s13, 6912
    s_cmp_ge_u32 s16, 18
    s_cselect_b32 s68, s4, s54
    s_cselect_b32 s69, s5, s55
    s_cselect_b32 s70, 2658816, s70
    s_cselect_b32 s13, 2304, s13
    s_cmp_eq_u32 s17, 8
    s_cselect_b32 s68, s56, s68
    s_cselect_b32 s69, s57, s69
    s_cselect_b32 s70, 7962624, s70
    s_cselect_b32 s13, 6912, s13
    s_cselect_b32 s14, 4, s14
    s_lshl_b32 s12, s11, s14
    s_add_u32 s18, s18, s12
    v_lshrrev_b32 v212, 3, v2
    v_add_u32 v213, s18, v212
    v_mul_lo_u32 v213, v213, s7
    v_lshrrev_b32 v212, 4, v2
    v_and_b32 v214, 7, v2
    v_xor_b32 v214, v214, v212
    v_lshl_add_u32 v200, v214, 4, v213
    v_xor_b32 v214, 4, v214
    v_lshl_add_u32 v201, v214, 4, v213
    s_lshl_b32 s3, s7, 3
    s_sub_u32 s3, s3, 1024
    v_add_u32 v201, s3, v201
    s_lshl_b32 s3, s3, 1
    v_add_u32 v202, s3, v200
    v_add_u32 v203, s3, v201
    s_lshl_b32 s3, s7, 5
    v_add_u32 v204, s3, v200
    v_add_u32 v205, s3, v201
    v_add_u32 v206, s3, v202
    v_add_u32 v207, s3, v203
    s_lshl_b32 s3, s11, 4
    v_add_u32 v213, s3, v212
    v_mul_lo_u32 v213, v213, s13
    v_add_u32 v213, s19, v213
    v_and_b32 v214, 1, v2
    v_lshl_add_u32 v213, v214, 4, v213
    v_bfe_u32 v214, v2, 1, 3
    v_xor_b32 v214, v214, v212
    v_lshl_add_u32 v208, v214, 5, v213
    s_lshl_b32 s3, s13, 2
    s_sub_u32 s3, s3, 1024
    v_add_u32 v209, s3, v208
    v_xor_b32 v214, 4, v214
    v_lshl_add_u32 v210, v214, 5, v213
    v_add_u32 v210, s3, v210
    v_add_u32 v210, s3, v210
    v_add_u32 v211, s3, v210
    s_lshl_b32 s101, s13, 6
    s_mov_b32 s62, 0
    s_mov_b32 s63, 0
    s_lshl_b32 s64, s12, 7
    s_lshl_b32 s65, s11, 12
    s_add_u32 s65, s65, 32768
    s_add_u32 s66, s64, 147456
    s_add_u32 s67, s65, 147456
P2:
    s_and_b32 s16, s80, 0xff
    s_bfe_u32 s17, s80, 0x80008
    s_cmp_ge_u32 s16, 18
    s_cselect_b32 s15, 1, 0
    s_cmp_ge_u32 s17, 8
    s_cselect_b32 s15, 0, s15
    s_cmp_eq_u32 s17, 9
    s_cbranch_scc1 P2_gate
    s_cmp_lt_u32 s10, 4
    s_cbranch_scc1 P2_cons
    s_cmp_eq_u32 s17, 10
    s_cbranch_scc1 P3
    s_cmp_eq_u32 s15, 1
    s_cbranch_scc1 P2_lv
    s_mov_b32 m0, s65
    s_add_u32 s65, s65, 49152
    buffer_load_dwordx4 v208, s[68:71], s63 offen offset:0 sc1 lds
    buffer_load_dwordx4 v209, s[68:71], s63 offen offset:1024 sc1 lds
    buffer_load_dwordx4 v210, s[68:71], s63 offen offset:2048 sc1 lds
    buffer_load_dwordx4 v211, s[68:71], s63 offen offset:3072 sc1 lds
    s_add_u32 s63, s63, s101
    s_cmp_eq_u32 s65, s67
    s_cselect_b32 s3, 147456, 0
    s_sub_u32 s65, s65, s3
    s_mov_b32 m0, s65
    s_add_u32 s65, s65, 49152
    buffer_load_dwordx4 v208, s[68:71], s63 offen offset:0 sc1 lds
    buffer_load_dwordx4 v209, s[68:71], s63 offen offset:1024 sc1 lds
    buffer_load_dwordx4 v210, s[68:71], s63 offen offset:2048 sc1 lds
    buffer_load_dwordx4 v211, s[68:71], s63 offen offset:3072 sc1 lds
    s_add_u32 s63, s63, s101
    s_cmp_eq_u32 s65, s67
    s_cselect_b32 s3, 147456, 0
    s_sub_u32 s65, s65, s3
    s_mov_b32 m0, s65
    s_add_u32 s65, s65, 49152
    buffer_load_dwordx4 v208, s[68:71], s63 offen offset:0 sc1 lds
    buffer_load_dwordx4 v209, s[68:71], s63 offen offset:1024 sc1 lds
    buffer_load_dwordx4 v210, s[68:71], s63 offen offset:2048 sc1 lds
    buffer_load_dwordx4 v211, s[68:71], s63 offen offset:3072 sc1 lds
    s_add_u32 s63, s63, s101
    s_cmp_eq_u32 s65, s67
    s_cselect_b32 s3, 147456, 0
    s_sub_u32 s65, s65, s3
    s_cmp_lg_u32 s10, 4
    s_cbranch_scc1 LD_5
    v_and_b32 v8, 0xff, v250
    v_lshlrev_b32 v8, 7, v8
    v_lshrrev_b32 v9, 8, v250
    v_readfirstlane_b32 s3, v250
    v_cmp_lt_u32 vcc, 7, v9
    s_nop 0
    v_mov_b32 v10, s3
    v_cndmask_b32 v10, v250, v10, vcc
    v_and_b32 v8, 0xff, v10
    v_lshlrev_b32 v8, 7, v8
    v_lshrrev_b32 v9, 8, v10
    v_add_u32 v9, s86, v9
    s_mov_b32 s3, 0x400000
POLL_7:
    buffer_load_dword v10, v8, s[76:79], 0 offen sc1
    s_sub_u32 s3, s3, 1
    s_waitcnt vmcnt(0)
    v_sub_u32 v10, v10, v9
    v_cmp_lt_u32 vcc, 7, v10
    s_nop 0
    s_cbranch_vccz POLLE_8
    s_cmp_eq_u32 s3, 0
    s_cbranch_scc1 POLLE_8
    s_nop 0
    s_branch POLL_7
POLLE_8:
    v_mov_b32 v8, 147460
    v_mov_b32 v9, 4
    ds_write_b32 v8, v9
    s_branch LDE_6
LD_5:
    v_mov_b32 v8, 147460
    s_mov_b32 s3, 0x2000000
LW_9:
    ds_read_b32 v9, v8
    s_sub_u32 s3, s3, 1
    s_waitcnt lgkmcnt(0)
    v_cmp_le_u32 vcc, 4, v9
    s_cmp_eq_u32 s3, 0
    s_cbranch_scc1 LWE_10
    s_cbranch_vccnz LWE_10
    s_sleep 1
    s_branch LW_9
LWE_10:
    s_waitcnt vmcnt(0)
LDE_6:
    s_cmp_eq_u32 s17, 8
    s_cbranch_scc1 P2_lt
    s_mov_b32 m0, s64
    s_add_u32 s64, s64, 49152
    buffer_load_dwordx4 v200, s[72:75], s62 offen offset:0 sc1 lds
    buffer_load_dwordx4 v201, s[72:75], s62 offen offset:1024 sc1 lds
    buffer_load_dwordx4 v202, s[72:75], s62 offen offset:2048 sc1 lds
    buffer_load_dwordx4 v203, s[72:75], s62 offen offset:3072 sc1 lds
    s_add_u32 m0, m0, 4096
    s_nop 0
    buffer_load_dwordx4 v204, s[72:75], s62 offen offset:0 sc1 lds
    buffer_load_dwordx4 v205, s[72:75], s62 offen offset:1024 sc1 lds
    buffer_load_dwordx4 v206, s[72:75], s62 offen offset:2048 sc1 lds
    buffer_load_dwordx4 v207, s[72:75], s62 offen offset:3072 sc1 lds
    s_cmp_eq_u32 s64, s66
    s_cselect_b32 s3, 147456, 0
    s_sub_u32 s64, s64, s3
    s_add_u32 s62, s62, 128
    s_mov_b32 m0, s64
    s_add_u32 s64, s64, 49152
    buffer_load_dwordx4 v200, s[72:75], s62 offen offset:0 sc1 lds
    buffer_load_dwordx4 v201, s[72:75], s62 offen offset:1024 sc1 lds
    buffer_load_dwordx4 v202, s[72:75], s62 offen offset:2048 sc1 lds
    buffer_load_dwordx4 v203, s[72:75], s62 offen offset:3072 sc1 lds
    s_add_u32 m0, m0, 4096
    s_nop 0
    buffer_load_dwordx4 v204, s[72:75], s62 offen offset:0 sc1 lds
    buffer_load_dwordx4 v205, s[72:75], s62 offen offset:1024 sc1 lds
    buffer_load_dwordx4 v206, s[72:75], s62 offen offset:2048 sc1 lds
    buffer_load_dwordx4 v207, s[72:75], s62 offen offset:3072 sc1 lds
    s_cmp_eq_u32 s64, s66
    s_cselect_b32 s3, 147456, 0
    s_sub_u32 s64, s64, s3
    s_add_u32 s62, s62, 128
    s_waitcnt vmcnt(8)
    s_barrier
    s_mov_b32 m0, s64
    s_add_u32 s64, s64, 49152
    buffer_load_dwordx4 v200, s[72:75], s62 offen offset:0 sc1 lds
    buffer_load_dwordx4 v201, s[72:75], s62 offen offset:1024 sc1 lds
    buffer_load_dwordx4 v202, s[72:75], s62 offen offset:2048 sc1 lds
    buffer_load_dwordx4 v203, s[72:75], s62 offen offset:3072 sc1 lds
    s_add_u32 m0, m0, 4096
    s_nop 0
    buffer_load_dwordx4 v204, s[72:75], s62 offen offset:0 sc1 lds
    buffer_load_dwordx4 v205, s[72:75], s62 offen offset:1024 sc1 lds
    buffer_load_dwordx4 v206, s[72:75], s62 offen offset:2048 sc1 lds
    buffer_load_dwordx4 v207, s[72:75], s62 offen offset:3072 sc1 lds
    s_cmp_eq_u32 s64, s66
    s_cselect_b32 s3, 147456, 0
    s_sub_u32 s64, s64, s3
    s_add_u32 s62, s62, 128
    s_waitcnt vmcnt(8)
    s_barrier
    s_mov_b32 m0, s64
    s_add_u32 s64, s64, 49152
    buffer_load_dwordx4 v200, s[72:75], s62 offen offset:0 sc1 lds
    buffer_load_dwordx4 v201, s[72:75], s62 offen offset:1024 sc1 lds
    buffer_load_dwordx4 v202, s[72:75], s62 offen offset:2048 sc1 lds
    buffer_load_dwordx4 v203, s[72:75], s62 offen offset:3072 sc1 lds
    s_add_u32 m0, m0, 4096
    s_nop 0
    buffer_load_dwordx4 v204, s[72:75], s62 offen offset:0 sc1 lds
    buffer_load_dwordx4 v205, s[72:75], s62 offen offset:1024 sc1 lds
    buffer_load_dwordx4 v206, s[72:75], s62 offen offset:2048 sc1 lds
    buffer_load_dwordx4 v207, s[72:75], s62 offen offset:3072 sc1 lds
    s_cmp_eq_u32 s64, s66
    s_cselect_b32 s3, 147456, 0
    s_sub_u32 s64, s64, s3
    s_add_u32 s62, s62, 128
    s_mov_b32 m0, s65
    s_add_u32 s65, s65, 49152
    buffer_load_dwordx4 v208, s[68:71], s63 offen offset:0 sc1 lds
    buffer_load_dwordx4 v209, s[68:71], s63 offen offset:1024 sc1 lds
    buffer_load_dwordx4 v210, s[68:71], s63 offen offset:2048 sc1 lds
    buffer_load_dwordx4 v211, s[68:71], s63 offen offset:3072 sc1 lds
    s_add_u32 s63, s63, s101
    s_cmp_eq_u32 s65, s67
    s_cselect_b32 s3, 147456, 0
    s_sub_u32 s65, s65, s3
P2_join:
    s_mov_b32 s60, 14
P2_lloop:
    s_waitcnt vmcnt(12)
    s_barrier
    s_mov_b32 m0, s64
    s_add_u32 s64, s64, 49152
    buffer_load_dwordx4 v200, s[72:75], s62 offen offset:0 sc1 lds
    buffer_load_dwordx4 v201, s[72:75], s62 offen offset:1024 sc1 lds
    buffer_load_dwordx4 v202, s[72:75], s62 offen offset:2048 sc1 lds
    buffer_load_dwordx4 v203, s[72:75], s62 offen offset:3072 sc1 lds
    s_add_u32 m0, m0, 4096
    s_nop 0
    buffer_load_dwordx4 v204, s[72:75], s62 offen offset:0 sc1 lds
    buffer_load_dwordx4 v205, s[72:75], s62 offen offset:1024 sc1 lds
    buffer_load_dwordx4 v206, s[72:75], s62 offen offset:2048 sc1 lds
    buffer_load_dwordx4 v207, s[72:75], s62 offen offset:3072 sc1 lds
    s_cmp_eq_u32 s64, s66
    s_cselect_b32 s3, 147456, 0
    s_sub_u32 s64, s64, s3
    s_add_u32 s62, s62, 128
    s_mov_b32 m0, s65
    s_add_u32 s65, s65, 49152
    buffer_load_dwordx4 v208, s[68:71], s63 offen offset:0 sc1 lds
    buffer_load_dwordx4 v209, s[68:71], s63 offen offset:1024 sc1 lds
    buffer_load_dwordx4 v210, s[68:71], s63 offen offset:2048 sc1 lds
    buffer_load_dwordx4 v211, s[68:71], s63 offen offset:3072 sc1 lds
    s_add_u32 s63, s63, s101
    s_cmp_eq_u32 s65, s67
    s_cselect_b32 s3, 147456, 0
    s_sub_u32 s65, s65, s3
    s_sub_u32 s60, s60, 1
    s_cmp_lg_u32 s60, 0
    s_cbranch_scc1 P2_lloop
    s_bfe_u32 s12, s82, 0x40004
    s_lshl_b32 s12, s12, 3
    s_bfe_u32 s3, s82, 0x80008
    s_add_u32 s12, s12, s3
    s_lshl_b32 s12, s12, 2
    s_add_u32 s12, s12, s11
    s_mul_i32 s12, s12, 73728
    s_lshr_b32 s3, s82, 16
    s_mul_i32 s3, s3, 192
    s_add_u32 s12, s12, s3
    v_and_b32 v8, 15, v2
    v_mul_u32_u24 v8, 2304, v8
    v_lshrrev_b32 v9, 4, v2
    v_lshl_add_u32 v8, v9, 4, v8
    v_add_u32 v9, 36864, v8
    s_mov_b32 s20, s48
    s_mov_b32 s21, s49
    s_mov_b32 s22, 0x480000
    s_mov_b32 s23, 0x20000
    s_and_b32 s3, s82, 15
    s_cselect_b32 s22, 0, s22
    s_cselect_b32 s12, 0, s12
    buffer_load_dwordx4 v[216:219], v8, s[20:23], s12 offen offset:0
    buffer_load_dwordx4 v[220:223], v8, s[20:23], s12 offen offset:64
    buffer_load_dwordx4 v[224:227], v8, s[20:23], s12 offen offset:128
    buffer_load_dwordx4 v[228:231], v9, s[20:23], s12 offen offset:0
    buffer_load_dwordx4 v[232:235], v9, s[20:23], s12 offen offset:64
    buffer_load_dwordx4 v[236:239], v9, s[20:23], s12 offen offset:128
    s_waitcnt vmcnt(18)
    s_barrier
    s_waitcnt vmcnt(6)
    s_barrier
    s_barrier
    s_branch P3
P2_lt:
    s_mov_b32 m0, s64
    s_add_u32 s64, s64, 49152
    buffer_load_dwordx4 v200, s[72:75], s62 offen offset:0 sc1 lds
    buffer_load_dwordx4 v201, s[72:75], s62 offen offset:1024 sc1 lds
    s_cmp_eq_u32 s64, s66
    s_cselect_b32 s3, 147456, 0
    s_sub_u32 s64, s64, s3
    s_add_u32 s62, s62, 128
    s_mov_b32 m0, s64
    s_add_u32 s64, s64, 49152
    buffer_load_dwordx4 v200, s[72:75], s62 offen offset:0 sc1 lds
    buffer_load_dwordx4 v201, s[72:75], s62 offen offset:1024 sc1 lds
    s_cmp_eq_u32 s64, s66
    s_cselect_b32 s3, 147456, 0
    s_sub_u32 s64, s64, s3
    s_add_u32 s62, s62, 128
    s_waitcnt vmcnt(2)
    s_barrier
    s_mov_b32 m0, s64
    s_add_u32 s64, s64, 49152
    buffer_load_dwordx4 v200, s[72:75], s62 offen offset:0 sc1 lds
    buffer_load_dwordx4 v201, s[72:75], s62 offen offset:1024 sc1 lds
    s_cmp_eq_u32 s64, s66
    s_cselect_b32 s3, 147456, 0
    s_sub_u32 s64, s64, s3
    s_add_u32 s62, s62, 128
    s_waitcnt vmcnt(2)
    s_barrier
    s_mov_b32 m0, s64
    s_add_u32 s64, s64, 49152
    buffer_load_dwordx4 v200, s[72:75], s62 offen offset:0 sc1 lds
    buffer_load_dwordx4 v201, s[72:75], s62 offen offset:1024 sc1 lds
    s_cmp_eq_u32 s64, s66
    s_cselect_b32 s3, 147456, 0
    s_sub_u32 s64, s64, s3
    s_add_u32 s62, s62, 128
    s_mov_b32 m0, s65
    s_add_u32 s65, s65, 49152
    buffer_load_dwordx4 v208, s[68:71], s63 offen offset:0 sc1 lds
    buffer_load_dwordx4 v209, s[68:71], s63 offen offset:1024 sc1 lds
    buffer_load_dwordx4 v210, s[68:71], s63 offen offset:2048 sc1 lds
    buffer_load_dwordx4 v211, s[68:71], s63 offen offset:3072 sc1 lds
    s_add_u32 s63, s63, s101
    s_cmp_eq_u32 s65, s67
    s_cselect_b32 s3, 147456, 0
    s_sub_u32 s65, s65, s3
    s_mov_b32 s60, 14
P2T_lloop:
    s_waitcnt vmcnt(6)
    s_barrier
    s_mov_b32 m0, s64
    s_add_u32 s64, s64, 49152
    buffer_load_dwordx4 v200, s[72:75], s62 offen offset:0 sc1 lds
    buffer_load_dwordx4 v201, s[72:75], s62 offen offset:1024 sc1 lds
    s_cmp_eq_u32 s64, s66
    s_cselect_b32 s3, 147456, 0
    s_sub_u32 s64, s64, s3
    s_add_u32 s62, s62, 128
    s_mov_b32 m0, s65
    s_add_u32 s65, s65, 49152
    buffer_load_dwordx4 v208, s[68:71], s63 offen offset:0 sc1 lds
    buffer_load_dwordx4 v209, s[68:71], s63 offen offset:1024 sc1 lds
    buffer_load_dwordx4 v210, s[68:71], s63 offen offset:2048 sc1 lds
    buffer_load_dwordx4 v211, s[68:71], s63 offen offset:3072 sc1 lds
    s_add_u32 s63, s63, s101
    s_cmp_eq_u32 s65, s67
    s_cselect_b32 s3, 147456, 0
    s_sub_u32 s65, s65, s3
    s_sub_u32 s60, s60, 1
    s_cmp_lg_u32 s60, 0
    s_cbranch_scc1 P2T_lloop
    s_waitcnt vmcnt(6)
    s_barrier
    s_waitcnt vmcnt(0)
    s_barrier
    s_barrier
    s_branch PX
P2_lv:
    s_load_dwordx2 s[4:5], s[0:1], 48
    v_mov_b32 v8, 147464
    s_mov_b32 s3, 0x2000000
LW_11:
    ds_read_b32 v9, v8
    s_sub_u32 s3, s3, 1
    s_waitcnt lgkmcnt(0)
    v_cmp_le_u32 vcc, 3, v9
    s_cmp_eq_u32 s3, 0
    s_cbranch_scc1 LWE_12
    s_cbranch_vccnz LWE_12
    s_sleep 1
    s_branch LW_11
LWE_12:
    s_mov_b32 s20, s4
    s_mov_b32 s21, s5
    s_mov_b32 s22, 0x288000
    s_mov_b32 s23, 0x20000
    s_sub_u32 s3, s2, 144
    s_lshl_b32 s3, s3, 2
    s_add_u32 s3, s3, s11
    s_mul_i32 s3, s3, 9216
    v_lshlrev_b32 v8, 7, v2
    v_min_u32 v9, 896, v8
    buffer_load_dword v199, v8, s[20:23], s3 offen
    s_add_u32 s3, s3, 8192
    buffer_load_dword v199, v9, s[20:23], s3 offen
    s_cmp_lg_u32 s10, 4
    s_cbranch_scc1 LD_13
    v_and_b32 v8, 0xff, v250
    v_lshlrev_b32 v8, 7, v8
    v_lshrrev_b32 v9, 8, v250
    v_add_u32 v9, s86, v9
    s_mov_b32 s3, 0x400000
POLL_15:
    buffer_load_dword v10, v8, s[76:79], 0 offen sc1
    s_sub_u32 s3, s3, 1
    s_waitcnt vmcnt(0)
    v_sub_u32 v10, v10, v9
    v_cmp_lt_u32 vcc, 7, v10
    s_nop 0
    s_cbranch_vccz POLLE_16
    s_cmp_eq_u32 s3, 0
    s_cbranch_scc1 POLLE_16
    s_nop 0
    s_branch POLL_15
POLLE_16:
    v_mov_b32 v8, 147460
    v_mov_b32 v9, 4
    ds_write_b32 v8, v9
    s_branch LDE_14
LD_13:
    v_mov_b32 v8, 147460
    s_mov_b32 s3, 0x2000000
LW_17:
    ds_read_b32 v9, v8
    s_sub_u32 s3, s3, 1
    s_waitcnt lgkmcnt(0)
    v_cmp_le_u32 vcc, 4, v9
    s_cmp_eq_u32 s3, 0
    s_cbranch_scc1 LWE_18
    s_cbranch_vccnz LWE_18
    s_sleep 1
    s_branch LW_17
LWE_18:
    s_waitcnt vmcnt(0)
LDE_14:
    s_mov_b32 m0, s64
    s_add_u32 s64, s64, 49152
    buffer_load_dwordx4 v200, s[72:75], s62 offen offset:0 sc1 lds
    buffer_load_dwordx4 v201, s[72:75], s62 offen offset:1024 sc1 lds
    buffer_load_dwordx4 v202, s[72:75], s62 offen offset:2048 sc1 lds
    buffer_load_dwordx4 v203, s[72:75], s62 offen offset:3072 sc1 lds
    s_add_u32 m0, m0, 4096
    s_nop 0
    buffer_load_dwordx4 v204, s[72:75], s62 offen offset:0 sc1 lds
    buffer_load_dwordx4 v205, s[72:75], s62 offen offset:1024 sc1 lds
    buffer_load_dwordx4 v206, s[72:75], s62 offen offset:2048 sc1 lds
    buffer_load_dwordx4 v207, s[72:75], s62 offen offset:3072 sc1 lds
    s_cmp_eq_u32 s64, s66
    s_cselect_b32 s3, 147456, 0
    s_sub_u32 s64, s64, s3
    s_add_u32 s62, s62, 128
    s_mov_b32 m0, s65
    s_add_u32 s65, s65, 49152
    buffer_load_dwordx4 v208, s[68:71], s63 offen offset:0 sc1 lds
    buffer_load_dwordx4 v209, s[68:71], s63 offen offset:1024 sc1 lds
    buffer_load_dwordx4 v210, s[68:71], s63 offen offset:2048 sc1 lds
    buffer_load_dwordx4 v211, s[68:71], s63 offen offset:3072 sc1 lds
    s_add_u32 s63, s63, s101
    s_cmp_eq_u32 s65, s67
    s_cselect_b32 s3, 147456, 0
    s_sub_u32 s65, s65, s3
    s_mov_b32 m0, s64
    s_add_u32 s64, s64, 49152
    buffer_load_dwordx4 v200, s[72:75], s62 offen offset:0 sc1 lds
    buffer_load_dwordx4 v201, s[72:75], s62 offen offset:1024 sc1 lds
    buffer_load_dwordx4 v202, s[72:75], s62 offen offset:2048 sc1 lds
    buffer_load_dwordx4 v203, s[72:75], s62 offen offset:3072 sc1 lds
    s_add_u32 m0, m0, 4096
    s_nop 0
    buffer_load_dwordx4 v204, s[72:75], s62 offen offset:0 sc1 lds
    buffer_load_dwordx4 v205, s[72:75], s62 offen offset:1024 sc1 lds
    buffer_load_dwordx4 v206, s[72:75], s62 offen offset:2048 sc1 lds
    buffer_load_dwordx4 v207, s[72:75], s62 offen offset:3072 sc1 lds
    s_cmp_eq_u32 s64, s66
    s_cselect_b32 s3, 147456, 0
    s_sub_u32 s64, s64, s3
    s_add_u32 s62, s62, 128
    s_mov_b32 m0, s65
    s_add_u32 s65, s65, 49152
    buffer_load_dwordx4 v208, s[68:71], s63 offen offset:0 sc1 lds
    buffer_load_dwordx4 v209, s[68:71], s63 offen offset:1024 sc1 lds
    buffer_load_dwordx4 v210, s[68:71], s63 offen offset:2048 sc1 lds
    buffer_load_dwordx4 v211, s[68:71], s63 offen offset:3072 sc1 lds
    s_add_u32 s63, s63, s101
    s_cmp_eq_u32 s65, s67
    s_cselect_b32 s3, 147456, 0
    s_sub_u32 s65, s65, s3
    s_waitcnt vmcnt(12)
    s_barrier
    s_mov_b32 m0, s64
    s_add_u32 s64, s64, 49152
    buffer_load_dwordx4 v200, s[72:75], s62 offen offset:0 sc1 lds
    buffer_load_dwordx4 v201, s[72:75], s62 offen offset:1024 sc1 lds
    buffer_load_dwordx4 v202, s[72:75], s62 offen offset:2048 sc1 lds
    buffer_load_dwordx4 v203, s[72:75], s62 offen offset:3072 sc1 lds
    s_add_u32 m0, m0, 4096
    s_nop 0
    buffer_load_dwordx4 v204, s[72:75], s62 offen offset:0 sc1 lds
    buffer_load_dwordx4 v205, s[72:75], s62 offen offset:1024 sc1 lds
    buffer_load_dwordx4 v206, s[72:75], s62 offen offset:2048 sc1 lds
    buffer_load_dwordx4 v207, s[72:75], s62 offen offset:3072 sc1 lds
    s_cmp_eq_u32 s64, s66
    s_cselect_b32 s3, 147456, 0
    s_sub_u32 s64, s64, s3
    s_add_u32 s62, s62, 128
    s_mov_b32 m0, s65
    s_add_u32 s65, s65, 49152
    buffer_load_dwordx4 v208, s[68:71], s63 offen offset:0 sc1 lds
    buffer_load_dwordx4 v209, s[68:71], s63 offen offset:1024 sc1 lds
    buffer_load_dwordx4 v210, s[68:71], s63 offen offset:2048 sc1 lds
    buffer_load_dwordx4 v211, s[68:71], s63 offen offset:3072 sc1 lds
    s_add_u32 s63, s63, s101
    s_cmp_eq_u32 s65, s67
    s_cselect_b32 s3, 147456, 0
    s_sub_u32 s65, s65, s3
    s_mov_b32 s60, 15
P2V_lloop:
    s_waitcnt vmcnt(12)
    s_barrier
    s_mov_b32 m0, s64
    s_add_u32 s64, s64, 49152
    buffer_load_dwordx4 v200, s[72:75], s62 offen offset:0 sc1 lds
    buffer_load_dwordx4 v201, s[72:75], s62 offen offset:1024 sc1 lds
    buffer_load_dwordx4 v202, s[72:75], s62 offen offset:2048 sc1 lds
    buffer_load_dwordx4 v203, s[72:75], s62 offen offset:3072 sc1 lds
    s_add_u32 m0, m0, 4096
    s_nop 0
    buffer_load_dwordx4 v204, s[72:75], s62 offen offset:0 sc1 lds
    buffer_load_dwordx4 v205, s[72:75], s62 offen offset:1024 sc1 lds
    buffer_load_dwordx4 v206, s[72:75], s62 offen offset:2048 sc1 lds
    buffer_load_dwordx4 v207, s[72:75], s62 offen offset:3072 sc1 lds
    s_cmp_eq_u32 s64, s66
    s_cselect_b32 s3, 147456, 0
    s_sub_u32 s64, s64, s3
    s_add_u32 s62, s62, 128
    s_mov_b32 m0, s65
    s_add_u32 s65, s65, 49152
    buffer_load_dwordx4 v208, s[68:71], s63 offen offset:0 sc1 lds
    buffer_load_dwordx4 v209, s[68:71], s63 offen offset:1024 sc1 lds
    buffer_load_dwordx4 v210, s[68:71], s63 offen offset:2048 sc1 lds
    buffer_load_dwordx4 v211, s[68:71], s63 offen offset:3072 sc1 lds
    s_add_u32 s63, s63, s101
    s_cmp_eq_u32 s65, s67
    s_cselect_b32 s3, 147456, 0
    s_sub_u32 s65, s65, s3
    s_sub_u32 s60, s60, 1
    s_cmp_lg_u32 s60, 0
    s_cbranch_scc1 P2V_lloop
    s_bfe_u32 s12, s82, 0x40004
    s_lshl_b32 s12, s12, 3
    s_bfe_u32 s3, s82, 0x80008
    s_add_u32 s12, s12, s3
    s_lshl_b32 s12, s12, 2
    s_add_u32 s12, s12, s11
    s_mul_i32 s12, s12, 73728
    s_lshr_b32 s3, s82, 16
    s_mul_i32 s3, s3, 192
    s_add_u32 s12, s12, s3
    v_and_b32 v8, 15, v2
    v_mul_u32_u24 v8, 2304, v8
    v_lshrrev_b32 v9, 4, v2
    v_lshl_add_u32 v8, v9, 4, v8
    v_add_u32 v9, 36864, v8
    s_mov_b32 s20, s48
    s_mov_b32 s21, s49
    s_mov_b32 s22, 0x480000
    s_mov_b32 s23, 0x20000
    s_and_b32 s3, s82, 15
    s_cselect_b32 s22, 0, s22
    s_cselect_b32 s12, 0, s12
    buffer_load_dwordx4 v[216:219], v8, s[20:23], s12 offen offset:0
    buffer_load_dwordx4 v[220:223], v8, s[20:23], s12 offen offset:64
    buffer_load_dwordx4 v[224:227], v8, s[20:23], s12 offen offset:128
    buffer_load_dwordx4 v[228:231], v9, s[20:23], s12 offen offset:0
    buffer_load_dwordx4 v[232:235], v9, s[20:23], s12 offen offset:64
    buffer_load_dwordx4 v[236:239], v9, s[20:23], s12 offen offset:128
    s_waitcnt vmcnt(18)
    s_barrier
    s_waitcnt vmcnt(6)
    s_barrier
    s_barrier
    s_branch P3
P2_cons:
    s_cmp_eq_u32 s17, 10
    s_cbranch_scc1 P2_fin
    s_lshr_b32 s18, s10, 1
    s_and_b32 s19, s10, 1
    s_lshl_b32 s42, s19, 14
    v_lshrrev_b32 v4, 4, v2
    v_bfe_u32 v5, v2, 1, 3
    v_xor_b32 v5, v5, v4
    v_and_b32 v6, 15, v2
    v_lshlrev_b32 v6, 7, v6
    v_lshl_add_u32 v6, v5, 4, v6
    v_add_u32 v112, s42, v6
    v_bfe_u32 v5, v2, 2, 2
    v_lshl_add_u32 v6, v4, 3, v5
    v_lshlrev_b32 v6, 8, v6
    v_add_u32 v6, 32768, v6
    v_and_b32 v4, 1, v4
    v_xor_b32 v4, s18, v4
    v_lshl_add_u32 v6, v4, 7, v6
    v_and_b32 v7, 3, v2
    v_lshl_add_u32 v6, v7, 3, v6
    v_xor_b32 v7, 0, v5
    v_lshl_add_u32 v113, v7, 5, v6
    v_xor_b32 v7, 1, v5
    v_lshl_add_u32 v114, v7, 5, v6
    v_xor_b32 v7, 2, v5
    v_lshl_add_u32 v115, v7, 5, v6
    v_xor_b32 v7, 3, v5
    v_lshl_add_u32 v116, v7, 5, v6
    v_mov_b32 v117, v112
    v_xor_b32 v124, 64, v112
    v_mov_b32 v118, v113
    v_mov_b32 v119, v114
    v_mov_b32 v120, v115
    v_mov_b32 v121, v116
    v_mov_b64 v[128:129], 0
    v_mov_b64 v[130:131], 0
    v_mov_b64 v[132:133], 0
    v_mov_b64 v[134:135], 0
    v_mov_b64 v[136:137], 0
    v_mov_b64 v[138:139], 0
    v_mov_b64 v[140:141], 0
    v_mov_b64 v[142:143], 0
    v_mov_b64 v[144:145], 0
    v_mov_b64 v[146:147], 0
    v_mov_b64 v[148:149], 0
    v_mov_b64 v[150:151], 0
    v_mov_b64 v[152:153], 0
    v_mov_b64 v[154:155], 0
    v_mov_b64 v[156:157], 0
    v_mov_b64 v[158:159], 0
    v_mov_b64 v[160:161], 0
    v_mov_b64 v[162:163], 0
    v_mov_b64 v[164:165], 0
    v_mov_b64 v[166:167], 0
    v_mov_b64 v[168:169], 0
    v_mov_b64 v[170:171], 0
    v_mov_b64 v[172:173], 0
    v_mov_b64 v[174:175], 0
    v_mov_b64 v[176:177], 0
    v_mov_b64 v[178:179], 0
    v_mov_b64 v[180:181], 0
    v_mov_b64 v[182:183], 0
    v_mov_b64 v[184:185], 0
    v_mov_b64 v[186:187], 0
    v_mov_b64 v[188:189], 0
    v_mov_b64 v[190:191], 0
    v_mov_b64 v[192:193], 0
    v_mov_b64 v[194:195], 0
    v_mov_b64 v[196:197], 0
    v_mov_b64 v[198:199], 0
    v_mov_b64 v[200:201], 0
    v_mov_b64 v[202:203], 0
    v_mov_b64 v[204:205], 0
    v_mov_b64 v[206:207], 0
    v_mov_b64 v[208:209], 0
    v_mov_b64 v[210:211], 0
    v_mov_b64 v[212:213], 0
    v_mov_b64 v[214:215], 0
    v_mov_b64 v[216:217], 0
    v_mov_b64 v[218:219], 0
    v_mov_b64 v[220:221], 0
    v_mov_b64 v[222:223], 0
    v_mov_b64 v[224:225], 0
    v_mov_b64 v[226:227], 0
    v_mov_b64 v[228:229], 0
    v_mov_b64 v[230:231], 0
    v_mov_b64 v[232:233], 0
    v_mov_b64 v[234:235], 0
    v_mov_b64 v[236:237], 0
    v_mov_b64 v[238:239], 0
    v_mov_b64 v[240:241], 0
    v_mov_b64 v[242:243], 0
    v_mov_b64 v[244:245], 0
    v_mov_b64 v[246:247], 0
    v_mov_b64 v[248:249], 0
    v_mov_b64 v[250:251], 0
    v_mov_b64 v[252:253], 0
    v_mov_b64 v[254:255], 0
    s_mov_b32 s44, 0
    s_mov_b32 s45, 18
    s_cmp_eq_u32 s15, 1
    s_cbranch_scc1 P2_cv
    s_add_u32 s28, s84, 0x600000
    s_addc_u32 s29, s85, 0
    s_mov_b32 s30, 0xdec000
    s_mov_b32 s31, 0x20000
    s_mul_i32 s43, s16, 7282
    s_lshr_b32 s43, s43, 16
    s_mul_i32 s41, s43, 9
    s_sub_u32 s41, s16, s41
    s_lshl_b32 s46, s41, 8
    s_lshl_b32 s41, s41, 2
    s_lshl_b32 s42, s18, 1
    s_add_u32 s41, s41, s42
    s_lshl_b32 s41, s41, 10
    s_mul_i32 s43, s43, 4866048
    s_add_u32 s41, s41, s43
    s_lshr_b32 s43, s17, 2
    s_mul_i32 s43, s43, 66
    s_and_b32 s42, s17, 3
    s_lshl_b32 s42, s42, 4
    s_add_u32 s43, s43, s42
    s_lshl_b32 s42, s19, 3
    s_add_u32 s43, s43, s42
    s_cmp_eq_u32 s17, 8
    s_cselect_b32 s43, 64, s43
    s_mul_i32 s43, s43, 36864
    s_add_u32 s41, s41, s43
    s_cmp_eq_u32 s17, 8
    s_cbranch_scc1 P2_txt
    s_mov_b32 s45, 17
    s_barrier
    ds_read_b64_tr_b16 v[16:17], v118 offset:0
    ds_read_b64_tr_b16 v[18:19], v118 offset:1024
    ds_read_b128 v[32:35], v117 offset:0
    ds_read_b128 v[36:39], v117 offset:2048
    ds_read_b128 v[40:43], v117 offset:4096
    ds_read_b64_tr_b16 v[20:21], v119 offset:0
    ds_read_b64_tr_b16 v[22:23], v119 offset:1024
    ds_read_b128 v[44:47], v117 offset:6144
    ds_read_b128 v[48:51], v117 offset:8192
    ds_read_b128 v[52:55], v117 offset:10240
    ds_read_b64_tr_b16 v[24:25], v120 offset:0
    ds_read_b64_tr_b16 v[26:27], v120 offset:1024
    ds_read_b128 v[56:59], v117 offset:12288
    ds_read_b128 v[60:63], v117 offset:14336
    ds_read_b64_tr_b16 v[28:29], v121 offset:0
    ds_read_b64_tr_b16 v[30:31], v121 offset:1024
    s_branch P2_mid
P2_loop:
    v_mfma_f32_16x16x32_bf16 v[128:131], v[64:67], v[80:83], v[128:131]
    v_mfma_f32_16x16x32_bf16 v[132:135], v[64:67], v[84:87], v[132:135]
    s_barrier
    v_mfma_f32_16x16x32_bf16 v[136:139], v[64:67], v[88:91], v[136:139]
    ds_read_b64_tr_b16 v[16:17], v118 offset:0
    v_mfma_f32_16x16x32_bf16 v[140:143], v[64:67], v[92:95], v[140:143]
    ds_read_b64_tr_b16 v[18:19], v118 offset:1024
    v_mfma_f32_16x16x32_bf16 v[144:147], v[64:67], v[96:99], v[144:147]
    ds_read_b128 v[32:35], v117 offset:0
    v_mfma_f32_16x16x32_bf16 v[148:151], v[64:67], v[100:103], v[148:151]
    ds_read_b128 v[36:39], v117 offset:2048
    v_mfma_f32_16x16x32_bf16 v[152:155], v[64:67], v[104:107], v[152:155]
    v_mfma_f32_16x16x32_bf16 v[156:159], v[64:67], v[108:111], v[156:159]
    ds_read_b128 v[40:43], v117 offset:4096
    v_mfma_f32_16x16x32_bf16 v[160:163], v[68:71], v[80:83], v[160:163]
    ds_read_b64_tr_b16 v[20:21], v119 offset:0
    v_mfma_f32_16x16x32_bf16 v[164:167], v[68:71], v[84:87], v[164:167]
    ds_read_b64_tr_b16 v[22:23], v119 offset:1024
    v_mfma_f32_16x16x32_bf16 v[168:171], v[68:71], v[88:91], v[168:171]
    v_mfma_f32_16x16x32_bf16 v[172:175], v[68:71], v[92:95], v[172:175]
    ds_read_b128 v[44:47], v117 offset:6144
    v_mfma_f32_16x16x32_bf16 v[176:179], v[68:71], v[96:99], v[176:179]
    ds_read_b128 v[48:51], v117 offset:8192
    v_mfma_f32_16x16x32_bf16 v[180:183], v[68:71], v[100:103], v[180:183]
    ds_read_b128 v[52:55], v117 offset:10240
    v_mfma_f32_16x16x32_bf16 v[184:187], v[68:71], v[104:107], v[184:187]
    v_mfma_f32_16x16x32_bf16 v[188:191], v[68:71], v[108:111], v[188:191]
    ds_read_b64_tr_b16 v[24:25], v120 offset:0
    v_mfma_f32_16x16x32_bf16 v[192:195], v[72:75], v[80:83], v[192:195]
    ds_read_b64_tr_b16 v[26:27], v120 offset:1024
    v_mfma_f32_16x16x32_bf16 v[196:199], v[72:75], v[84:87], v[196:199]
    ds_read_b128 v[56:59], v117 offset:12288
    v_mfma_f32_16x16x32_bf16 v[200:203], v[72:75], v[88:91], v[200:203]
    ds_read_b128 v[60:63], v117 offset:14336
    v_mfma_f32_16x16x32_bf16 v[204:207], v[72:75], v[92:95], v[204:207]
    v_mfma_f32_16x16x32_bf16 v[208:211], v[72:75], v[96:99], v[208:211]
    ds_read_b64_tr_b16 v[28:29], v121 offset:0
    v_mfma_f32_16x16x32_bf16 v[212:215], v[72:75], v[100:103], v[212:215]
    ds_read_b64_tr_b16 v[30:31], v121 offset:1024
    v_mfma_f32_16x16x32_bf16 v[216:219], v[72:75], v[104:107], v[216:219]
    v_mfma_f32_16x16x32_bf16 v[220:223], v[72:75], v[108:111], v[220:223]
    v_mfma_f32_16x16x32_bf16 v[224:227], v[76:79], v[80:83], v[224:227]
    v_mfma_f32_16x16x32_bf16 v[228:231], v[76:79], v[84:87], v[228:231]
    v_mfma_f32_16x16x32_bf16 v[232:235], v[76:79], v[88:91], v[232:235]
    v_mfma_f32_16x16x32_bf16 v[236:239], v[76:79], v[92:95], v[236:239]
    v_mfma_f32_16x16x32_bf16 v[240:243], v[76:79], v[96:99], v[240:243]
    v_mfma_f32_16x16x32_bf16 v[244:247], v[76:79], v[100:103], v[244:247]
    v_mfma_f32_16x16x32_bf16 v[248:251], v[76:79], v[104:107], v[248:251]
    v_mfma_f32_16x16x32_bf16 v[252:255], v[76:79], v[108:111], v[252:255]
P2_mid:
    s_waitcnt lgkmcnt(0)
    v_mfma_f32_16x16x32_bf16 v[128:131], v[16:19], v[32:35], v[128:131]
    ds_read_b64_tr_b16 v[64:65], v118 offset:8192
    v_mfma_f32_16x16x32_bf16 v[132:135], v[16:19], v[36:39], v[132:135]
    ds_read_b64_tr_b16 v[66:67], v118 offset:9216
    v_mfma_f32_16x16x32_bf16 v[136:139], v[16:19], v[40:43], v[136:139]
    ds_read_b128 v[80:83], v124 offset:0
    v_mfma_f32_16x16x32_bf16 v[140:143], v[16:19], v[44:47], v[140:143]
    ds_read_b128 v[84:87], v124 offset:2048
    v_mfma_f32_16x16x32_bf16 v[144:147], v[16:19], v[48:51], v[144:147]
    ds_read_b128 v[88:91], v124 offset:4096
    v_mfma_f32_16x16x32_bf16 v[148:151], v[16:19], v[52:55], v[148:151]
    ds_read_b64_tr_b16 v[68:69], v119 offset:8192
    v_mfma_f32_16x16x32_bf16 v[152:155], v[16:19], v[56:59], v[152:155]
    ds_read_b64_tr_b16 v[70:71], v119 offset:9216
    v_mfma_f32_16x16x32_bf16 v[156:159], v[16:19], v[60:63], v[156:159]
    v_mfma_f32_16x16x32_bf16 v[160:163], v[20:23], v[32:35], v[160:163]
    ds_read_b128 v[92:95], v124 offset:6144
    v_mfma_f32_16x16x32_bf16 v[164:167], v[20:23], v[36:39], v[164:167]
    ds_read_b128 v[96:99], v124 offset:8192
    v_mfma_f32_16x16x32_bf16 v[168:171], v[20:23], v[40:43], v[168:171]
    ds_read_b128 v[100:103], v124 offset:10240
    v_mfma_f32_16x16x32_bf16 v[172:175], v[20:23], v[44:47], v[172:175]
    ds_read_b64_tr_b16 v[72:73], v120 offset:8192
    v_mfma_f32_16x16x32_bf16 v[176:179], v[20:23], v[48:51], v[176:179]
    ds_read_b64_tr_b16 v[74:75], v120 offset:9216
    v_mfma_f32_16x16x32_bf16 v[180:183], v[20:23], v[52:55], v[180:183]
    ds_read_b128 v[104:107], v124 offset:12288
    v_mfma_f32_16x16x32_bf16 v[184:187], v[20:23], v[56:59], v[184:187]
    ds_read_b128 v[108:111], v124 offset:14336
    v_mfma_f32_16x16x32_bf16 v[188:191], v[20:23], v[60:63], v[188:191]
    v_mfma_f32_16x16x32_bf16 v[192:195], v[24:27], v[32:35], v[192:195]
    ds_read_b64_tr_b16 v[76:77], v121 offset:8192
    v_mfma_f32_16x16x32_bf16 v[196:199], v[24:27], v[36:39], v[196:199]
    ds_read_b64_tr_b16 v[78:79], v121 offset:9216
    v_mfma_f32_16x16x32_bf16 v[200:203], v[24:27], v[40:43], v[200:203]
    s_add_u32 s44, s44, 49152
    v_mfma_f32_16x16x32_bf16 v[204:207], v[24:27], v[44:47], v[204:207]
    s_cmp_eq_u32 s44, 147456
    v_mfma_f32_16x16x32_bf16 v[208:211], v[24:27], v[48:51], v[208:211]
    s_cselect_b32 s44, 0, s44
    v_mfma_f32_16x16x32_bf16 v[212:215], v[24:27], v[52:55], v[212:215]
    v_add_u32 v117, s44, v112
    v_mfma_f32_16x16x32_bf16 v[216:219], v[24:27], v[56:59], v[216:219]
    v_mfma_f32_16x16x32_bf16 v[220:223], v[24:27], v[60:63], v[220:223]
    v_xor_b32 v124, 64, v117
    v_mfma_f32_16x16x32_bf16 v[224:227], v[28:31], v[32:35], v[224:227]
    v_add_u32 v118, s44, v113
    v_mfma_f32_16x16x32_bf16 v[228:231], v[28:31], v[36:39], v[228:231]
    v_add_u32 v119, s44, v114
    v_mfma_f32_16x16x32_bf16 v[232:235], v[28:31], v[40:43], v[232:235]
    v_add_u32 v120, s44, v115
    v_mfma_f32_16x16x32_bf16 v[236:239], v[28:31], v[44:47], v[236:239]
    v_add_u32 v121, s44, v116
    v_mfma_f32_16x16x32_bf16 v[240:243], v[28:31], v[48:51], v[240:243]
    s_sub_u32 s45, s45, 1
    v_mfma_f32_16x16x32_bf16 v[244:247], v[28:31], v[52:55], v[244:247]
    s_cmp_lg_u32 s45, 0
    v_mfma_f32_16x16x32_bf16 v[248:251], v[28:31], v[56:59], v[248:251]
    v_mfma_f32_16x16x32_bf16 v[252:255], v[28:31], v[60:63], v[252:255]
    s_waitcnt lgkmcnt(0)
    s_cbranch_scc1 P2_loop
    v_mfma_f32_16x16x32_bf16 v[128:131], v[64:67], v[80:83], v[128:131]
    v_mfma_f32_16x16x32_bf16 v[132:135], v[64:67], v[84:87], v[132:135]
    s_barrier
    v_mfma_f32_16x16x32_bf16 v[136:139], v[64:67], v[88:91], v[136:139]
    ds_read_b64_tr_b16 v[16:17], v118 offset:0
    v_mfma_f32_16x16x32_bf16 v[140:143], v[64:67], v[92:95], v[140:143]
    ds_read_b64_tr_b16 v[18:19], v118 offset:1024
    v_mfma_f32_16x16x32_bf16 v[144:147], v[64:67], v[96:99], v[144:147]
    ds_read_b128 v[32:35], v117 offset:0
    v_mfma_f32_16x16x32_bf16 v[148:151], v[64:67], v[100:103], v[148:151]
    ds_read_b128 v[36:39], v117 offset:2048
    v_mfma_f32_16x16x32_bf16 v[152:155], v[64:67], v[104:107], v[152:155]
    v_mfma_f32_16x16x32_bf16 v[156:159], v[64:67], v[108:111], v[156:159]
    ds_read_b128 v[40:43], v117 offset:4096
    v_mfma_f32_16x16x32_bf16 v[160:163], v[68:71], v[80:83], v[160:163]
    ds_read_b64_tr_b16 v[20:21], v119 offset:0
    v_mfma_f32_16x16x32_bf16 v[164:167], v[68:71], v[84:87], v[164:167]
    ds_read_b64_tr_b16 v[22:23], v119 offset:1024
    v_mfma_f32_16x16x32_bf16 v[168:171], v[68:71], v[88:91], v[168:171]
    v_mfma_f32_16x16x32_bf16 v[172:175], v[68:71], v[92:95], v[172:175]
    ds_read_b128 v[44:47], v117 offset:6144
    v_mfma_f32_16x16x32_bf16 v[176:179], v[68:71], v[96:99], v[176:179]
    ds_read_b128 v[48:51], v117 offset:8192
    v_mfma_f32_16x16x32_bf16 v[180:183], v[68:71], v[100:103], v[180:183]
    ds_read_b128 v[52:55], v117 offset:10240
    v_mfma_f32_16x16x32_bf16 v[184:187], v[68:71], v[104:107], v[184:187]
    v_mfma_f32_16x16x32_bf16 v[188:191], v[68:71], v[108:111], v[188:191]
    ds_read_b64_tr_b16 v[24:25], v120 offset:0
    v_mfma_f32_16x16x32_bf16 v[192:195], v[72:75], v[80:83], v[192:195]
    ds_read_b64_tr_b16 v[26:27], v120 offset:1024
    v_mfma_f32_16x16x32_bf16 v[196:199], v[72:75], v[84:87], v[196:199]
    ds_read_b128 v[56:59], v117 offset:12288
    v_mfma_f32_16x16x32_bf16 v[200:203], v[72:75], v[88:91], v[200:203]
    ds_read_b128 v[60:63], v117 offset:14336
    v_mfma_f32_16x16x32_bf16 v[204:207], v[72:75], v[92:95], v[204:207]
    v_mfma_f32_16x16x32_bf16 v[208:211], v[72:75], v[96:99], v[208:211]
    ds_read_b64_tr_b16 v[28:29], v121 offset:0
    v_mfma_f32_16x16x32_bf16 v[212:215], v[72:75], v[100:103], v[212:215]
    ds_read_b64_tr_b16 v[30:31], v121 offset:1024
    v_mfma_f32_16x16x32_bf16 v[216:219], v[72:75], v[104:107], v[216:219]
    v_mfma_f32_16x16x32_bf16 v[220:223], v[72:75], v[108:111], v[220:223]
    v_mfma_f32_16x16x32_bf16 v[224:227], v[76:79], v[80:83], v[224:227]
    v_mfma_f32_16x16x32_bf16 v[228:231], v[76:79], v[84:87], v[228:231]
    v_mfma_f32_16x16x32_bf16 v[232:235], v[76:79], v[88:91], v[232:235]
    v_mfma_f32_16x16x32_bf16 v[236:239], v[76:79], v[92:95], v[236:239]
    v_mfma_f32_16x16x32_bf16 v[240:243], v[76:79], v[96:99], v[240:243]
    v_mfma_f32_16x16x32_bf16 v[244:247], v[76:79], v[100:103], v[244:247]
    v_mfma_f32_16x16x32_bf16 v[248:251], v[76:79], v[104:107], v[248:251]
    v_mfma_f32_16x16x32_bf16 v[252:255], v[76:79], v[108:111], v[252:255]
    s_waitcnt lgkmcnt(0)
    v_mfma_f32_16x16x32_bf16 v[128:131], v[16:19], v[32:35], v[128:131]
    ds_read_b64_tr_b16 v[64:65], v118 offset:8192
    ds_read_b64_tr_b16 v[66:67], v118 offset:9216
    v_mfma_f32_16x16x32_bf16 v[160:163], v[20:23], v[32:35], v[160:163]
    ds_read_b64_tr_b16 v[68:69], v119 offset:8192
    ds_read_b64_tr_b16 v[70:71], v119 offset:9216
    v_mfma_f32_16x16x32_bf16 v[192:195], v[24:27], v[32:35], v[192:195]
    ds_read_b64_tr_b16 v[72:73], v120 offset:8192
    ds_read_b64_tr_b16 v[74:75], v120 offset:9216
    v_mfma_f32_16x16x32_bf16 v[224:227], v[28:31], v[32:35], v[224:227]
    ds_read_b64_tr_b16 v[76:77], v121 offset:8192
    ds_read_b64_tr_b16 v[78:79], v121 offset:9216
    v_mfma_f32_16x16x32_bf16 v[132:135], v[16:19], v[36:39], v[132:135]
    ds_read_b128 v[80:83], v124 offset:0
    ds_read_b128 v[84:87], v124 offset:2048
    v_mfma_f32_16x16x32_bf16 v[164:167], v[20:23], v[36:39], v[164:167]
    ds_read_b128 v[88:91], v124 offset:4096
    ds_read_b128 v[92:95], v124 offset:6144
    v_mfma_f32_16x16x32_bf16 v[196:199], v[24:27], v[36:39], v[196:199]
    ds_read_b128 v[96:99], v124 offset:8192
    ds_read_b128 v[100:103], v124 offset:10240
    v_mfma_f32_16x16x32_bf16 v[228:231], v[28:31], v[36:39], v[228:231]
    ds_read_b128 v[104:107], v124 offset:12288
    ds_read_b128 v[108:111], v124 offset:14336
    v_mfma_f32_16x16x32_bf16 v[136:139], v[16:19], v[40:43], v[136:139]
    v_mfma_f32_16x16x32_bf16 v[168:171], v[20:23], v[40:43], v[168:171]
    v_mfma_f32_16x16x32_bf16 v[200:203], v[24:27], v[40:43], v[200:203]
    v_mfma_f32_16x16x32_bf16 v[232:235], v[28:31], v[40:43], v[232:235]
    s_waitcnt lgkmcnt(0)
    s_barrier
    v_mfma_f32_16x16x32_bf16 v[128:131], v[64:67], v[80:83], v[128:131]
    v_mfma_f32_16x16x32_bf16 v[160:163], v[68:71], v[80:83], v[160:163]
    v_mfma_f32_16x16x32_bf16 v[192:195], v[72:75], v[80:83], v[192:195]
    v_mfma_f32_16x16x32_bf16 v[224:227], v[76:79], v[80:83], v[224:227]
    v_mfma_f32_16x16x32_bf16 v[140:143], v[16:19], v[44:47], v[140:143]
    v_mfma_f32_16x16x32_bf16 v[172:175], v[20:23], v[44:47], v[172:175]
    v_mfma_f32_16x16x32_bf16 v[204:207], v[24:27], v[44:47], v[204:207]
    v_mfma_f32_16x16x32_bf16 v[236:239], v[28:31], v[44:47], v[236:239]
    v_mfma_f32_16x16x32_bf16 v[132:135], v[64:67], v[84:87], v[132:135]
    v_mfma_f32_16x16x32_bf16 v[164:167], v[68:71], v[84:87], v[164:167]
    v_mfma_f32_16x16x32_bf16 v[196:199], v[72:75], v[84:87], v[196:199]
    v_cvt_pk_bf16_f32 v32, v128, v129
    v_cvt_pk_bf16_f32 v33, v130, v131
    v_mfma_f32_16x16x32_bf16 v[228:231], v[76:79], v[84:87], v[228:231]
    v_cvt_pk_bf16_f32 v34, v160, v161
    v_cvt_pk_bf16_f32 v35, v162, v163
    v_mfma_f32_16x16x32_bf16 v[144:147], v[16:19], v[48:51], v[144:147]
    buffer_store_dwordx4 v[32:35], v3, s[28:31], s41 offen offset:0 sc1
    v_cvt_pk_bf16_f32 v80, v192, v193
    v_mfma_f32_16x16x32_bf16 v[176:179], v[20:23], v[48:51], v[176:179]
    v_cvt_pk_bf16_f32 v81, v194, v195
    v_cvt_pk_bf16_f32 v82, v224, v225
    v_mfma_f32_16x16x32_bf16 v[208:211], v[24:27], v[48:51], v[208:211]
    v_cvt_pk_bf16_f32 v83, v226, v227
    buffer_store_dwordx4 v[80:83], v3, s[28:31], s41 offen offset:1024 sc1
    v_mfma_f32_16x16x32_bf16 v[240:243], v[28:31], v[48:51], v[240:243]
    s_add_u32 s41, s41, 36864
    v_mfma_f32_16x16x32_bf16 v[136:139], v[64:67], v[88:91], v[136:139]
    v_mfma_f32_16x16x32_bf16 v[168:171], v[68:71], v[88:91], v[168:171]
    v_mfma_f32_16x16x32_bf16 v[200:203], v[72:75], v[88:91], v[200:203]
    v_cvt_pk_bf16_f32 v36, v132, v133
    v_cvt_pk_bf16_f32 v37, v134, v135
    v_mfma_f32_16x16x32_bf16 v[232:235], v[76:79], v[88:91], v[232:235]
    v_cvt_pk_bf16_f32 v38, v164, v165
    v_cvt_pk_bf16_f32 v39, v166, v167
    v_mfma_f32_16x16x32_bf16 v[148:151], v[16:19], v[52:55], v[148:151]
    buffer_store_dwordx4 v[36:39], v3, s[28:31], s41 offen offset:0 sc1
    v_cvt_pk_bf16_f32 v84, v196, v197
    v_mfma_f32_16x16x32_bf16 v[180:183], v[20:23], v[52:55], v[180:183]
    v_cvt_pk_bf16_f32 v85, v198, v199
    v_cvt_pk_bf16_f32 v86, v228, v229
    v_mfma_f32_16x16x32_bf16 v[212:215], v[24:27], v[52:55], v[212:215]
    v_cvt_pk_bf16_f32 v87, v230, v231
    buffer_store_dwordx4 v[84:87], v3, s[28:31], s41 offen offset:1024 sc1
    v_mfma_f32_16x16x32_bf16 v[244:247], v[28:31], v[52:55], v[244:247]
    s_add_u32 s41, s41, 36864
    v_mfma_f32_16x16x32_bf16 v[140:143], v[64:67], v[92:95], v[140:143]
    v_mfma_f32_16x16x32_bf16 v[172:175], v[68:71], v[92:95], v[172:175]
    v_mfma_f32_16x16x32_bf16 v[204:207], v[72:75], v[92:95], v[204:207]
    v_cvt_pk_bf16_f32 v40, v136, v137
    v_cvt_pk_bf16_f32 v41, v138, v139
    v_mfma_f32_16x16x32_bf16 v[236:239], v[76:79], v[92:95], v[236:239]
    v_cvt_pk_bf16_f32 v42, v168, v169
    v_cvt_pk_bf16_f32 v43, v170, v171
    v_mfma_f32_16x16x32_bf16 v[152:155], v[16:19], v[56:59], v[152:155]
    buffer_store_dwordx4 v[40:43], v3, s[28:31], s41 offen offset:0 sc1
    v_cvt_pk_bf16_f32 v88, v200, v201
    v_mfma_f32_16x16x32_bf16 v[184:187], v[20:23], v[56:59], v[184:187]
    v_cvt_pk_bf16_f32 v89, v202, v203
    v_cvt_pk_bf16_f32 v90, v232, v233
    v_mfma_f32_16x16x32_bf16 v[216:219], v[24:27], v[56:59], v[216:219]
    v_cvt_pk_bf16_f32 v91, v234, v235
    buffer_store_dwordx4 v[88:91], v3, s[28:31], s41 offen offset:1024 sc1
    v_mfma_f32_16x16x32_bf16 v[248:251], v[28:31], v[56:59], v[248:251]
    s_add_u32 s41, s41, 36864
    v_mfma_f32_16x16x32_bf16 v[144:147], v[64:67], v[96:99], v[144:147]
    v_mfma_f32_16x16x32_bf16 v[176:179], v[68:71], v[96:99], v[176:179]
    v_mfma_f32_16x16x32_bf16 v[208:211], v[72:75], v[96:99], v[208:211]
    v_cvt_pk_bf16_f32 v44, v140, v141
    v_cvt_pk_bf16_f32 v45, v142, v143
    v_mfma_f32_16x16x32_bf16 v[240:243], v[76:79], v[96:99], v[240:243]
    v_cvt_pk_bf16_f32 v46, v172, v173
    v_cvt_pk_bf16_f32 v47, v174, v175
    v_mfma_f32_16x16x32_bf16 v[156:159], v[16:19], v[60:63], v[156:159]
    buffer_store_dwordx4 v[44:47], v3, s[28:31], s41 offen offset:0 sc1
    v_cvt_pk_bf16_f32 v92, v204, v205
    v_mfma_f32_16x16x32_bf16 v[188:191], v[20:23], v[60:63], v[188:191]
    v_cvt_pk_bf16_f32 v93, v206, v207
    v_cvt_pk_bf16_f32 v94, v236, v237
    v_mfma_f32_16x16x32_bf16 v[220:223], v[24:27], v[60:63], v[220:223]
    v_cvt_pk_bf16_f32 v95, v238, v239
    buffer_store_dwordx4 v[92:95], v3, s[28:31], s41 offen offset:1024 sc1
    v_mfma_f32_16x16x32_bf16 v[252:255], v[28:31], v[60:63], v[252:255]
    s_add_u32 s41, s41, 36864
    v_mfma_f32_16x16x32_bf16 v[148:151], v[64:67], v[100:103], v[148:151]
    v_cvt_pk_bf16_f32 v48, v144, v145
    v_cvt_pk_bf16_f32 v49, v146, v147
    v_cvt_pk_bf16_f32 v50, v176, v177
    v_cvt_pk_bf16_f32 v51, v178, v179
    v_mfma_f32_16x16x32_bf16 v[180:183], v[68:71], v[100:103], v[180:183]
    buffer_store_dwordx4 v[48:51], v3, s[28:31], s41 offen offset:0 sc1
    v_cvt_pk_bf16_f32 v96, v208, v209
    v_cvt_pk_bf16_f32 v97, v210, v211
    v_mfma_f32_16x16x32_bf16 v[212:215], v[72:75], v[100:103], v[212:215]
    v_cvt_pk_bf16_f32 v98, v240, v241
    v_cvt_pk_bf16_f32 v99, v242, v243
    buffer_store_dwordx4 v[96:99], v3, s[28:31], s41 offen offset:1024 sc1
    v_mfma_f32_16x16x32_bf16 v[244:247], v[76:79], v[100:103], v[244:247]
    s_add_u32 s41, s41, 36864
    v_mfma_f32_16x16x32_bf16 v[152:155], v[64:67], v[104:107], v[152:155]
    v_cvt_pk_bf16_f32 v52, v148, v149
    v_cvt_pk_bf16_f32 v53, v150, v151
    v_cvt_pk_bf16_f32 v54, v180, v181
    v_cvt_pk_bf16_f32 v55, v182, v183
    v_mfma_f32_16x16x32_bf16 v[184:187], v[68:71], v[104:107], v[184:187]
    buffer_store_dwordx4 v[52:55], v3, s[28:31], s41 offen offset:0 sc1
    v_cvt_pk_bf16_f32 v100, v212, v213
    v_cvt_pk_bf16_f32 v101, v214, v215
    v_mfma_f32_16x16x32_bf16 v[216:219], v[72:75], v[104:107], v[216:219]
    v_cvt_pk_bf16_f32 v102, v244, v245
    v_cvt_pk_bf16_f32 v103, v246, v247
    buffer_store_dwordx4 v[100:103], v3, s[28:31], s41 offen offset:1024 sc1
    v_mfma_f32_16x16x32_bf16 v[248:251], v[76:79], v[104:107], v[248:251]
    s_add_u32 s41, s41, 36864
    v_mfma_f32_16x16x32_bf16 v[156:159], v[64:67], v[108:111], v[156:159]
    v_cvt_pk_bf16_f32 v56, v152, v153
    v_cvt_pk_bf16_f32 v57, v154, v155
    v_cvt_pk_bf16_f32 v58, v184, v185
    v_cvt_pk_bf16_f32 v59, v186, v187
    v_mfma_f32_16x16x32_bf16 v[188:191], v[68:71], v[108:111], v[188:191]
    buffer_store_dwordx4 v[56:59], v3, s[28:31], s41 offen offset:0 sc1
    v_cvt_pk_bf16_f32 v104, v216, v217
    v_cvt_pk_bf16_f32 v105, v218, v219
    v_mfma_f32_16x16x32_bf16 v[220:223], v[72:75], v[108:111], v[220:223]
    v_cvt_pk_bf16_f32 v106, v248, v249
    v_cvt_pk_bf16_f32 v107, v250, v251
    buffer_store_dwordx4 v[104:107], v3, s[28:31], s41 offen offset:1024 sc1
    v_mfma_f32_16x16x32_bf16 v[252:255], v[76:79], v[108:111], v[252:255]
    s_add_u32 s41, s41, 36864
    v_cvt_pk_bf16_f32 v60, v156, v157
    v_cvt_pk_bf16_f32 v61, v158, v159
    v_cvt_pk_bf16_f32 v62, v188, v189
    v_cvt_pk_bf16_f32 v63, v190, v191
    buffer_store_dwordx4 v[60:63], v3, s[28:31], s41 offen offset:0 sc1
    v_cvt_pk_bf16_f32 v108, v220, v221
    v_cvt_pk_bf16_f32 v109, v222, v223
    v_cvt_pk_bf16_f32 v110, v252, v253
    v_cvt_pk_bf16_f32 v111, v254, v255
    buffer_store_dwordx4 v[108:111], v3, s[28:31], s41 offen offset:1024 sc1
    s_branch P2_fin
P2_txt:
    s_mov_b32 s20, s56
    s_mov_b32 s21, s57
    s_mov_b32 s22, 0x798000
    s_mov_b32 s23, 0x20000
    v_lshrrev_b32 v8, 1, v0
    v_mul_u32_u24 v8, 6912, v8
    v_and_b32 v9, 1, v0
    v_lshl_add_u32 v8, v9, 7, v8
    s_lshl_b32 s3, s16, 8
    s_add_u32 s3, s3, 1769472
    buffer_load_dword v10, v8, s[20:23], s3 offen
    s_add_u32 s3, s3, 884736
    buffer_load_dword v10, v8, s[20:23], s3 offen
    s_add_u32 s3, s3, 884736
    buffer_load_dword v10, v8, s[20:23], s3 offen
    s_add_u32 s3, s3, 884736
    buffer_load_dword v10, v8, s[20:23], s3 offen
    s_add_u32 s3, s3, 884736
    s_add_u32 s32, s84, 0x48000
    s_addc_u32 s33, s85, 0
    s_mov_b32 s34, 0x24000
    s_mov_b32 s35, 0x20000
    s_cmp_ge_u32 s16, 18
    s_cselect_b32 s34, s34, 0
    s_lshl_b32 s3, s18, 7
    s_add_u32 s46, s46, s3
    v_and_b32 v4, 15, v2
    v_mul_u32_u24 v4, 2304, v4
    v_lshrrev_b32 v5, 4, v2
    v_lshl_add_u32 v122, v5, 4, v4
    s_cmp_eq_u32 s19, 1
    s_cbranch_scc1 P2_idle
    s_barrier
    ds_read_b64_tr_b16 v[16:17], v118 offset:0
    ds_read_b64_tr_b16 v[18:19], v118 offset:1024
    ds_read_b128 v[32:35], v117 offset:0
    ds_read_b128 v[36:39], v117 offset:2048
    ds_read_b128 v[40:43], v117 offset:4096
    ds_read_b64_tr_b16 v[20:21], v119 offset:0
    ds_read_b64_tr_b16 v[22:23], v119 offset:1024
    ds_read_b128 v[44:47], v117 offset:6144
    ds_read_b64_tr_b16 v[24:25], v120 offset:0
    ds_read_b64_tr_b16 v[26:27], v120 offset:1024
    ds_read_b64_tr_b16 v[28:29], v121 offset:0
    ds_read_b64_tr_b16 v[30:31], v121 offset:1024
    s_branch P2T_mid
P2T_loop:
    v_mfma_f32_16x16x32_bf16 v[128:131], v[64:67], v[80:83], v[128:131]
    v_mfma_f32_16x16x32_bf16 v[132:135], v[64:67], v[84:87], v[132:135]
    s_barrier
    v_mfma_f32_16x16x32_bf16 v[136:139], v[64:67], v[88:91], v[136:139]
    ds_read_b64_tr_b16 v[16:17], v118 offset:0
    ds_read_b64_tr_b16 v[18:19], v118 offset:1024
    v_mfma_f32_16x16x32_bf16 v[140:143], v[64:67], v[92:95], v[140:143]
    ds_read_b128 v[32:35], v117 offset:0
    ds_read_b128 v[36:39], v117 offset:2048
    v_mfma_f32_16x16x32_bf16 v[160:163], v[68:71], v[80:83], v[160:163]
    ds_read_b128 v[40:43], v117 offset:4096
    v_mfma_f32_16x16x32_bf16 v[164:167], v[68:71], v[84:87], v[164:167]
    ds_read_b64_tr_b16 v[20:21], v119 offset:0
    ds_read_b64_tr_b16 v[22:23], v119 offset:1024
    v_mfma_f32_16x16x32_bf16 v[168:171], v[68:71], v[88:91], v[168:171]
    ds_read_b128 v[44:47], v117 offset:6144
    v_mfma_f32_16x16x32_bf16 v[172:175], v[68:71], v[92:95], v[172:175]
    ds_read_b64_tr_b16 v[24:25], v120 offset:0
    ds_read_b64_tr_b16 v[26:27], v120 offset:1024
    v_mfma_f32_16x16x32_bf16 v[192:195], v[72:75], v[80:83], v[192:195]
    ds_read_b64_tr_b16 v[28:29], v121 offset:0
    v_mfma_f32_16x16x32_bf16 v[196:199], v[72:75], v[84:87], v[196:199]
    ds_read_b64_tr_b16 v[30:31], v121 offset:1024
    v_mfma_f32_16x16x32_bf16 v[200:203], v[72:75], v[88:91], v[200:203]
    v_mfma_f32_16x16x32_bf16 v[204:207], v[72:75], v[92:95], v[204:207]
    v_mfma_f32_16x16x32_bf16 v[224:227], v[76:79], v[80:83], v[224:227]
    v_mfma_f32_16x16x32_bf16 v[228:231], v[76:79], v[84:87], v[228:231]
    v_mfma_f32_16x16x32_bf16 v[232:235], v[76:79], v[88:91], v[232:235]
    v_mfma_f32_16x16x32_bf16 v[236:239], v[76:79], v[92:95], v[236:239]
P2T_mid:
    s_waitcnt lgkmcnt(0)
    v_mfma_f32_16x16x32_bf16 v[128:131], v[16:19], v[32:35], v[128:131]
    ds_read_b64_tr_b16 v[64:65], v118 offset:8192
    ds_read_b64_tr_b16 v[66:67], v118 offset:9216
    v_mfma_f32_16x16x32_bf16 v[132:135], v[16:19], v[36:39], v[132:135]
    ds_read_b128 v[80:83], v124 offset:0
    ds_read_b128 v[84:87], v124 offset:2048
    v_mfma_f32_16x16x32_bf16 v[136:139], v[16:19], v[40:43], v[136:139]
    ds_read_b128 v[88:91], v124 offset:4096
    ds_read_b64_tr_b16 v[68:69], v119 offset:8192
    v_mfma_f32_16x16x32_bf16 v[140:143], v[16:19], v[44:47], v[140:143]
    ds_read_b64_tr_b16 v[70:71], v119 offset:9216
    v_mfma_f32_16x16x32_bf16 v[160:163], v[20:23], v[32:35], v[160:163]
    ds_read_b128 v[92:95], v124 offset:6144
    ds_read_b64_tr_b16 v[72:73], v120 offset:8192
    v_mfma_f32_16x16x32_bf16 v[164:167], v[20:23], v[36:39], v[164:167]
    ds_read_b64_tr_b16 v[74:75], v120 offset:9216
    ds_read_b64_tr_b16 v[76:77], v121 offset:8192
    v_mfma_f32_16x16x32_bf16 v[168:171], v[20:23], v[40:43], v[168:171]
    ds_read_b64_tr_b16 v[78:79], v121 offset:9216
    s_add_u32 s44, s44, 49152
    v_mfma_f32_16x16x32_bf16 v[172:175], v[20:23], v[44:47], v[172:175]
    s_cmp_eq_u32 s44, 147456
    v_mfma_f32_16x16x32_bf16 v[192:195], v[24:27], v[32:35], v[192:195]
    s_cselect_b32 s44, 0, s44
    v_add_u32 v117, s44, v112
    v_mfma_f32_16x16x32_bf16 v[196:199], v[24:27], v[36:39], v[196:199]
    v_xor_b32 v124, 64, v117
    v_add_u32 v118, s44, v113
    v_mfma_f32_16x16x32_bf16 v[200:203], v[24:27], v[40:43], v[200:203]
    v_add_u32 v119, s44, v114
    v_add_u32 v120, s44, v115
    v_mfma_f32_16x16x32_bf16 v[204:207], v[24:27], v[44:47], v[204:207]
    v_add_u32 v121, s44, v116
    v_mfma_f32_16x16x32_bf16 v[224:227], v[28:31], v[32:35], v[224:227]
    s_sub_u32 s45, s45, 1
    s_cmp_lg_u32 s45, 0
    v_mfma_f32_16x16x32_bf16 v[228:231], v[28:31], v[36:39], v[228:231]
    v_mfma_f32_16x16x32_bf16 v[232:235], v[28:31], v[40:43], v[232:235]
    v_mfma_f32_16x16x32_bf16 v[236:239], v[28:31], v[44:47], v[236:239]
    s_waitcnt lgkmcnt(0)
    s_cbranch_scc1 P2T_loop
    s_barrier
    v_mfma_f32_16x16x32_bf16 v[128:131], v[64:67], v[80:83], v[128:131]
    v_mfma_f32_16x16x32_bf16 v[160:163], v[68:71], v[80:83], v[160:163]
    v_mfma_f32_16x16x32_bf16 v[192:195], v[72:75], v[80:83], v[192:195]
    v_mfma_f32_16x16x32_bf16 v[224:227], v[76:79], v[80:83], v[224:227]
    v_mfma_f32_16x16x32_bf16 v[132:135], v[64:67], v[84:87], v[132:135]
    v_mfma_f32_16x16x32_bf16 v[164:167], v[68:71], v[84:87], v[164:167]
    v_mfma_f32_16x16x32_bf16 v[196:199], v[72:75], v[84:87], v[196:199]
    v_mfma_f32_16x16x32_bf16 v[228:231], v[76:79], v[84:87], v[228:231]
    v_mfma_f32_16x16x32_bf16 v[136:139], v[64:67], v[88:91], v[136:139]
    v_cvt_pk_bf16_f32 v16, v128, v129
    v_cvt_pk_bf16_f32 v17, v130, v131
    v_cvt_pk_bf16_f32 v18, v160, v161
    v_mfma_f32_16x16x32_bf16 v[168:171], v[68:71], v[88:91], v[168:171]
    v_cvt_pk_bf16_f32 v19, v162, v163
    buffer_store_dwordx4 v[16:19], v3, s[28:31], s41 offen offset:0 sc1
    v_cvt_pk_bf16_f32 v20, v192, v193
    v_mfma_f32_16x16x32_bf16 v[200:203], v[72:75], v[88:91], v[200:203]
    v_cvt_pk_bf16_f32 v21, v194, v195
    v_cvt_pk_bf16_f32 v22, v224, v225
    v_cvt_pk_bf16_f32 v23, v226, v227
    v_mfma_f32_16x16x32_bf16 v[232:235], v[76:79], v[88:91], v[232:235]
    buffer_store_dwordx4 v[20:23], v3, s[28:31], s41 offen offset:1024 sc1
    s_add_u32 s41, s41, 36864
    v_mfma_f32_16x16x32_bf16 v[140:143], v[64:67], v[92:95], v[140:143]
    v_cvt_pk_bf16_f32 v24, v132, v133
    v_cvt_pk_bf16_f32 v25, v134, v135
    v_cvt_pk_bf16_f32 v26, v164, v165
    v_mfma_f32_16x16x32_bf16 v[172:175], v[68:71], v[92:95], v[172:175]
    v_cvt_pk_bf16_f32 v27, v166, v167
    buffer_store_dwordx4 v[24:27], v3, s[28:31], s41 offen offset:0 sc1
    v_cvt_pk_bf16_f32 v28, v196, v197
    v_mfma_f32_16x16x32_bf16 v[204:207], v[72:75], v[92:95], v[204:207]
    v_cvt_pk_bf16_f32 v29, v198, v199
    v_cvt_pk_bf16_f32 v30, v228, v229
    v_cvt_pk_bf16_f32 v31, v230, v231
    v_mfma_f32_16x16x32_bf16 v[236:239], v[76:79], v[92:95], v[236:239]
    buffer_store_dwordx4 v[28:31], v3, s[28:31], s41 offen offset:1024 sc1
    s_add_u32 s41, s41, 2396160
    v_cvt_pk_bf16_f32 v32, v136, v137
    v_cvt_pk_bf16_f32 v33, v138, v139
    v_cvt_pk_bf16_f32 v34, v168, v169
    v_cvt_pk_bf16_f32 v35, v170, v171
    buffer_store_dwordx4 v[32:35], v3, s[28:31], s41 offen offset:0 sc1
    v_cvt_pk_bf16_f32 v36, v200, v201
    v_cvt_pk_bf16_f32 v37, v202, v203
    v_cvt_pk_bf16_f32 v38, v232, v233
    v_cvt_pk_bf16_f32 v39, v234, v235
    buffer_store_dwordx4 v[36:39], v3, s[28:31], s41 offen offset:1024 sc1
    s_add_u32 s41, s41, 36864
    v_cvt_pk_bf16_f32 v40, v140, v141
    v_cvt_pk_bf16_f32 v41, v142, v143
    v_cvt_pk_bf16_f32 v42, v172, v173
    v_cvt_pk_bf16_f32 v43, v174, v175
    buffer_store_dwordx4 v[40:43], v3, s[28:31], s41 offen offset:0 sc1
    v_cvt_pk_bf16_f32 v44, v204, v205
    v_cvt_pk_bf16_f32 v45, v206, v207
    v_cvt_pk_bf16_f32 v46, v236, v237
    v_cvt_pk_bf16_f32 v47, v238, v239
    buffer_store_dwordx4 v[44:47], v3, s[28:31], s41 offen offset:1024 sc1
    v_mov_b32 v8, 147456
    v_mov_b32 v9, 1
    s_add_u32 s100, s100, 4
    s_waitcnt vmcnt(0)
    s_mov_b64 exec, 1
    ds_add_rtn_u32 v10, v8, v9
    s_mov_b64 exec, -1
    s_waitcnt lgkmcnt(0)
    v_readfirstlane_b32 s3, v10
    s_nop 0
    s_add_u32 s3, s3, 1
    s_cmp_lg_u32 s3, s100
    s_cbranch_scc1 PB_19
    s_add_u32 s3, s86, 4
    v_mov_b32 v9, s3
    v_mov_b32 v10, 0
    s_lshl_b32 s3, s2, 7
    s_mov_b64 exec, 1
    buffer_store_dword v9, v10, s[76:79], s3 offen sc1
    s_mov_b64 exec, -1
    v_mov_b32 v11, 4
    ds_write_b32 v8, v11 offset:8
PB_19:
    buffer_store_dwordx4 v[16:19], v122, s[32:35], s46 offen offset:0 sc1
    buffer_store_dwordx4 v[20:23], v122, s[32:35], s46 offen offset:64 sc1
    s_add_u32 s46, s46, 36864
    buffer_store_dwordx4 v[24:27], v122, s[32:35], s46 offen offset:0 sc1
    buffer_store_dwordx4 v[28:31], v122, s[32:35], s46 offen offset:64 sc1
    s_add_u32 s46, s46, 36864
    buffer_store_dwordx4 v[32:35], v122, s[32:35], s46 offen offset:0 sc1
    buffer_store_dwordx4 v[36:39], v122, s[32:35], s46 offen offset:64 sc1
    s_add_u32 s46, s46, 36864
    buffer_store_dwordx4 v[40:43], v122, s[32:35], s46 offen offset:0 sc1
    buffer_store_dwordx4 v[44:47], v122, s[32:35], s46 offen offset:64 sc1
    s_add_u32 s46, s46, 36864
    s_branch PX
P2_cv:
    s_add_u32 s28, s84, 0x1841000
    s_addc_u32 s29, s85, 0
    s_mov_b32 s30, 0x4a4000
    s_mov_b32 s31, 0x20000
    s_lshr_b32 s41, s17, 2
    s_mul_i32 s41, s41, 72
    s_sub_u32 s42, s16, 18
    s_lshl_b32 s42, s42, 3
    s_add_u32 s41, s41, s42
    s_lshl_b32 s42, s18, 2
    s_add_u32 s41, s41, s42
    s_mul_i32 s41, s41, 33
    s_and_b32 s42, s17, 3
    s_lshl_b32 s42, s42, 3
    s_add_u32 s41, s41, s42
    s_lshl_b32 s42, s19, 2
    s_add_u32 s41, s41, s42
    s_lshl_b32 s20, s41, 10
    s_add_u32 s21, s20, 33792
    s_add_u32 s22, s21, 33792
    s_add_u32 s23, s22, 33792
    s_mov_b32 s32, s60
    s_mov_b32 s33, s61
    s_mov_b32 s34, 0x288000
    s_mov_b32 s35, 0x20000
    s_sub_u32 s3, s2, 144
    s_lshl_b32 s3, s3, 2
    s_add_u32 s3, s3, s10
    s_lshl_b32 s3, s3, 13
    v_lshlrev_b32 v122, 7, v2
    v_add_u32 v122, s3, v122
    s_barrier
    ds_read_b64_tr_b16 v[16:17], v118 offset:0
    ds_read_b64_tr_b16 v[18:19], v118 offset:1024
    ds_read_b128 v[32:35], v117 offset:0
    ds_read_b128 v[36:39], v117 offset:2048
    ds_read_b128 v[40:43], v117 offset:4096
    ds_read_b64_tr_b16 v[20:21], v119 offset:0
    ds_read_b64_tr_b16 v[22:23], v119 offset:1024
    ds_read_b128 v[44:47], v117 offset:6144
    ds_read_b128 v[48:51], v117 offset:8192
    ds_read_b128 v[52:55], v117 offset:10240
    ds_read_b64_tr_b16 v[24:25], v120 offset:0
    ds_read_b64_tr_b16 v[26:27], v120 offset:1024
    ds_read_b128 v[56:59], v117 offset:12288
    ds_read_b128 v[60:63], v117 offset:14336
    ds_read_b64_tr_b16 v[28:29], v121 offset:0
    ds_read_b64_tr_b16 v[30:31], v121 offset:1024
    s_branch P2V_mid
P2V_loop:
    v_mfma_f32_16x16x32_bf16 v[128:131], v[80:83], v[64:67], v[128:131]
    v_mfma_f32_16x16x32_bf16 v[132:135], v[84:87], v[64:67], v[132:135]
    s_barrier
    v_mfma_f32_16x16x32_bf16 v[136:139], v[88:91], v[64:67], v[136:139]
    ds_read_b64_tr_b16 v[16:17], v118 offset:0
    v_mfma_f32_16x16x32_bf16 v[140:143], v[92:95], v[64:67], v[140:143]
    ds_read_b64_tr_b16 v[18:19], v118 offset:1024
    v_mfma_f32_16x16x32_bf16 v[144:147], v[96:99], v[64:67], v[144:147]
    ds_read_b128 v[32:35], v117 offset:0
    v_mfma_f32_16x16x32_bf16 v[148:151], v[100:103], v[64:67], v[148:151]
    ds_read_b128 v[36:39], v117 offset:2048
    v_mfma_f32_16x16x32_bf16 v[152:155], v[104:107], v[64:67], v[152:155]
    v_mfma_f32_16x16x32_bf16 v[156:159], v[108:111], v[64:67], v[156:159]
    ds_read_b128 v[40:43], v117 offset:4096
    v_mfma_f32_16x16x32_bf16 v[160:163], v[80:83], v[68:71], v[160:163]
    ds_read_b64_tr_b16 v[20:21], v119 offset:0
    v_mfma_f32_16x16x32_bf16 v[164:167], v[84:87], v[68:71], v[164:167]
    ds_read_b64_tr_b16 v[22:23], v119 offset:1024
    v_mfma_f32_16x16x32_bf16 v[168:171], v[88:91], v[68:71], v[168:171]
    v_mfma_f32_16x16x32_bf16 v[172:175], v[92:95], v[68:71], v[172:175]
    ds_read_b128 v[44:47], v117 offset:6144
    v_mfma_f32_16x16x32_bf16 v[176:179], v[96:99], v[68:71], v[176:179]
    ds_read_b128 v[48:51], v117 offset:8192
    v_mfma_f32_16x16x32_bf16 v[180:183], v[100:103], v[68:71], v[180:183]
    ds_read_b128 v[52:55], v117 offset:10240
    v_mfma_f32_16x16x32_bf16 v[184:187], v[104:107], v[68:71], v[184:187]
    v_mfma_f32_16x16x32_bf16 v[188:191], v[108:111], v[68:71], v[188:191]
    ds_read_b64_tr_b16 v[24:25], v120 offset:0
    v_mfma_f32_16x16x32_bf16 v[192:195], v[80:83], v[72:75], v[192:195]
    ds_read_b64_tr_b16 v[26:27], v120 offset:1024
    v_mfma_f32_16x16x32_bf16 v[196:199], v[84:87], v[72:75], v[196:199]
    ds_read_b128 v[56:59], v117 offset:12288
    v_mfma_f32_16x16x32_bf16 v[200:203], v[88:91], v[72:75], v[200:203]
    ds_read_b128 v[60:63], v117 offset:14336
    v_mfma_f32_16x16x32_bf16 v[204:207], v[92:95], v[72:75], v[204:207]
    v_mfma_f32_16x16x32_bf16 v[208:211], v[96:99], v[72:75], v[208:211]
    ds_read_b64_tr_b16 v[28:29], v121 offset:0
    v_mfma_f32_16x16x32_bf16 v[212:215], v[100:103], v[72:75], v[212:215]
    ds_read_b64_tr_b16 v[30:31], v121 offset:1024
    v_mfma_f32_16x16x32_bf16 v[216:219], v[104:107], v[72:75], v[216:219]
    v_mfma_f32_16x16x32_bf16 v[220:223], v[108:111], v[72:75], v[220:223]
    v_mfma_f32_16x16x32_bf16 v[224:227], v[80:83], v[76:79], v[224:227]
    v_mfma_f32_16x16x32_bf16 v[228:231], v[84:87], v[76:79], v[228:231]
    v_mfma_f32_16x16x32_bf16 v[232:235], v[88:91], v[76:79], v[232:235]
    v_mfma_f32_16x16x32_bf16 v[236:239], v[92:95], v[76:79], v[236:239]
    v_mfma_f32_16x16x32_bf16 v[240:243], v[96:99], v[76:79], v[240:243]
    v_mfma_f32_16x16x32_bf16 v[244:247], v[100:103], v[76:79], v[244:247]
    v_mfma_f32_16x16x32_bf16 v[248:251], v[104:107], v[76:79], v[248:251]
    v_mfma_f32_16x16x32_bf16 v[252:255], v[108:111], v[76:79], v[252:255]
P2V_mid:
    s_waitcnt lgkmcnt(0)
    v_mfma_f32_16x16x32_bf16 v[128:131], v[32:35], v[16:19], v[128:131]
    ds_read_b64_tr_b16 v[64:65], v118 offset:8192
    v_mfma_f32_16x16x32_bf16 v[132:135], v[36:39], v[16:19], v[132:135]
    ds_read_b64_tr_b16 v[66:67], v118 offset:9216
    v_mfma_f32_16x16x32_bf16 v[136:139], v[40:43], v[16:19], v[136:139]
    ds_read_b128 v[80:83], v124 offset:0
    v_mfma_f32_16x16x32_bf16 v[140:143], v[44:47], v[16:19], v[140:143]
    ds_read_b128 v[84:87], v124 offset:2048
    v_mfma_f32_16x16x32_bf16 v[144:147], v[48:51], v[16:19], v[144:147]
    ds_read_b128 v[88:91], v124 offset:4096
    v_mfma_f32_16x16x32_bf16 v[148:151], v[52:55], v[16:19], v[148:151]
    ds_read_b64_tr_b16 v[68:69], v119 offset:8192
    v_mfma_f32_16x16x32_bf16 v[152:155], v[56:59], v[16:19], v[152:155]
    ds_read_b64_tr_b16 v[70:71], v119 offset:9216
    v_mfma_f32_16x16x32_bf16 v[156:159], v[60:63], v[16:19], v[156:159]
    v_mfma_f32_16x16x32_bf16 v[160:163], v[32:35], v[20:23], v[160:163]
    ds_read_b128 v[92:95], v124 offset:6144
    v_mfma_f32_16x16x32_bf16 v[164:167], v[36:39], v[20:23], v[164:167]
    ds_read_b128 v[96:99], v124 offset:8192
    v_mfma_f32_16x16x32_bf16 v[168:171], v[40:43], v[20:23], v[168:171]
    ds_read_b128 v[100:103], v124 offset:10240
    v_mfma_f32_16x16x32_bf16 v[172:175], v[44:47], v[20:23], v[172:175]
    ds_read_b64_tr_b16 v[72:73], v120 offset:8192
    v_mfma_f32_16x16x32_bf16 v[176:179], v[48:51], v[20:23], v[176:179]
    ds_read_b64_tr_b16 v[74:75], v120 offset:9216
    v_mfma_f32_16x16x32_bf16 v[180:183], v[52:55], v[20:23], v[180:183]
    ds_read_b128 v[104:107], v124 offset:12288
    v_mfma_f32_16x16x32_bf16 v[184:187], v[56:59], v[20:23], v[184:187]
    ds_read_b128 v[108:111], v124 offset:14336
    v_mfma_f32_16x16x32_bf16 v[188:191], v[60:63], v[20:23], v[188:191]
    v_mfma_f32_16x16x32_bf16 v[192:195], v[32:35], v[24:27], v[192:195]
    ds_read_b64_tr_b16 v[76:77], v121 offset:8192
    v_mfma_f32_16x16x32_bf16 v[196:199], v[36:39], v[24:27], v[196:199]
    ds_read_b64_tr_b16 v[78:79], v121 offset:9216
    v_mfma_f32_16x16x32_bf16 v[200:203], v[40:43], v[24:27], v[200:203]
    s_add_u32 s44, s44, 49152
    v_mfma_f32_16x16x32_bf16 v[204:207], v[44:47], v[24:27], v[204:207]
    s_cmp_eq_u32 s44, 147456
    v_mfma_f32_16x16x32_bf16 v[208:211], v[48:51], v[24:27], v[208:211]
    s_cselect_b32 s44, 0, s44
    v_mfma_f32_16x16x32_bf16 v[212:215], v[52:55], v[24:27], v[212:215]
    v_add_u32 v117, s44, v112
    v_mfma_f32_16x16x32_bf16 v[216:219], v[56:59], v[24:27], v[216:219]
    v_mfma_f32_16x16x32_bf16 v[220:223], v[60:63], v[24:27], v[220:223]
    v_xor_b32 v124, 64, v117
    v_mfma_f32_16x16x32_bf16 v[224:227], v[32:35], v[28:31], v[224:227]
    v_add_u32 v118, s44, v113
    v_mfma_f32_16x16x32_bf16 v[228:231], v[36:39], v[28:31], v[228:231]
    v_add_u32 v119, s44, v114
    v_mfma_f32_16x16x32_bf16 v[232:235], v[40:43], v[28:31], v[232:235]
    v_add_u32 v120, s44, v115
    v_mfma_f32_16x16x32_bf16 v[236:239], v[44:47], v[28:31], v[236:239]
    v_add_u32 v121, s44, v116
    v_mfma_f32_16x16x32_bf16 v[240:243], v[48:51], v[28:31], v[240:243]
    s_sub_u32 s45, s45, 1
    v_mfma_f32_16x16x32_bf16 v[244:247], v[52:55], v[28:31], v[244:247]
    s_cmp_lg_u32 s45, 0
    v_mfma_f32_16x16x32_bf16 v[248:251], v[56:59], v[28:31], v[248:251]
    v_mfma_f32_16x16x32_bf16 v[252:255], v[60:63], v[28:31], v[252:255]
    s_waitcnt lgkmcnt(0)
    s_cbranch_scc1 P2V_loop
    s_barrier
    v_mfma_f32_16x16x32_bf16 v[128:131], v[80:83], v[64:67], v[128:131]
    v_mfma_f32_16x16x32_bf16 v[160:163], v[80:83], v[68:71], v[160:163]
    v_mfma_f32_16x16x32_bf16 v[192:195], v[80:83], v[72:75], v[192:195]
    v_mfma_f32_16x16x32_bf16 v[224:227], v[80:83], v[76:79], v[224:227]
    v_mfma_f32_16x16x32_bf16 v[132:135], v[84:87], v[64:67], v[132:135]
    v_mfma_f32_16x16x32_bf16 v[164:167], v[84:87], v[68:71], v[164:167]
    v_mfma_f32_16x16x32_bf16 v[196:199], v[84:87], v[72:75], v[196:199]
    v_mfma_f32_16x16x32_bf16 v[228:231], v[84:87], v[76:79], v[228:231]
    v_mfma_f32_16x16x32_bf16 v[136:139], v[88:91], v[64:67], v[136:139]
    v_mfma_f32_16x16x32_bf16 v[168:171], v[88:91], v[68:71], v[168:171]
    v_mfma_f32_16x16x32_bf16 v[200:203], v[88:91], v[72:75], v[200:203]
    v_cvt_pk_bf16_f32 v16, v128, v129
    v_cvt_pk_bf16_f32 v17, v130, v131
    v_cvt_pk_bf16_f32 v18, v132, v133
    v_cvt_pk_bf16_f32 v19, v134, v135
    v_mfma_f32_16x16x32_bf16 v[232:235], v[88:91], v[76:79], v[232:235]
    buffer_store_dwordx4 v[16:19], v3, s[28:31], s20 offen offset:0 sc1
    v_cvt_pk_bf16_f32 v20, v160, v161
    v_cvt_pk_bf16_f32 v21, v162, v163
    v_mfma_f32_16x16x32_bf16 v[140:143], v[92:95], v[64:67], v[140:143]
    v_cvt_pk_bf16_f32 v22, v164, v165
    v_cvt_pk_bf16_f32 v23, v166, v167
    buffer_store_dwordx4 v[20:23], v3, s[28:31], s21 offen offset:0 sc1
    v_mfma_f32_16x16x32_bf16 v[172:175], v[92:95], v[68:71], v[172:175]
    v_cvt_pk_bf16_f32 v24, v192, v193
    v_cvt_pk_bf16_f32 v25, v194, v195
    v_cvt_pk_bf16_f32 v26, v196, v197
    v_cvt_pk_bf16_f32 v27, v198, v199
    v_mfma_f32_16x16x32_bf16 v[204:207], v[92:95], v[72:75], v[204:207]
    buffer_store_dwordx4 v[24:27], v3, s[28:31], s22 offen offset:0 sc1
    v_cvt_pk_bf16_f32 v28, v224, v225
    v_cvt_pk_bf16_f32 v29, v226, v227
    v_mfma_f32_16x16x32_bf16 v[236:239], v[92:95], v[76:79], v[236:239]
    v_cvt_pk_bf16_f32 v30, v228, v229
    v_cvt_pk_bf16_f32 v31, v230, v231
    buffer_store_dwordx4 v[28:31], v3, s[28:31], s23 offen offset:0 sc1
    v_mfma_f32_16x16x32_bf16 v[144:147], v[96:99], v[64:67], v[144:147]
    v_mfma_f32_16x16x32_bf16 v[176:179], v[96:99], v[68:71], v[176:179]
    v_mfma_f32_16x16x32_bf16 v[208:211], v[96:99], v[72:75], v[208:211]
    v_cvt_pk_bf16_f32 v32, v136, v137
    v_cvt_pk_bf16_f32 v33, v138, v139
    v_cvt_pk_bf16_f32 v34, v140, v141
    v_cvt_pk_bf16_f32 v35, v142, v143
    v_mfma_f32_16x16x32_bf16 v[240:243], v[96:99], v[76:79], v[240:243]
    buffer_store_dwordx4 v[32:35], v3, s[28:31], s20 offen offset:1024 sc1
    v_cvt_pk_bf16_f32 v36, v168, v169
    v_cvt_pk_bf16_f32 v37, v170, v171
    v_mfma_f32_16x16x32_bf16 v[148:151], v[100:103], v[64:67], v[148:151]
    v_cvt_pk_bf16_f32 v38, v172, v173
    v_cvt_pk_bf16_f32 v39, v174, v175
    buffer_store_dwordx4 v[36:39], v3, s[28:31], s21 offen offset:1024 sc1
    v_mfma_f32_16x16x32_bf16 v[180:183], v[100:103], v[68:71], v[180:183]
    v_cvt_pk_bf16_f32 v40, v200, v201
    v_cvt_pk_bf16_f32 v41, v202, v203
    v_cvt_pk_bf16_f32 v42, v204, v205
    v_cvt_pk_bf16_f32 v43, v206, v207
    v_mfma_f32_16x16x32_bf16 v[212:215], v[100:103], v[72:75], v[212:215]
    buffer_store_dwordx4 v[40:43], v3, s[28:31], s22 offen offset:1024 sc1
    v_cvt_pk_bf16_f32 v44, v232, v233
    v_cvt_pk_bf16_f32 v45, v234, v235
    v_mfma_f32_16x16x32_bf16 v[244:247], v[100:103], v[76:79], v[244:247]
    v_cvt_pk_bf16_f32 v46, v236, v237
    v_cvt_pk_bf16_f32 v47, v238, v239
    buffer_store_dwordx4 v[44:47], v3, s[28:31], s23 offen offset:1024 sc1
    v_mfma_f32_16x16x32_bf16 v[152:155], v[104:107], v[64:67], v[152:155]
    v_mfma_f32_16x16x32_bf16 v[184:187], v[104:107], v[68:71], v[184:187]
    v_mfma_f32_16x16x32_bf16 v[216:219], v[104:107], v[72:75], v[216:219]
    v_cvt_pk_bf16_f32 v48, v144, v145
    v_cvt_pk_bf16_f32 v49, v146, v147
    v_cvt_pk_bf16_f32 v50, v148, v149
    v_cvt_pk_bf16_f32 v51, v150, v151
    v_mfma_f32_16x16x32_bf16 v[248:251], v[104:107], v[76:79], v[248:251]
    buffer_store_dwordx4 v[48:51], v3, s[28:31], s20 offen offset:2048 sc1
    v_cvt_pk_bf16_f32 v52, v176, v177
    v_cvt_pk_bf16_f32 v53, v178, v179
    v_mfma_f32_16x16x32_bf16 v[156:159], v[108:111], v[64:67], v[156:159]
    v_cvt_pk_bf16_f32 v54, v180, v181
    v_cvt_pk_bf16_f32 v55, v182, v183
    buffer_store_dwordx4 v[52:55], v3, s[28:31], s21 offen offset:2048 sc1
    v_mfma_f32_16x16x32_bf16 v[188:191], v[108:111], v[68:71], v[188:191]
    v_cvt_pk_bf16_f32 v56, v208, v209
    v_cvt_pk_bf16_f32 v57, v210, v211
    v_cvt_pk_bf16_f32 v58, v212, v213
    v_cvt_pk_bf16_f32 v59, v214, v215
    v_mfma_f32_16x16x32_bf16 v[220:223], v[108:111], v[72:75], v[220:223]
    buffer_store_dwordx4 v[56:59], v3, s[28:31], s22 offen offset:2048 sc1
    v_cvt_pk_bf16_f32 v60, v240, v241
    v_cvt_pk_bf16_f32 v61, v242, v243
    v_mfma_f32_16x16x32_bf16 v[252:255], v[108:111], v[76:79], v[252:255]
    v_cvt_pk_bf16_f32 v62, v244, v245
    v_cvt_pk_bf16_f32 v63, v246, v247
    buffer_store_dwordx4 v[60:63], v3, s[28:31], s23 offen offset:2048 sc1
    v_cvt_pk_bf16_f32 v16, v152, v153
    v_cvt_pk_bf16_f32 v17, v154, v155
    v_cvt_pk_bf16_f32 v18, v156, v157
    v_cvt_pk_bf16_f32 v19, v158, v159
    buffer_store_dwordx4 v[16:19], v3, s[28:31], s20 offen offset:3072 sc1
    v_cvt_pk_bf16_f32 v20, v184, v185
    v_cvt_pk_bf16_f32 v21, v186, v187
    v_cvt_pk_bf16_f32 v22, v188, v189
    v_cvt_pk_bf16_f32 v23, v190, v191
    buffer_store_dwordx4 v[20:23], v3, s[28:31], s21 offen offset:3072 sc1
    v_cvt_pk_bf16_f32 v24, v216, v217
    v_cvt_pk_bf16_f32 v25, v218, v219
    v_cvt_pk_bf16_f32 v26, v220, v221
    v_cvt_pk_bf16_f32 v27, v222, v223
    buffer_store_dwordx4 v[24:27], v3, s[28:31], s22 offen offset:3072 sc1
    v_cvt_pk_bf16_f32 v28, v248, v249
    v_cvt_pk_bf16_f32 v29, v250, v251
    v_cvt_pk_bf16_f32 v30, v252, v253
    v_cvt_pk_bf16_f32 v31, v254, v255
    buffer_store_dwordx4 v[28:31], v3, s[28:31], s23 offen offset:3072 sc1
    s_branch P2_fin
P2_gate:
    s_load_dwordx4 s[4:7], s[0:1], 56
    s_cmp_lg_u32 s10, 4
    s_cbranch_scc1 P2_g0
    v_and_b32 v8, 0xff, v250
    v_lshlrev_b32 v8, 7, v8
    v_lshrrev_b32 v9, 8, v250
    v_and_b32 v9, 7, v9
    v_add_u32 v9, s86, v9
    s_mov_b32 s3, 0x400000
POLL_20:
    buffer_load_dword v10, v8, s[76:79], 0 offen sc1
    s_sub_u32 s3, s3, 1
    s_waitcnt vmcnt(0)
    v_sub_u32 v10, v10, v9
    v_cmp_lt_u32 vcc, 7, v10
    s_nop 0
    s_cbranch_vccz POLLE_21
    s_cmp_eq_u32 s3, 0
    s_cbranch_scc1 POLLE_21
    s_nop 0
    s_branch POLL_20
POLLE_21:
P2_g0:
    s_bfe_u32 s18, s80, 0x60018
    s_lshr_b32 s19, s80, 30
    v_lshrrev_b32 v1, 3, v2
    s_mul_i32 s17, s10, 144
    v_add_u32 v1, s17, v1
    s_movk_i32 s17, 13824
    v_mul_lo_u32 v4, v1, s17
    v_and_b32 v7, 7, v2
    v_lshlrev_b32 v7, 4, v7
    v_add_u32 v4, v4, v7
    v_lshlrev_b32 v5, 2, v1
    s_movk_i32 s41, 4608
    s_lshl_b32 s17, s10, 9
    v_and_b32 v1, 32, v2
    v_lshlrev_b32 v1, 3, v1
    v_lshl_add_u32 v1, v7, 1, v1
    v_and_b32 v6, 16, v2
    v_add3_u32 v1, v1, v6, s17
    v_min_u32 v6, 31, v2
    v_lshlrev_b32 v7, 4, v6
    v_lshrrev_b32 v68, 4, v6
    v_mul_u32_u24 v68, 2176, v68
    v_lshl_add_u32 v68, v6, 3, v68
    s_add_u32 s24, s84, 0x28000
    s_addc_u32 s25, s85, 0
    s_mov_b32 s26, 0x2400
    s_mov_b32 s27, 0x20000
    s_add_u32 s32, s84, 0x20000
    s_addc_u32 s33, s85, 0
    s_mov_b32 s34, 0x2400
    s_mov_b32 s35, 0x20000
    s_waitcnt lgkmcnt(0)
    s_barrier
    buffer_load_dword v8, v5, s[24:27], 0 offen offset:0 sc1
    buffer_load_dword v9, v5, s[24:27], s41 offen offset:0 sc1
    buffer_load_dword v10, v5, s[24:27], 0 offen offset:32 sc1
    buffer_load_dword v11, v5, s[24:27], s41 offen offset:32 sc1
    buffer_load_dword v12, v5, s[24:27], 0 offen offset:64 sc1
    buffer_load_dword v13, v5, s[24:27], s41 offen offset:64 sc1
    buffer_load_dword v14, v5, s[24:27], 0 offen offset:96 sc1
    buffer_load_dword v15, v5, s[24:27], s41 offen offset:96 sc1
    buffer_load_dword v16, v5, s[24:27], 0 offen offset:128 sc1
    buffer_load_dword v17, v5, s[24:27], s41 offen offset:128 sc1
    buffer_load_dword v18, v5, s[24:27], 0 offen offset:160 sc1
    buffer_load_dword v19, v5, s[24:27], s41 offen offset:160 sc1
    buffer_load_dword v20, v5, s[24:27], 0 offen offset:192 sc1
    buffer_load_dword v21, v5, s[24:27], s41 offen offset:192 sc1
    buffer_load_dword v22, v5, s[24:27], 0 offen offset:224 sc1
    buffer_load_dword v23, v5, s[24:27], s41 offen offset:224 sc1
    buffer_load_dword v24, v5, s[24:27], 0 offen offset:256 sc1
    buffer_load_dword v25, v5, s[24:27], s41 offen offset:256 sc1
    buffer_load_dword v26, v5, s[24:27], 0 offen offset:288 sc1
    buffer_load_dword v27, v5, s[24:27], s41 offen offset:288 sc1
    buffer_load_dword v28, v5, s[24:27], 0 offen offset:320 sc1
    buffer_load_dword v29, v5, s[24:27], s41 offen offset:320 sc1
    buffer_load_dword v30, v5, s[24:27], 0 offen offset:352 sc1
    buffer_load_dword v31, v5, s[24:27], s41 offen offset:352 sc1
    buffer_load_dword v32, v5, s[24:27], 0 offen offset:384 sc1
    buffer_load_dword v33, v5, s[24:27], s41 offen offset:384 sc1
    buffer_load_dword v34, v5, s[24:27], 0 offen offset:416 sc1
    buffer_load_dword v35, v5, s[24:27], s41 offen offset:416 sc1
    buffer_load_dword v36, v5, s[24:27], 0 offen offset:448 sc1
    buffer_load_dword v37, v5, s[24:27], s41 offen offset:448 sc1
    buffer_load_dword v38, v5, s[24:27], 0 offen offset:480 sc1
    buffer_load_dword v39, v5, s[24:27], s41 offen offset:480 sc1
    buffer_load_dword v40, v5, s[24:27], 0 offen offset:512 sc1
    buffer_load_dword v41, v5, s[24:27], s41 offen offset:512 sc1
    buffer_load_dword v42, v5, s[24:27], 0 offen offset:544 sc1
    buffer_load_dword v43, v5, s[24:27], s41 offen offset:544 sc1
P2_gl:
    s_cmp_ge_u32 s18, 18
    s_cselect_b32 s20, s6, s4
    s_cselect_b32 s21, s7, s5
    s_cselect_b32 s14, 18, 0
    s_cselect_b32 s16, 4608, 0
    s_mov_b32 s22, 15925248
    s_mov_b32 s23, 0x20000
    s_sub_u32 s14, s18, s14
    s_lshl_b32 s14, s14, 7
    s_add_u32 s16, s16, s14
    s_add_u32 s42, s14, 4608
    buffer_load_dwordx4 v[100:103], v4, s[20:23], s42 offen nt
    s_add_u32 s42, s42, 110592
    buffer_load_dwordx4 v[104:107], v4, s[20:23], s42 offen nt
    s_add_u32 s42, s42, 110592
    buffer_load_dwordx4 v[108:111], v4, s[20:23], s42 offen nt
    s_add_u32 s42, s42, 110592
    buffer_load_dwordx4 v[112:115], v4, s[20:23], s42 offen nt
    s_add_u32 s42, s42, 110592
    buffer_load_dwordx4 v[116:119], v4, s[20:23], s42 offen nt
    s_add_u32 s42, s42, 110592
    buffer_load_dwordx4 v[120:123], v4, s[20:23], s42 offen nt
    s_add_u32 s42, s42, 110592
    buffer_load_dwordx4 v[124:127], v4, s[20:23], s42 offen nt
    s_add_u32 s42, s42, 110592
    buffer_load_dwordx4 v[128:131], v4, s[20:23], s42 offen nt
    s_add_u32 s42, s42, 110592
    buffer_load_dwordx4 v[132:135], v4, s[20:23], s42 offen nt
    s_add_u32 s42, s42, 110592
    buffer_load_dwordx4 v[136:139], v4, s[20:23], s42 offen nt
    s_add_u32 s42, s42, 110592
    buffer_load_dwordx4 v[140:143], v4, s[20:23], s42 offen nt
    s_add_u32 s42, s42, 110592
    buffer_load_dwordx4 v[144:147], v4, s[20:23], s42 offen nt
    s_add_u32 s42, s42, 110592
    buffer_load_dwordx4 v[148:151], v4, s[20:23], s42 offen nt
    s_add_u32 s42, s42, 110592
    buffer_load_dwordx4 v[152:155], v4, s[20:23], s42 offen nt
    s_add_u32 s42, s42, 110592
    buffer_load_dwordx4 v[156:159], v4, s[20:23], s42 offen nt
    s_add_u32 s42, s42, 110592
    buffer_load_dwordx4 v[160:163], v4, s[20:23], s42 offen nt
    s_add_u32 s42, s42, 110592
    buffer_load_dwordx4 v[164:167], v4, s[20:23], s42 offen nt
    s_add_u32 s42, s42, 110592
    buffer_load_dwordx4 v[168:171], v4, s[20:23], s42 offen nt
    s_add_u32 s42, s42, 110592
    v_mov_b64 v[52:53], 0
    v_mov_b64 v[54:55], 0
    v_mov_b64 v[56:57], 0
    v_mov_b64 v[58:59], 0
    v_mov_b64 v[60:61], 0
    v_mov_b64 v[62:63], 0
    v_mov_b64 v[64:65], 0
    v_mov_b64 v[66:67], 0
    s_waitcnt vmcnt(17)
    v_lshlrev_b32 v44, 16, v100
    v_and_b32 v45, s40, v100
    v_lshlrev_b32 v46, 16, v101
    v_and_b32 v47, s40, v101
    v_lshlrev_b32 v48, 16, v102
    v_and_b32 v49, s40, v102
    v_lshlrev_b32 v50, 16, v103
    v_and_b32 v51, s40, v103
    v_pk_fma_f32 v[52:53], v[44:45], v[8:9], v[52:53] op_sel_hi:[1,0,1]
    v_pk_fma_f32 v[54:55], v[46:47], v[8:9], v[54:55] op_sel_hi:[1,0,1]
    v_pk_fma_f32 v[56:57], v[48:49], v[8:9], v[56:57] op_sel_hi:[1,0,1]
    v_pk_fma_f32 v[58:59], v[50:51], v[8:9], v[58:59] op_sel_hi:[1,0,1]
    v_pk_fma_f32 v[60:61], v[44:45], v[8:9], v[60:61] op_sel:[0,1,0] op_sel_hi:[1,1,1]
    v_pk_fma_f32 v[62:63], v[46:47], v[8:9], v[62:63] op_sel:[0,1,0] op_sel_hi:[1,1,1]
    v_pk_fma_f32 v[64:65], v[48:49], v[8:9], v[64:65] op_sel:[0,1,0] op_sel_hi:[1,1,1]
    v_pk_fma_f32 v[66:67], v[50:51], v[8:9], v[66:67] op_sel:[0,1,0] op_sel_hi:[1,1,1]
    s_waitcnt vmcnt(16)
    v_lshlrev_b32 v44, 16, v104
    v_and_b32 v45, s40, v104
    v_lshlrev_b32 v46, 16, v105
    v_and_b32 v47, s40, v105
    v_lshlrev_b32 v48, 16, v106
    v_and_b32 v49, s40, v106
    v_lshlrev_b32 v50, 16, v107
    v_and_b32 v51, s40, v107
    v_pk_fma_f32 v[52:53], v[44:45], v[10:11], v[52:53] op_sel_hi:[1,0,1]
    v_pk_fma_f32 v[54:55], v[46:47], v[10:11], v[54:55] op_sel_hi:[1,0,1]
    v_pk_fma_f32 v[56:57], v[48:49], v[10:11], v[56:57] op_sel_hi:[1,0,1]
    v_pk_fma_f32 v[58:59], v[50:51], v[10:11], v[58:59] op_sel_hi:[1,0,1]
    v_pk_fma_f32 v[60:61], v[44:45], v[10:11], v[60:61] op_sel:[0,1,0] op_sel_hi:[1,1,1]
    v_pk_fma_f32 v[62:63], v[46:47], v[10:11], v[62:63] op_sel:[0,1,0] op_sel_hi:[1,1,1]
    v_pk_fma_f32 v[64:65], v[48:49], v[10:11], v[64:65] op_sel:[0,1,0] op_sel_hi:[1,1,1]
    v_pk_fma_f32 v[66:67], v[50:51], v[10:11], v[66:67] op_sel:[0,1,0] op_sel_hi:[1,1,1]
    s_waitcnt vmcnt(15)
    v_lshlrev_b32 v44, 16, v108
    v_and_b32 v45, s40, v108
    v_lshlrev_b32 v46, 16, v109
    v_and_b32 v47, s40, v109
    v_lshlrev_b32 v48, 16, v110
    v_and_b32 v49, s40, v110
    v_lshlrev_b32 v50, 16, v111
    v_and_b32 v51, s40, v111
    v_pk_fma_f32 v[52:53], v[44:45], v[12:13], v[52:53] op_sel_hi:[1,0,1]
    v_pk_fma_f32 v[54:55], v[46:47], v[12:13], v[54:55] op_sel_hi:[1,0,1]
    v_pk_fma_f32 v[56:57], v[48:49], v[12:13], v[56:57] op_sel_hi:[1,0,1]
    v_pk_fma_f32 v[58:59], v[50:51], v[12:13], v[58:59] op_sel_hi:[1,0,1]
    v_pk_fma_f32 v[60:61], v[44:45], v[12:13], v[60:61] op_sel:[0,1,0] op_sel_hi:[1,1,1]
    v_pk_fma_f32 v[62:63], v[46:47], v[12:13], v[62:63] op_sel:[0,1,0] op_sel_hi:[1,1,1]
    v_pk_fma_f32 v[64:65], v[48:49], v[12:13], v[64:65] op_sel:[0,1,0] op_sel_hi:[1,1,1]
    v_pk_fma_f32 v[66:67], v[50:51], v[12:13], v[66:67] op_sel:[0,1,0] op_sel_hi:[1,1,1]
    s_waitcnt vmcnt(14)
    v_lshlrev_b32 v44, 16, v112
    v_and_b32 v45, s40, v112
    v_lshlrev_b32 v46, 16, v113
    v_and_b32 v47, s40, v113
    v_lshlrev_b32 v48, 16, v114
    v_and_b32 v49, s40, v114
    v_lshlrev_b32 v50, 16, v115
    v_and_b32 v51, s40, v115
    v_pk_fma_f32 v[52:53], v[44:45], v[14:15], v[52:53] op_sel_hi:[1,0,1]
    v_pk_fma_f32 v[54:55], v[46:47], v[14:15], v[54:55] op_sel_hi:[1,0,1]
    v_pk_fma_f32 v[56:57], v[48:49], v[14:15], v[56:57] op_sel_hi:[1,0,1]
    v_pk_fma_f32 v[58:59], v[50:51], v[14:15], v[58:59] op_sel_hi:[1,0,1]
    v_pk_fma_f32 v[60:61], v[44:45], v[14:15], v[60:61] op_sel:[0,1,0] op_sel_hi:[1,1,1]
    v_pk_fma_f32 v[62:63], v[46:47], v[14:15], v[62:63] op_sel:[0,1,0] op_sel_hi:[1,1,1]
    v_pk_fma_f32 v[64:65], v[48:49], v[14:15], v[64:65] op_sel:[0,1,0] op_sel_hi:[1,1,1]
    v_pk_fma_f32 v[66:67], v[50:51], v[14:15], v[66:67] op_sel:[0,1,0] op_sel_hi:[1,1,1]
    s_waitcnt vmcnt(13)
    v_lshlrev_b32 v44, 16, v116
    v_and_b32 v45, s40, v116
    v_lshlrev_b32 v46, 16, v117
    v_and_b32 v47, s40, v117
    v_lshlrev_b32 v48, 16, v118
    v_and_b32 v49, s40, v118
    v_lshlrev_b32 v50, 16, v119
    v_and_b32 v51, s40, v119
    v_pk_fma_f32 v[52:53], v[44:45], v[16:17], v[52:53] op_sel_hi:[1,0,1]
    v_pk_fma_f32 v[54:55], v[46:47], v[16:17], v[54:55] op_sel_hi:[1,0,1]
    v_pk_fma_f32 v[56:57], v[48:49], v[16:17], v[56:57] op_sel_hi:[1,0,1]
    v_pk_fma_f32 v[58:59], v[50:51], v[16:17], v[58:59] op_sel_hi:[1,0,1]
    v_pk_fma_f32 v[60:61], v[44:45], v[16:17], v[60:61] op_sel:[0,1,0] op_sel_hi:[1,1,1]
    v_pk_fma_f32 v[62:63], v[46:47], v[16:17], v[62:63] op_sel:[0,1,0] op_sel_hi:[1,1,1]
    v_pk_fma_f32 v[64:65], v[48:49], v[16:17], v[64:65] op_sel:[0,1,0] op_sel_hi:[1,1,1]
    v_pk_fma_f32 v[66:67], v[50:51], v[16:17], v[66:67] op_sel:[0,1,0] op_sel_hi:[1,1,1]
    s_waitcnt vmcnt(12)
    v_lshlrev_b32 v44, 16, v120
    v_and_b32 v45, s40, v120
    v_lshlrev_b32 v46, 16, v121
    v_and_b32 v47, s40, v121
    v_lshlrev_b32 v48, 16, v122
    v_and_b32 v49, s40, v122
    v_lshlrev_b32 v50, 16, v123
    v_and_b32 v51, s40, v123
    v_pk_fma_f32 v[52:53], v[44:45], v[18:19], v[52:53] op_sel_hi:[1,0,1]
    v_pk_fma_f32 v[54:55], v[46:47], v[18:19], v[54:55] op_sel_hi:[1,0,1]
    v_pk_fma_f32 v[56:57], v[48:49], v[18:19], v[56:57] op_sel_hi:[1,0,1]
    v_pk_fma_f32 v[58:59], v[50:51], v[18:19], v[58:59] op_sel_hi:[1,0,1]
    v_pk_fma_f32 v[60:61], v[44:45], v[18:19], v[60:61] op_sel:[0,1,0] op_sel_hi:[1,1,1]
    v_pk_fma_f32 v[62:63], v[46:47], v[18:19], v[62:63] op_sel:[0,1,0] op_sel_hi:[1,1,1]
    v_pk_fma_f32 v[64:65], v[48:49], v[18:19], v[64:65] op_sel:[0,1,0] op_sel_hi:[1,1,1]
    v_pk_fma_f32 v[66:67], v[50:51], v[18:19], v[66:67] op_sel:[0,1,0] op_sel_hi:[1,1,1]
    s_waitcnt vmcnt(11)
    v_lshlrev_b32 v44, 16, v124
    v_and_b32 v45, s40, v124
    v_lshlrev_b32 v46, 16, v125
    v_and_b32 v47, s40, v125
    v_lshlrev_b32 v48, 16, v126
    v_and_b32 v49, s40, v126
    v_lshlrev_b32 v50, 16, v127
    v_and_b32 v51, s40, v127
    v_pk_fma_f32 v[52:53], v[44:45], v[20:21], v[52:53] op_sel_hi:[1,0,1]
    v_pk_fma_f32 v[54:55], v[46:47], v[20:21], v[54:55] op_sel_hi:[1,0,1]
    v_pk_fma_f32 v[56:57], v[48:49], v[20:21], v[56:57] op_sel_hi:[1,0,1]
    v_pk_fma_f32 v[58:59], v[50:51], v[20:21], v[58:59] op_sel_hi:[1,0,1]
    v_pk_fma_f32 v[60:61], v[44:45], v[20:21], v[60:61] op_sel:[0,1,0] op_sel_hi:[1,1,1]
    v_pk_fma_f32 v[62:63], v[46:47], v[20:21], v[62:63] op_sel:[0,1,0] op_sel_hi:[1,1,1]
    v_pk_fma_f32 v[64:65], v[48:49], v[20:21], v[64:65] op_sel:[0,1,0] op_sel_hi:[1,1,1]
    v_pk_fma_f32 v[66:67], v[50:51], v[20:21], v[66:67] op_sel:[0,1,0] op_sel_hi:[1,1,1]
    s_waitcnt vmcnt(10)
    v_lshlrev_b32 v44, 16, v128
    v_and_b32 v45, s40, v128
    v_lshlrev_b32 v46, 16, v129
    v_and_b32 v47, s40, v129
    v_lshlrev_b32 v48, 16, v130
    v_and_b32 v49, s40, v130
    v_lshlrev_b32 v50, 16, v131
    v_and_b32 v51, s40, v131
    v_pk_fma_f32 v[52:53], v[44:45], v[22:23], v[52:53] op_sel_hi:[1,0,1]
    v_pk_fma_f32 v[54:55], v[46:47], v[22:23], v[54:55] op_sel_hi:[1,0,1]
    v_pk_fma_f32 v[56:57], v[48:49], v[22:23], v[56:57] op_sel_hi:[1,0,1]
    v_pk_fma_f32 v[58:59], v[50:51], v[22:23], v[58:59] op_sel_hi:[1,0,1]
    v_pk_fma_f32 v[60:61], v[44:45], v[22:23], v[60:61] op_sel:[0,1,0] op_sel_hi:[1,1,1]
    v_pk_fma_f32 v[62:63], v[46:47], v[22:23], v[62:63] op_sel:[0,1,0] op_sel_hi:[1,1,1]
    v_pk_fma_f32 v[64:65], v[48:49], v[22:23], v[64:65] op_sel:[0,1,0] op_sel_hi:[1,1,1]
    v_pk_fma_f32 v[66:67], v[50:51], v[22:23], v[66:67] op_sel:[0,1,0] op_sel_hi:[1,1,1]
    s_waitcnt vmcnt(9)
    v_lshlrev_b32 v44, 16, v132
    v_and_b32 v45, s40, v132
    v_lshlrev_b32 v46, 16, v133
    v_and_b32 v47, s40, v133
    v_lshlrev_b32 v48, 16, v134
    v_and_b32 v49, s40, v134
    v_lshlrev_b32 v50, 16, v135
    v_and_b32 v51, s40, v135
    v_pk_fma_f32 v[52:53], v[44:45], v[24:25], v[52:53] op_sel_hi:[1,0,1]
    v_pk_fma_f32 v[54:55], v[46:47], v[24:25], v[54:55] op_sel_hi:[1,0,1]
    v_pk_fma_f32 v[56:57], v[48:49], v[24:25], v[56:57] op_sel_hi:[1,0,1]
    v_pk_fma_f32 v[58:59], v[50:51], v[24:25], v[58:59] op_sel_hi:[1,0,1]
    v_pk_fma_f32 v[60:61], v[44:45], v[24:25], v[60:61] op_sel:[0,1,0] op_sel_hi:[1,1,1]
    v_pk_fma_f32 v[62:63], v[46:47], v[24:25], v[62:63] op_sel:[0,1,0] op_sel_hi:[1,1,1]
    v_pk_fma_f32 v[64:65], v[48:49], v[24:25], v[64:65] op_sel:[0,1,0] op_sel_hi:[1,1,1]
    v_pk_fma_f32 v[66:67], v[50:51], v[24:25], v[66:67] op_sel:[0,1,0] op_sel_hi:[1,1,1]
    s_waitcnt vmcnt(8)
    v_lshlrev_b32 v44, 16, v136
    v_and_b32 v45, s40, v136
    v_lshlrev_b32 v46, 16, v137
    v_and_b32 v47, s40, v137
    v_lshlrev_b32 v48, 16, v138
    v_and_b32 v49, s40, v138
    v_lshlrev_b32 v50, 16, v139
    v_and_b32 v51, s40, v139
    v_pk_fma_f32 v[52:53], v[44:45], v[26:27], v[52:53] op_sel_hi:[1,0,1]
    v_pk_fma_f32 v[54:55], v[46:47], v[26:27], v[54:55] op_sel_hi:[1,0,1]
    v_pk_fma_f32 v[56:57], v[48:49], v[26:27], v[56:57] op_sel_hi:[1,0,1]
    v_pk_fma_f32 v[58:59], v[50:51], v[26:27], v[58:59] op_sel_hi:[1,0,1]
    v_pk_fma_f32 v[60:61], v[44:45], v[26:27], v[60:61] op_sel:[0,1,0] op_sel_hi:[1,1,1]
    v_pk_fma_f32 v[62:63], v[46:47], v[26:27], v[62:63] op_sel:[0,1,0] op_sel_hi:[1,1,1]
    v_pk_fma_f32 v[64:65], v[48:49], v[26:27], v[64:65] op_sel:[0,1,0] op_sel_hi:[1,1,1]
    v_pk_fma_f32 v[66:67], v[50:51], v[26:27], v[66:67] op_sel:[0,1,0] op_sel_hi:[1,1,1]
    s_waitcnt vmcnt(7)
    v_lshlrev_b32 v44, 16, v140
    v_and_b32 v45, s40, v140
    v_lshlrev_b32 v46, 16, v141
    v_and_b32 v47, s40, v141
    v_lshlrev_b32 v48, 16, v142
    v_and_b32 v49, s40, v142
    v_lshlrev_b32 v50, 16, v143
    v_and_b32 v51, s40, v143
    v_pk_fma_f32 v[52:53], v[44:45], v[28:29], v[52:53] op_sel_hi:[1,0,1]
    v_pk_fma_f32 v[54:55], v[46:47], v[28:29], v[54:55] op_sel_hi:[1,0,1]
    v_pk_fma_f32 v[56:57], v[48:49], v[28:29], v[56:57] op_sel_hi:[1,0,1]
    v_pk_fma_f32 v[58:59], v[50:51], v[28:29], v[58:59] op_sel_hi:[1,0,1]
    v_pk_fma_f32 v[60:61], v[44:45], v[28:29], v[60:61] op_sel:[0,1,0] op_sel_hi:[1,1,1]
    v_pk_fma_f32 v[62:63], v[46:47], v[28:29], v[62:63] op_sel:[0,1,0] op_sel_hi:[1,1,1]
    v_pk_fma_f32 v[64:65], v[48:49], v[28:29], v[64:65] op_sel:[0,1,0] op_sel_hi:[1,1,1]
    v_pk_fma_f32 v[66:67], v[50:51], v[28:29], v[66:67] op_sel:[0,1,0] op_sel_hi:[1,1,1]
    s_waitcnt vmcnt(6)
    v_lshlrev_b32 v44, 16, v144
    v_and_b32 v45, s40, v144
    v_lshlrev_b32 v46, 16, v145
    v_and_b32 v47, s40, v145
    v_lshlrev_b32 v48, 16, v146
    v_and_b32 v49, s40, v146
    v_lshlrev_b32 v50, 16, v147
    v_and_b32 v51, s40, v147
    v_pk_fma_f32 v[52:53], v[44:45], v[30:31], v[52:53] op_sel_hi:[1,0,1]
    v_pk_fma_f32 v[54:55], v[46:47], v[30:31], v[54:55] op_sel_hi:[1,0,1]
    v_pk_fma_f32 v[56:57], v[48:49], v[30:31], v[56:57] op_sel_hi:[1,0,1]
    v_pk_fma_f32 v[58:59], v[50:51], v[30:31], v[58:59] op_sel_hi:[1,0,1]
    v_pk_fma_f32 v[60:61], v[44:45], v[30:31], v[60:61] op_sel:[0,1,0] op_sel_hi:[1,1,1]
    v_pk_fma_f32 v[62:63], v[46:47], v[30:31], v[62:63] op_sel:[0,1,0] op_sel_hi:[1,1,1]
    v_pk_fma_f32 v[64:65], v[48:49], v[30:31], v[64:65] op_sel:[0,1,0] op_sel_hi:[1,1,1]
    v_pk_fma_f32 v[66:67], v[50:51], v[30:31], v[66:67] op_sel:[0,1,0] op_sel_hi:[1,1,1]
    s_waitcnt vmcnt(5)
    v_lshlrev_b32 v44, 16, v148
    v_and_b32 v45, s40, v148
    v_lshlrev_b32 v46, 16, v149
    v_and_b32 v47, s40, v149
    v_lshlrev_b32 v48, 16, v150
    v_and_b32 v49, s40, v150
    v_lshlrev_b32 v50, 16, v151
    v_and_b32 v51, s40, v151
    v_pk_fma_f32 v[52:53], v[44:45], v[32:33], v[52:53] op_sel_hi:[1,0,1]
    v_pk_fma_f32 v[54:55], v[46:47], v[32:33], v[54:55] op_sel_hi:[1,0,1]
    v_pk_fma_f32 v[56:57], v[48:49], v[32:33], v[56:57] op_sel_hi:[1,0,1]
    v_pk_fma_f32 v[58:59], v[50:51], v[32:33], v[58:59] op_sel_hi:[1,0,1]
    v_pk_fma_f32 v[60:61], v[44:45], v[32:33], v[60:61] op_sel:[0,1,0] op_sel_hi:[1,1,1]
    v_pk_fma_f32 v[62:63], v[46:47], v[32:33], v[62:63] op_sel:[0,1,0] op_sel_hi:[1,1,1]
    v_pk_fma_f32 v[64:65], v[48:49], v[32:33], v[64:65] op_sel:[0,1,0] op_sel_hi:[1,1,1]
    v_pk_fma_f32 v[66:67], v[50:51], v[32:33], v[66:67] op_sel:[0,1,0] op_sel_hi:[1,1,1]
    s_waitcnt vmcnt(4)
    v_lshlrev_b32 v44, 16, v152
    v_and_b32 v45, s40, v152
    v_lshlrev_b32 v46, 16, v153
    v_and_b32 v47, s40, v153
    v_lshlrev_b32 v48, 16, v154
    v_and_b32 v49, s40, v154
    v_lshlrev_b32 v50, 16, v155
    v_and_b32 v51, s40, v155
    v_pk_fma_f32 v[52:53], v[44:45], v[34:35], v[52:53] op_sel_hi:[1,0,1]
    v_pk_fma_f32 v[54:55], v[46:47], v[34:35], v[54:55] op_sel_hi:[1,0,1]
    v_pk_fma_f32 v[56:57], v[48:49], v[34:35], v[56:57] op_sel_hi:[1,0,1]
    v_pk_fma_f32 v[58:59], v[50:51], v[34:35], v[58:59] op_sel_hi:[1,0,1]
    v_pk_fma_f32 v[60:61], v[44:45], v[34:35], v[60:61] op_sel:[0,1,0] op_sel_hi:[1,1,1]
    v_pk_fma_f32 v[62:63], v[46:47], v[34:35], v[62:63] op_sel:[0,1,0] op_sel_hi:[1,1,1]
    v_pk_fma_f32 v[64:65], v[48:49], v[34:35], v[64:65] op_sel:[0,1,0] op_sel_hi:[1,1,1]
    v_pk_fma_f32 v[66:67], v[50:51], v[34:35], v[66:67] op_sel:[0,1,0] op_sel_hi:[1,1,1]
    s_waitcnt vmcnt(3)
    v_lshlrev_b32 v44, 16, v156
    v_and_b32 v45, s40, v156
    v_lshlrev_b32 v46, 16, v157
    v_and_b32 v47, s40, v157
    v_lshlrev_b32 v48, 16, v158
    v_and_b32 v49, s40, v158
    v_lshlrev_b32 v50, 16, v159
    v_and_b32 v51, s40, v159
    v_pk_fma_f32 v[52:53], v[44:45], v[36:37], v[52:53] op_sel_hi:[1,0,1]
    v_pk_fma_f32 v[54:55], v[46:47], v[36:37], v[54:55] op_sel_hi:[1,0,1]
    v_pk_fma_f32 v[56:57], v[48:49], v[36:37], v[56:57] op_sel_hi:[1,0,1]
    v_pk_fma_f32 v[58:59], v[50:51], v[36:37], v[58:59] op_sel_hi:[1,0,1]
    v_pk_fma_f32 v[60:61], v[44:45], v[36:37], v[60:61] op_sel:[0,1,0] op_sel_hi:[1,1,1]
    v_pk_fma_f32 v[62:63], v[46:47], v[36:37], v[62:63] op_sel:[0,1,0] op_sel_hi:[1,1,1]
    v_pk_fma_f32 v[64:65], v[48:49], v[36:37], v[64:65] op_sel:[0,1,0] op_sel_hi:[1,1,1]
    v_pk_fma_f32 v[66:67], v[50:51], v[36:37], v[66:67] op_sel:[0,1,0] op_sel_hi:[1,1,1]
    s_waitcnt vmcnt(2)
    v_lshlrev_b32 v44, 16, v160
    v_and_b32 v45, s40, v160
    v_lshlrev_b32 v46, 16, v161
    v_and_b32 v47, s40, v161
    v_lshlrev_b32 v48, 16, v162
    v_and_b32 v49, s40, v162
    v_lshlrev_b32 v50, 16, v163
    v_and_b32 v51, s40, v163
    v_pk_fma_f32 v[52:53], v[44:45], v[38:39], v[52:53] op_sel_hi:[1,0,1]
    v_pk_fma_f32 v[54:55], v[46:47], v[38:39], v[54:55] op_sel_hi:[1,0,1]
    v_pk_fma_f32 v[56:57], v[48:49], v[38:39], v[56:57] op_sel_hi:[1,0,1]
    v_pk_fma_f32 v[58:59], v[50:51], v[38:39], v[58:59] op_sel_hi:[1,0,1]
    v_pk_fma_f32 v[60:61], v[44:45], v[38:39], v[60:61] op_sel:[0,1,0] op_sel_hi:[1,1,1]
    v_pk_fma_f32 v[62:63], v[46:47], v[38:39], v[62:63] op_sel:[0,1,0] op_sel_hi:[1,1,1]
    v_pk_fma_f32 v[64:65], v[48:49], v[38:39], v[64:65] op_sel:[0,1,0] op_sel_hi:[1,1,1]
    v_pk_fma_f32 v[66:67], v[50:51], v[38:39], v[66:67] op_sel:[0,1,0] op_sel_hi:[1,1,1]
    s_waitcnt vmcnt(1)
    v_lshlrev_b32 v44, 16, v164
    v_and_b32 v45, s40, v164
    v_lshlrev_b32 v46, 16, v165
    v_and_b32 v47, s40, v165
    v_lshlrev_b32 v48, 16, v166
    v_and_b32 v49, s40, v166
    v_lshlrev_b32 v50, 16, v167
    v_and_b32 v51, s40, v167
    v_pk_fma_f32 v[52:53], v[44:45], v[40:41], v[52:53] op_sel_hi:[1,0,1]
    v_pk_fma_f32 v[54:55], v[46:47], v[40:41], v[54:55] op_sel_hi:[1,0,1]
    v_pk_fma_f32 v[56:57], v[48:49], v[40:41], v[56:57] op_sel_hi:[1,0,1]
    v_pk_fma_f32 v[58:59], v[50:51], v[40:41], v[58:59] op_sel_hi:[1,0,1]
    v_pk_fma_f32 v[60:61], v[44:45], v[40:41], v[60:61] op_sel:[0,1,0] op_sel_hi:[1,1,1]
    v_pk_fma_f32 v[62:63], v[46:47], v[40:41], v[62:63] op_sel:[0,1,0] op_sel_hi:[1,1,1]
    v_pk_fma_f32 v[64:65], v[48:49], v[40:41], v[64:65] op_sel:[0,1,0] op_sel_hi:[1,1,1]
    v_pk_fma_f32 v[66:67], v[50:51], v[40:41], v[66:67] op_sel:[0,1,0] op_sel_hi:[1,1,1]
    s_waitcnt vmcnt(0)
    v_lshlrev_b32 v44, 16, v168
    v_and_b32 v45, s40, v168
    v_lshlrev_b32 v46, 16, v169
    v_and_b32 v47, s40, v169
    v_lshlrev_b32 v48, 16, v170
    v_and_b32 v49, s40, v170
    v_lshlrev_b32 v50, 16, v171
    v_and_b32 v51, s40, v171
    v_pk_fma_f32 v[52:53], v[44:45], v[42:43], v[52:53] op_sel_hi:[1,0,1]
    v_pk_fma_f32 v[54:55], v[46:47], v[42:43], v[54:55] op_sel_hi:[1,0,1]
    v_pk_fma_f32 v[56:57], v[48:49], v[42:43], v[56:57] op_sel_hi:[1,0,1]
    v_pk_fma_f32 v[58:59], v[50:51], v[42:43], v[58:59] op_sel_hi:[1,0,1]
    v_pk_fma_f32 v[60:61], v[44:45], v[42:43], v[60:61] op_sel:[0,1,0] op_sel_hi:[1,1,1]
    v_pk_fma_f32 v[62:63], v[46:47], v[42:43], v[62:63] op_sel:[0,1,0] op_sel_hi:[1,1,1]
    v_pk_fma_f32 v[64:65], v[48:49], v[42:43], v[64:65] op_sel:[0,1,0] op_sel_hi:[1,1,1]
    v_pk_fma_f32 v[66:67], v[50:51], v[42:43], v[66:67] op_sel:[0,1,0] op_sel_hi:[1,1,1]
    v_permlane32_swap_b32 v52, v60
    v_permlane32_swap_b32 v53, v61
    v_permlane32_swap_b32 v54, v62
    v_permlane32_swap_b32 v55, v63
    v_permlane32_swap_b32 v56, v64
    v_permlane32_swap_b32 v57, v65
    v_permlane32_swap_b32 v58, v66
    v_permlane32_swap_b32 v59, v67
    v_add_f32 v52, v52, v60
    v_add_f32 v53, v53, v61
    v_add_f32 v54, v54, v62
    v_add_f32 v55, v55, v63
    v_add_f32 v56, v56, v64
    v_add_f32 v57, v57, v65
    v_add_f32 v58, v58, v66
    v_add_f32 v59, v59, v67
    v_permlane16_swap_b32 v52, v56
    v_permlane16_swap_b32 v53, v57
    v_permlane16_swap_b32 v54, v58
    v_permlane16_swap_b32 v55, v59
    v_add_f32 v52, v52, v56
    v_add_f32 v53, v53, v57
    v_add_f32 v54, v54, v58
    v_add_f32 v55, v55, v59
    v_add_f32_dpp v56, v52, v52 row_ror:8 row_mask:0xf bank_mask:0xf
    v_add_f32_dpp v57, v53, v53 row_ror:8 row_mask:0xf bank_mask:0xf
    v_add_f32_dpp v58, v54, v54 row_ror:8 row_mask:0xf bank_mask:0xf
    v_add_f32_dpp v59, v55, v55 row_ror:8 row_mask:0xf bank_mask:0xf
    ds_write_b128 v1, v[56:59]
    s_waitcnt lgkmcnt(0)
    s_barrier
    s_cmp_lg_u32 s10, 0
    s_cbranch_scc1 P2_g1
    ds_read_b128 v[100:103], v7 offset:0
    ds_read_b128 v[104:107], v7 offset:512
    ds_read_b128 v[108:111], v7 offset:1024
    ds_read_b128 v[112:115], v7 offset:1536
    ds_read_b128 v[116:119], v7 offset:2048
    ds_read_b128 v[120:123], v7 offset:2560
    ds_read_b128 v[124:127], v7 offset:3072
    ds_read_b128 v[128:131], v7 offset:3584
    s_waitcnt lgkmcnt(0)
    v_pk_add_f32 v[100:101], v[100:101], v[104:105]
    v_pk_add_f32 v[102:103], v[102:103], v[106:107]
    v_pk_add_f32 v[100:101], v[100:101], v[108:109]
    v_pk_add_f32 v[102:103], v[102:103], v[110:111]
    v_pk_add_f32 v[100:101], v[100:101], v[112:113]
    v_pk_add_f32 v[102:103], v[102:103], v[114:115]
    v_pk_add_f32 v[100:101], v[100:101], v[116:117]
    v_pk_add_f32 v[102:103], v[102:103], v[118:119]
    v_pk_add_f32 v[100:101], v[100:101], v[120:121]
    v_pk_add_f32 v[102:103], v[102:103], v[122:123]
    v_pk_add_f32 v[100:101], v[100:101], v[124:125]
    v_pk_add_f32 v[102:103], v[102:103], v[126:127]
    v_pk_add_f32 v[100:101], v[100:101], v[128:129]
    v_pk_add_f32 v[102:103], v[102:103], v[130:131]
    v_cvt_pk_bf16_f32 v70, v100, v101
    v_cvt_pk_bf16_f32 v71, v102, v103
    buffer_store_dwordx2 v[70:71], v68, s[32:35], s16 offen sc1
P2_g1:
    s_barrier
    s_add_u32 s18, s18, 1
    s_sub_u32 s19, s19, 1
    s_cmp_lg_u32 s19, 0
    s_cbranch_scc1 P2_gl
    s_cmp_ge_u32 s10, 4
    s_cbranch_scc1 P3
    s_bfe_u32 s3, s80, 0x80008
    s_cmp_eq_u32 s3, 9
    s_cbranch_scc1 P2_fin
    v_mov_b32 v8, 147456
    v_mov_b32 v9, 1
    s_add_u32 s100, s100, 4
    s_waitcnt vmcnt(0)
    s_mov_b64 exec, 1
    ds_add_rtn_u32 v10, v8, v9
    s_mov_b64 exec, -1
    s_waitcnt lgkmcnt(0)
    v_readfirstlane_b32 s3, v10
    s_nop 0
    s_add_u32 s3, s3, 1
    s_cmp_lg_u32 s3, s100
    s_cbranch_scc1 PB_22
    s_add_u32 s3, s86, 5
    v_mov_b32 v9, s3
    v_mov_b32 v10, 0
    s_lshl_b32 s3, s2, 7
    s_mov_b64 exec, 1
    buffer_store_dword v9, v10, s[76:79], s3 offen sc1
    s_mov_b64 exec, -1
    v_mov_b32 v11, 5
    ds_write_b32 v8, v11 offset:8
PB_22:
    s_branch P3
P2_idle:
    s_barrier
    s_sub_u32 s45, s45, 1
    s_cmp_lg_u32 s45, 0
    s_cbranch_scc1 P2_idle
    s_barrier
P2_fin:
    v_mov_b32 v8, 147456
    v_mov_b32 v9, 1
    s_add_u32 s100, s100, 4
    s_waitcnt vmcnt(0)
    s_mov_b64 exec, 1
    ds_add_rtn_u32 v10, v8, v9
    s_mov_b64 exec, -1
    s_waitcnt lgkmcnt(0)
    v_readfirstlane_b32 s3, v10
    s_nop 0
    s_add_u32 s3, s3, 1
    s_cmp_lg_u32 s3, s100
    s_cbranch_scc1 PB_23
    s_add_u32 s3, s86, 4
    v_mov_b32 v9, s3
    v_mov_b32 v10, 0
    s_lshl_b32 s3, s2, 7
    s_mov_b64 exec, 1
    buffer_store_dword v9, v10, s[76:79], s3 offen sc1
    s_mov_b64 exec, -1
    v_mov_b32 v11, 4
    ds_write_b32 v8, v11 offset:8
PB_23:
PX:
    s_bfe_u32 s3, s80, 0x80008
    s_cmp_lg_u32 s3, 8
    s_cbranch_scc1 P3
    s_lshr_b32 s3, s80, 30
    s_cbranch_scc1 P2_gate
    s_cmp_ge_u32 s10, 4
    s_cbranch_scc1 P3
    v_mov_b32 v8, 147456
    v_mov_b32 v9, 1
    s_add_u32 s100, s100, 4
    s_waitcnt vmcnt(0)
    s_mov_b64 exec, 1
    ds_add_rtn_u32 v10, v8, v9
    s_mov_b64 exec, -1
    s_waitcnt lgkmcnt(0)
    v_readfirstlane_b32 s3, v10
    s_nop 0
    s_add_u32 s3, s3, 1
    s_cmp_lg_u32 s3, s100
    s_cbranch_scc1 PB_24
    s_add_u32 s3, s86, 5
    v_mov_b32 v9, s3
    v_mov_b32 v10, 0
    s_lshl_b32 s3, s2, 7
    s_mov_b64 exec, 1
    buffer_store_dword v9, v10, s[76:79], s3 offen sc1
    s_mov_b64 exec, -1
    v_mov_b32 v11, 5
    ds_write_b32 v8, v11 offset:8
PB_24:
    s_branch P3
PV:
    s_cmp_lt_u32 s10, 4
    s_cbranch_scc1 PX_cons
    s_sub_u32 s11, s10, 4
    s_mov_b32 s44, 0
    s_mov_b32 s45, 0
    s_lshr_b32 s17, s11, 1
    s_mul_i32 s17, s17, 66
    s_and_b32 s18, s11, 1
    s_add_u32 s17, s17, s18
    s_add_u32 s17, s17, 328
    s_mul_i32 s64, s17, 36864
    s_lshl_b32 s43, s11, 11
    s_add_u32 s42, s43, 8192
    s_lshl_b32 s67, s16, 7
    s_mul_i32 s18, s11, 36864
    s_add_u32 s67, s67, s18
    v_lshrrev_b32 v4, 3, v2
    v_mul_u32_u24 v4, 2304, v4
    v_lshrrev_b32 v5, 4, v2
    v_lshlrev_b32 v5, 1, v5
    v_and_b32 v6, 7, v2
    v_xor_b32 v5, v5, v6
    v_lshl_add_u32 v12, v5, 4, v4
    v_add_u32 v13, 17408, v12
    s_mov_b32 s20, s58
    s_mov_b32 s21, s59
    s_mov_b32 s22, 0x288000
    s_mov_b32 s23, 0x20000
    v_mov_b32 v8, 147464
    s_mov_b32 s3, 0x2000000
LW_25:
    ds_read_b32 v9, v8
    s_sub_u32 s3, s3, 1
    s_waitcnt lgkmcnt(0)
    v_cmp_le_u32 vcc, 4, v9
    s_cmp_eq_u32 s3, 0
    s_cbranch_scc1 LWE_26
    s_cbranch_vccnz LWE_26
    s_sleep 1
    s_branch LW_25
LWE_26:
    s_add_u32 m0, s45, s42
    s_nop 0
    buffer_load_dwordx4 v12, s[20:23], s67 offen lds
    buffer_load_dwordx4 v13, s[20:23], s67 offen offset:1024 lds
    s_add_u32 s67, s67, 147456
    s_add_u32 s45, s45, 16384
    s_cmp_eq_u32 s45, 147456
    s_cselect_b32 s45, 0, s45
    s_add_u32 m0, s45, s42
    s_nop 0
    buffer_load_dwordx4 v12, s[20:23], s67 offen lds
    buffer_load_dwordx4 v13, s[20:23], s67 offen offset:1024 lds
    s_add_u32 s67, s67, 147456
    s_add_u32 s45, s45, 16384
    s_cmp_eq_u32 s45, 147456
    s_cselect_b32 s45, 0, s45
    s_add_u32 m0, s45, s42
    s_nop 0
    buffer_load_dwordx4 v12, s[20:23], s67 offen lds
    buffer_load_dwordx4 v13, s[20:23], s67 offen offset:1024 lds
    s_add_u32 s67, s67, 147456
    s_add_u32 s45, s45, 16384
    s_cmp_eq_u32 s45, 147456
    s_cselect_b32 s45, 0, s45
    s_add_u32 m0, s45, s42
    s_nop 0
    buffer_load_dwordx4 v12, s[20:23], s67 offen lds
    buffer_load_dwordx4 v13, s[20:23], s67 offen offset:1024 lds
    s_add_u32 s67, s67, 147456
    s_add_u32 s45, s45, 16384
    s_cmp_eq_u32 s45, 147456
    s_cselect_b32 s45, 0, s45
    s_add_u32 m0, s45, s42
    s_nop 0
    buffer_load_dwordx4 v12, s[20:23], s67 offen lds
    buffer_load_dwordx4 v13, s[20:23], s67 offen offset:1024 lds
    s_add_u32 s67, s67, 147456
    s_add_u32 s45, s45, 16384
    s_cmp_eq_u32 s45, 147456
    s_cselect_b32 s45, 0, s45
    s_add_u32 m0, s45, s42
    s_nop 0
    buffer_load_dwordx4 v12, s[20:23], s67 offen lds
    buffer_load_dwordx4 v13, s[20:23], s67 offen offset:1024 lds
    s_add_u32 s67, s67, 147456
    s_add_u32 s45, s45, 16384
    s_cmp_eq_u32 s45, 147456
    s_cselect_b32 s45, 0, s45
    s_add_u32 m0, s45, s42
    s_nop 0
    buffer_load_dwordx4 v12, s[20:23], s67 offen lds
    buffer_load_dwordx4 v13, s[20:23], s67 offen offset:1024 lds
    s_add_u32 s67, s67, 147456
    s_add_u32 s45, s45, 16384
    s_cmp_eq_u32 s45, 147456
    s_cselect_b32 s45, 0, s45
    s_add_u32 m0, s45, s42
    s_nop 0
    buffer_load_dwordx4 v12, s[20:23], s67 offen lds
    buffer_load_dwordx4 v13, s[20:23], s67 offen offset:1024 lds
    s_add_u32 s67, s67, 147456
    s_add_u32 s45, s45, 16384
    s_cmp_eq_u32 s45, 147456
    s_cselect_b32 s45, 0, s45
    s_add_u32 m0, s45, s42
    s_nop 0
    buffer_load_dwordx4 v12, s[20:23], s67 offen lds
    buffer_load_dwordx4 v13, s[20:23], s67 offen offset:1024 lds
    s_add_u32 s67, s67, 147456
    s_add_u32 s45, s45, 16384
    s_cmp_eq_u32 s45, 147456
    s_cselect_b32 s45, 0, s45
    s_cmp_lg_u32 s10, 4
    s_cbranch_scc1 LD_27
    v_and_b32 v8, 0xff, v251
    v_lshlrev_b32 v8, 7, v8
    v_lshrrev_b32 v9, 8, v251
    v_add_u32 v9, s86, v9
    s_mov_b32 s3, 0x400000
POLL_29:
    buffer_load_dword v10, v8, s[76:79], 0 offen sc1
    s_sub_u32 s3, s3, 1
    s_waitcnt vmcnt(0)
    v_sub_u32 v10, v10, v9
    v_cmp_lt_u32 vcc, 7, v10
    s_nop 0
    s_cbranch_vccz POLLE_30
    s_cmp_eq_u32 s3, 0
    s_cbranch_scc1 POLLE_30
    s_nop 0
    s_branch POLL_29
POLLE_30:
    v_mov_b32 v8, 147460
    v_mov_b32 v9, 6
    ds_write_b32 v8, v9
    s_branch LDE_28
LD_27:
    v_mov_b32 v8, 147460
    s_mov_b32 s3, 0x2000000
LW_31:
    ds_read_b32 v9, v8
    s_sub_u32 s3, s3, 1
    s_waitcnt lgkmcnt(0)
    v_cmp_le_u32 vcc, 6, v9
    s_cmp_eq_u32 s3, 0
    s_cbranch_scc1 LWE_32
    s_cbranch_vccnz LWE_32
    s_sleep 1
    s_branch LW_31
LWE_32:
    s_waitcnt vmcnt(0)
LDE_28:
    s_add_u32 m0, s44, s43
    s_nop 0
    buffer_load_dwordx4 v3, s[24:27], s64 offen sc1 lds
    buffer_load_dwordx4 v3, s[24:27], s64 offen offset:1024 sc1 lds
    s_add_u32 s64, s64, 2048
    s_add_u32 s44, s44, 16384
    s_cmp_eq_u32 s44, 147456
    s_cselect_b32 s44, 0, s44
    s_add_u32 m0, s44, s43
    s_nop 0
    buffer_load_dwordx4 v3, s[24:27], s64 offen sc1 lds
    buffer_load_dwordx4 v3, s[24:27], s64 offen offset:1024 sc1 lds
    s_add_u32 s64, s64, 2048
    s_add_u32 s44, s44, 16384
    s_cmp_eq_u32 s44, 147456
    s_cselect_b32 s44, 0, s44
    s_add_u32 m0, s44, s43
    s_nop 0
    buffer_load_dwordx4 v3, s[24:27], s64 offen sc1 lds
    buffer_load_dwordx4 v3, s[24:27], s64 offen offset:1024 sc1 lds
    s_add_u32 s64, s64, 2048
    s_add_u32 s44, s44, 16384
    s_cmp_eq_u32 s44, 147456
    s_cselect_b32 s44, 0, s44
    s_add_u32 m0, s44, s43
    s_nop 0
    buffer_load_dwordx4 v3, s[24:27], s64 offen sc1 lds
    buffer_load_dwordx4 v3, s[24:27], s64 offen offset:1024 sc1 lds
    s_add_u32 s64, s64, 2048
    s_add_u32 s44, s44, 16384
    s_cmp_eq_u32 s44, 147456
    s_cselect_b32 s44, 0, s44
    s_add_u32 m0, s44, s43
    s_nop 0
    buffer_load_dwordx4 v3, s[24:27], s64 offen sc1 lds
    buffer_load_dwordx4 v3, s[24:27], s64 offen offset:1024 sc1 lds
    s_add_u32 s64, s64, 2048
    s_add_u32 s44, s44, 16384
    s_cmp_eq_u32 s44, 147456
    s_cselect_b32 s44, 0, s44
    s_add_u32 m0, s44, s43
    s_nop 0
    buffer_load_dwordx4 v3, s[24:27], s64 offen sc1 lds
    buffer_load_dwordx4 v3, s[24:27], s64 offen offset:1024 sc1 lds
    s_add_u32 s64, s64, 2048
    s_add_u32 s44, s44, 16384
    s_cmp_eq_u32 s44, 147456
    s_cselect_b32 s44, 0, s44
    s_waitcnt vmcnt(6)
    s_barrier
    s_add_u32 m0, s44, s43
    s_nop 0
    buffer_load_dwordx4 v3, s[24:27], s64 offen sc1 lds
    buffer_load_dwordx4 v3, s[24:27], s64 offen offset:1024 sc1 lds
    s_add_u32 s64, s64, 2048
    s_add_u32 s44, s44, 16384
    s_cmp_eq_u32 s44, 147456
    s_cselect_b32 s44, 0, s44
    s_add_u32 m0, s44, s43
    s_nop 0
    buffer_load_dwordx4 v3, s[24:27], s64 offen sc1 lds
    buffer_load_dwordx4 v3, s[24:27], s64 offen offset:1024 sc1 lds
    s_add_u32 s64, s64, 2048
    s_add_u32 s44, s44, 16384
    s_cmp_eq_u32 s44, 147456
    s_cselect_b32 s44, 0, s44
    s_add_u32 m0, s44, s43
    s_nop 0
    buffer_load_dwordx4 v3, s[24:27], s64 offen sc1 lds
    buffer_load_dwordx4 v3, s[24:27], s64 offen offset:1024 sc1 lds
    s_add_u32 s64, s64, 2048
    s_add_u32 s44, s44, 16384
    s_cmp_eq_u32 s44, 147456
    s_cselect_b32 s44, 0, s44
    s_waitcnt vmcnt(6)
    s_barrier
    s_add_u32 m0, s44, s43
    s_nop 0
    buffer_load_dwordx4 v3, s[24:27], s64 offen sc1 lds
    buffer_load_dwordx4 v3, s[24:27], s64 offen offset:1024 sc1 lds
    s_add_u32 s64, s64, 2048
    s_add_u32 s44, s44, 16384
    s_cmp_eq_u32 s44, 147456
    s_cselect_b32 s44, 0, s44
    s_add_u32 m0, s44, s43
    s_nop 0
    buffer_load_dwordx4 v3, s[24:27], s64 offen sc1 lds
    buffer_load_dwordx4 v3, s[24:27], s64 offen offset:1024 sc1 lds
    s_add_u32 s64, s64, 2048
    s_add_u32 s44, s44, 16384
    s_cmp_eq_u32 s44, 147456
    s_cselect_b32 s44, 0, s44
    s_add_u32 m0, s44, s43
    s_nop 0
    buffer_load_dwordx4 v3, s[24:27], s64 offen sc1 lds
    buffer_load_dwordx4 v3, s[24:27], s64 offen offset:1024 sc1 lds
    s_add_u32 s64, s64, 2048
    s_add_u32 s44, s44, 16384
    s_cmp_eq_u32 s44, 147456
    s_cselect_b32 s44, 0, s44
    s_add_u32 m0, s45, s42
    s_nop 0
    buffer_load_dwordx4 v12, s[20:23], s67 offen lds
    buffer_load_dwordx4 v13, s[20:23], s67 offen offset:1024 lds
    s_add_u32 s67, s67, 147456
    s_add_u32 s45, s45, 16384
    s_cmp_eq_u32 s45, 147456
    s_cselect_b32 s45, 0, s45
    s_add_u32 m0, s45, s42
    s_nop 0
    buffer_load_dwordx4 v12, s[20:23], s67 offen lds
    buffer_load_dwordx4 v13, s[20:23], s67 offen offset:1024 lds
    s_add_u32 s67, s67, 147456
    s_add_u32 s45, s45, 16384
    s_cmp_eq_u32 s45, 147456
    s_cselect_b32 s45, 0, s45
    s_add_u32 m0, s45, s42
    s_nop 0
    buffer_load_dwordx4 v12, s[20:23], s67 offen lds
    buffer_load_dwordx4 v13, s[20:23], s67 offen offset:1024 lds
    s_add_u32 s67, s67, 147456
    s_add_u32 s45, s45, 16384
    s_cmp_eq_u32 s45, 147456
    s_cselect_b32 s45, 0, s45
    s_mov_b32 s60, 2
PX_lloop:
    s_waitcnt vmcnt(12)
    s_barrier
    s_add_u32 m0, s44, s43
    s_nop 0
    buffer_load_dwordx4 v3, s[24:27], s64 offen sc1 lds
    buffer_load_dwordx4 v3, s[24:27], s64 offen offset:1024 sc1 lds
    s_add_u32 s64, s64, 2048
    s_add_u32 s44, s44, 16384
    s_cmp_eq_u32 s44, 147456
    s_cselect_b32 s44, 0, s44
    s_add_u32 m0, s44, s43
    s_nop 0
    buffer_load_dwordx4 v3, s[24:27], s64 offen sc1 lds
    buffer_load_dwordx4 v3, s[24:27], s64 offen offset:1024 sc1 lds
    s_add_u32 s64, s64, 2048
    s_add_u32 s44, s44, 16384
    s_cmp_eq_u32 s44, 147456
    s_cselect_b32 s44, 0, s44
    s_add_u32 m0, s44, s43
    s_nop 0
    buffer_load_dwordx4 v3, s[24:27], s64 offen sc1 lds
    buffer_load_dwordx4 v3, s[24:27], s64 offen offset:1024 sc1 lds
    s_add_u32 s64, s64, 2048
    s_add_u32 s44, s44, 16384
    s_cmp_eq_u32 s44, 147456
    s_cselect_b32 s44, 0, s44
    s_add_u32 m0, s45, s42
    s_nop 0
    buffer_load_dwordx4 v12, s[20:23], s67 offen lds
    buffer_load_dwordx4 v13, s[20:23], s67 offen offset:1024 lds
    s_add_u32 s67, s67, 147456
    s_add_u32 s45, s45, 16384
    s_cmp_eq_u32 s45, 147456
    s_cselect_b32 s45, 0, s45
    s_add_u32 m0, s45, s42
    s_nop 0
    buffer_load_dwordx4 v12, s[20:23], s67 offen lds
    buffer_load_dwordx4 v13, s[20:23], s67 offen offset:1024 lds
    s_add_u32 s67, s67, 147456
    s_add_u32 s45, s45, 16384
    s_cmp_eq_u32 s45, 147456
    s_cselect_b32 s45, 0, s45
    s_add_u32 m0, s45, s42
    s_nop 0
    buffer_load_dwordx4 v12, s[20:23], s67 offen lds
    buffer_load_dwordx4 v13, s[20:23], s67 offen offset:1024 lds
    s_add_u32 s67, s67, 147456
    s_add_u32 s45, s45, 16384
    s_cmp_eq_u32 s45, 147456
    s_cselect_b32 s45, 0, s45
    s_sub_u32 s60, s60, 1
    s_cmp_lg_u32 s60, 0
    s_cbranch_scc1 PX_lloop
    s_waitcnt vmcnt(12)
    s_barrier
    s_waitcnt vmcnt(0)
    s_barrier
    s_barrier
    s_branch P4
PX_cons:
    v_mov_b64 v[128:129], 0
    v_mov_b64 v[130:131], 0
    v_mov_b64 v[132:133], 0
    v_mov_b64 v[134:135], 0
    v_mov_b64 v[136:137], 0
    v_mov_b64 v[138:139], 0
    v_mov_b64 v[140:141], 0
    v_mov_b64 v[142:143], 0
    s_add_u32 s32, s84, 0x1841000
    s_addc_u32 s33, s85, 0
    s_mov_b32 s34, 0x4a4000
    s_mov_b32 s35, 0x20000
    s_lshr_b32 s17, s10, 1
    s_and_b32 s18, s10, 1
    s_lshl_b32 s43, s17, 12
    v_add_u32 v120, s43, v3
    v_lshrrev_b32 v4, 2, v2
    v_lshlrev_b32 v4, 7, v4
    v_and_b32 v5, 3, v2
    v_lshl_add_u32 v4, v5, 3, v4
    v_add_u32 v4, 8192, v4
    v_bfe_u32 v5, v2, 3, 2
    s_lshl_b32 s19, s18, 1
    v_xor_b32 v5, s19, v5
    v_lshl_add_u32 v121, v5, 5, v4
    v_xor_b32 v122, 32, v121
    s_mul_i32 s46, s17, 72
    s_lshl_b32 s41, s16, 2
    s_add_u32 s46, s46, s41
    s_add_u32 s46, s46, s19
    s_mul_i32 s46, s46, 33
    s_add_u32 s46, s46, 32
    s_lshl_b32 s46, s46, 10
    v_bfe_u32 v4, v2, 2, 1
    v_mul_u32_u24 v4, 33792, v4
    v_lshrrev_b32 v5, 4, v2
    v_lshl_add_u32 v4, v5, 8, v4
    v_bfe_u32 v5, v2, 3, 1
    v_lshl_add_u32 v4, v5, 6, v4
    v_and_b32 v5, 3, v2
    v_lshl_add_u32 v4, v5, 4, v4
    s_mov_b32 s44, 0
    s_mov_b32 s45, 6
PX_loop:
    v_add_u32 v124, s44, v120
    v_add_u32 v125, s44, v121
    v_add_u32 v126, s44, v122
    s_barrier
    ds_read_b128 v[16:19], v124 offset:0
    ds_read_b128 v[20:23], v124 offset:2048
    ds_read_b64_tr_b16 v[24:25], v125 offset:0
    ds_read_b64_tr_b16 v[26:27], v125 offset:2048
    ds_read_b64_tr_b16 v[28:29], v126 offset:0
    ds_read_b64_tr_b16 v[30:31], v126 offset:2048
    ds_read_b128 v[32:35], v124 offset:1024
    ds_read_b128 v[36:39], v124 offset:3072
    ds_read_b64_tr_b16 v[40:41], v125 offset:4096
    ds_read_b64_tr_b16 v[42:43], v125 offset:6144
    ds_read_b64_tr_b16 v[44:45], v126 offset:4096
    ds_read_b64_tr_b16 v[46:47], v126 offset:6144
    ds_read_b128 v[48:51], v124 offset:16384
    ds_read_b128 v[52:55], v124 offset:18432
    ds_read_b64_tr_b16 v[56:57], v125 offset:16384
    ds_read_b64_tr_b16 v[58:59], v125 offset:18432
    ds_read_b64_tr_b16 v[60:61], v126 offset:16384
    ds_read_b64_tr_b16 v[62:63], v126 offset:18432
    s_waitcnt lgkmcnt(12)
    v_mfma_f32_16x16x32_bf16 v[128:131], v[16:19], v[24:27], v[128:131]
    v_mfma_f32_16x16x32_bf16 v[136:139], v[20:23], v[24:27], v[136:139]
    v_mfma_f32_16x16x32_bf16 v[132:135], v[16:19], v[28:31], v[132:135]
    v_mfma_f32_16x16x32_bf16 v[140:143], v[20:23], v[28:31], v[140:143]
    ds_read_b128 v[64:67], v124 offset:17408
    ds_read_b128 v[68:71], v124 offset:19456
    ds_read_b64_tr_b16 v[72:73], v125 offset:20480
    ds_read_b64_tr_b16 v[74:75], v125 offset:22528
    ds_read_b64_tr_b16 v[76:77], v126 offset:20480
    ds_read_b64_tr_b16 v[78:79], v126 offset:22528
    s_waitcnt lgkmcnt(12)
    v_mfma_f32_16x16x32_bf16 v[128:131], v[32:35], v[40:43], v[128:131]
    v_mfma_f32_16x16x32_bf16 v[136:139], v[36:39], v[40:43], v[136:139]
    v_mfma_f32_16x16x32_bf16 v[132:135], v[32:35], v[44:47], v[132:135]
    v_mfma_f32_16x16x32_bf16 v[140:143], v[36:39], v[44:47], v[140:143]
    ds_read_b128 v[80:83], v124 offset:32768
    ds_read_b128 v[84:87], v124 offset:34816
    ds_read_b64_tr_b16 v[88:89], v125 offset:32768
    ds_read_b64_tr_b16 v[90:91], v125 offset:34816
    ds_read_b64_tr_b16 v[92:93], v126 offset:32768
    ds_read_b64_tr_b16 v[94:95], v126 offset:34816
    s_waitcnt lgkmcnt(12)
    v_mfma_f32_16x16x32_bf16 v[128:131], v[48:51], v[56:59], v[128:131]
    v_mfma_f32_16x16x32_bf16 v[136:139], v[52:55], v[56:59], v[136:139]
    v_mfma_f32_16x16x32_bf16 v[132:135], v[48:51], v[60:63], v[132:135]
    v_mfma_f32_16x16x32_bf16 v[140:143], v[52:55], v[60:63], v[140:143]
    ds_read_b128 v[96:99], v124 offset:33792
    ds_read_b128 v[100:103], v124 offset:35840
    ds_read_b64_tr_b16 v[104:105], v125 offset:36864
    ds_read_b64_tr_b16 v[106:107], v125 offset:38912
    ds_read_b64_tr_b16 v[108:109], v126 offset:36864
    ds_read_b64_tr_b16 v[110:111], v126 offset:38912
    s_waitcnt lgkmcnt(12)
    v_mfma_f32_16x16x32_bf16 v[128:131], v[64:67], v[72:75], v[128:131]
    v_mfma_f32_16x16x32_bf16 v[136:139], v[68:71], v[72:75], v[136:139]
    v_mfma_f32_16x16x32_bf16 v[132:135], v[64:67], v[76:79], v[132:135]
    v_mfma_f32_16x16x32_bf16 v[140:143], v[68:71], v[76:79], v[140:143]
    s_add_u32 s44, s44, 49152
    s_cmp_eq_u32 s44, 147456
    s_cselect_b32 s44, 0, s44
    s_waitcnt lgkmcnt(6)
    v_mfma_f32_16x16x32_bf16 v[128:131], v[80:83], v[88:91], v[128:131]
    v_mfma_f32_16x16x32_bf16 v[136:139], v[84:87], v[88:91], v[136:139]
    v_mfma_f32_16x16x32_bf16 v[132:135], v[80:83], v[92:95], v[132:135]
    v_mfma_f32_16x16x32_bf16 v[140:143], v[84:87], v[92:95], v[140:143]
    s_sub_u32 s45, s45, 1
    s_cmp_lg_u32 s45, 0
    s_waitcnt lgkmcnt(0)
    v_mfma_f32_16x16x32_bf16 v[128:131], v[96:99], v[104:107], v[128:131]
    v_mfma_f32_16x16x32_bf16 v[136:139], v[100:103], v[104:107], v[136:139]
    v_mfma_f32_16x16x32_bf16 v[132:135], v[96:99], v[108:111], v[132:135]
    v_mfma_f32_16x16x32_bf16 v[140:143], v[100:103], v[108:111], v[140:143]
    s_cbranch_scc1 PX_loop
    s_barrier
    s_nop 2
    v_cvt_pk_bf16_f32 v16, v128, v129
    v_cvt_pk_bf16_f32 v17, v130, v131
    v_cvt_pk_bf16_f32 v18, v136, v137
    v_cvt_pk_bf16_f32 v19, v138, v139
    buffer_store_dwordx4 v[16:19], v4, s[32:35], s46 offen offset:0 sc1
    v_cvt_pk_bf16_f32 v20, v132, v133
    v_cvt_pk_bf16_f32 v21, v134, v135
    v_cvt_pk_bf16_f32 v22, v140, v141
    v_cvt_pk_bf16_f32 v23, v142, v143
    buffer_store_dwordx4 v[20:23], v4, s[32:35], s46 offen offset:128 sc1
    s_branch P3_fin
P3:
    v_and_b32 v2, 63, v0
    v_lshlrev_b32 v3, 4, v2
    s_mov_b32 s10, s87
    s_and_b32 s3, s82, 15
    s_cmp_lg_u32 s3, 2
    s_cbranch_scc1 P3_a
    s_lshr_b32 s3, s82, 16
    s_add_u32 s3, s3, 1
    s_bitcmp1_b32 s3, 1
    s_cbranch_scc1 P3_a
    s_load_dwordx2 s[4:5], s[0:1], 24
    s_lshr_b32 s16, s82, 16
    s_movk_i32 s19, 10923
    s_mul_i32 s18, s16, 96
    s_mul_i32 s41, s10, 3072
    s_and_b32 s42, s10, 3
    s_lshr_b32 s43, s10, 2
    v_add_u32 v4, 0, v2
    v_mul_lo_u32 v5, v4, s19
    v_lshrrev_b32 v5, 16, v5
    v_mul_u32_u24 v6, 6, v5
    v_sub_u32 v6, v4, v6
    v_mul_u32_u24 v5, 6912, v5
    v_lshl_add_u32 v8, v6, 4, v5
    v_add_u32 v4, 64, v2
    v_mul_lo_u32 v5, v4, s19
    v_lshrrev_b32 v5, 16, v5
    v_mul_u32_u24 v6, 6, v5
    v_sub_u32 v6, v4, v6
    v_mul_u32_u24 v5, 6912, v5
    v_lshl_add_u32 v9, v6, 4, v5
    v_subrev_u32 v9, 1024, v9
    v_add_u32 v4, 128, v2
    v_mul_lo_u32 v5, v4, s19
    v_lshrrev_b32 v5, 16, v5
    v_mul_u32_u24 v6, 6, v5
    v_sub_u32 v6, v4, v6
    v_mul_u32_u24 v5, 6912, v5
    v_lshl_add_u32 v10, v6, 4, v5
    v_subrev_u32 v10, 2048, v10
    v_lshrrev_b32 v4, 2, v2
    v_mul_u32_u24 v4, 96, v4
    v_and_b32 v5, 3, v2
    v_lshl_add_u32 v4, v5, 3, v4
    s_mul_i32 s3, s42, 3072
    v_add_u32 v4, s3, v4
    v_add_u32 v5, 61440, v4
    s_bfe_u32 s15, s80, 0x80008
    s_cmp_eq_u32 s15, 8
    s_cselect_b32 s15, 5, 4
    v_mov_b32 v12, 147464
    s_mov_b32 s3, 0x2000000
LW_33:
    ds_read_b32 v13, v12
    s_sub_u32 s3, s3, 1
    s_waitcnt lgkmcnt(0)
    v_cmp_le_u32 vcc, s15, v13
    s_cmp_eq_u32 s3, 0
    s_cbranch_scc1 LWE_34
    s_cbranch_vccnz LWE_34
    s_sleep 1
    s_branch LW_33
LWE_34:
    s_add_u32 s20, s4, 0x1200
    s_addc_u32 s21, s5, 0
    s_mov_b32 s22, 0x796e00
    s_mov_b32 s23, 0x20000
    s_add_u32 s24, s84, 0x48000
    s_addc_u32 s25, s85, 0
    s_mov_b32 s26, 0x24000
    s_mov_b32 s27, 0x20000
    s_mul_i32 s17, s10, 221184
    s_add_u32 s17, s17, s18
    s_add_u32 m0, s41, 0
    s_nop 0
    buffer_load_dwordx4 v8, s[20:23], s17 offen offset:0 lds
    buffer_load_dwordx4 v9, s[20:23], s17 offen offset:1024 lds
    buffer_load_dwordx4 v10, s[20:23], s17 offen offset:2048 lds
    s_add_u32 s17, s17, 1769472
    s_add_u32 m0, s41, 24576
    s_nop 0
    buffer_load_dwordx4 v8, s[20:23], s17 offen offset:0 lds
    buffer_load_dwordx4 v9, s[20:23], s17 offen offset:1024 lds
    buffer_load_dwordx4 v10, s[20:23], s17 offen offset:2048 lds
    s_add_u32 s17, s17, 1769472
    s_add_u32 m0, s41, 49152
    s_nop 0
    buffer_load_dwordx4 v8, s[20:23], s17 offen offset:0 lds
    buffer_load_dwordx4 v9, s[20:23], s17 offen offset:1024 lds
    buffer_load_dwordx4 v10, s[20:23], s17 offen offset:2048 lds
    s_add_u32 s17, s17, 1769472
    s_add_u32 m0, s41, 73728
    s_nop 0
    buffer_load_dwordx4 v8, s[20:23], s17 offen offset:0 lds
    buffer_load_dwordx4 v9, s[20:23], s17 offen offset:1024 lds
    buffer_load_dwordx4 v10, s[20:23], s17 offen offset:2048 lds
    s_add_u32 s17, s17, 1769472
    s_cmp_ge_u32 s10, 4
    s_cbranch_scc1 P3_o1
    s_add_u32 m0, s41, 98304
    s_nop 0
    buffer_load_dwordx4 v8, s[20:23], s17 offen offset:0 lds
    buffer_load_dwordx4 v9, s[20:23], s17 offen offset:1024 lds
    buffer_load_dwordx4 v10, s[20:23], s17 offen offset:2048 lds
    s_add_u32 s17, s17, 1769472
P3_o1:
    s_cmp_lt_u32 s10, 6
    s_cbranch_scc1 P3_o2
    v_and_b32 v12, 0xff, v252
    v_lshlrev_b32 v12, 7, v12
    v_lshrrev_b32 v13, 8, v252
    v_readfirstlane_b32 s3, v252
    v_cmp_lt_u32 vcc, 7, v13
    s_nop 0
    v_mov_b32 v14, s3
    v_cndmask_b32 v14, v252, v14, vcc
    v_and_b32 v12, 0xff, v14
    v_lshlrev_b32 v12, 7, v12
    v_lshrrev_b32 v13, 8, v14
    v_add_u32 v13, s86, v13
    s_mov_b32 s3, 0x400000
POLL_35:
    buffer_load_dword v14, v12, s[76:79], 0 offen sc1
    s_sub_u32 s3, s3, 1
    s_waitcnt vmcnt(0)
    v_sub_u32 v14, v14, v13
    v_cmp_lt_u32 vcc, 7, v14
    s_nop 0
    s_cbranch_vccz POLLE_36
    s_cmp_eq_u32 s3, 0
    s_cbranch_scc1 POLLE_36
    s_nop 0
    s_branch POLL_35
POLLE_36:
    s_sub_u32 s3, s10, 6
    s_mul_i32 s17, s3, 73728
    s_and_b32 s19, s18, 0xffffffc0
    s_add_u32 s17, s17, s19
    s_lshl_b32 s3, s3, 12
    s_add_u32 m0, s3, 110592
    v_lshrrev_b32 v6, 3, v2
    v_mul_u32_u24 v6, 2304, v6
    v_and_b32 v7, 7, v2
    v_lshl_add_u32 v6, v7, 4, v6
    buffer_load_dwordx4 v6, s[24:27], s17 offen offset:0 sc1 lds
    s_add_u32 s17, s17, 17408
    buffer_load_dwordx4 v6, s[24:27], s17 offen offset:1024 sc1 lds
    s_add_u32 s17, s17, 17408
    buffer_load_dwordx4 v6, s[24:27], s17 offen offset:2048 sc1 lds
    s_add_u32 s17, s17, 17408
    buffer_load_dwordx4 v6, s[24:27], s17 offen offset:3072 sc1 lds
    s_add_u32 s17, s17, 17408
P3_o2:
    s_lshl_b32 s3, s43, 12
    s_add_u32 s3, s3, 110592
    v_lshrrev_b32 v6, 2, v2
    v_lshlrev_b32 v6, 7, v6
    v_and_b32 v7, 3, v2
    v_lshl_add_u32 v6, v7, 4, v6
    v_add_u32 v6, s3, v6
    s_bitcmp1_b32 s16, 0
    s_cselect_b32 s3, 8, 0
    v_add_u32 v14, s3, v6
    s_cselect_b32 s3, 64, 8
    v_add_u32 v15, s3, v6
    s_cselect_b32 s3, 72, 64
    v_add_u32 v6, s3, v6
    s_waitcnt vmcnt(0)
    s_barrier
    ds_read_b64_tr_b16 v[100:101], v4 offset:0
    ds_read_b64_tr_b16 v[102:103], v4 offset:1536
    ds_read_b64_tr_b16 v[104:105], v4 offset:32
    ds_read_b64_tr_b16 v[106:107], v4 offset:1568
    ds_read_b64_tr_b16 v[108:109], v4 offset:64
    ds_read_b64_tr_b16 v[110:111], v4 offset:1600
    ds_read_b64_tr_b16 v[112:113], v4 offset:12288
    ds_read_b64_tr_b16 v[114:115], v4 offset:13824
    ds_read_b64_tr_b16 v[116:117], v4 offset:12320
    ds_read_b64_tr_b16 v[118:119], v4 offset:13856
    ds_read_b64_tr_b16 v[120:121], v4 offset:12352
    ds_read_b64_tr_b16 v[122:123], v4 offset:13888
    ds_read_b64_tr_b16 v[124:125], v4 offset:24576
    ds_read_b64_tr_b16 v[126:127], v4 offset:26112
    ds_read_b64_tr_b16 v[128:129], v4 offset:24608
    ds_read_b64_tr_b16 v[130:131], v4 offset:26144
    ds_read_b64_tr_b16 v[132:133], v4 offset:24640
    ds_read_b64_tr_b16 v[134:135], v4 offset:26176
    ds_read_b64_tr_b16 v[136:137], v4 offset:36864
    ds_read_b64_tr_b16 v[138:139], v4 offset:38400
    ds_read_b64_tr_b16 v[140:141], v4 offset:36896
    ds_read_b64_tr_b16 v[142:143], v4 offset:38432
    ds_read_b64_tr_b16 v[144:145], v4 offset:36928
    ds_read_b64_tr_b16 v[146:147], v4 offset:38464
    ds_read_b64_tr_b16 v[148:149], v4 offset:49152
    ds_read_b64_tr_b16 v[150:151], v4 offset:50688
    ds_read_b64_tr_b16 v[152:153], v4 offset:49184
    ds_read_b64_tr_b16 v[154:155], v4 offset:50720
    ds_read_b64_tr_b16 v[156:157], v4 offset:49216
    ds_read_b64_tr_b16 v[158:159], v4 offset:50752
    ds_read_b64_tr_b16 v[160:161], v5 offset:0
    ds_read_b64_tr_b16 v[162:163], v5 offset:1536
    ds_read_b64_tr_b16 v[164:165], v5 offset:32
    ds_read_b64_tr_b16 v[166:167], v5 offset:1568
    ds_read_b64_tr_b16 v[168:169], v5 offset:64
    ds_read_b64_tr_b16 v[170:171], v5 offset:1600
    ds_read_b64_tr_b16 v[172:173], v5 offset:12288
    ds_read_b64_tr_b16 v[174:175], v5 offset:13824
    ds_read_b64_tr_b16 v[176:177], v5 offset:12320
    ds_read_b64_tr_b16 v[178:179], v5 offset:13856
    ds_read_b64_tr_b16 v[180:181], v5 offset:12352
    ds_read_b64_tr_b16 v[182:183], v5 offset:13888
    ds_read_b64_tr_b16 v[184:185], v5 offset:24576
    ds_read_b64_tr_b16 v[186:187], v5 offset:26112
    ds_read_b64_tr_b16 v[188:189], v5 offset:24608
    ds_read_b64_tr_b16 v[190:191], v5 offset:26144
    ds_read_b64_tr_b16 v[192:193], v5 offset:24640
    ds_read_b64_tr_b16 v[194:195], v5 offset:26176
    ds_read_b64_tr_b16 v[196:197], v5 offset:36864
    ds_read_b64_tr_b16 v[198:199], v5 offset:38400
    ds_read_b64_tr_b16 v[200:201], v5 offset:36896
    ds_read_b64_tr_b16 v[202:203], v5 offset:38432
    ds_read_b64_tr_b16 v[204:205], v5 offset:36928
    ds_read_b64_tr_b16 v[206:207], v5 offset:38464
    ds_read_b64_tr_b16 v[208:209], v14 offset:0
    ds_read_b64_tr_b16 v[210:211], v14 offset:2048
    ds_read_b64_tr_b16 v[212:213], v15 offset:0
    ds_read_b64_tr_b16 v[214:215], v15 offset:2048
    ds_read_b64_tr_b16 v[216:217], v6 offset:0
    ds_read_b64_tr_b16 v[218:219], v6 offset:2048
    s_waitcnt lgkmcnt(0)
    s_barrier
P3_a:
    s_and_b32 s13, s81, 15
    s_bfe_u32 s14, s81, 0x40004
    s_bfe_u32 s15, s81, 0x80008
    s_lshr_b32 s16, s81, 16
    s_add_u32 s24, s84, 0x600000
    s_addc_u32 s25, s85, 0
    s_mov_b32 s26, 0xdec000
    s_mov_b32 s27, 0x20000
    s_cmp_eq_u32 s13, 3
    s_cbranch_scc1 PV
    s_cmp_lt_u32 s10, 4
    s_cbranch_scc1 P3_cons
    s_cmp_eq_u32 s13, 15
    s_cbranch_scc1 P4
    s_sub_u32 s11, s10, 4
    s_mov_b32 s44, 0
    s_mul_i32 s17, s14, 66
    s_mul_i32 s18, s15, 6
    s_add_u32 s18, s18, s17
    s_add_u32 s18, s18, 132
    s_mul_i32 s19, s16, 6
    s_cmp_eq_u32 s13, 4
    s_cselect_b32 s19, 64, s19
    s_add_u32 s19, s19, s17
    s_and_b32 s3, s13, 3
    s_cmp_eq_u32 s3, 0
    s_cselect_b32 s41, 6, 12
    s_sub_u32 s19, s19, s41
    s_cmp_eq_u32 s13, 2
    s_cselect_b32 s47, 6, 0
    s_sub_u32 s47, s18, s47
    s_lshl_b32 s43, s11, 11
    s_add_u32 s45, s11, 0
    s_cmp_lt_u32 s45, 6
    s_cselect_b32 s46, s18, s47
    s_cmp_lt_u32 s45, s41
    s_cselect_b32 s46, s46, s19
    s_add_u32 s45, s45, s46
    s_mul_i32 s64, s45, 36864
    s_add_u32 s45, s11, 4
    s_cmp_lt_u32 s45, 6
    s_cselect_b32 s46, s18, s47
    s_cmp_lt_u32 s45, s41
    s_cselect_b32 s46, s46, s19
    s_add_u32 s45, s45, s46
    s_mul_i32 s65, s45, 36864
    s_add_u32 s45, s11, 8
    s_cmp_lt_u32 s45, 6
    s_cselect_b32 s46, s18, s47
    s_cmp_lt_u32 s45, s41
    s_cselect_b32 s46, s46, s19
    s_add_u32 s45, s45, s46
    s_mul_i32 s66, s45, 36864
    s_add_u32 s45, s11, 12
    s_cmp_lt_u32 s45, 6
    s_cselect_b32 s46, s18, s47
    s_cmp_lt_u32 s45, s41
    s_cselect_b32 s46, s46, s19
    s_add_u32 s45, s45, s46
    s_mul_i32 s67, s45, 36864
    s_lshr_b32 s45, s11, 1
    s_add_u32 s45, s45, s19
    s_add_u32 s45, s45, 16
    s_mul_i32 s45, s45, 36
    s_and_b32 s46, s11, 1
    s_add_u32 s45, s45, s46
    s_lshl_b32 s68, s45, 10
    s_lshl_b32 s42, s11, 10
    s_add_u32 s42, s42, 32768
    s_cmp_lg_u32 s10, 4
    s_cbranch_scc1 LD_37
    v_mov_b32 v8, 147464
    s_mov_b32 s3, 0x2000000
LW_39:
    ds_read_b32 v9, v8
    s_sub_u32 s3, s3, 1
    s_waitcnt lgkmcnt(0)
    v_cmp_le_u32 vcc, 4, v9
    s_cmp_eq_u32 s3, 0
    s_cbranch_scc1 LWE_40
    s_cbranch_vccnz LWE_40
    s_sleep 1
    s_branch LW_39
LWE_40:
    v_and_b32 v8, 0xff, v251
    v_lshlrev_b32 v8, 7, v8
    v_lshrrev_b32 v9, 8, v251
    v_add_u32 v9, s86, v9
    s_mov_b32 s3, 0x400000
POLL_41:
    buffer_load_dword v10, v8, s[76:79], 0 offen sc1
    s_sub_u32 s3, s3, 1
    s_waitcnt vmcnt(0)
    v_sub_u32 v10, v10, v9
    v_cmp_lt_u32 vcc, 7, v10
    s_nop 0
    s_cbranch_vccz POLLE_42
    s_cmp_eq_u32 s3, 0
    s_cbranch_scc1 POLLE_42
    s_nop 0
    s_branch POLL_41
POLLE_42:
    v_mov_b32 v8, 147460
    v_mov_b32 v9, 6
    ds_write_b32 v8, v9
    s_branch LDE_38
LD_37:
    v_mov_b32 v8, 147460
    s_mov_b32 s3, 0x2000000
LW_43:
    ds_read_b32 v9, v8
    s_sub_u32 s3, s3, 1
    s_waitcnt lgkmcnt(0)
    v_cmp_le_u32 vcc, 6, v9
    s_cmp_eq_u32 s3, 0
    s_cbranch_scc1 LWE_44
    s_cbranch_vccnz LWE_44
    s_sleep 1
    s_branch LW_43
LWE_44:
    s_waitcnt vmcnt(0)
LDE_38:
    s_cmp_eq_u32 s13, 4
    s_cbranch_scc1 P3_tload
    s_add_u32 m0, s44, s43
    s_nop 0
    buffer_load_dwordx4 v3, s[24:27], s64 offen sc1 lds
    buffer_load_dwordx4 v3, s[24:27], s64 offen offset:1024 sc1 lds
    s_add_u32 m0, m0, 8192
    s_add_u32 s64, s64, 2048
    buffer_load_dwordx4 v3, s[24:27], s65 offen sc1 lds
    buffer_load_dwordx4 v3, s[24:27], s65 offen offset:1024 sc1 lds
    s_add_u32 m0, m0, 8192
    s_add_u32 s65, s65, 2048
    buffer_load_dwordx4 v3, s[24:27], s66 offen sc1 lds
    buffer_load_dwordx4 v3, s[24:27], s66 offen offset:1024 sc1 lds
    s_add_u32 m0, m0, 8192
    s_add_u32 s66, s66, 2048
    buffer_load_dwordx4 v3, s[24:27], s67 offen sc1 lds
    buffer_load_dwordx4 v3, s[24:27], s67 offen offset:1024 sc1 lds
    s_add_u32 m0, s44, s42
    s_add_u32 s67, s67, 2048
    buffer_load_dwordx4 v3, s[24:27], s68 offen sc1 lds
    s_add_u32 s68, s68, 2048
    s_add_u32 s44, s44, 36864
    s_cmp_eq_u32 s44, 147456
    s_cselect_b32 s44, 0, s44
    s_add_u32 m0, s44, s43
    s_nop 0
    buffer_load_dwordx4 v3, s[24:27], s64 offen sc1 lds
    buffer_load_dwordx4 v3, s[24:27], s64 offen offset:1024 sc1 lds
    s_add_u32 m0, m0, 8192
    s_add_u32 s64, s64, 2048
    buffer_load_dwordx4 v3, s[24:27], s65 offen sc1 lds
    buffer_load_dwordx4 v3, s[24:27], s65 offen offset:1024 sc1 lds
    s_add_u32 m0, m0, 8192
    s_add_u32 s65, s65, 2048
    buffer_load_dwordx4 v3, s[24:27], s66 offen sc1 lds
    buffer_load_dwordx4 v3, s[24:27], s66 offen offset:1024 sc1 lds
    s_add_u32 m0, m0, 8192
    s_add_u32 s66, s66, 2048
    buffer_load_dwordx4 v3, s[24:27], s67 offen sc1 lds
    buffer_load_dwordx4 v3, s[24:27], s67 offen offset:1024 sc1 lds
    s_add_u32 m0, s44, s42
    s_add_u32 s67, s67, 2048
    buffer_load_dwordx4 v3, s[24:27], s68 offen sc1 lds
    s_add_u32 s68, s68, 2048
    s_add_u32 s44, s44, 36864
    s_cmp_eq_u32 s44, 147456
    s_cselect_b32 s44, 0, s44
    s_waitcnt vmcnt(9)
    s_barrier
    s_add_u32 m0, s44, s43
    s_nop 0
    buffer_load_dwordx4 v3, s[24:27], s64 offen sc1 lds
    buffer_load_dwordx4 v3, s[24:27], s64 offen offset:1024 sc1 lds
    s_add_u32 m0, m0, 8192
    s_add_u32 s64, s64, 2048
    buffer_load_dwordx4 v3, s[24:27], s65 offen sc1 lds
    buffer_load_dwordx4 v3, s[24:27], s65 offen offset:1024 sc1 lds
    s_add_u32 m0, m0, 8192
    s_add_u32 s65, s65, 2048
    buffer_load_dwordx4 v3, s[24:27], s66 offen sc1 lds
    buffer_load_dwordx4 v3, s[24:27], s66 offen offset:1024 sc1 lds
    s_add_u32 m0, m0, 8192
    s_add_u32 s66, s66, 2048
    buffer_load_dwordx4 v3, s[24:27], s67 offen sc1 lds
    buffer_load_dwordx4 v3, s[24:27], s67 offen offset:1024 sc1 lds
    s_add_u32 m0, s44, s42
    s_add_u32 s67, s67, 2048
    buffer_load_dwordx4 v3, s[24:27], s68 offen sc1 lds
    s_add_u32 s68, s68, 2048
    s_add_u32 s44, s44, 36864
    s_cmp_eq_u32 s44, 147456
    s_cselect_b32 s44, 0, s44
    s_add_u32 m0, s44, s43
    s_nop 0
    buffer_load_dwordx4 v3, s[24:27], s64 offen sc1 lds
    buffer_load_dwordx4 v3, s[24:27], s64 offen offset:1024 sc1 lds
    s_add_u32 m0, m0, 8192
    s_add_u32 s64, s64, 2048
    buffer_load_dwordx4 v3, s[24:27], s65 offen sc1 lds
    buffer_load_dwordx4 v3, s[24:27], s65 offen offset:1024 sc1 lds
    s_add_u32 m0, m0, 8192
    s_add_u32 s65, s65, 2048
    buffer_load_dwordx4 v3, s[24:27], s66 offen sc1 lds
    buffer_load_dwordx4 v3, s[24:27], s66 offen offset:1024 sc1 lds
    s_add_u32 m0, m0, 8192
    s_add_u32 s66, s66, 2048
    buffer_load_dwordx4 v3, s[24:27], s67 offen sc1 lds
    buffer_load_dwordx4 v3, s[24:27], s67 offen offset:1024 sc1 lds
    s_add_u32 m0, s44, s42
    s_add_u32 s67, s67, 2048
    buffer_load_dwordx4 v3, s[24:27], s68 offen sc1 lds
    s_add_u32 s68, s68, 2048
    s_add_u32 s44, s44, 36864
    s_cmp_eq_u32 s44, 147456
    s_cselect_b32 s44, 0, s44
    s_mov_b32 s60, 14
P3S_lloop:
    s_waitcnt vmcnt(18)
    s_barrier
    s_add_u32 m0, s44, s43
    s_nop 0
    buffer_load_dwordx4 v3, s[24:27], s64 offen sc1 lds
    buffer_load_dwordx4 v3, s[24:27], s64 offen offset:1024 sc1 lds
    s_add_u32 m0, m0, 8192
    s_add_u32 s64, s64, 2048
    buffer_load_dwordx4 v3, s[24:27], s65 offen sc1 lds
    buffer_load_dwordx4 v3, s[24:27], s65 offen offset:1024 sc1 lds
    s_add_u32 m0, m0, 8192
    s_add_u32 s65, s65, 2048
    buffer_load_dwordx4 v3, s[24:27], s66 offen sc1 lds
    buffer_load_dwordx4 v3, s[24:27], s66 offen offset:1024 sc1 lds
    s_add_u32 m0, m0, 8192
    s_add_u32 s66, s66, 2048
    buffer_load_dwordx4 v3, s[24:27], s67 offen sc1 lds
    buffer_load_dwordx4 v3, s[24:27], s67 offen offset:1024 sc1 lds
    s_add_u32 m0, s44, s42
    s_add_u32 s67, s67, 2048
    buffer_load_dwordx4 v3, s[24:27], s68 offen sc1 lds
    s_add_u32 s68, s68, 2048
    s_add_u32 s44, s44, 36864
    s_cmp_eq_u32 s44, 147456
    s_cselect_b32 s44, 0, s44
    s_sub_u32 s60, s60, 1
    s_cmp_lg_u32 s60, 0
    s_cbranch_scc1 P3S_lloop
    s_waitcnt vmcnt(18)
    s_barrier
    s_waitcnt vmcnt(9)
    s_barrier
    s_waitcnt vmcnt(0)
    s_barrier
    s_barrier
    s_branch P4
P3_tload:
    s_add_u32 m0, s44, s43
    s_nop 0
    buffer_load_dwordx4 v3, s[24:27], s64 offen sc1 lds
    buffer_load_dwordx4 v3, s[24:27], s64 offen offset:1024 sc1 lds
    s_add_u32 m0, m0, 8192
    s_add_u32 s64, s64, 2048
    buffer_load_dwordx4 v3, s[24:27], s65 offen sc1 lds
    buffer_load_dwordx4 v3, s[24:27], s65 offen offset:1024 sc1 lds
    s_add_u32 m0, m0, 8192
    s_add_u32 s65, s65, 2048
    s_add_u32 s44, s44, 36864
    s_cmp_eq_u32 s44, 147456
    s_cselect_b32 s44, 0, s44
    s_add_u32 m0, s44, s43
    s_nop 0
    buffer_load_dwordx4 v3, s[24:27], s64 offen sc1 lds
    buffer_load_dwordx4 v3, s[24:27], s64 offen offset:1024 sc1 lds
    s_add_u32 m0, m0, 8192
    s_add_u32 s64, s64, 2048
    buffer_load_dwordx4 v3, s[24:27], s65 offen sc1 lds
    buffer_load_dwordx4 v3, s[24:27], s65 offen offset:1024 sc1 lds
    s_add_u32 m0, m0, 8192
    s_add_u32 s65, s65, 2048
    s_add_u32 s44, s44, 36864
    s_cmp_eq_u32 s44, 147456
    s_cselect_b32 s44, 0, s44
    s_add_u32 m0, s44, s43
    s_nop 0
    buffer_load_dwordx4 v3, s[24:27], s64 offen sc1 lds
    buffer_load_dwordx4 v3, s[24:27], s64 offen offset:1024 sc1 lds
    s_add_u32 m0, m0, 8192
    s_add_u32 s64, s64, 2048
    buffer_load_dwordx4 v3, s[24:27], s65 offen sc1 lds
    buffer_load_dwordx4 v3, s[24:27], s65 offen offset:1024 sc1 lds
    s_add_u32 m0, m0, 8192
    s_add_u32 s65, s65, 2048
    s_add_u32 s44, s44, 36864
    s_cmp_eq_u32 s44, 147456
    s_cselect_b32 s44, 0, s44
    s_waitcnt vmcnt(8)
    s_barrier
    s_add_u32 m0, s44, s43
    s_nop 0
    buffer_load_dwordx4 v3, s[24:27], s64 offen sc1 lds
    buffer_load_dwordx4 v3, s[24:27], s64 offen offset:1024 sc1 lds
    s_add_u32 m0, m0, 8192
    s_add_u32 s64, s64, 2048
    buffer_load_dwordx4 v3, s[24:27], s65 offen sc1 lds
    buffer_load_dwordx4 v3, s[24:27], s65 offen offset:1024 sc1 lds
    s_add_u32 m0, m0, 8192
    s_add_u32 s65, s65, 2048
    s_add_u32 s44, s44, 36864
    s_cmp_eq_u32 s44, 147456
    s_cselect_b32 s44, 0, s44
    s_mov_b32 s60, 14
P3T_lloop:
    s_waitcnt vmcnt(8)
    s_barrier
    s_add_u32 m0, s44, s43
    s_nop 0
    buffer_load_dwordx4 v3, s[24:27], s64 offen sc1 lds
    buffer_load_dwordx4 v3, s[24:27], s64 offen offset:1024 sc1 lds
    s_add_u32 m0, m0, 8192
    s_add_u32 s64, s64, 2048
    buffer_load_dwordx4 v3, s[24:27], s65 offen sc1 lds
    buffer_load_dwordx4 v3, s[24:27], s65 offen offset:1024 sc1 lds
    s_add_u32 m0, m0, 8192
    s_add_u32 s65, s65, 2048
    s_add_u32 s44, s44, 36864
    s_cmp_eq_u32 s44, 147456
    s_cselect_b32 s44, 0, s44
    s_sub_u32 s60, s60, 1
    s_cmp_lg_u32 s60, 0
    s_cbranch_scc1 P3T_lloop
    s_waitcnt vmcnt(8)
    s_barrier
    s_waitcnt vmcnt(4)
    s_barrier
    s_waitcnt vmcnt(0)
    s_barrier
    s_barrier
    s_branch P4
P3_cons:
    s_cmp_eq_u32 s13, 15
    s_cbranch_scc1 P3_fin
    s_add_u32 s28, s84, 0x1400000
    s_addc_u32 s29, s85, 0
    s_mov_b32 s30, 0x441000
    s_mov_b32 s31, 0x20000
    s_add_u32 s36, s84, 0x30000
    s_addc_u32 s37, s85, 0
    s_mov_b32 s38, 0x16b00
    s_mov_b32 s39, 0x20000
    s_mov_b32 s45, 18
    s_lshr_b32 s17, s10, 1
    s_and_b32 s18, s10, 1
    s_cmp_ge_u32 s13, 2
    s_cselect_b32 s3, s17, 0
    s_cmp_eq_u32 s3, 1
    s_cbranch_scc1 P3_idle
    s_mul_i32 s19, s10, 3
    s_add_u32 s46, s19, 6
    s_mul_i32 s41, s18, 3
    s_add_u32 s42, s41, 12
    s_mul_i32 s43, s17, 6
    s_cmp_eq_u32 s13, 0
    s_cselect_b32 s46, s46, s42
    s_cselect_b32 s43, 0, s43
    s_cselect_b32 s19, s19, s41
    s_cselect_b32 s41, 0, s17
    s_mul_i32 s16, s16, 6
    s_add_u32 s16, s16, s19
    s_add_u32 s3, s10, 6
    s_add_u32 s19, s10, 64
    s_cmp_eq_u32 s13, 4
    s_cselect_b32 s46, s3, s46
    s_cselect_b32 s16, s19, s16
    s_lshl_b32 s46, s46, 11
    s_lshl_b32 s43, s43, 11
    v_add_u32 v96, s43, v3
    v_add_u32 v97, s46, v3
    s_add_u32 s15, s15, s41
    s_mul_i32 s46, s14, 66
    s_add_u32 s46, s46, s16
    s_mul_i32 s46, s46, 33
    s_mul_i32 s41, s15, 3
    s_add_u32 s46, s46, s41
    s_lshl_b32 s46, s46, 10
    s_mul_i32 s41, s14, 11
    s_add_u32 s41, s41, s15
    s_mul_i32 s41, s41, 66
    s_add_u32 s41, s41, s16
    s_lshl_b32 s41, s41, 6
    v_and_b32 v4, 15, v2
    v_lshlrev_b32 v4, 2, v4
    s_mov_b32 s62, 0x47800080
    s_mov_b32 s63, 0x47800080
    s_mov_b32 s64, 0xc7800000
    s_mov_b32 s65, 0xc7800000
    s_mov_b32 s66, 0x3cf15bef
    s_mov_b32 s67, 0x3cf15bef
    s_mov_b32 s68, 0x3fb8aa3b
    s_mov_b32 s69, 0x3fb8aa3b
    s_cmp_eq_u32 s13, 4
    s_cbranch_scc1 P3_tc
    v_mov_b64 v[100:101], 0
    v_mov_b64 v[102:103], 0
    v_mov_b64 v[104:105], 0
    v_mov_b64 v[106:107], 0
    v_mov_b64 v[108:109], 0
    v_mov_b64 v[110:111], 0
    v_mov_b64 v[112:113], 0
    v_mov_b64 v[114:115], 0
    v_mov_b64 v[116:117], 0
    v_mov_b64 v[118:119], 0
    v_mov_b64 v[120:121], 0
    v_mov_b64 v[122:123], 0
    v_mov_b64 v[124:125], 0
    v_mov_b64 v[126:127], 0
    v_mov_b64 v[128:129], 0
    v_mov_b64 v[130:131], 0
    v_mov_b64 v[132:133], 0
    v_mov_b64 v[134:135], 0
    v_mov_b64 v[136:137], 0
    v_mov_b64 v[138:139], 0
    v_mov_b64 v[140:141], 0
    v_mov_b64 v[142:143], 0
    v_mov_b64 v[144:145], 0
    v_mov_b64 v[146:147], 0
    v_mov_b64 v[148:149], 0
    v_mov_b64 v[150:151], 0
    v_mov_b64 v[152:153], 0
    v_mov_b64 v[154:155], 0
    v_mov_b64 v[156:157], 0
    v_mov_b64 v[158:159], 0
    v_mov_b64 v[160:161], 0
    v_mov_b64 v[162:163], 0
    v_mov_b64 v[164:165], 0
    v_mov_b64 v[166:167], 0
    v_mov_b64 v[168:169], 0
    v_mov_b64 v[170:171], 0
    v_mov_b32 v98, v96
    v_mov_b32 v99, v97
    s_mov_b32 s44, 0
    s_mov_b32 s45, 18
    s_barrier
    ds_read_b128 v[16:19], v98 offset:0
    ds_read_b128 v[40:43], v99 offset:0
    ds_read_b128 v[44:47], v99 offset:2048
    ds_read_b128 v[48:51], v99 offset:4096
    ds_read_b128 v[20:23], v98 offset:2048
    ds_read_b128 v[24:27], v98 offset:4096
    ds_read_b128 v[28:31], v98 offset:6144
    ds_read_b128 v[32:35], v98 offset:8192
    ds_read_b128 v[36:39], v98 offset:10240
    s_branch P3S_mid
P3S_loop:
    v_mfma_f32_16x16x32_bf16 v[100:103], v[52:55], v[76:79], v[100:103]
    v_mfma_f32_16x16x32_bf16 v[104:107], v[52:55], v[80:83], v[104:107]
    s_barrier
    v_mfma_f32_16x16x32_bf16 v[108:111], v[52:55], v[84:87], v[108:111]
    ds_read_b128 v[16:19], v98 offset:0
    v_mfma_f32_16x16x32_bf16 v[112:115], v[56:59], v[76:79], v[112:115]
    ds_read_b128 v[40:43], v99 offset:0
    v_mfma_f32_16x16x32_bf16 v[116:119], v[56:59], v[80:83], v[116:119]
    ds_read_b128 v[44:47], v99 offset:2048
    v_mfma_f32_16x16x32_bf16 v[120:123], v[56:59], v[84:87], v[120:123]
    ds_read_b128 v[48:51], v99 offset:4096
    v_mfma_f32_16x16x32_bf16 v[124:127], v[60:63], v[76:79], v[124:127]
    ds_read_b128 v[20:23], v98 offset:2048
    v_mfma_f32_16x16x32_bf16 v[128:131], v[60:63], v[80:83], v[128:131]
    ds_read_b128 v[24:27], v98 offset:4096
    v_mfma_f32_16x16x32_bf16 v[132:135], v[60:63], v[84:87], v[132:135]
    ds_read_b128 v[28:31], v98 offset:6144
    v_mfma_f32_16x16x32_bf16 v[136:139], v[64:67], v[76:79], v[136:139]
    ds_read_b128 v[32:35], v98 offset:8192
    v_mfma_f32_16x16x32_bf16 v[140:143], v[64:67], v[80:83], v[140:143]
    ds_read_b128 v[36:39], v98 offset:10240
    v_mfma_f32_16x16x32_bf16 v[144:147], v[64:67], v[84:87], v[144:147]
    v_mfma_f32_16x16x32_bf16 v[148:151], v[68:71], v[76:79], v[148:151]
    v_mfma_f32_16x16x32_bf16 v[152:155], v[68:71], v[80:83], v[152:155]
    v_mfma_f32_16x16x32_bf16 v[156:159], v[68:71], v[84:87], v[156:159]
    v_mfma_f32_16x16x32_bf16 v[160:163], v[72:75], v[76:79], v[160:163]
    v_mfma_f32_16x16x32_bf16 v[164:167], v[72:75], v[80:83], v[164:167]
    v_mfma_f32_16x16x32_bf16 v[168:171], v[72:75], v[84:87], v[168:171]
P3S_mid:
    s_waitcnt lgkmcnt(0)
    v_mfma_f32_16x16x32_bf16 v[100:103], v[16:19], v[40:43], v[100:103]
    ds_read_b128 v[52:55], v98 offset:1024
    v_mfma_f32_16x16x32_bf16 v[104:107], v[16:19], v[44:47], v[104:107]
    ds_read_b128 v[76:79], v99 offset:1024
    v_mfma_f32_16x16x32_bf16 v[108:111], v[16:19], v[48:51], v[108:111]
    ds_read_b128 v[80:83], v99 offset:3072
    v_mfma_f32_16x16x32_bf16 v[112:115], v[20:23], v[40:43], v[112:115]
    ds_read_b128 v[84:87], v99 offset:5120
    v_mfma_f32_16x16x32_bf16 v[116:119], v[20:23], v[44:47], v[116:119]
    ds_read_b128 v[56:59], v98 offset:3072
    v_mfma_f32_16x16x32_bf16 v[120:123], v[20:23], v[48:51], v[120:123]
    ds_read_b128 v[60:63], v98 offset:5120
    v_mfma_f32_16x16x32_bf16 v[124:127], v[24:27], v[40:43], v[124:127]
    ds_read_b128 v[64:67], v98 offset:7168
    v_mfma_f32_16x16x32_bf16 v[128:131], v[24:27], v[44:47], v[128:131]
    ds_read_b128 v[68:71], v98 offset:9216
    v_mfma_f32_16x16x32_bf16 v[132:135], v[24:27], v[48:51], v[132:135]
    ds_read_b128 v[72:75], v98 offset:11264
    v_mfma_f32_16x16x32_bf16 v[136:139], v[28:31], v[40:43], v[136:139]
    v_mfma_f32_16x16x32_bf16 v[140:143], v[28:31], v[44:47], v[140:143]
    s_add_u32 s44, s44, 36864
    v_mfma_f32_16x16x32_bf16 v[144:147], v[28:31], v[48:51], v[144:147]
    s_cmp_eq_u32 s44, 147456
    v_mfma_f32_16x16x32_bf16 v[148:151], v[32:35], v[40:43], v[148:151]
    s_cselect_b32 s44, 0, s44
    v_mfma_f32_16x16x32_bf16 v[152:155], v[32:35], v[44:47], v[152:155]
    v_add_u32 v98, s44, v96
    v_mfma_f32_16x16x32_bf16 v[156:159], v[32:35], v[48:51], v[156:159]
    v_add_u32 v99, s44, v97
    v_mfma_f32_16x16x32_bf16 v[160:163], v[36:39], v[40:43], v[160:163]
    s_sub_u32 s45, s45, 1
    v_mfma_f32_16x16x32_bf16 v[164:167], v[36:39], v[44:47], v[164:167]
    s_cmp_lg_u32 s45, 0
    v_mfma_f32_16x16x32_bf16 v[168:171], v[36:39], v[48:51], v[168:171]
    s_waitcnt lgkmcnt(0)
    s_cbranch_scc1 P3S_loop
    s_barrier
    v_mfma_f32_16x16x32_bf16 v[100:103], v[52:55], v[76:79], v[100:103]
    v_mfma_f32_16x16x32_bf16 v[112:115], v[56:59], v[76:79], v[112:115]
    v_mfma_f32_16x16x32_bf16 v[124:127], v[60:63], v[76:79], v[124:127]
    v_mfma_f32_16x16x32_bf16 v[136:139], v[64:67], v[76:79], v[136:139]
    v_mfma_f32_16x16x32_bf16 v[148:151], v[68:71], v[76:79], v[148:151]
    v_mfma_f32_16x16x32_bf16 v[160:163], v[72:75], v[76:79], v[160:163]
    v_mfma_f32_16x16x32_bf16 v[104:107], v[52:55], v[80:83], v[104:107]
    v_mfma_f32_16x16x32_bf16 v[116:119], v[56:59], v[80:83], v[116:119]
    v_mfma_f32_16x16x32_bf16 v[128:131], v[60:63], v[80:83], v[128:131]
    v_mfma_f32_16x16x32_bf16 v[140:143], v[64:67], v[80:83], v[140:143]
    v_mfma_f32_16x16x32_bf16 v[152:155], v[68:71], v[80:83], v[152:155]
    v_mfma_f32_16x16x32_bf16 v[164:167], v[72:75], v[80:83], v[164:167]
    v_mfma_f32_16x16x32_bf16 v[108:111], v[52:55], v[84:87], v[108:111]
    v_mfma_f32_16x16x32_bf16 v[120:123], v[56:59], v[84:87], v[120:123]
    v_mfma_f32_16x16x32_bf16 v[132:135], v[60:63], v[84:87], v[132:135]
    v_mfma_f32_16x16x32_bf16 v[144:147], v[64:67], v[84:87], v[144:147]
    v_mfma_f32_16x16x32_bf16 v[156:159], v[68:71], v[84:87], v[156:159]
    v_mfma_f32_16x16x32_bf16 v[168:171], v[72:75], v[84:87], v[168:171]
    s_cmp_ge_u32 s16, 63
    s_cbranch_scc1 P3_one
    v_pk_mul_f32 v[172:173], v[100:101], s[62:63]
    v_pk_mul_f32 v[174:175], v[102:103], s[62:63]
    v_pk_mul_f32 v[176:177], v[112:113], s[62:63]
    v_pk_mul_f32 v[178:179], v[114:115], s[62:63]
    v_pk_mul_f32 v[180:181], v[124:125], s[62:63]
    v_pk_mul_f32 v[182:183], v[126:127], s[62:63]
    v_pk_mul_f32 v[184:185], v[136:137], s[62:63]
    v_pk_mul_f32 v[186:187], v[138:139], s[62:63]
    v_pk_mul_f32 v[188:189], v[148:149], s[62:63]
    v_pk_mul_f32 v[190:191], v[150:151], s[62:63]
    v_pk_mul_f32 v[192:193], v[160:161], s[62:63]
    v_pk_mul_f32 v[194:195], v[162:163], s[62:63]
    v_pk_fma_f32 v[100:101], v[100:101], s[64:65], v[172:173]
    v_pk_fma_f32 v[102:103], v[102:103], s[64:65], v[174:175]
    v_pk_fma_f32 v[112:113], v[112:113], s[64:65], v[176:177]
    v_pk_fma_f32 v[114:115], v[114:115], s[64:65], v[178:179]
    v_pk_fma_f32 v[124:125], v[124:125], s[64:65], v[180:181]
    v_pk_fma_f32 v[126:127], v[126:127], s[64:65], v[182:183]
    v_pk_fma_f32 v[136:137], v[136:137], s[64:65], v[184:185]
    v_pk_fma_f32 v[138:139], v[138:139], s[64:65], v[186:187]
    v_pk_fma_f32 v[148:149], v[148:149], s[64:65], v[188:189]
    v_pk_fma_f32 v[150:151], v[150:151], s[64:65], v[190:191]
    v_pk_fma_f32 v[160:161], v[160:161], s[64:65], v[192:193]
    v_pk_fma_f32 v[162:163], v[162:163], s[64:65], v[194:195]
    v_pk_mul_f32 v[100:101], v[100:101], s[66:67]
    v_pk_mul_f32 v[102:103], v[102:103], s[66:67]
    v_pk_mul_f32 v[112:113], v[112:113], s[66:67]
    v_pk_mul_f32 v[114:115], v[114:115], s[66:67]
    v_pk_mul_f32 v[124:125], v[124:125], s[66:67]
    v_pk_mul_f32 v[126:127], v[126:127], s[66:67]
    v_pk_mul_f32 v[136:137], v[136:137], s[66:67]
    v_pk_mul_f32 v[138:139], v[138:139], s[66:67]
    v_pk_mul_f32 v[148:149], v[148:149], s[66:67]
    v_pk_mul_f32 v[150:151], v[150:151], s[66:67]
    v_pk_mul_f32 v[160:161], v[160:161], s[66:67]
    v_pk_mul_f32 v[162:163], v[162:163], s[66:67]
    v_pk_mul_f32 v[172:173], v[100:101], s[62:63]
    v_pk_mul_f32 v[174:175], v[102:103], s[62:63]
    v_pk_mul_f32 v[176:177], v[112:113], s[62:63]
    v_pk_mul_f32 v[178:179], v[114:115], s[62:63]
    v_pk_mul_f32 v[180:181], v[124:125], s[62:63]
    v_pk_mul_f32 v[182:183], v[126:127], s[62:63]
    v_pk_mul_f32 v[184:185], v[136:137], s[62:63]
    v_pk_mul_f32 v[186:187], v[138:139], s[62:63]
    v_pk_mul_f32 v[188:189], v[148:149], s[62:63]
    v_pk_mul_f32 v[190:191], v[150:151], s[62:63]
    v_pk_mul_f32 v[192:193], v[160:161], s[62:63]
    v_pk_mul_f32 v[194:195], v[162:163], s[62:63]
    v_pk_fma_f32 v[100:101], v[100:101], s[64:65], v[172:173]
    v_pk_fma_f32 v[102:103], v[102:103], s[64:65], v[174:175]
    v_pk_fma_f32 v[112:113], v[112:113], s[64:65], v[176:177]
    v_pk_fma_f32 v[114:115], v[114:115], s[64:65], v[178:179]
    v_pk_fma_f32 v[124:125], v[124:125], s[64:65], v[180:181]
    v_pk_fma_f32 v[126:127], v[126:127], s[64:65], v[182:183]
    v_pk_fma_f32 v[136:137], v[136:137], s[64:65], v[184:185]
    v_pk_fma_f32 v[138:139], v[138:139], s[64:65], v[186:187]
    v_pk_fma_f32 v[148:149], v[148:149], s[64:65], v[188:189]
    v_pk_fma_f32 v[150:151], v[150:151], s[64:65], v[190:191]
    v_pk_fma_f32 v[160:161], v[160:161], s[64:65], v[192:193]
    v_pk_fma_f32 v[162:163], v[162:163], s[64:65], v[194:195]
    v_max3_f32 v172, v100, v101, v102
    v_max3_f32 v176, v103, v112, v113
    v_max3_f32 v173, v114, v115, v124
    v_max3_f32 v177, v125, v126, v127
    v_max3_f32 v174, v136, v137, v138
    v_max3_f32 v178, v139, v148, v149
    v_max3_f32 v175, v150, v151, v160
    v_max3_f32 v179, v161, v162, v163
    v_pk_mul_f32 v[196:197], v[104:105], s[62:63]
    v_max3_f32 v172, v172, v173, v174
    v_pk_mul_f32 v[198:199], v[106:107], s[62:63]
    v_pk_mul_f32 v[200:201], v[116:117], s[62:63]
    v_pk_mul_f32 v[202:203], v[118:119], s[62:63]
    v_max3_f32 v175, v175, v176, v177
    v_pk_mul_f32 v[204:205], v[128:129], s[62:63]
    v_pk_mul_f32 v[206:207], v[130:131], s[62:63]
    v_pk_mul_f32 v[208:209], v[140:141], s[62:63]
    v_max3_f32 v172, v172, v178, v179
    v_pk_mul_f32 v[210:211], v[142:143], s[62:63]
    v_pk_mul_f32 v[212:213], v[152:153], s[62:63]
    v_pk_mul_f32 v[214:215], v[154:155], s[62:63]
    v_max_f32 v172, v172, v175
    v_pk_mul_f32 v[216:217], v[164:165], s[62:63]
    v_pk_mul_f32 v[218:219], v[166:167], s[62:63]
    v_pk_fma_f32 v[104:105], v[104:105], s[64:65], v[196:197]
    v_mov_b32 v173, v172
    v_pk_fma_f32 v[106:107], v[106:107], s[64:65], v[198:199]
    v_pk_fma_f32 v[116:117], v[116:117], s[64:65], v[200:201]
    v_pk_fma_f32 v[118:119], v[118:119], s[64:65], v[202:203]
    v_permlane32_swap_b32 v172, v173
    v_pk_fma_f32 v[128:129], v[128:129], s[64:65], v[204:205]
    v_pk_fma_f32 v[130:131], v[130:131], s[64:65], v[206:207]
    v_pk_fma_f32 v[140:141], v[140:141], s[64:65], v[208:209]
    v_max_f32 v172, v172, v173
    v_pk_fma_f32 v[142:143], v[142:143], s[64:65], v[210:211]
    v_pk_fma_f32 v[152:153], v[152:153], s[64:65], v[212:213]
    v_pk_fma_f32 v[154:155], v[154:155], s[64:65], v[214:215]
    v_mov_b32 v173, v172
    v_pk_fma_f32 v[164:165], v[164:165], s[64:65], v[216:217]
    v_pk_fma_f32 v[166:167], v[166:167], s[64:65], v[218:219]
    v_pk_mul_f32 v[104:105], v[104:105], s[66:67]
    v_permlane16_swap_b32 v172, v173
    v_pk_mul_f32 v[106:107], v[106:107], s[66:67]
    v_pk_mul_f32 v[116:117], v[116:117], s[66:67]
    v_pk_mul_f32 v[118:119], v[118:119], s[66:67]
    v_max_f32 v172, v172, v173
    v_pk_mul_f32 v[128:129], v[128:129], s[66:67]
    v_pk_mul_f32 v[130:131], v[130:131], s[66:67]
    v_pk_mul_f32 v[140:141], v[140:141], s[66:67]
    v_mul_f32 v172, s68, v172
    v_pk_mul_f32 v[142:143], v[142:143], s[66:67]
    v_pk_mul_f32 v[152:153], v[152:153], s[66:67]
    v_pk_mul_f32 v[154:155], v[154:155], s[66:67]
    v_ceil_f32 v8, v172
    v_pk_mul_f32 v[164:165], v[164:165], s[66:67]
    v_pk_mul_f32 v[166:167], v[166:167], s[66:67]
    v_pk_mul_f32 v[196:197], v[104:105], s[62:63]
    buffer_store_dword v8, v4, s[36:39], s41 offen offset:0 sc1
    v_pk_mul_f32 v[198:199], v[106:107], s[62:63]
    v_pk_mul_f32 v[200:201], v[116:117], s[62:63]
    v_pk_mul_f32 v[202:203], v[118:119], s[62:63]
    v_pk_mul_f32 v[204:205], v[128:129], s[62:63]
    v_pk_mul_f32 v[206:207], v[130:131], s[62:63]
    v_pk_mul_f32 v[208:209], v[140:141], s[62:63]
    v_pk_mul_f32 v[210:211], v[142:143], s[62:63]
    v_pk_mul_f32 v[212:213], v[152:153], s[62:63]
    v_pk_mul_f32 v[214:215], v[154:155], s[62:63]
    v_pk_mul_f32 v[216:217], v[164:165], s[62:63]
    v_pk_mul_f32 v[218:219], v[166:167], s[62:63]
    v_pk_fma_f32 v[104:105], v[104:105], s[64:65], v[196:197]
    v_pk_fma_f32 v[106:107], v[106:107], s[64:65], v[198:199]
    v_pk_fma_f32 v[116:117], v[116:117], s[64:65], v[200:201]
    v_pk_fma_f32 v[118:119], v[118:119], s[64:65], v[202:203]
    v_pk_fma_f32 v[128:129], v[128:129], s[64:65], v[204:205]
    v_pk_fma_f32 v[130:131], v[130:131], s[64:65], v[206:207]
    v_pk_fma_f32 v[140:141], v[140:141], s[64:65], v[208:209]
    v_pk_fma_f32 v[142:143], v[142:143], s[64:65], v[210:211]
    v_pk_fma_f32 v[152:153], v[152:153], s[64:65], v[212:213]
    v_pk_fma_f32 v[154:155], v[154:155], s[64:65], v[214:215]
    v_pk_fma_f32 v[164:165], v[164:165], s[64:65], v[216:217]
    v_pk_fma_f32 v[166:167], v[166:167], s[64:65], v[218:219]
    v_max3_f32 v196, v104, v105, v106
    v_max3_f32 v200, v107, v116, v117
    v_max3_f32 v197, v118, v119, v128
    v_max3_f32 v201, v129, v130, v131
    v_max3_f32 v198, v140, v141, v142
    v_max3_f32 v202, v143, v152, v153
    v_max3_f32 v199, v154, v155, v164
    v_max3_f32 v203, v165, v166, v167
    v_pk_fma_f32 v[100:101], v[100:101], s[68:69], v[8:9] op_sel_hi:[1,1,0] neg_lo:[0,0,1] neg_hi:[0,0,1]
    v_max3_f32 v196, v196, v197, v198
    v_pk_fma_f32 v[102:103], v[102:103], s[68:69], v[8:9] op_sel_hi:[1,1,0] neg_lo:[0,0,1] neg_hi:[0,0,1]
    v_pk_fma_f32 v[112:113], v[112:113], s[68:69], v[8:9] op_sel_hi:[1,1,0] neg_lo:[0,0,1] neg_hi:[0,0,1]
    v_pk_fma_f32 v[114:115], v[114:115], s[68:69], v[8:9] op_sel_hi:[1,1,0] neg_lo:[0,0,1] neg_hi:[0,0,1]
    v_max3_f32 v199, v199, v200, v201
    v_pk_fma_f32 v[124:125], v[124:125], s[68:69], v[8:9] op_sel_hi:[1,1,0] neg_lo:[0,0,1] neg_hi:[0,0,1]
    v_pk_fma_f32 v[126:127], v[126:127], s[68:69], v[8:9] op_sel_hi:[1,1,0] neg_lo:[0,0,1] neg_hi:[0,0,1]
    v_pk_fma_f32 v[136:137], v[136:137], s[68:69], v[8:9] op_sel_hi:[1,1,0] neg_lo:[0,0,1] neg_hi:[0,0,1]
    v_max3_f32 v196, v196, v202, v203
    v_pk_fma_f32 v[138:139], v[138:139], s[68:69], v[8:9] op_sel_hi:[1,1,0] neg_lo:[0,0,1] neg_hi:[0,0,1]
    v_pk_fma_f32 v[148:149], v[148:149], s[68:69], v[8:9] op_sel_hi:[1,1,0] neg_lo:[0,0,1] neg_hi:[0,0,1]
    v_pk_fma_f32 v[150:151], v[150:151], s[68:69], v[8:9] op_sel_hi:[1,1,0] neg_lo:[0,0,1] neg_hi:[0,0,1]
    v_max_f32 v196, v196, v199
    v_pk_fma_f32 v[160:161], v[160:161], s[68:69], v[8:9] op_sel_hi:[1,1,0] neg_lo:[0,0,1] neg_hi:[0,0,1]
    v_pk_fma_f32 v[162:163], v[162:163], s[68:69], v[8:9] op_sel_hi:[1,1,0] neg_lo:[0,0,1] neg_hi:[0,0,1]
    v_exp_f32 v100, v100
    v_mov_b32 v197, v196
    v_exp_f32 v101, v101
    v_exp_f32 v102, v102
    v_exp_f32 v103, v103
    v_permlane32_swap_b32 v196, v197
    v_exp_f32 v112, v112
    v_exp_f32 v113, v113
    v_exp_f32 v114, v114
    v_max_f32 v196, v196, v197
    v_exp_f32 v115, v115
    v_cvt_pk_bf16_f32 v16, v100, v101
    v_cvt_pk_bf16_f32 v17, v102, v103
    v_mov_b32 v197, v196
    v_cvt_pk_bf16_f32 v18, v112, v113
    v_cvt_pk_bf16_f32 v19, v114, v115
    buffer_store_dwordx4 v[16:19], v3, s[28:31], s46 offen offset:0 sc1
    v_permlane16_swap_b32 v196, v197
    v_exp_f32 v124, v124
    v_exp_f32 v125, v125
    v_exp_f32 v126, v126
    v_max_f32 v196, v196, v197
    v_exp_f32 v127, v127
    v_exp_f32 v136, v136
    v_exp_f32 v137, v137
    v_mul_f32 v196, s68, v196
    v_exp_f32 v138, v138
    v_exp_f32 v139, v139
    v_cvt_pk_bf16_f32 v20, v124, v125
    v_ceil_f32 v10, v196
    v_cvt_pk_bf16_f32 v21, v126, v127
    v_cvt_pk_bf16_f32 v22, v136, v137
    v_cvt_pk_bf16_f32 v23, v138, v139
    buffer_store_dword v10, v4, s[36:39], s41 offen offset:64 sc1
    buffer_store_dwordx4 v[20:23], v3, s[28:31], s46 offen offset:1024 sc1
    v_exp_f32 v148, v148
    v_exp_f32 v149, v149
    v_exp_f32 v150, v150
    v_exp_f32 v151, v151
    v_exp_f32 v160, v160
    v_exp_f32 v161, v161
    v_exp_f32 v162, v162
    v_exp_f32 v163, v163
    v_cvt_pk_bf16_f32 v24, v148, v149
    v_cvt_pk_bf16_f32 v25, v150, v151
    v_cvt_pk_bf16_f32 v26, v160, v161
    v_cvt_pk_bf16_f32 v27, v162, v163
    buffer_store_dwordx4 v[24:27], v3, s[28:31], s46 offen offset:2048 sc1
    s_add_u32 s46, s46, 33792
    v_pk_mul_f32 v[172:173], v[108:109], s[62:63]
    v_pk_mul_f32 v[174:175], v[110:111], s[62:63]
    v_pk_mul_f32 v[176:177], v[120:121], s[62:63]
    v_pk_mul_f32 v[178:179], v[122:123], s[62:63]
    v_pk_mul_f32 v[180:181], v[132:133], s[62:63]
    v_pk_mul_f32 v[182:183], v[134:135], s[62:63]
    v_pk_mul_f32 v[184:185], v[144:145], s[62:63]
    v_pk_mul_f32 v[186:187], v[146:147], s[62:63]
    v_pk_mul_f32 v[188:189], v[156:157], s[62:63]
    v_pk_mul_f32 v[190:191], v[158:159], s[62:63]
    v_pk_mul_f32 v[192:193], v[168:169], s[62:63]
    v_pk_mul_f32 v[194:195], v[170:171], s[62:63]
    v_pk_fma_f32 v[108:109], v[108:109], s[64:65], v[172:173]
    v_pk_fma_f32 v[110:111], v[110:111], s[64:65], v[174:175]
    v_pk_fma_f32 v[120:121], v[120:121], s[64:65], v[176:177]
    v_pk_fma_f32 v[122:123], v[122:123], s[64:65], v[178:179]
    v_pk_fma_f32 v[132:133], v[132:133], s[64:65], v[180:181]
    v_pk_fma_f32 v[134:135], v[134:135], s[64:65], v[182:183]
    v_pk_fma_f32 v[144:145], v[144:145], s[64:65], v[184:185]
    v_pk_fma_f32 v[146:147], v[146:147], s[64:65], v[186:187]
    v_pk_fma_f32 v[156:157], v[156:157], s[64:65], v[188:189]
    v_pk_fma_f32 v[158:159], v[158:159], s[64:65], v[190:191]
    v_pk_fma_f32 v[168:169], v[168:169], s[64:65], v[192:193]
    v_pk_fma_f32 v[170:171], v[170:171], s[64:65], v[194:195]
    v_pk_mul_f32 v[108:109], v[108:109], s[66:67]
    v_pk_mul_f32 v[110:111], v[110:111], s[66:67]
    v_pk_mul_f32 v[120:121], v[120:121], s[66:67]
    v_pk_mul_f32 v[122:123], v[122:123], s[66:67]
    v_pk_mul_f32 v[132:133], v[132:133], s[66:67]
    v_pk_mul_f32 v[134:135], v[134:135], s[66:67]
    v_pk_mul_f32 v[144:145], v[144:145], s[66:67]
    v_pk_mul_f32 v[146:147], v[146:147], s[66:67]
    v_pk_mul_f32 v[156:157], v[156:157], s[66:67]
    v_pk_mul_f32 v[158:159], v[158:159], s[66:67]
    v_pk_mul_f32 v[168:169], v[168:169], s[66:67]
    v_pk_mul_f32 v[170:171], v[170:171], s[66:67]
    v_pk_mul_f32 v[172:173], v[108:109], s[62:63]
    v_pk_mul_f32 v[174:175], v[110:111], s[62:63]
    v_pk_mul_f32 v[176:177], v[120:121], s[62:63]
    v_pk_mul_f32 v[178:179], v[122:123], s[62:63]
    v_pk_mul_f32 v[180:181], v[132:133], s[62:63]
    v_pk_mul_f32 v[182:183], v[134:135], s[62:63]
    v_pk_mul_f32 v[184:185], v[144:145], s[62:63]
    v_pk_mul_f32 v[186:187], v[146:147], s[62:63]
    v_pk_mul_f32 v[188:189], v[156:157], s[62:63]
    v_pk_mul_f32 v[190:191], v[158:159], s[62:63]
    v_pk_mul_f32 v[192:193], v[168:169], s[62:63]
    v_pk_mul_f32 v[194:195], v[170:171], s[62:63]
    v_pk_fma_f32 v[108:109], v[108:109], s[64:65], v[172:173]
    v_pk_fma_f32 v[110:111], v[110:111], s[64:65], v[174:175]
    v_pk_fma_f32 v[120:121], v[120:121], s[64:65], v[176:177]
    v_pk_fma_f32 v[122:123], v[122:123], s[64:65], v[178:179]
    v_pk_fma_f32 v[132:133], v[132:133], s[64:65], v[180:181]
    v_pk_fma_f32 v[134:135], v[134:135], s[64:65], v[182:183]
    v_pk_fma_f32 v[144:145], v[144:145], s[64:65], v[184:185]
    v_pk_fma_f32 v[146:147], v[146:147], s[64:65], v[186:187]
    v_pk_fma_f32 v[156:157], v[156:157], s[64:65], v[188:189]
    v_pk_fma_f32 v[158:159], v[158:159], s[64:65], v[190:191]
    v_pk_fma_f32 v[168:169], v[168:169], s[64:65], v[192:193]
    v_pk_fma_f32 v[170:171], v[170:171], s[64:65], v[194:195]
    v_max3_f32 v172, v108, v109, v110
    v_max3_f32 v176, v111, v120, v121
    v_max3_f32 v173, v122, v123, v132
    v_max3_f32 v177, v133, v134, v135
    v_max3_f32 v174, v144, v145, v146
    v_max3_f32 v178, v147, v156, v157
    v_max3_f32 v175, v158, v159, v168
    v_max3_f32 v179, v169, v170, v171
    v_pk_fma_f32 v[104:105], v[104:105], s[68:69], v[10:11] op_sel_hi:[1,1,0] neg_lo:[0,0,1] neg_hi:[0,0,1]
    v_max3_f32 v172, v172, v173, v174
    v_pk_fma_f32 v[106:107], v[106:107], s[68:69], v[10:11] op_sel_hi:[1,1,0] neg_lo:[0,0,1] neg_hi:[0,0,1]
    v_pk_fma_f32 v[116:117], v[116:117], s[68:69], v[10:11] op_sel_hi:[1,1,0] neg_lo:[0,0,1] neg_hi:[0,0,1]
    v_pk_fma_f32 v[118:119], v[118:119], s[68:69], v[10:11] op_sel_hi:[1,1,0] neg_lo:[0,0,1] neg_hi:[0,0,1]
    v_max3_f32 v175, v175, v176, v177
    v_pk_fma_f32 v[128:129], v[128:129], s[68:69], v[10:11] op_sel_hi:[1,1,0] neg_lo:[0,0,1] neg_hi:[0,0,1]
    v_pk_fma_f32 v[130:131], v[130:131], s[68:69], v[10:11] op_sel_hi:[1,1,0] neg_lo:[0,0,1] neg_hi:[0,0,1]
    v_pk_fma_f32 v[140:141], v[140:141], s[68:69], v[10:11] op_sel_hi:[1,1,0] neg_lo:[0,0,1] neg_hi:[0,0,1]
    v_max3_f32 v172, v172, v178, v179
    v_pk_fma_f32 v[142:143], v[142:143], s[68:69], v[10:11] op_sel_hi:[1,1,0] neg_lo:[0,0,1] neg_hi:[0,0,1]
    v_pk_fma_f32 v[152:153], v[152:153], s[68:69], v[10:11] op_sel_hi:[1,1,0] neg_lo:[0,0,1] neg_hi:[0,0,1]
    v_pk_fma_f32 v[154:155], v[154:155], s[68:69], v[10:11] op_sel_hi:[1,1,0] neg_lo:[0,0,1] neg_hi:[0,0,1]
    v_max_f32 v172, v172, v175
    v_pk_fma_f32 v[164:165], v[164:165], s[68:69], v[10:11] op_sel_hi:[1,1,0] neg_lo:[0,0,1] neg_hi:[0,0,1]
    v_pk_fma_f32 v[166:167], v[166:167], s[68:69], v[10:11] op_sel_hi:[1,1,0] neg_lo:[0,0,1] neg_hi:[0,0,1]
    v_exp_f32 v104, v104
    v_mov_b32 v173, v172
    v_exp_f32 v105, v105
    v_exp_f32 v106, v106
    v_exp_f32 v107, v107
    v_permlane32_swap_b32 v172, v173
    v_exp_f32 v116, v116
    v_exp_f32 v117, v117
    v_exp_f32 v118, v118
    v_max_f32 v172, v172, v173
    v_exp_f32 v119, v119
    v_cvt_pk_bf16_f32 v28, v104, v105
    v_cvt_pk_bf16_f32 v29, v106, v107
    v_mov_b32 v173, v172
    v_cvt_pk_bf16_f32 v30, v116, v117
    v_cvt_pk_bf16_f32 v31, v118, v119
    buffer_store_dwordx4 v[28:31], v3, s[28:31], s46 offen offset:0 sc1
    v_permlane16_swap_b32 v172, v173
    v_exp_f32 v128, v128
    v_exp_f32 v129, v129
    v_exp_f32 v130, v130
    v_max_f32 v172, v172, v173
    v_exp_f32 v131, v131
    v_exp_f32 v140, v140
    v_exp_f32 v141, v141
    v_mul_f32 v172, s68, v172
    v_exp_f32 v142, v142
    v_exp_f32 v143, v143
    v_cvt_pk_bf16_f32 v32, v128, v129
    v_ceil_f32 v12, v172
    v_cvt_pk_bf16_f32 v33, v130, v131
    v_cvt_pk_bf16_f32 v34, v140, v141
    v_cvt_pk_bf16_f32 v35, v142, v143
    buffer_store_dword v12, v4, s[36:39], s41 offen offset:128 sc1
    buffer_store_dwordx4 v[32:35], v3, s[28:31], s46 offen offset:1024 sc1
    v_exp_f32 v152, v152
    v_exp_f32 v153, v153
    v_exp_f32 v154, v154
    v_exp_f32 v155, v155
    v_exp_f32 v164, v164
    v_exp_f32 v165, v165
    v_exp_f32 v166, v166
    v_exp_f32 v167, v167
    v_cvt_pk_bf16_f32 v36, v152, v153
    v_cvt_pk_bf16_f32 v37, v154, v155
    v_cvt_pk_bf16_f32 v38, v164, v165
    v_cvt_pk_bf16_f32 v39, v166, v167
    buffer_store_dwordx4 v[36:39], v3, s[28:31], s46 offen offset:2048 sc1
    s_add_u32 s46, s46, 33792
    v_pk_fma_f32 v[108:109], v[108:109], s[68:69], v[12:13] op_sel_hi:[1,1,0] neg_lo:[0,0,1] neg_hi:[0,0,1]
    v_pk_fma_f32 v[110:111], v[110:111], s[68:69], v[12:13] op_sel_hi:[1,1,0] neg_lo:[0,0,1] neg_hi:[0,0,1]
    v_pk_fma_f32 v[120:121], v[120:121], s[68:69], v[12:13] op_sel_hi:[1,1,0] neg_lo:[0,0,1] neg_hi:[0,0,1]
    v_pk_fma_f32 v[122:123], v[122:123], s[68:69], v[12:13] op_sel_hi:[1,1,0] neg_lo:[0,0,1] neg_hi:[0,0,1]
    v_pk_fma_f32 v[132:133], v[132:133], s[68:69], v[12:13] op_sel_hi:[1,1,0] neg_lo:[0,0,1] neg_hi:[0,0,1]
    v_pk_fma_f32 v[134:135], v[134:135], s[68:69], v[12:13] op_sel_hi:[1,1,0] neg_lo:[0,0,1] neg_hi:[0,0,1]
    v_pk_fma_f32 v[144:145], v[144:145], s[68:69], v[12:13] op_sel_hi:[1,1,0] neg_lo:[0,0,1] neg_hi:[0,0,1]
    v_pk_fma_f32 v[146:147], v[146:147], s[68:69], v[12:13] op_sel_hi:[1,1,0] neg_lo:[0,0,1] neg_hi:[0,0,1]
    v_pk_fma_f32 v[156:157], v[156:157], s[68:69], v[12:13] op_sel_hi:[1,1,0] neg_lo:[0,0,1] neg_hi:[0,0,1]
    v_pk_fma_f32 v[158:159], v[158:159], s[68:69], v[12:13] op_sel_hi:[1,1,0] neg_lo:[0,0,1] neg_hi:[0,0,1]
    v_pk_fma_f32 v[168:169], v[168:169], s[68:69], v[12:13] op_sel_hi:[1,1,0] neg_lo:[0,0,1] neg_hi:[0,0,1]
    v_pk_fma_f32 v[170:171], v[170:171], s[68:69], v[12:13] op_sel_hi:[1,1,0] neg_lo:[0,0,1] neg_hi:[0,0,1]
    v_exp_f32 v108, v108
    v_exp_f32 v109, v109
    v_exp_f32 v110, v110
    v_exp_f32 v111, v111
    v_exp_f32 v120, v120
    v_exp_f32 v121, v121
    v_exp_f32 v122, v122
    v_exp_f32 v123, v123
    v_cvt_pk_bf16_f32 v40, v108, v109
    v_cvt_pk_bf16_f32 v41, v110, v111
    v_cvt_pk_bf16_f32 v42, v120, v121
    v_cvt_pk_bf16_f32 v43, v122, v123
    buffer_store_dwordx4 v[40:43], v3, s[28:31], s46 offen offset:0 sc1
    v_exp_f32 v132, v132
    v_exp_f32 v133, v133
    v_exp_f32 v134, v134
    v_exp_f32 v135, v135
    v_exp_f32 v144, v144
    v_exp_f32 v145, v145
    v_exp_f32 v146, v146
    v_exp_f32 v147, v147
    v_cvt_pk_bf16_f32 v44, v132, v133
    v_cvt_pk_bf16_f32 v45, v134, v135
    v_cvt_pk_bf16_f32 v46, v144, v145
    v_cvt_pk_bf16_f32 v47, v146, v147
    buffer_store_dwordx4 v[44:47], v3, s[28:31], s46 offen offset:1024 sc1
    v_exp_f32 v156, v156
    v_exp_f32 v157, v157
    v_exp_f32 v158, v158
    v_exp_f32 v159, v159
    v_exp_f32 v168, v168
    v_exp_f32 v169, v169
    v_exp_f32 v170, v170
    v_exp_f32 v171, v171
    v_cvt_pk_bf16_f32 v48, v156, v157
    v_cvt_pk_bf16_f32 v49, v158, v159
    v_cvt_pk_bf16_f32 v50, v168, v169
    v_cvt_pk_bf16_f32 v51, v170, v171
    buffer_store_dwordx4 v[48:51], v3, s[28:31], s46 offen offset:2048 sc1
    s_add_u32 s46, s46, 33792
    s_branch P3_fin
P3_one:
    v_pk_mul_f32 v[172:173], v[100:101], s[62:63]
    v_pk_mul_f32 v[174:175], v[102:103], s[62:63]
    v_pk_mul_f32 v[176:177], v[112:113], s[62:63]
    v_pk_mul_f32 v[178:179], v[114:115], s[62:63]
    v_pk_mul_f32 v[180:181], v[124:125], s[62:63]
    v_pk_mul_f32 v[182:183], v[126:127], s[62:63]
    v_pk_mul_f32 v[184:185], v[136:137], s[62:63]
    v_pk_mul_f32 v[186:187], v[138:139], s[62:63]
    v_pk_mul_f32 v[188:189], v[148:149], s[62:63]
    v_pk_mul_f32 v[190:191], v[150:151], s[62:63]
    v_pk_mul_f32 v[192:193], v[160:161], s[62:63]
    v_pk_mul_f32 v[194:195], v[162:163], s[62:63]
    v_pk_fma_f32 v[100:101], v[100:101], s[64:65], v[172:173]
    v_pk_fma_f32 v[102:103], v[102:103], s[64:65], v[174:175]
    v_pk_fma_f32 v[112:113], v[112:113], s[64:65], v[176:177]
    v_pk_fma_f32 v[114:115], v[114:115], s[64:65], v[178:179]
    v_pk_fma_f32 v[124:125], v[124:125], s[64:65], v[180:181]
    v_pk_fma_f32 v[126:127], v[126:127], s[64:65], v[182:183]
    v_pk_fma_f32 v[136:137], v[136:137], s[64:65], v[184:185]
    v_pk_fma_f32 v[138:139], v[138:139], s[64:65], v[186:187]
    v_pk_fma_f32 v[148:149], v[148:149], s[64:65], v[188:189]
    v_pk_fma_f32 v[150:151], v[150:151], s[64:65], v[190:191]
    v_pk_fma_f32 v[160:161], v[160:161], s[64:65], v[192:193]
    v_pk_fma_f32 v[162:163], v[162:163], s[64:65], v[194:195]
    v_pk_mul_f32 v[100:101], v[100:101], s[66:67]
    v_pk_mul_f32 v[102:103], v[102:103], s[66:67]
    v_pk_mul_f32 v[112:113], v[112:113], s[66:67]
    v_pk_mul_f32 v[114:115], v[114:115], s[66:67]
    v_pk_mul_f32 v[124:125], v[124:125], s[66:67]
    v_pk_mul_f32 v[126:127], v[126:127], s[66:67]
    v_pk_mul_f32 v[136:137], v[136:137], s[66:67]
    v_pk_mul_f32 v[138:139], v[138:139], s[66:67]
    v_pk_mul_f32 v[148:149], v[148:149], s[66:67]
    v_pk_mul_f32 v[150:151], v[150:151], s[66:67]
    v_pk_mul_f32 v[160:161], v[160:161], s[66:67]
    v_pk_mul_f32 v[162:163], v[162:163], s[66:67]
    v_pk_mul_f32 v[172:173], v[100:101], s[62:63]
    v_pk_mul_f32 v[174:175], v[102:103], s[62:63]
    v_pk_mul_f32 v[176:177], v[112:113], s[62:63]
    v_pk_mul_f32 v[178:179], v[114:115], s[62:63]
    v_pk_mul_f32 v[180:181], v[124:125], s[62:63]
    v_pk_mul_f32 v[182:183], v[126:127], s[62:63]
    v_pk_mul_f32 v[184:185], v[136:137], s[62:63]
    v_pk_mul_f32 v[186:187], v[138:139], s[62:63]
    v_pk_mul_f32 v[188:189], v[148:149], s[62:63]
    v_pk_mul_f32 v[190:191], v[150:151], s[62:63]
    v_pk_mul_f32 v[192:193], v[160:161], s[62:63]
    v_pk_mul_f32 v[194:195], v[162:163], s[62:63]
    v_pk_fma_f32 v[100:101], v[100:101], s[64:65], v[172:173]
    v_pk_fma_f32 v[102:103], v[102:103], s[64:65], v[174:175]
    v_pk_fma_f32 v[112:113], v[112:113], s[64:65], v[176:177]
    v_pk_fma_f32 v[114:115], v[114:115], s[64:65], v[178:179]
    v_pk_fma_f32 v[124:125], v[124:125], s[64:65], v[180:181]
    v_pk_fma_f32 v[126:127], v[126:127], s[64:65], v[182:183]
    v_pk_fma_f32 v[136:137], v[136:137], s[64:65], v[184:185]
    v_pk_fma_f32 v[138:139], v[138:139], s[64:65], v[186:187]
    v_pk_fma_f32 v[148:149], v[148:149], s[64:65], v[188:189]
    v_pk_fma_f32 v[150:151], v[150:151], s[64:65], v[190:191]
    v_pk_fma_f32 v[160:161], v[160:161], s[64:65], v[192:193]
    v_pk_fma_f32 v[162:163], v[162:163], s[64:65], v[194:195]
    v_max3_f32 v172, v100, v101, v102
    v_max3_f32 v176, v103, v112, v113
    v_max3_f32 v173, v114, v115, v124
    v_max3_f32 v177, v125, v126, v127
    v_max3_f32 v174, v136, v137, v138
    v_max3_f32 v178, v139, v148, v149
    v_max3_f32 v175, v150, v151, v160
    v_max3_f32 v179, v161, v162, v163
    v_max3_f32 v172, v172, v173, v174
    v_max3_f32 v175, v175, v176, v177
    v_max3_f32 v172, v172, v178, v179
    v_max_f32 v172, v172, v175
    v_mov_b32 v173, v172
    s_nop 1
    v_permlane32_swap_b32 v172, v173
    v_max_f32 v172, v172, v173
    v_mov_b32 v173, v172
    s_nop 1
    v_permlane16_swap_b32 v172, v173
    v_max_f32 v172, v172, v173
    v_mul_f32 v172, s68, v172
    v_ceil_f32 v8, v172
    buffer_store_dword v8, v4, s[36:39], s41 offen offset:0 sc1
    v_pk_fma_f32 v[100:101], v[100:101], s[68:69], v[8:9] op_sel_hi:[1,1,0] neg_lo:[0,0,1] neg_hi:[0,0,1]
    v_pk_fma_f32 v[102:103], v[102:103], s[68:69], v[8:9] op_sel_hi:[1,1,0] neg_lo:[0,0,1] neg_hi:[0,0,1]
    v_pk_fma_f32 v[112:113], v[112:113], s[68:69], v[8:9] op_sel_hi:[1,1,0] neg_lo:[0,0,1] neg_hi:[0,0,1]
    v_pk_fma_f32 v[114:115], v[114:115], s[68:69], v[8:9] op_sel_hi:[1,1,0] neg_lo:[0,0,1] neg_hi:[0,0,1]
    v_pk_fma_f32 v[124:125], v[124:125], s[68:69], v[8:9] op_sel_hi:[1,1,0] neg_lo:[0,0,1] neg_hi:[0,0,1]
    v_pk_fma_f32 v[126:127], v[126:127], s[68:69], v[8:9] op_sel_hi:[1,1,0] neg_lo:[0,0,1] neg_hi:[0,0,1]
    v_pk_fma_f32 v[136:137], v[136:137], s[68:69], v[8:9] op_sel_hi:[1,1,0] neg_lo:[0,0,1] neg_hi:[0,0,1]
    v_pk_fma_f32 v[138:139], v[138:139], s[68:69], v[8:9] op_sel_hi:[1,1,0] neg_lo:[0,0,1] neg_hi:[0,0,1]
    v_pk_fma_f32 v[148:149], v[148:149], s[68:69], v[8:9] op_sel_hi:[1,1,0] neg_lo:[0,0,1] neg_hi:[0,0,1]
    v_pk_fma_f32 v[150:151], v[150:151], s[68:69], v[8:9] op_sel_hi:[1,1,0] neg_lo:[0,0,1] neg_hi:[0,0,1]
    v_pk_fma_f32 v[160:161], v[160:161], s[68:69], v[8:9] op_sel_hi:[1,1,0] neg_lo:[0,0,1] neg_hi:[0,0,1]
    v_pk_fma_f32 v[162:163], v[162:163], s[68:69], v[8:9] op_sel_hi:[1,1,0] neg_lo:[0,0,1] neg_hi:[0,0,1]
    v_exp_f32 v100, v100
    v_exp_f32 v101, v101
    v_exp_f32 v102, v102
    v_exp_f32 v103, v103
    v_exp_f32 v112, v112
    v_exp_f32 v113, v113
    v_exp_f32 v114, v114
    v_exp_f32 v115, v115
    v_cvt_pk_bf16_f32 v16, v100, v101
    v_cvt_pk_bf16_f32 v17, v102, v103
    v_cvt_pk_bf16_f32 v18, v112, v113
    v_cvt_pk_bf16_f32 v19, v114, v115
    buffer_store_dwordx4 v[16:19], v3, s[28:31], s46 offen offset:0 sc1
    v_exp_f32 v124, v124
    v_exp_f32 v125, v125
    v_exp_f32 v126, v126
    v_exp_f32 v127, v127
    v_exp_f32 v136, v136
    v_exp_f32 v137, v137
    v_exp_f32 v138, v138
    v_exp_f32 v139, v139
    v_cvt_pk_bf16_f32 v20, v124, v125
    v_cvt_pk_bf16_f32 v21, v126, v127
    v_cvt_pk_bf16_f32 v22, v136, v137
    v_cvt_pk_bf16_f32 v23, v138, v139
    buffer_store_dwordx4 v[20:23], v3, s[28:31], s46 offen offset:1024 sc1
    v_exp_f32 v148, v148
    v_exp_f32 v149, v149
    v_exp_f32 v150, v150
    v_exp_f32 v151, v151
    v_exp_f32 v160, v160
    v_exp_f32 v161, v161
    v_exp_f32 v162, v162
    v_exp_f32 v163, v163
    v_cvt_pk_bf16_f32 v24, v148, v149
    v_cvt_pk_bf16_f32 v25, v150, v151
    v_cvt_pk_bf16_f32 v26, v160, v161
    v_cvt_pk_bf16_f32 v27, v162, v163
    buffer_store_dwordx4 v[24:27], v3, s[28:31], s46 offen offset:2048 sc1
    s_add_u32 s46, s46, 33792
    s_branch P3_fin
P3_tc:
    v_mov_b64 v[72:73], 0
    v_mov_b64 v[74:75], 0
    v_mov_b64 v[76:77], 0
    v_mov_b64 v[78:79], 0
    v_mov_b64 v[80:81], 0
    v_mov_b64 v[82:83], 0
    v_mov_b64 v[84:85], 0
    v_mov_b64 v[86:87], 0
    v_mov_b64 v[88:89], 0
    v_mov_b64 v[90:91], 0
    v_mov_b64 v[92:93], 0
    v_mov_b64 v[94:95], 0
    v_mov_b32 v98, v96
    v_mov_b32 v99, v97
    s_mov_b32 s44, 0
    s_mov_b32 s45, 18
    s_barrier
    ds_read_b128 v[16:19], v98 offset:0
    ds_read_b128 v[40:43], v99 offset:0
    ds_read_b128 v[20:23], v98 offset:2048
    ds_read_b128 v[24:27], v98 offset:4096
    ds_read_b128 v[28:31], v98 offset:6144
    ds_read_b128 v[32:35], v98 offset:8192
    ds_read_b128 v[36:39], v98 offset:10240
    s_branch P3T_mid
P3T_loop:
    v_mfma_f32_16x16x32_bf16 v[72:75], v[44:47], v[68:71], v[72:75]
    v_mfma_f32_16x16x32_bf16 v[76:79], v[48:51], v[68:71], v[76:79]
    s_barrier
    v_mfma_f32_16x16x32_bf16 v[80:83], v[52:55], v[68:71], v[80:83]
    ds_read_b128 v[16:19], v98 offset:0
    ds_read_b128 v[40:43], v99 offset:0
    ds_read_b128 v[20:23], v98 offset:2048
    v_mfma_f32_16x16x32_bf16 v[84:87], v[56:59], v[68:71], v[84:87]
    ds_read_b128 v[24:27], v98 offset:4096
    ds_read_b128 v[28:31], v98 offset:6144
    v_mfma_f32_16x16x32_bf16 v[88:91], v[60:63], v[68:71], v[88:91]
    ds_read_b128 v[32:35], v98 offset:8192
    ds_read_b128 v[36:39], v98 offset:10240
    v_mfma_f32_16x16x32_bf16 v[92:95], v[64:67], v[68:71], v[92:95]
P3T_mid:
    s_waitcnt lgkmcnt(0)
    v_mfma_f32_16x16x32_bf16 v[72:75], v[16:19], v[40:43], v[72:75]
    ds_read_b128 v[44:47], v98 offset:1024
    ds_read_b128 v[68:71], v99 offset:1024
    ds_read_b128 v[48:51], v98 offset:3072
    v_mfma_f32_16x16x32_bf16 v[76:79], v[20:23], v[40:43], v[76:79]
    ds_read_b128 v[52:55], v98 offset:5120
    ds_read_b128 v[56:59], v98 offset:7168
    v_mfma_f32_16x16x32_bf16 v[80:83], v[24:27], v[40:43], v[80:83]
    ds_read_b128 v[60:63], v98 offset:9216
    ds_read_b128 v[64:67], v98 offset:11264
    v_mfma_f32_16x16x32_bf16 v[84:87], v[28:31], v[40:43], v[84:87]
    s_add_u32 s44, s44, 36864
    s_cmp_eq_u32 s44, 147456
    s_cselect_b32 s44, 0, s44
    v_add_u32 v98, s44, v96
    v_mfma_f32_16x16x32_bf16 v[88:91], v[32:35], v[40:43], v[88:91]
    v_add_u32 v99, s44, v97
    s_sub_u32 s45, s45, 1
    s_cmp_lg_u32 s45, 0
    v_mfma_f32_16x16x32_bf16 v[92:95], v[36:39], v[40:43], v[92:95]
    s_waitcnt lgkmcnt(0)
    s_cbranch_scc1 P3T_loop
    s_barrier
    v_mfma_f32_16x16x32_bf16 v[72:75], v[44:47], v[68:71], v[72:75]
    v_mfma_f32_16x16x32_bf16 v[76:79], v[48:51], v[68:71], v[76:79]
    v_mfma_f32_16x16x32_bf16 v[80:83], v[52:55], v[68:71], v[80:83]
    v_mfma_f32_16x16x32_bf16 v[84:87], v[56:59], v[68:71], v[84:87]
    v_mfma_f32_16x16x32_bf16 v[88:91], v[60:63], v[68:71], v[88:91]
    v_mfma_f32_16x16x32_bf16 v[92:95], v[64:67], v[68:71], v[92:95]
    s_nop 2
    v_pk_mul_f32 v[16:17], v[72:73], s[62:63]
    v_pk_mul_f32 v[18:19], v[74:75], s[62:63]
    v_pk_mul_f32 v[20:21], v[76:77], s[62:63]
    v_pk_mul_f32 v[22:23], v[78:79], s[62:63]
    v_pk_mul_f32 v[24:25], v[80:81], s[62:63]
    v_pk_mul_f32 v[26:27], v[82:83], s[62:63]
    v_pk_mul_f32 v[28:29], v[84:85], s[62:63]
    v_pk_mul_f32 v[30:31], v[86:87], s[62:63]
    v_pk_mul_f32 v[32:33], v[88:89], s[62:63]
    v_pk_mul_f32 v[34:35], v[90:91], s[62:63]
    v_pk_mul_f32 v[36:37], v[92:93], s[62:63]
    v_pk_mul_f32 v[38:39], v[94:95], s[62:63]
    v_pk_fma_f32 v[72:73], v[72:73], s[64:65], v[16:17]
    v_pk_fma_f32 v[74:75], v[74:75], s[64:65], v[18:19]
    v_pk_fma_f32 v[76:77], v[76:77], s[64:65], v[20:21]
    v_pk_fma_f32 v[78:79], v[78:79], s[64:65], v[22:23]
    v_pk_fma_f32 v[80:81], v[80:81], s[64:65], v[24:25]
    v_pk_fma_f32 v[82:83], v[82:83], s[64:65], v[26:27]
    v_pk_fma_f32 v[84:85], v[84:85], s[64:65], v[28:29]
    v_pk_fma_f32 v[86:87], v[86:87], s[64:65], v[30:31]
    v_pk_fma_f32 v[88:89], v[88:89], s[64:65], v[32:33]
    v_pk_fma_f32 v[90:91], v[90:91], s[64:65], v[34:35]
    v_pk_fma_f32 v[92:93], v[92:93], s[64:65], v[36:37]
    v_pk_fma_f32 v[94:95], v[94:95], s[64:65], v[38:39]
    v_pk_mul_f32 v[72:73], v[72:73], s[66:67]
    v_pk_mul_f32 v[74:75], v[74:75], s[66:67]
    v_pk_mul_f32 v[76:77], v[76:77], s[66:67]
    v_pk_mul_f32 v[78:79], v[78:79], s[66:67]
    v_pk_mul_f32 v[80:81], v[80:81], s[66:67]
    v_pk_mul_f32 v[82:83], v[82:83], s[66:67]
    v_pk_mul_f32 v[84:85], v[84:85], s[66:67]
    v_pk_mul_f32 v[86:87], v[86:87], s[66:67]
    v_pk_mul_f32 v[88:89], v[88:89], s[66:67]
    v_pk_mul_f32 v[90:91], v[90:91], s[66:67]
    v_pk_mul_f32 v[92:93], v[92:93], s[66:67]
    v_pk_mul_f32 v[94:95], v[94:95], s[66:67]
    v_pk_mul_f32 v[16:17], v[72:73], s[62:63]
    v_pk_mul_f32 v[18:19], v[74:75], s[62:63]
    v_pk_mul_f32 v[20:21], v[76:77], s[62:63]
    v_pk_mul_f32 v[22:23], v[78:79], s[62:63]
    v_pk_mul_f32 v[24:25], v[80:81], s[62:63]
    v_pk_mul_f32 v[26:27], v[82:83], s[62:63]
    v_pk_mul_f32 v[28:29], v[84:85], s[62:63]
    v_pk_mul_f32 v[30:31], v[86:87], s[62:63]
    v_pk_mul_f32 v[32:33], v[88:89], s[62:63]
    v_pk_mul_f32 v[34:35], v[90:91], s[62:63]
    v_pk_mul_f32 v[36:37], v[92:93], s[62:63]
    v_pk_mul_f32 v[38:39], v[94:95], s[62:63]
    v_pk_fma_f32 v[72:73], v[72:73], s[64:65], v[16:17]
    v_pk_fma_f32 v[74:75], v[74:75], s[64:65], v[18:19]
    v_pk_fma_f32 v[76:77], v[76:77], s[64:65], v[20:21]
    v_pk_fma_f32 v[78:79], v[78:79], s[64:65], v[22:23]
    v_pk_fma_f32 v[80:81], v[80:81], s[64:65], v[24:25]
    v_pk_fma_f32 v[82:83], v[82:83], s[64:65], v[26:27]
    v_pk_fma_f32 v[84:85], v[84:85], s[64:65], v[28:29]
    v_pk_fma_f32 v[86:87], v[86:87], s[64:65], v[30:31]
    v_pk_fma_f32 v[88:89], v[88:89], s[64:65], v[32:33]
    v_pk_fma_f32 v[90:91], v[90:91], s[64:65], v[34:35]
    v_pk_fma_f32 v[92:93], v[92:93], s[64:65], v[36:37]
    v_pk_fma_f32 v[94:95], v[94:95], s[64:65], v[38:39]
    v_max3_f32 v16, v72, v73, v74
    v_max3_f32 v20, v75, v76, v77
    v_max3_f32 v17, v78, v79, v80
    v_max3_f32 v21, v81, v82, v83
    v_max3_f32 v18, v84, v85, v86
    v_max3_f32 v22, v87, v88, v89
    v_max3_f32 v19, v90, v91, v92
    v_max3_f32 v23, v93, v94, v95
    v_max3_f32 v16, v16, v17, v18
    v_max3_f32 v19, v19, v20, v21
    v_max3_f32 v16, v16, v22, v23
    v_max_f32 v16, v16, v19
    v_mov_b32 v17, v16
    s_nop 1
    v_permlane32_swap_b32 v16, v17
    v_max_f32 v16, v16, v17
    v_mov_b32 v17, v16
    s_nop 1
    v_permlane16_swap_b32 v16, v17
    v_max_f32 v16, v16, v17
    v_mul_f32 v16, s68, v16
    v_ceil_f32 v8, v16
    buffer_store_dword v8, v4, s[36:39], s41 offen offset:0 sc1
    v_pk_fma_f32 v[72:73], v[72:73], s[68:69], v[8:9] op_sel_hi:[1,1,0] neg_lo:[0,0,1] neg_hi:[0,0,1]
    v_pk_fma_f32 v[74:75], v[74:75], s[68:69], v[8:9] op_sel_hi:[1,1,0] neg_lo:[0,0,1] neg_hi:[0,0,1]
    v_pk_fma_f32 v[76:77], v[76:77], s[68:69], v[8:9] op_sel_hi:[1,1,0] neg_lo:[0,0,1] neg_hi:[0,0,1]
    v_pk_fma_f32 v[78:79], v[78:79], s[68:69], v[8:9] op_sel_hi:[1,1,0] neg_lo:[0,0,1] neg_hi:[0,0,1]
    v_pk_fma_f32 v[80:81], v[80:81], s[68:69], v[8:9] op_sel_hi:[1,1,0] neg_lo:[0,0,1] neg_hi:[0,0,1]
    v_pk_fma_f32 v[82:83], v[82:83], s[68:69], v[8:9] op_sel_hi:[1,1,0] neg_lo:[0,0,1] neg_hi:[0,0,1]
    v_pk_fma_f32 v[84:85], v[84:85], s[68:69], v[8:9] op_sel_hi:[1,1,0] neg_lo:[0,0,1] neg_hi:[0,0,1]
    v_pk_fma_f32 v[86:87], v[86:87], s[68:69], v[8:9] op_sel_hi:[1,1,0] neg_lo:[0,0,1] neg_hi:[0,0,1]
    v_pk_fma_f32 v[88:89], v[88:89], s[68:69], v[8:9] op_sel_hi:[1,1,0] neg_lo:[0,0,1] neg_hi:[0,0,1]
    v_pk_fma_f32 v[90:91], v[90:91], s[68:69], v[8:9] op_sel_hi:[1,1,0] neg_lo:[0,0,1] neg_hi:[0,0,1]
    v_pk_fma_f32 v[92:93], v[92:93], s[68:69], v[8:9] op_sel_hi:[1,1,0] neg_lo:[0,0,1] neg_hi:[0,0,1]
    v_pk_fma_f32 v[94:95], v[94:95], s[68:69], v[8:9] op_sel_hi:[1,1,0] neg_lo:[0,0,1] neg_hi:[0,0,1]
    v_exp_f32 v72, v72
    v_exp_f32 v73, v73
    v_exp_f32 v74, v74
    v_exp_f32 v75, v75
    v_exp_f32 v76, v76
    v_exp_f32 v77, v77
    v_exp_f32 v78, v78
    v_exp_f32 v79, v79
    v_cvt_pk_bf16_f32 v44, v72, v73
    v_cvt_pk_bf16_f32 v45, v74, v75
    v_cvt_pk_bf16_f32 v46, v76, v77
    v_cvt_pk_bf16_f32 v47, v78, v79
    buffer_store_dwordx4 v[44:47], v3, s[28:31], s46 offen offset:0 sc1
    v_exp_f32 v80, v80
    v_exp_f32 v81, v81
    v_exp_f32 v82, v82
    v_exp_f32 v83, v83
    v_exp_f32 v84, v84
    v_exp_f32 v85, v85
    v_exp_f32 v86, v86
    v_exp_f32 v87, v87
    v_cvt_pk_bf16_f32 v48, v80, v81
    v_cvt_pk_bf16_f32 v49, v82, v83
    v_cvt_pk_bf16_f32 v50, v84, v85
    v_cvt_pk_bf16_f32 v51, v86, v87
    buffer_store_dwordx4 v[48:51], v3, s[28:31], s46 offen offset:1024 sc1
    v_exp_f32 v88, v88
    v_exp_f32 v89, v89
    v_exp_f32 v90, v90
    v_exp_f32 v91, v91
    v_exp_f32 v92, v92
    v_exp_f32 v93, v93
    v_exp_f32 v94, v94
    v_exp_f32 v95, v95
    v_cvt_pk_bf16_f32 v52, v88, v89
    v_cvt_pk_bf16_f32 v53, v90, v91
    v_cvt_pk_bf16_f32 v54, v92, v93
    v_cvt_pk_bf16_f32 v55, v94, v95
    buffer_store_dwordx4 v[52:55], v3, s[28:31], s46 offen offset:2048 sc1
    s_add_u32 s46, s46, 33792
    s_branch P3_fin
P3_idle:
    s_barrier
    s_sub_u32 s45, s45, 1
    s_cmp_lg_u32 s45, 0
    s_cbranch_scc1 P3_idle
    s_barrier
    s_branch P3_fin
P3_fin:
    v_mov_b32 v60, 147456
    v_mov_b32 v61, 1
    s_add_u32 s100, s100, 4
    s_waitcnt vmcnt(0)
    s_mov_b64 exec, 1
    ds_add_rtn_u32 v62, v60, v61
    s_mov_b64 exec, -1
    s_waitcnt lgkmcnt(0)
    v_readfirstlane_b32 s3, v62
    s_nop 0
    s_add_u32 s3, s3, 1
    s_cmp_lg_u32 s3, s100
    s_cbranch_scc1 PB_45
    s_add_u32 s3, s86, 6
    v_mov_b32 v61, s3
    v_mov_b32 v62, 0
    s_lshl_b32 s3, s2, 7
    s_mov_b64 exec, 1
    buffer_store_dword v61, v62, s[76:79], s3 offen sc1
    s_mov_b64 exec, -1
    v_mov_b32 v63, 6
    ds_write_b32 v60, v63 offset:8
PB_45:
P4:
    s_load_dwordx4 s[4:7], s[0:1], 0
    s_load_dwordx2 s[54:55], s[0:1], 48
    s_load_dwordx2 s[56:57], s[0:1], 24
    s_load_dwordx2 s[52:53], s[0:1], 72
    v_and_b32 v2, 63, v0
    v_lshlrev_b32 v3, 4, v2
    s_mov_b32 s10, s87
    s_and_b32 s13, s82, 15
    s_bfe_u32 s14, s82, 0x40004
    s_bfe_u32 s15, s82, 0x80008
    s_lshr_b32 s16, s82, 16
    s_add_u32 s24, s84, 0x1400000
    s_addc_u32 s25, s85, 0
    s_mov_b32 s26, 0x8e5000
    s_mov_b32 s27, 0x20000
    s_add_u32 s36, s84, 0x30000
    s_addc_u32 s37, s85, 0
    s_mov_b32 s38, 0x16b00
    s_mov_b32 s39, 0x20000
    s_cmp_eq_u32 s13, 15
    s_cbranch_scc1 P4_done
    s_cmp_eq_u32 s13, 1
    s_cbranch_scc1 P4_txt
    s_cmp_eq_u32 s13, 2
    s_cbranch_scc1 P4_ot
    s_cmp_lt_u32 s10, 4
    s_cbranch_scc1 P4_cons
    s_sub_u32 s11, s10, 4
    s_mov_b32 s44, 0
    s_mov_b32 s45, 0
    s_mul_i32 s17, s14, 72
    s_mul_i32 s18, s16, 6
    s_add_u32 s17, s17, s18
    s_add_u32 s17, s17, 132
    s_mul_i32 s18, s14, 66
    s_lshl_b32 s19, s15, 3
    s_add_u32 s18, s18, s19
    s_lshl_b32 s19, s11, 1
    s_add_u32 s18, s18, s19
    s_mul_i32 s64, s18, 33792
    s_add_u32 s65, s64, 33792
    s_mul_i32 s43, s11, 6144
    s_add_u32 s43, s43, 18432
    s_add_u32 s18, s17, s11
    s_mul_i32 s66, s18, 33792
    s_mul_i32 s61, s11, 3072
    s_lshr_b32 s41, s11, 1
    s_add_u32 s41, s41, 4
    s_add_u32 s18, s41, s17
    s_mul_i32 s18, s18, 33792
    s_and_b32 s46, s11, 1
    s_lshl_b32 s47, s46, 11
    s_add_u32 s67, s18, s47
    s_mul_i32 s42, s41, 3072
    s_add_u32 s42, s42, s47
    s_cmp_eq_u32 s46, 1
    s_cselect_b32 s19, 0x7ffff000, 0
    s_cselect_b32 s47, 43008, s42
    s_cselect_b32 s46, 0, 1024
    s_add_u32 s47, s47, s46
    v_or_b32 v4, s19, v3
    v_add_u32 v4, 1024, v4
    s_mul_i32 s3, s11, 6144
    s_add_u32 s3, s3, 108544
    v_add_u32 v8, s3, v3
    s_waitcnt vmcnt(0)
    ds_write_b128 v8, v[216:219] offset:0
    ds_write_b128 v8, v[220:223] offset:1024
    ds_write_b128 v8, v[224:227] offset:2048
    ds_write_b128 v8, v[228:231] offset:3072
    ds_write_b128 v8, v[232:235] offset:4096
    ds_write_b128 v8, v[236:239] offset:5120
    s_lshl_b32 s3, s11, 2
    s_add_u32 s3, s3, 147472
    v_mov_b32 v8, s3
    v_mov_b32 v9, 1
    ds_write_b32 v8, v9
    s_cmp_eq_u32 s81, 15
    s_cbranch_scc1 P4_lv
    s_cmp_lg_u32 s10, 4
    s_cbranch_scc1 LD_46
    v_mov_b32 v8, 147464
    s_mov_b32 s3, 0x2000000
LW_48:
    ds_read_b32 v9, v8
    s_sub_u32 s3, s3, 1
    s_waitcnt lgkmcnt(0)
    v_cmp_le_u32 vcc, 6, v9
    s_cmp_eq_u32 s3, 0
    s_cbranch_scc1 LWE_49
    s_cbranch_vccnz LWE_49
    s_sleep 1
    s_branch LW_48
LWE_49:
    v_and_b32 v8, 0xff, v252
    v_lshlrev_b32 v8, 7, v8
    v_lshrrev_b32 v9, 8, v252
    v_add_u32 v9, s86, v9
    s_mov_b32 s3, 0x400000
POLL_50:
    buffer_load_dword v10, v8, s[76:79], 0 offen sc1
    s_sub_u32 s3, s3, 1
    s_waitcnt vmcnt(0)
    v_sub_u32 v10, v10, v9
    v_cmp_lt_u32 vcc, 7, v10
    s_nop 0
    s_cbranch_vccz POLLE_51
    s_cmp_eq_u32 s3, 0
    s_cbranch_scc1 POLLE_51
    s_nop 0
    s_branch POLL_50
POLLE_51:
    v_mov_b32 v8, 147460
    v_mov_b32 v9, 8
    ds_write_b32 v8, v9
    s_branch LDE_47
LD_46:
    v_mov_b32 v8, 147460
    s_mov_b32 s3, 0x2000000
LW_52:
    ds_read_b32 v9, v8
    s_sub_u32 s3, s3, 1
    s_waitcnt lgkmcnt(0)
    v_cmp_le_u32 vcc, 8, v9
    s_cmp_eq_u32 s3, 0
    s_cbranch_scc1 LWE_53
    s_cbranch_vccnz LWE_53
    s_sleep 1
    s_branch LW_52
LWE_53:
    s_waitcnt vmcnt(0)
LDE_47:
    s_add_u32 m0, s44, s43
    s_nop 0
    buffer_load_dwordx4 v3, s[24:27], s64 offen offset:0 sc1 lds
    buffer_load_dwordx4 v3, s[24:27], s64 offen offset:1024 sc1 lds
    buffer_load_dwordx4 v3, s[24:27], s64 offen offset:2048 sc1 lds
    s_add_u32 m0, m0, 3072
    s_add_u32 s64, s64, 3072
    buffer_load_dwordx4 v3, s[24:27], s65 offen offset:0 sc1 lds
    buffer_load_dwordx4 v3, s[24:27], s65 offen offset:1024 sc1 lds
    buffer_load_dwordx4 v3, s[24:27], s65 offen offset:2048 sc1 lds
    s_add_u32 s65, s65, 3072
    s_add_u32 s44, s44, 45056
    s_cmp_eq_u32 s44, 135168
    s_cselect_b32 s44, 0, s44
    s_add_u32 m0, s45, s61
    s_nop 0
    buffer_load_dwordx4 v3, s[24:27], s66 offen offset:0 sc1 lds
    buffer_load_dwordx4 v3, s[24:27], s66 offen offset:1024 sc1 lds
    buffer_load_dwordx4 v3, s[24:27], s66 offen offset:2048 sc1 lds
    s_add_u32 m0, s45, s42
    s_add_u32 s66, s66, 3072
    buffer_load_dwordx4 v3, s[24:27], s67 offen sc1 lds
    s_add_u32 m0, s45, s47
    s_nop 0
    buffer_load_dwordx4 v4, s[24:27], s67 offen sc1 lds
    s_add_u32 s67, s67, 3072
    s_add_u32 s45, s45, 45056
    s_cmp_eq_u32 s45, 135168
    s_cselect_b32 s45, 0, s45
    s_add_u32 m0, s44, s43
    s_nop 0
    buffer_load_dwordx4 v3, s[24:27], s64 offen offset:0 sc1 lds
    buffer_load_dwordx4 v3, s[24:27], s64 offen offset:1024 sc1 lds
    buffer_load_dwordx4 v3, s[24:27], s64 offen offset:2048 sc1 lds
    s_add_u32 m0, m0, 3072
    s_add_u32 s64, s64, 3072
    buffer_load_dwordx4 v3, s[24:27], s65 offen offset:0 sc1 lds
    buffer_load_dwordx4 v3, s[24:27], s65 offen offset:1024 sc1 lds
    buffer_load_dwordx4 v3, s[24:27], s65 offen offset:2048 sc1 lds
    s_add_u32 s65, s65, 3072
    s_add_u32 s44, s44, 45056
    s_cmp_eq_u32 s44, 135168
    s_cselect_b32 s44, 0, s44
    s_add_u32 m0, s45, s61
    s_nop 0
    buffer_load_dwordx4 v3, s[24:27], s66 offen offset:0 sc1 lds
    buffer_load_dwordx4 v3, s[24:27], s66 offen offset:1024 sc1 lds
    buffer_load_dwordx4 v3, s[24:27], s66 offen offset:2048 sc1 lds
    s_add_u32 m0, s45, s42
    s_add_u32 s66, s66, 3072
    buffer_load_dwordx4 v3, s[24:27], s67 offen sc1 lds
    s_add_u32 m0, s45, s47
    s_nop 0
    buffer_load_dwordx4 v4, s[24:27], s67 offen sc1 lds
    s_add_u32 s67, s67, 3072
    s_add_u32 s45, s45, 45056
    s_cmp_eq_u32 s45, 135168
    s_cselect_b32 s45, 0, s45
    s_waitcnt vmcnt(11)
    s_barrier
    s_add_u32 m0, s44, s43
    s_nop 0
    buffer_load_dwordx4 v3, s[24:27], s64 offen offset:0 sc1 lds
    buffer_load_dwordx4 v3, s[24:27], s64 offen offset:1024 sc1 lds
    buffer_load_dwordx4 v3, s[24:27], s64 offen offset:2048 sc1 lds
    s_add_u32 m0, m0, 3072
    s_add_u32 s64, s64, 3072
    buffer_load_dwordx4 v3, s[24:27], s65 offen offset:0 sc1 lds
    buffer_load_dwordx4 v3, s[24:27], s65 offen offset:1024 sc1 lds
    buffer_load_dwordx4 v3, s[24:27], s65 offen offset:2048 sc1 lds
    s_add_u32 s65, s65, 3072
    s_add_u32 s44, s44, 45056
    s_cmp_eq_u32 s44, 135168
    s_cselect_b32 s44, 0, s44
    s_add_u32 m0, s45, s61
    s_nop 0
    buffer_load_dwordx4 v3, s[24:27], s66 offen offset:0 sc1 lds
    buffer_load_dwordx4 v3, s[24:27], s66 offen offset:1024 sc1 lds
    buffer_load_dwordx4 v3, s[24:27], s66 offen offset:2048 sc1 lds
    s_add_u32 m0, s45, s42
    s_add_u32 s66, s66, 3072
    buffer_load_dwordx4 v3, s[24:27], s67 offen sc1 lds
    s_add_u32 m0, s45, s47
    s_nop 0
    buffer_load_dwordx4 v4, s[24:27], s67 offen sc1 lds
    s_add_u32 s67, s67, 3072
    s_add_u32 s45, s45, 45056
    s_cmp_eq_u32 s45, 135168
    s_cselect_b32 s45, 0, s45
    s_waitcnt vmcnt(11)
    s_barrier
    s_add_u32 m0, s44, s43
    s_nop 0
    buffer_load_dwordx4 v3, s[24:27], s64 offen offset:0 sc1 lds
    buffer_load_dwordx4 v3, s[24:27], s64 offen offset:1024 sc1 lds
    buffer_load_dwordx4 v3, s[24:27], s64 offen offset:2048 sc1 lds
    s_add_u32 m0, m0, 3072
    s_add_u32 s64, s64, 3072
    buffer_load_dwordx4 v3, s[24:27], s65 offen offset:0 sc1 lds
    buffer_load_dwordx4 v3, s[24:27], s65 offen offset:1024 sc1 lds
    buffer_load_dwordx4 v3, s[24:27], s65 offen offset:2048 sc1 lds
    s_add_u32 s65, s65, 3072
    s_add_u32 s44, s44, 45056
    s_cmp_eq_u32 s44, 135168
    s_cselect_b32 s44, 0, s44
    s_add_u32 m0, s45, s61
    s_nop 0
    buffer_load_dwordx4 v3, s[24:27], s66 offen offset:0 sc1 lds
    buffer_load_dwordx4 v3, s[24:27], s66 offen offset:1024 sc1 lds
    buffer_load_dwordx4 v3, s[24:27], s66 offen offset:2048 sc1 lds
    s_add_u32 m0, s45, s42
    s_add_u32 s66, s66, 3072
    buffer_load_dwordx4 v3, s[24:27], s67 offen sc1 lds
    s_add_u32 m0, s45, s47
    s_nop 0
    buffer_load_dwordx4 v4, s[24:27], s67 offen sc1 lds
    s_add_u32 s67, s67, 3072
    s_add_u32 s45, s45, 45056
    s_cmp_eq_u32 s45, 135168
    s_cselect_b32 s45, 0, s45
    s_branch P4_join
P4_lv:
    v_mov_b32 v8, 147464
    s_mov_b32 s3, 0x2000000
LW_54:
    ds_read_b32 v9, v8
    s_sub_u32 s3, s3, 1
    s_waitcnt lgkmcnt(0)
    v_cmp_le_u32 vcc, 6, v9
    s_cmp_eq_u32 s3, 0
    s_cbranch_scc1 LWE_55
    s_cbranch_vccnz LWE_55
    s_sleep 1
    s_branch LW_54
LWE_55:
    v_and_b32 v8, 0xff, v252
    v_lshlrev_b32 v8, 7, v8
    v_lshrrev_b32 v9, 8, v252
    v_min_u32 v9, 4, v9
    v_add_u32 v9, s86, v9
    s_mov_b32 s3, 0x400000
POLL_56:
    buffer_load_dword v10, v8, s[76:79], 0 offen sc1
    s_sub_u32 s3, s3, 1
    s_waitcnt vmcnt(0)
    v_sub_u32 v10, v10, v9
    v_cmp_lt_u32 vcc, 7, v10
    s_nop 0
    s_cbranch_vccz POLLE_57
    s_cmp_eq_u32 s3, 0
    s_cbranch_scc1 POLLE_57
    s_nop 0
    s_branch POLL_56
POLLE_57:
    s_add_u32 m0, s45, s61
    s_nop 0
    buffer_load_dwordx4 v3, s[24:27], s66 offen offset:0 sc1 lds
    buffer_load_dwordx4 v3, s[24:27], s66 offen offset:1024 sc1 lds
    buffer_load_dwordx4 v3, s[24:27], s66 offen offset:2048 sc1 lds
    s_add_u32 m0, s45, s42
    s_add_u32 s66, s66, 3072
    buffer_load_dwordx4 v3, s[24:27], s67 offen sc1 lds
    s_add_u32 m0, s45, s47
    s_nop 0
    buffer_load_dwordx4 v4, s[24:27], s67 offen sc1 lds
    s_add_u32 s67, s67, 3072
    s_add_u32 s45, s45, 45056
    s_cmp_eq_u32 s45, 135168
    s_cselect_b32 s45, 0, s45
    s_add_u32 m0, s45, s61
    s_nop 0
    buffer_load_dwordx4 v3, s[24:27], s66 offen offset:0 sc1 lds
    buffer_load_dwordx4 v3, s[24:27], s66 offen offset:1024 sc1 lds
    buffer_load_dwordx4 v3, s[24:27], s66 offen offset:2048 sc1 lds
    s_add_u32 m0, s45, s42
    s_add_u32 s66, s66, 3072
    buffer_load_dwordx4 v3, s[24:27], s67 offen sc1 lds
    s_add_u32 m0, s45, s47
    s_nop 0
    buffer_load_dwordx4 v4, s[24:27], s67 offen sc1 lds
    s_add_u32 s67, s67, 3072
    s_add_u32 s45, s45, 45056
    s_cmp_eq_u32 s45, 135168
    s_cselect_b32 s45, 0, s45
    s_add_u32 m0, s45, s61
    s_nop 0
    buffer_load_dwordx4 v3, s[24:27], s66 offen offset:0 sc1 lds
    buffer_load_dwordx4 v3, s[24:27], s66 offen offset:1024 sc1 lds
    buffer_load_dwordx4 v3, s[24:27], s66 offen offset:2048 sc1 lds
    s_add_u32 m0, s45, s42
    s_add_u32 s66, s66, 3072
    buffer_load_dwordx4 v3, s[24:27], s67 offen sc1 lds
    s_add_u32 m0, s45, s47
    s_nop 0
    buffer_load_dwordx4 v4, s[24:27], s67 offen sc1 lds
    s_add_u32 s67, s67, 3072
    s_add_u32 s45, s45, 45056
    s_cmp_eq_u32 s45, 135168
    s_cselect_b32 s45, 0, s45
    s_cmp_lg_u32 s10, 4
    s_cbranch_scc1 LD_58
    v_mov_b32 v8, 147464
    s_mov_b32 s3, 0x2000000
LW_60:
    ds_read_b32 v9, v8
    s_sub_u32 s3, s3, 1
    s_waitcnt lgkmcnt(0)
    v_cmp_le_u32 vcc, 6, v9
    s_cmp_eq_u32 s3, 0
    s_cbranch_scc1 LWE_61
    s_cbranch_vccnz LWE_61
    s_sleep 1
    s_branch LW_60
LWE_61:
    v_and_b32 v8, 0xff, v252
    v_lshlrev_b32 v8, 7, v8
    v_lshrrev_b32 v9, 8, v252
    v_add_u32 v9, s86, v9
    s_mov_b32 s3, 0x400000
POLL_62:
    buffer_load_dword v10, v8, s[76:79], 0 offen sc1
    s_sub_u32 s3, s3, 1
    s_waitcnt vmcnt(0)
    v_sub_u32 v10, v10, v9
    v_cmp_lt_u32 vcc, 7, v10
    s_nop 0
    s_cbranch_vccz POLLE_63
    s_cmp_eq_u32 s3, 0
    s_cbranch_scc1 POLLE_63
    s_nop 0
    s_branch POLL_62
POLLE_63:
    v_mov_b32 v8, 147460
    v_mov_b32 v9, 8
    ds_write_b32 v8, v9
    s_branch LDE_59
LD_58:
    v_mov_b32 v8, 147460
    s_mov_b32 s3, 0x2000000
LW_64:
    ds_read_b32 v9, v8
    s_sub_u32 s3, s3, 1
    s_waitcnt lgkmcnt(0)
    v_cmp_le_u32 vcc, 8, v9
    s_cmp_eq_u32 s3, 0
    s_cbranch_scc1 LWE_65
    s_cbranch_vccnz LWE_65
    s_sleep 1
    s_branch LW_64
LWE_65:
    s_waitcnt vmcnt(0)
LDE_59:
    s_add_u32 m0, s44, s43
    s_nop 0
    buffer_load_dwordx4 v3, s[24:27], s64 offen offset:0 sc1 lds
    buffer_load_dwordx4 v3, s[24:27], s64 offen offset:1024 sc1 lds
    buffer_load_dwordx4 v3, s[24:27], s64 offen offset:2048 sc1 lds
    s_add_u32 m0, m0, 3072
    s_add_u32 s64, s64, 3072
    buffer_load_dwordx4 v3, s[24:27], s65 offen offset:0 sc1 lds
    buffer_load_dwordx4 v3, s[24:27], s65 offen offset:1024 sc1 lds
    buffer_load_dwordx4 v3, s[24:27], s65 offen offset:2048 sc1 lds
    s_add_u32 s65, s65, 3072
    s_add_u32 s44, s44, 45056
    s_cmp_eq_u32 s44, 135168
    s_cselect_b32 s44, 0, s44
    s_add_u32 m0, s44, s43
    s_nop 0
    buffer_load_dwordx4 v3, s[24:27], s64 offen offset:0 sc1 lds
    buffer_load_dwordx4 v3, s[24:27], s64 offen offset:1024 sc1 lds
    buffer_load_dwordx4 v3, s[24:27], s64 offen offset:2048 sc1 lds
    s_add_u32 m0, m0, 3072
    s_add_u32 s64, s64, 3072
    buffer_load_dwordx4 v3, s[24:27], s65 offen offset:0 sc1 lds
    buffer_load_dwordx4 v3, s[24:27], s65 offen offset:1024 sc1 lds
    buffer_load_dwordx4 v3, s[24:27], s65 offen offset:2048 sc1 lds
    s_add_u32 s65, s65, 3072
    s_add_u32 s44, s44, 45056
    s_cmp_eq_u32 s44, 135168
    s_cselect_b32 s44, 0, s44
    s_waitcnt vmcnt(6)
    s_barrier
    s_add_u32 m0, s44, s43
    s_nop 0
    buffer_load_dwordx4 v3, s[24:27], s64 offen offset:0 sc1 lds
    buffer_load_dwordx4 v3, s[24:27], s64 offen offset:1024 sc1 lds
    buffer_load_dwordx4 v3, s[24:27], s64 offen offset:2048 sc1 lds
    s_add_u32 m0, m0, 3072
    s_add_u32 s64, s64, 3072
    buffer_load_dwordx4 v3, s[24:27], s65 offen offset:0 sc1 lds
    buffer_load_dwordx4 v3, s[24:27], s65 offen offset:1024 sc1 lds
    buffer_load_dwordx4 v3, s[24:27], s65 offen offset:2048 sc1 lds
    s_add_u32 s65, s65, 3072
    s_add_u32 s44, s44, 45056
    s_cmp_eq_u32 s44, 135168
    s_cselect_b32 s44, 0, s44
    s_waitcnt vmcnt(6)
    s_barrier
    s_add_u32 m0, s44, s43
    s_nop 0
    buffer_load_dwordx4 v3, s[24:27], s64 offen offset:0 sc1 lds
    buffer_load_dwordx4 v3, s[24:27], s64 offen offset:1024 sc1 lds
    buffer_load_dwordx4 v3, s[24:27], s64 offen offset:2048 sc1 lds
    s_add_u32 m0, m0, 3072
    s_add_u32 s64, s64, 3072
    buffer_load_dwordx4 v3, s[24:27], s65 offen offset:0 sc1 lds
    buffer_load_dwordx4 v3, s[24:27], s65 offen offset:1024 sc1 lds
    buffer_load_dwordx4 v3, s[24:27], s65 offen offset:2048 sc1 lds
    s_add_u32 s65, s65, 3072
    s_add_u32 s44, s44, 45056
    s_cmp_eq_u32 s44, 135168
    s_cselect_b32 s44, 0, s44
    s_add_u32 m0, s45, s61
    s_nop 0
    buffer_load_dwordx4 v3, s[24:27], s66 offen offset:0 sc1 lds
    buffer_load_dwordx4 v3, s[24:27], s66 offen offset:1024 sc1 lds
    buffer_load_dwordx4 v3, s[24:27], s66 offen offset:2048 sc1 lds
    s_add_u32 m0, s45, s42
    s_add_u32 s66, s66, 3072
    buffer_load_dwordx4 v3, s[24:27], s67 offen sc1 lds
    s_add_u32 m0, s45, s47
    s_nop 0
    buffer_load_dwordx4 v4, s[24:27], s67 offen sc1 lds
    s_add_u32 s67, s67, 3072
    s_add_u32 s45, s45, 45056
    s_cmp_eq_u32 s45, 135168
    s_cselect_b32 s45, 0, s45
P4_join:
    s_mov_b32 s60, 7
P4_lloop:
    s_waitcnt vmcnt(11)
    s_barrier
    s_add_u32 m0, s44, s43
    s_nop 0
    buffer_load_dwordx4 v3, s[24:27], s64 offen offset:0 sc1 lds
    buffer_load_dwordx4 v3, s[24:27], s64 offen offset:1024 sc1 lds
    buffer_load_dwordx4 v3, s[24:27], s64 offen offset:2048 sc1 lds
    s_add_u32 m0, m0, 3072
    s_add_u32 s64, s64, 3072
    buffer_load_dwordx4 v3, s[24:27], s65 offen offset:0 sc1 lds
    buffer_load_dwordx4 v3, s[24:27], s65 offen offset:1024 sc1 lds
    buffer_load_dwordx4 v3, s[24:27], s65 offen offset:2048 sc1 lds
    s_add_u32 s65, s65, 3072
    s_add_u32 s44, s44, 45056
    s_cmp_eq_u32 s44, 135168
    s_cselect_b32 s44, 0, s44
    s_add_u32 m0, s45, s61
    s_nop 0
    buffer_load_dwordx4 v3, s[24:27], s66 offen offset:0 sc1 lds
    buffer_load_dwordx4 v3, s[24:27], s66 offen offset:1024 sc1 lds
    buffer_load_dwordx4 v3, s[24:27], s66 offen offset:2048 sc1 lds
    s_add_u32 m0, s45, s42
    s_add_u32 s66, s66, 3072
    buffer_load_dwordx4 v3, s[24:27], s67 offen sc1 lds
    s_add_u32 m0, s45, s47
    s_nop 0
    buffer_load_dwordx4 v4, s[24:27], s67 offen sc1 lds
    s_add_u32 s67, s67, 3072
    s_add_u32 s45, s45, 45056
    s_cmp_eq_u32 s45, 135168
    s_cselect_b32 s45, 0, s45
    s_sub_u32 s60, s60, 1
    s_cmp_lg_u32 s60, 0
    s_cbranch_scc1 P4_lloop
    s_waitcnt vmcnt(11)
    s_barrier
    s_waitcnt vmcnt(0)
    s_barrier
    s_endpgm
P4_cons:
    v_and_b32 v4, 15, v2
    v_lshrrev_b32 v11, 4, v2
    v_mul_u32_u24 v12, 2304, v4
    v_lshlrev_b32 v11, 4, v11
    v_add_u32 v12, v11, v12
    v_add_u32 v13, 36864, v12
    s_lshl_b32 s17, s14, 10
    s_lshl_b32 s18, s15, 7
    s_add_u32 s17, s17, s18
    s_lshl_b32 s18, s10, 5
    s_add_u32 s17, s17, s18
    s_mul_i32 s17, s17, 2304
    s_mul_i32 s18, s16, 192
    s_add_u32 s17, s17, s18
    s_mul_i32 s19, s14, 2304
    s_add_u32 s19, s19, s18
    s_waitcnt lgkmcnt(0)
    s_mov_b32 s20, s4
    s_mov_b32 s21, s5
    s_mov_b32 s22, 0x480000
    s_mov_b32 s23, 0x20000
    s_mov_b32 s28, s52
    s_mov_b32 s29, s53
    s_mov_b32 s30, 0x480000
    s_mov_b32 s31, 0x20000
    s_add_u32 s32, s84, 0x20000
    s_addc_u32 s33, s85, 0
    s_mov_b32 s34, 0x2400
    s_mov_b32 s35, 0x20000
    v_mov_b64 v[112:113], 0
    v_mov_b64 v[114:115], 0
    v_mov_b64 v[116:117], 0
    v_mov_b64 v[118:119], 0
    v_mov_b64 v[120:121], 0
    v_mov_b64 v[122:123], 0
    v_mov_b64 v[124:125], 0
    v_mov_b64 v[126:127], 0
    v_mov_b64 v[128:129], 0
    v_mov_b64 v[130:131], 0
    v_mov_b64 v[132:133], 0
    v_mov_b64 v[134:135], 0
    v_mov_b64 v[136:137], 0
    v_mov_b64 v[138:139], 0
    v_mov_b64 v[140:141], 0
    v_mov_b64 v[142:143], 0
    v_mov_b64 v[144:145], 0
    v_mov_b64 v[146:147], 0
    v_mov_b64 v[148:149], 0
    v_mov_b64 v[150:151], 0
    v_mov_b64 v[152:153], 0
    v_mov_b64 v[154:155], 0
    v_mov_b64 v[156:157], 0
    v_mov_b64 v[158:159], 0
    v_mov_b64 v[160:161], 0
    v_mov_b64 v[162:163], 0
    v_mov_b64 v[164:165], 0
    v_mov_b64 v[166:167], 0
    v_mov_b32 v204, 0x3f803f80
    v_mov_b32 v205, 0x3f803f80
    v_mov_b32 v206, 0x3f803f80
    v_mov_b32 v207, 0x3f803f80
    v_mov_b32 v6, v3
    s_mul_i32 s18, s10, 6144
    s_add_u32 s18, s18, 18432
    v_add_u32 v7, s18, v3
    v_mov_b32 v8, v6
    v_mov_b32 v9, v7
    s_lshl_b32 s18, s10, 7
    s_add_u32 s18, s18, 135168
    v_lshl_add_u32 v10, v4, 2, s18
    s_mov_b32 s44, 0
    s_mov_b32 s45, 11
    v_and_b32 v1, 31, v2
    s_lshl_b32 s3, s10, 5
    v_add_u32 v1, s3, v1
    s_lshl_b32 s46, s10, 2
    s_add_u32 s46, s46, 147472
    v_mov_b32 v14, s46
    s_mov_b32 s3, 0x2000000
LW_66:
    ds_read_b32 v15, v14
    s_sub_u32 s3, s3, 1
    s_waitcnt lgkmcnt(0)
    v_cmp_le_u32 vcc, 1, v15
    s_cmp_eq_u32 s3, 0
    s_cbranch_scc1 LWE_67
    s_cbranch_vccnz LWE_67
    s_sleep 1
    s_branch LW_66
LWE_67:
    s_mul_i32 s3, s10, 6144
    s_add_u32 s3, s3, 108544
    v_add_u32 v14, s3, v3
    ds_read_b128 v[168:171], v14 offset:0
    ds_read_b128 v[172:175], v14 offset:1024
    ds_read_b128 v[176:179], v14 offset:2048
    ds_read_b128 v[180:183], v14 offset:3072
    ds_read_b128 v[184:187], v14 offset:4096
    ds_read_b128 v[188:191], v14 offset:5120
    s_waitcnt lgkmcnt(0)
    v_lshlrev_b32 v208, 16, v168
    v_and_b32 v209, s40, v168
    v_lshlrev_b32 v210, 16, v169
    v_and_b32 v211, s40, v169
    v_lshlrev_b32 v212, 16, v170
    v_and_b32 v213, s40, v170
    v_lshlrev_b32 v214, 16, v171
    v_and_b32 v215, s40, v171
    v_lshlrev_b32 v216, 16, v172
    v_and_b32 v217, s40, v172
    v_lshlrev_b32 v218, 16, v173
    v_and_b32 v219, s40, v173
    v_lshlrev_b32 v220, 16, v174
    v_and_b32 v221, s40, v174
    v_lshlrev_b32 v222, 16, v175
    v_and_b32 v223, s40, v175
    v_lshlrev_b32 v224, 16, v176
    v_and_b32 v225, s40, v176
    v_lshlrev_b32 v226, 16, v177
    v_and_b32 v227, s40, v177
    v_lshlrev_b32 v228, 16, v178
    v_and_b32 v229, s40, v178
    v_lshlrev_b32 v230, 16, v179
    v_and_b32 v231, s40, v179
    v_lshlrev_b32 v232, 16, v180
    v_and_b32 v233, s40, v180
    v_lshlrev_b32 v234, 16, v181
    v_and_b32 v235, s40, v181
    v_lshlrev_b32 v236, 16, v182
    v_and_b32 v237, s40, v182
    v_lshlrev_b32 v238, 16, v183
    v_and_b32 v239, s40, v183
    v_lshlrev_b32 v240, 16, v184
    v_and_b32 v241, s40, v184
    v_lshlrev_b32 v242, 16, v185
    v_and_b32 v243, s40, v185
    v_lshlrev_b32 v244, 16, v186
    v_and_b32 v245, s40, v186
    v_lshlrev_b32 v246, 16, v187
    v_and_b32 v247, s40, v187
    v_lshlrev_b32 v248, 16, v188
    v_and_b32 v249, s40, v188
    v_lshlrev_b32 v250, 16, v189
    v_and_b32 v251, s40, v189
    v_lshlrev_b32 v252, 16, v190
    v_and_b32 v253, s40, v190
    v_lshlrev_b32 v254, 16, v191
    v_and_b32 v255, s40, v191
    s_mul_i32 s41, s14, 46464
    s_lshl_b32 s3, s15, 9
    s_add_u32 s41, s41, s3
    v_lshlrev_b32 v5, 2, v1
    v_mov_b32 v14, 147460
    s_mov_b32 s3, 0x2000000
LW_68:
    ds_read_b32 v15, v14
    s_sub_u32 s3, s3, 1
    s_waitcnt lgkmcnt(0)
    v_cmp_le_u32 vcc, 8, v15
    s_cmp_eq_u32 s3, 0
    s_cbranch_scc1 LWE_69
    s_cbranch_vccnz LWE_69
    s_branch LW_68
LWE_69:
    buffer_load_dword v16, v5, s[36:39], s41 offen sc1
    s_add_u32 s41, s41, 4224
    buffer_load_dword v17, v5, s[36:39], s41 offen sc1
    s_add_u32 s41, s41, 4224
    buffer_load_dword v18, v5, s[36:39], s41 offen sc1
    s_add_u32 s41, s41, 4224
    buffer_load_dword v19, v5, s[36:39], s41 offen sc1
    s_add_u32 s41, s41, 4224
    buffer_load_dword v20, v5, s[36:39], s41 offen sc1
    s_add_u32 s41, s41, 4224
    buffer_load_dword v21, v5, s[36:39], s41 offen sc1
    s_add_u32 s41, s41, 4224
    buffer_load_dword v22, v5, s[36:39], s41 offen sc1
    s_add_u32 s41, s41, 4224
    buffer_load_dword v23, v5, s[36:39], s41 offen sc1
    s_add_u32 s41, s41, 4224
    buffer_load_dword v24, v5, s[36:39], s41 offen sc1
    s_add_u32 s41, s41, 4224
    buffer_load_dword v25, v5, s[36:39], s41 offen sc1
    s_add_u32 s41, s41, 4224
    buffer_load_dword v26, v5, s[36:39], s41 offen sc1
    buffer_load_dwordx4 v[192:195], v11, s[32:35], s19 offen offset:0 sc1
    buffer_load_dwordx4 v[196:199], v11, s[32:35], s19 offen offset:64 sc1
    buffer_load_dwordx4 v[200:203], v11, s[32:35], s19 offen offset:128 sc1
    s_waitcnt vmcnt(3)
    v_max3_f32 v27, v16, v17, v18
    v_max3_f32 v27, v27, v19, v20
    v_max3_f32 v27, v27, v21, v22
    v_max3_f32 v27, v27, v23, v24
    v_max3_f32 v27, v27, v25, v26
    v_add_u32 v5, 135168, v5
    v_sub_f32 v16, v27, v16
    v_sub_f32 v17, v27, v17
    v_sub_f32 v18, v27, v18
    v_sub_f32 v19, v27, v19
    v_sub_f32 v20, v27, v20
    v_sub_f32 v21, v27, v21
    v_sub_f32 v22, v27, v22
    v_sub_f32 v23, v27, v23
    v_sub_f32 v24, v27, v24
    v_sub_f32 v25, v27, v25
    v_sub_f32 v26, v27, v26
    v_cvt_u32_f32 v16, v16
    v_cvt_u32_f32 v17, v17
    v_cvt_u32_f32 v18, v18
    v_cvt_u32_f32 v19, v19
    v_cvt_u32_f32 v20, v20
    v_cvt_u32_f32 v21, v21
    v_cvt_u32_f32 v22, v22
    v_cvt_u32_f32 v23, v23
    v_cvt_u32_f32 v24, v24
    v_cvt_u32_f32 v25, v25
    v_cvt_u32_f32 v26, v26
    v_min_u32 v16, 255, v16
    v_min_u32 v17, 255, v17
    v_min_u32 v18, 255, v18
    v_min_u32 v19, 255, v19
    v_min_u32 v20, 255, v20
    v_min_u32 v21, 255, v21
    v_min_u32 v22, 255, v22
    v_min_u32 v23, 255, v23
    v_min_u32 v24, 255, v24
    v_min_u32 v25, 255, v25
    v_min_u32 v26, 255, v26
    v_mul_u32_u24 v16, 0x800080, v16
    v_mul_u32_u24 v17, 0x800080, v17
    v_mul_u32_u24 v18, 0x800080, v18
    v_mul_u32_u24 v19, 0x800080, v19
    v_mul_u32_u24 v20, 0x800080, v20
    v_mul_u32_u24 v21, 0x800080, v21
    v_mul_u32_u24 v22, 0x800080, v22
    v_mul_u32_u24 v23, 0x800080, v23
    v_mul_u32_u24 v24, 0x800080, v24
    v_mul_u32_u24 v25, 0x800080, v25
    v_mul_u32_u24 v26, 0x800080, v26
    ds_write_b32 v5, v16 offset:0
    ds_write_b32 v5, v17 offset:512
    ds_write_b32 v5, v18 offset:1024
    ds_write_b32 v5, v19 offset:1536
    ds_write_b32 v5, v20 offset:2048
    ds_write_b32 v5, v21 offset:2560
    ds_write_b32 v5, v22 offset:3072
    ds_write_b32 v5, v23 offset:3584
    ds_write_b32 v5, v24 offset:4096
    ds_write_b32 v5, v25 offset:4608
    ds_write_b32 v5, v26 offset:5120
    s_waitcnt lgkmcnt(0)
    s_barrier
    ds_read2_b32 v[14:15], v10 offset0:0 offset1:16
    ds_read_b128 v[40:43], v9 offset:0
    ds_read_b128 v[44:47], v9 offset:3072
    ds_read_b128 v[16:19], v8 offset:0
    ds_read_b128 v[20:23], v8 offset:3072
    ds_read_b128 v[24:27], v8 offset:6144
    ds_read_b128 v[28:31], v8 offset:9216
    ds_read_b128 v[32:35], v8 offset:12288
    ds_read_b128 v[36:39], v8 offset:15360
    ds_read_b128 v[72:75], v9 offset:1024
    ds_read_b128 v[76:79], v9 offset:4096
    ds_read_b128 v[48:51], v8 offset:1024
    ds_read_b128 v[52:55], v8 offset:4096
    ds_read_b128 v[56:59], v8 offset:7168
    ds_read_b128 v[60:63], v8 offset:10240
    ds_read_b128 v[64:67], v8 offset:13312
    ds_read_b128 v[68:71], v8 offset:16384
    s_waitcnt lgkmcnt(14)
    v_pk_sub_u16 v40, v40, v14 clamp
    v_pk_sub_u16 v41, v41, v14 clamp
    v_pk_sub_u16 v42, v42, v14 clamp
    v_pk_sub_u16 v43, v43, v14 clamp
    v_pk_sub_u16 v44, v44, v15 clamp
    v_pk_sub_u16 v45, v45, v15 clamp
    v_pk_sub_u16 v46, v46, v15 clamp
    v_pk_sub_u16 v47, v47, v15 clamp
    s_waitcnt lgkmcnt(8)
    s_branch P4_pc
P4_loop:
    v_mfma_f32_16x16x32_bf16 v[160:163], v[204:207], v[72:75], v[160:163]
    v_mfma_f32_16x16x32_bf16 v[164:167], v[204:207], v[76:79], v[164:167]
    v_mfma_f32_16x16x32_bf16 v[112:115], v[48:51], v[72:75], v[112:115]
    v_mfma_f32_16x16x32_bf16 v[116:119], v[48:51], v[76:79], v[116:119]
    s_waitcnt lgkmcnt(0)
    s_barrier
    v_mfma_f32_16x16x32_bf16 v[120:123], v[52:55], v[72:75], v[120:123]
    ds_read_b128 v[40:43], v9 offset:0
    v_pk_sub_u16 v104, v104, v14 clamp
    v_mfma_f32_16x16x32_bf16 v[124:127], v[52:55], v[76:79], v[124:127]
    ds_read_b128 v[44:47], v9 offset:3072
    v_pk_sub_u16 v105, v105, v14 clamp
    v_mfma_f32_16x16x32_bf16 v[128:131], v[56:59], v[72:75], v[128:131]
    ds_read_b128 v[16:19], v8 offset:0
    v_pk_sub_u16 v106, v106, v14 clamp
    v_mfma_f32_16x16x32_bf16 v[132:135], v[56:59], v[76:79], v[132:135]
    ds_read_b128 v[20:23], v8 offset:3072
    v_pk_sub_u16 v107, v107, v14 clamp
    v_mfma_f32_16x16x32_bf16 v[136:139], v[60:63], v[72:75], v[136:139]
    ds_read_b128 v[24:27], v8 offset:6144
    v_pk_sub_u16 v108, v108, v15 clamp
    v_mfma_f32_16x16x32_bf16 v[140:143], v[60:63], v[76:79], v[140:143]
    ds_read_b128 v[28:31], v8 offset:9216
    v_pk_sub_u16 v109, v109, v15 clamp
    v_mfma_f32_16x16x32_bf16 v[144:147], v[64:67], v[72:75], v[144:147]
    ds_read_b128 v[32:35], v8 offset:12288
    v_pk_sub_u16 v110, v110, v15 clamp
    v_mfma_f32_16x16x32_bf16 v[148:151], v[64:67], v[76:79], v[148:151]
    ds_read_b128 v[36:39], v8 offset:15360
    v_pk_sub_u16 v111, v111, v15 clamp
    v_mfma_f32_16x16x32_bf16 v[152:155], v[68:71], v[72:75], v[152:155]
    ds_read2_b32 v[14:15], v10 offset0:0 offset1:16
    v_mfma_f32_16x16x32_bf16 v[156:159], v[68:71], v[76:79], v[156:159]
    v_mfma_f32_16x16x32_bf16 v[112:115], v[80:83], v[104:107], v[112:115]
    ds_read_b128 v[72:75], v9 offset:1024
    ds_read_b128 v[76:79], v9 offset:4096
    v_mfma_f32_16x16x32_bf16 v[116:119], v[80:83], v[108:111], v[116:119]
    ds_read_b128 v[48:51], v8 offset:1024
    ds_read_b128 v[52:55], v8 offset:4096
    v_mfma_f32_16x16x32_bf16 v[120:123], v[84:87], v[104:107], v[120:123]
    ds_read_b128 v[56:59], v8 offset:7168
    ds_read_b128 v[60:63], v8 offset:10240
    v_mfma_f32_16x16x32_bf16 v[124:127], v[84:87], v[108:111], v[124:127]
    ds_read_b128 v[64:67], v8 offset:13312
    ds_read_b128 v[68:71], v8 offset:16384
    v_mfma_f32_16x16x32_bf16 v[128:131], v[88:91], v[104:107], v[128:131]
    v_mfma_f32_16x16x32_bf16 v[132:135], v[88:91], v[108:111], v[132:135]
    v_mfma_f32_16x16x32_bf16 v[136:139], v[92:95], v[104:107], v[136:139]
    v_mfma_f32_16x16x32_bf16 v[140:143], v[92:95], v[108:111], v[140:143]
    s_waitcnt lgkmcnt(8)
    v_pk_sub_u16 v40, v40, v14 clamp
    v_pk_sub_u16 v41, v41, v14 clamp
    v_mfma_f32_16x16x32_bf16 v[144:147], v[96:99], v[104:107], v[144:147]
    v_pk_sub_u16 v42, v42, v14 clamp
    v_pk_sub_u16 v43, v43, v14 clamp
    v_mfma_f32_16x16x32_bf16 v[148:151], v[96:99], v[108:111], v[148:151]
    v_pk_sub_u16 v44, v44, v15 clamp
    v_pk_sub_u16 v45, v45, v15 clamp
    v_mfma_f32_16x16x32_bf16 v[152:155], v[100:103], v[104:107], v[152:155]
    v_pk_sub_u16 v46, v46, v15 clamp
    v_pk_sub_u16 v47, v47, v15 clamp
    v_mfma_f32_16x16x32_bf16 v[156:159], v[100:103], v[108:111], v[156:159]
    v_mfma_f32_16x16x32_bf16 v[160:163], v[204:207], v[104:107], v[160:163]
    v_mfma_f32_16x16x32_bf16 v[164:167], v[204:207], v[108:111], v[164:167]
P4_pc:
    v_mfma_f32_16x16x32_bf16 v[112:115], v[16:19], v[40:43], v[112:115]
    ds_read_b128 v[104:107], v9 offset:2048
    ds_read_b128 v[108:111], v9 offset:5120
    v_mfma_f32_16x16x32_bf16 v[116:119], v[16:19], v[44:47], v[116:119]
    ds_read_b128 v[80:83], v8 offset:2048
    ds_read_b128 v[84:87], v8 offset:5120
    v_mfma_f32_16x16x32_bf16 v[120:123], v[20:23], v[40:43], v[120:123]
    ds_read_b128 v[88:91], v8 offset:8192
    ds_read_b128 v[92:95], v8 offset:11264
    v_mfma_f32_16x16x32_bf16 v[124:127], v[20:23], v[44:47], v[124:127]
    ds_read_b128 v[96:99], v8 offset:14336
    ds_read_b128 v[100:103], v8 offset:17408
    v_mfma_f32_16x16x32_bf16 v[128:131], v[24:27], v[40:43], v[128:131]
    v_mfma_f32_16x16x32_bf16 v[132:135], v[24:27], v[44:47], v[132:135]
    s_waitcnt lgkmcnt(8)
    v_pk_sub_u16 v72, v72, v14 clamp
    v_pk_sub_u16 v73, v73, v14 clamp
    v_mfma_f32_16x16x32_bf16 v[136:139], v[28:31], v[40:43], v[136:139]
    v_pk_sub_u16 v74, v74, v14 clamp
    v_pk_sub_u16 v75, v75, v14 clamp
    v_mfma_f32_16x16x32_bf16 v[140:143], v[28:31], v[44:47], v[140:143]
    v_pk_sub_u16 v76, v76, v15 clamp
    v_pk_sub_u16 v77, v77, v15 clamp
    v_mfma_f32_16x16x32_bf16 v[144:147], v[32:35], v[40:43], v[144:147]
    v_pk_sub_u16 v78, v78, v15 clamp
    v_pk_sub_u16 v79, v79, v15 clamp
    v_mfma_f32_16x16x32_bf16 v[148:151], v[32:35], v[44:47], v[148:151]
    s_add_u32 s44, s44, 45056
    s_cmp_eq_u32 s44, 135168
    v_mfma_f32_16x16x32_bf16 v[152:155], v[36:39], v[40:43], v[152:155]
    s_cselect_b32 s44, 0, s44
    v_add_u32 v8, s44, v6
    v_mfma_f32_16x16x32_bf16 v[156:159], v[36:39], v[44:47], v[156:159]
    v_add_u32 v9, s44, v7
    v_add_u32 v10, 512, v10
    v_mfma_f32_16x16x32_bf16 v[160:163], v[204:207], v[40:43], v[160:163]
    s_sub_u32 s45, s45, 1
    s_cmp_lg_u32 s45, 0
    v_mfma_f32_16x16x32_bf16 v[164:167], v[204:207], v[44:47], v[164:167]
    s_cbranch_scc1 P4_loop
    v_mfma_f32_16x16x32_bf16 v[160:163], v[204:207], v[72:75], v[160:163]
    v_mfma_f32_16x16x32_bf16 v[164:167], v[204:207], v[76:79], v[164:167]
    v_mfma_f32_16x16x32_bf16 v[112:115], v[48:51], v[72:75], v[112:115]
    v_mfma_f32_16x16x32_bf16 v[116:119], v[48:51], v[76:79], v[116:119]
    s_waitcnt lgkmcnt(0)
    v_pk_sub_u16 v104, v104, v14 clamp
    v_pk_sub_u16 v105, v105, v14 clamp
    v_mfma_f32_16x16x32_bf16 v[120:123], v[52:55], v[72:75], v[120:123]
    v_pk_sub_u16 v106, v106, v14 clamp
    v_pk_sub_u16 v107, v107, v14 clamp
    v_mfma_f32_16x16x32_bf16 v[124:127], v[52:55], v[76:79], v[124:127]
    v_pk_sub_u16 v108, v108, v15 clamp
    v_pk_sub_u16 v109, v109, v15 clamp
    v_mfma_f32_16x16x32_bf16 v[128:131], v[56:59], v[72:75], v[128:131]
    v_pk_sub_u16 v110, v110, v15 clamp
    v_pk_sub_u16 v111, v111, v15 clamp
    v_mfma_f32_16x16x32_bf16 v[132:135], v[56:59], v[76:79], v[132:135]
    s_waitcnt vmcnt(0)
    v_mfma_f32_16x16x32_bf16 v[136:139], v[60:63], v[72:75], v[136:139]
    v_lshlrev_b32 v16, 16, v192
    v_and_b32 v17, s40, v192
    v_lshlrev_b32 v18, 16, v193
    v_and_b32 v19, s40, v193
    v_mfma_f32_16x16x32_bf16 v[140:143], v[60:63], v[76:79], v[140:143]
    v_lshlrev_b32 v20, 16, v194
    v_and_b32 v21, s40, v194
    v_lshlrev_b32 v22, 16, v195
    v_and_b32 v23, s40, v195
    v_mfma_f32_16x16x32_bf16 v[144:147], v[64:67], v[72:75], v[144:147]
    v_lshlrev_b32 v24, 16, v196
    v_and_b32 v25, s40, v196
    v_lshlrev_b32 v26, 16, v197
    v_and_b32 v27, s40, v197
    v_mfma_f32_16x16x32_bf16 v[148:151], v[64:67], v[76:79], v[148:151]
    v_lshlrev_b32 v28, 16, v198
    v_and_b32 v29, s40, v198
    v_lshlrev_b32 v30, 16, v199
    v_and_b32 v31, s40, v199
    v_mfma_f32_16x16x32_bf16 v[152:155], v[68:71], v[72:75], v[152:155]
    v_lshlrev_b32 v32, 16, v200
    v_and_b32 v33, s40, v200
    v_lshlrev_b32 v34, 16, v201
    v_and_b32 v35, s40, v201
    v_mfma_f32_16x16x32_bf16 v[156:159], v[68:71], v[76:79], v[156:159]
    v_lshlrev_b32 v36, 16, v202
    v_and_b32 v37, s40, v202
    v_lshlrev_b32 v38, 16, v203
    v_and_b32 v39, s40, v203
    v_mfma_f32_16x16x32_bf16 v[160:163], v[204:207], v[104:107], v[160:163]
    v_mfma_f32_16x16x32_bf16 v[164:167], v[204:207], v[108:111], v[164:167]
    v_mfma_f32_16x16x32_bf16 v[112:115], v[80:83], v[104:107], v[112:115]
    v_mfma_f32_16x16x32_bf16 v[116:119], v[80:83], v[108:111], v[116:119]
    v_mfma_f32_16x16x32_bf16 v[120:123], v[84:87], v[104:107], v[120:123]
    v_mfma_f32_16x16x32_bf16 v[124:127], v[84:87], v[108:111], v[124:127]
    v_mfma_f32_16x16x32_bf16 v[128:131], v[88:91], v[104:107], v[128:131]
    v_mfma_f32_16x16x32_bf16 v[132:135], v[88:91], v[108:111], v[132:135]
    v_mfma_f32_16x16x32_bf16 v[136:139], v[92:95], v[104:107], v[136:139]
    v_mfma_f32_16x16x32_bf16 v[140:143], v[92:95], v[108:111], v[140:143]
    v_rcp_f32 v14, v160
    v_rcp_f32 v15, v164
    v_mfma_f32_16x16x32_bf16 v[144:147], v[96:99], v[104:107], v[144:147]
    v_mfma_f32_16x16x32_bf16 v[148:151], v[96:99], v[108:111], v[148:151]
    v_pk_mul_f32 v[112:113], v[112:113], v[14:15] op_sel_hi:[1,0]
    v_pk_mul_f32 v[114:115], v[114:115], v[14:15] op_sel_hi:[1,0]
    v_pk_mul_f32 v[120:121], v[120:121], v[14:15] op_sel_hi:[1,0]
    v_pk_mul_f32 v[122:123], v[122:123], v[14:15] op_sel_hi:[1,0]
    v_mfma_f32_16x16x32_bf16 v[152:155], v[100:103], v[104:107], v[152:155]
    v_pk_fma_f32 v[208:209], v[112:113], v[16:17], v[208:209]
    v_pk_fma_f32 v[210:211], v[114:115], v[18:19], v[210:211]
    v_pk_fma_f32 v[212:213], v[120:121], v[20:21], v[212:213]
    v_mfma_f32_16x16x32_bf16 v[156:159], v[100:103], v[108:111], v[156:159]
    v_pk_fma_f32 v[214:215], v[122:123], v[22:23], v[214:215]
    v_cvt_pk_bf16_f32 v168, v208, v209
    v_cvt_pk_bf16_f32 v169, v210, v211
    v_cvt_pk_bf16_f32 v170, v212, v213
    v_cvt_pk_bf16_f32 v171, v214, v215
    buffer_store_dwordx4 v[168:171], v12, s[28:31], s17 offen offset:0 sc1
    v_pk_mul_f32 v[116:117], v[116:117], v[14:15] op_sel:[0,1] op_sel_hi:[1,1]
    v_pk_mul_f32 v[118:119], v[118:119], v[14:15] op_sel:[0,1] op_sel_hi:[1,1]
    v_pk_mul_f32 v[124:125], v[124:125], v[14:15] op_sel:[0,1] op_sel_hi:[1,1]
    v_pk_mul_f32 v[126:127], v[126:127], v[14:15] op_sel:[0,1] op_sel_hi:[1,1]
    v_pk_fma_f32 v[232:233], v[116:117], v[16:17], v[232:233]
    v_pk_fma_f32 v[234:235], v[118:119], v[18:19], v[234:235]
    v_pk_fma_f32 v[236:237], v[124:125], v[20:21], v[236:237]
    v_pk_fma_f32 v[238:239], v[126:127], v[22:23], v[238:239]
    v_cvt_pk_bf16_f32 v180, v232, v233
    v_cvt_pk_bf16_f32 v181, v234, v235
    v_cvt_pk_bf16_f32 v182, v236, v237
    v_cvt_pk_bf16_f32 v183, v238, v239
    buffer_store_dwordx4 v[180:183], v13, s[28:31], s17 offen offset:0 sc1
    v_pk_mul_f32 v[128:129], v[128:129], v[14:15] op_sel_hi:[1,0]
    v_pk_mul_f32 v[130:131], v[130:131], v[14:15] op_sel_hi:[1,0]
    v_pk_mul_f32 v[136:137], v[136:137], v[14:15] op_sel_hi:[1,0]
    v_pk_mul_f32 v[138:139], v[138:139], v[14:15] op_sel_hi:[1,0]
    v_pk_fma_f32 v[216:217], v[128:129], v[24:25], v[216:217]
    v_pk_fma_f32 v[218:219], v[130:131], v[26:27], v[218:219]
    v_pk_fma_f32 v[220:221], v[136:137], v[28:29], v[220:221]
    v_pk_fma_f32 v[222:223], v[138:139], v[30:31], v[222:223]
    v_cvt_pk_bf16_f32 v172, v216, v217
    v_cvt_pk_bf16_f32 v173, v218, v219
    v_cvt_pk_bf16_f32 v174, v220, v221
    v_cvt_pk_bf16_f32 v175, v222, v223
    buffer_store_dwordx4 v[172:175], v12, s[28:31], s17 offen offset:64 sc1
    v_pk_mul_f32 v[132:133], v[132:133], v[14:15] op_sel:[0,1] op_sel_hi:[1,1]
    v_pk_mul_f32 v[134:135], v[134:135], v[14:15] op_sel:[0,1] op_sel_hi:[1,1]
    v_pk_mul_f32 v[140:141], v[140:141], v[14:15] op_sel:[0,1] op_sel_hi:[1,1]
    v_pk_mul_f32 v[142:143], v[142:143], v[14:15] op_sel:[0,1] op_sel_hi:[1,1]
    v_pk_fma_f32 v[240:241], v[132:133], v[24:25], v[240:241]
    v_pk_fma_f32 v[242:243], v[134:135], v[26:27], v[242:243]
    v_pk_fma_f32 v[244:245], v[140:141], v[28:29], v[244:245]
    v_pk_fma_f32 v[246:247], v[142:143], v[30:31], v[246:247]
    v_cvt_pk_bf16_f32 v184, v240, v241
    v_cvt_pk_bf16_f32 v185, v242, v243
    v_cvt_pk_bf16_f32 v186, v244, v245
    v_cvt_pk_bf16_f32 v187, v246, v247
    buffer_store_dwordx4 v[184:187], v13, s[28:31], s17 offen offset:64 sc1
    v_pk_mul_f32 v[144:145], v[144:145], v[14:15] op_sel_hi:[1,0]
    v_pk_mul_f32 v[146:147], v[146:147], v[14:15] op_sel_hi:[1,0]
    v_pk_mul_f32 v[152:153], v[152:153], v[14:15] op_sel_hi:[1,0]
    v_pk_mul_f32 v[154:155], v[154:155], v[14:15] op_sel_hi:[1,0]
    v_pk_fma_f32 v[224:225], v[144:145], v[32:33], v[224:225]
    v_pk_fma_f32 v[226:227], v[146:147], v[34:35], v[226:227]
    v_pk_fma_f32 v[228:229], v[152:153], v[36:37], v[228:229]
    v_pk_fma_f32 v[230:231], v[154:155], v[38:39], v[230:231]
    v_cvt_pk_bf16_f32 v176, v224, v225
    v_cvt_pk_bf16_f32 v177, v226, v227
    v_cvt_pk_bf16_f32 v178, v228, v229
    v_cvt_pk_bf16_f32 v179, v230, v231
    buffer_store_dwordx4 v[176:179], v12, s[28:31], s17 offen offset:128 sc1
    v_pk_mul_f32 v[148:149], v[148:149], v[14:15] op_sel:[0,1] op_sel_hi:[1,1]
    v_pk_mul_f32 v[150:151], v[150:151], v[14:15] op_sel:[0,1] op_sel_hi:[1,1]
    v_pk_mul_f32 v[156:157], v[156:157], v[14:15] op_sel:[0,1] op_sel_hi:[1,1]
    v_pk_mul_f32 v[158:159], v[158:159], v[14:15] op_sel:[0,1] op_sel_hi:[1,1]
    v_pk_fma_f32 v[248:249], v[148:149], v[32:33], v[248:249]
    v_pk_fma_f32 v[250:251], v[150:151], v[34:35], v[250:251]
    v_pk_fma_f32 v[252:253], v[156:157], v[36:37], v[252:253]
    v_pk_fma_f32 v[254:255], v[158:159], v[38:39], v[254:255]
    v_cvt_pk_bf16_f32 v188, v248, v249
    v_cvt_pk_bf16_f32 v189, v250, v251
    v_cvt_pk_bf16_f32 v190, v252, v253
    v_cvt_pk_bf16_f32 v191, v254, v255
    buffer_store_dwordx4 v[188:191], v13, s[28:31], s17 offen offset:128 sc1
    s_endpgm
P4_txt:
    s_add_u32 s48, s84, 0x100000
    s_addc_u32 s49, s85, 0
    s_mov_b32 s50, 0x4a4000
    s_mov_b32 s51, 0x20000
    s_bfe_u32 s14, s82, 0x40004
    s_lshr_b32 s16, s82, 16
    s_and_b32 s42, s10, 3
    s_lshl_b32 s18, s14, 5
    s_add_u32 s18, s18, s42
    s_mul_i32 s18, s18, 73728
    s_lshl_b32 s19, s16, 7
    s_add_u32 s18, s18, s19
    v_lshrrev_b32 v4, 3, v2
    v_mul_u32_u24 v4, 2304, v4
    v_lshrrev_b32 v5, 4, v2
    v_lshlrev_b32 v5, 1, v5
    v_and_b32 v6, 7, v2
    v_xor_b32 v5, v5, v6
    v_lshl_add_u32 v12, v5, 4, v4
    v_add_u32 v13, 17408, v12
    v_add_u32 v14, 17408, v13
    v_add_u32 v15, 17408, v14
    s_lshl_b32 s44, s42, 12
    s_cmp_lt_u32 s10, 4
    s_cbranch_scc1 P4_pre_0
    v_mov_b32 v8, 147464
    s_mov_b32 s3, 0x2000000
LW_70:
    ds_read_b32 v9, v8
    s_sub_u32 s3, s3, 1
    s_waitcnt lgkmcnt(0)
    v_cmp_le_u32 vcc, 6, v9
    s_cmp_eq_u32 s3, 0
    s_cbranch_scc1 LWE_71
    s_cbranch_vccnz LWE_71
    s_sleep 1
    s_branch LW_70
LWE_71:
    s_lshl_b32 s3, s14, 13
    v_lshlrev_b32 v8, 7, v2
    v_add_u32 v8, s3, v8
    s_add_u32 s3, s86, 2
    v_mov_b32 v9, s3
    s_mov_b32 s3, 0x400000
POLL_72:
    buffer_load_dword v10, v8, s[76:79], 0 offen sc1
    s_sub_u32 s3, s3, 1
    s_waitcnt vmcnt(0)
    v_sub_u32 v10, v10, v9
    v_cmp_lt_u32 vcc, 7, v10
    s_nop 0
    s_cbranch_vccz POLLE_73
    s_cmp_eq_u32 s3, 0
    s_cbranch_scc1 POLLE_73
    s_nop 0
    s_branch POLL_72
POLLE_73:
    s_add_u32 m0, s44, 0
    s_nop 0
    buffer_load_dwordx4 v12, s[48:51], s18 offen offset:0 sc1 lds
    buffer_load_dwordx4 v13, s[48:51], s18 offen offset:1024 sc1 lds
    buffer_load_dwordx4 v14, s[48:51], s18 offen offset:2048 sc1 lds
    buffer_load_dwordx4 v15, s[48:51], s18 offen offset:3072 sc1 lds
    s_add_u32 s18, s18, 294912
    s_add_u32 m0, s44, 16384
    s_nop 0
    buffer_load_dwordx4 v12, s[48:51], s18 offen offset:0 sc1 lds
    buffer_load_dwordx4 v13, s[48:51], s18 offen offset:1024 sc1 lds
    buffer_load_dwordx4 v14, s[48:51], s18 offen offset:2048 sc1 lds
    buffer_load_dwordx4 v15, s[48:51], s18 offen offset:3072 sc1 lds
    s_add_u32 s18, s18, 294912
    s_add_u32 m0, s44, 32768
    s_nop 0
    buffer_load_dwordx4 v12, s[48:51], s18 offen offset:0 sc1 lds
    buffer_load_dwordx4 v13, s[48:51], s18 offen offset:1024 sc1 lds
    buffer_load_dwordx4 v14, s[48:51], s18 offen offset:2048 sc1 lds
    buffer_load_dwordx4 v15, s[48:51], s18 offen offset:3072 sc1 lds
    s_add_u32 s18, s18, 294912
    s_add_u32 m0, s44, 49152
    s_nop 0
    buffer_load_dwordx4 v12, s[48:51], s18 offen offset:0 sc1 lds
    buffer_load_dwordx4 v13, s[48:51], s18 offen offset:1024 sc1 lds
    buffer_load_dwordx4 v14, s[48:51], s18 offen offset:2048 sc1 lds
    buffer_load_dwordx4 v15, s[48:51], s18 offen offset:3072 sc1 lds
    s_add_u32 s18, s18, 294912
    s_add_u32 m0, s44, 65536
    s_nop 0
    buffer_load_dwordx4 v12, s[48:51], s18 offen offset:0 sc1 lds
    buffer_load_dwordx4 v13, s[48:51], s18 offen offset:1024 sc1 lds
    buffer_load_dwordx4 v14, s[48:51], s18 offen offset:2048 sc1 lds
    buffer_load_dwordx4 v15, s[48:51], s18 offen offset:3072 sc1 lds
    s_add_u32 s18, s18, 294912
    s_add_u32 m0, s44, 81920
    s_nop 0
    buffer_load_dwordx4 v12, s[48:51], s18 offen offset:0 sc1 lds
    buffer_load_dwordx4 v13, s[48:51], s18 offen offset:1024 sc1 lds
    buffer_load_dwordx4 v14, s[48:51], s18 offen offset:2048 sc1 lds
    buffer_load_dwordx4 v15, s[48:51], s18 offen offset:3072 sc1 lds
    s_add_u32 s18, s18, 294912
    s_add_u32 m0, s44, 98304
    s_nop 0
    buffer_load_dwordx4 v12, s[48:51], s18 offen offset:0 sc1 lds
    buffer_load_dwordx4 v13, s[48:51], s18 offen offset:1024 sc1 lds
    buffer_load_dwordx4 v14, s[48:51], s18 offen offset:2048 sc1 lds
    buffer_load_dwordx4 v15, s[48:51], s18 offen offset:3072 sc1 lds
    s_add_u32 s18, s18, 294912
    s_add_u32 m0, s44, 114688
    s_nop 0
    buffer_load_dwordx4 v12, s[48:51], s18 offen offset:0 sc1 lds
    buffer_load_dwordx4 v13, s[48:51], s18 offen offset:1024 sc1 lds
    buffer_load_dwordx4 v14, s[48:51], s18 offen offset:2048 sc1 lds
    buffer_load_dwordx4 v15, s[48:51], s18 offen offset:3072 sc1 lds
    s_add_u32 s18, s18, 294912
    s_waitcnt vmcnt(0)
P4_pre_0:
    v_lshrrev_b32 v4, 2, v2
    v_lshlrev_b32 v4, 7, v4
    v_and_b32 v5, 3, v2
    v_lshl_add_u32 v4, v5, 3, v4
    v_add_u32 v4, s44, v4
    v_bfe_u32 v5, v2, 3, 2
    v_xor_b32 v6, 0, v5
    v_lshl_add_u32 v28, v6, 5, v4
    v_add_u32 v32, 65536, v28
    v_xor_b32 v6, 1, v5
    v_lshl_add_u32 v29, v6, 5, v4
    v_add_u32 v33, 65536, v29
    v_xor_b32 v6, 2, v5
    v_lshl_add_u32 v30, v6, 5, v4
    v_add_u32 v34, 65536, v30
    v_xor_b32 v6, 3, v5
    v_lshl_add_u32 v31, v6, 5, v4
    v_add_u32 v35, 65536, v31
    s_barrier
    ds_read_b64_tr_b16 v[100:101], v28 offset:0
    ds_read_b64_tr_b16 v[102:103], v28 offset:2048
    ds_read_b64_tr_b16 v[104:105], v29 offset:0
    ds_read_b64_tr_b16 v[106:107], v29 offset:2048
    ds_read_b64_tr_b16 v[108:109], v30 offset:0
    ds_read_b64_tr_b16 v[110:111], v30 offset:2048
    ds_read_b64_tr_b16 v[112:113], v31 offset:0
    ds_read_b64_tr_b16 v[114:115], v31 offset:2048
    ds_read_b64_tr_b16 v[116:117], v28 offset:16384
    ds_read_b64_tr_b16 v[118:119], v28 offset:18432
    ds_read_b64_tr_b16 v[120:121], v29 offset:16384
    ds_read_b64_tr_b16 v[122:123], v29 offset:18432
    ds_read_b64_tr_b16 v[124:125], v30 offset:16384
    ds_read_b64_tr_b16 v[126:127], v30 offset:18432
    ds_read_b64_tr_b16 v[128:129], v31 offset:16384
    ds_read_b64_tr_b16 v[130:131], v31 offset:18432
    ds_read_b64_tr_b16 v[132:133], v28 offset:32768
    ds_read_b64_tr_b16 v[134:135], v28 offset:34816
    ds_read_b64_tr_b16 v[136:137], v29 offset:32768
    ds_read_b64_tr_b16 v[138:139], v29 offset:34816
    ds_read_b64_tr_b16 v[140:141], v30 offset:32768
    ds_read_b64_tr_b16 v[142:143], v30 offset:34816
    ds_read_b64_tr_b16 v[144:145], v31 offset:32768
    ds_read_b64_tr_b16 v[146:147], v31 offset:34816
    ds_read_b64_tr_b16 v[148:149], v28 offset:49152
    ds_read_b64_tr_b16 v[150:151], v28 offset:51200
    ds_read_b64_tr_b16 v[152:153], v29 offset:49152
    ds_read_b64_tr_b16 v[154:155], v29 offset:51200
    ds_read_b64_tr_b16 v[156:157], v30 offset:49152
    ds_read_b64_tr_b16 v[158:159], v30 offset:51200
    ds_read_b64_tr_b16 v[160:161], v31 offset:49152
    ds_read_b64_tr_b16 v[162:163], v31 offset:51200
    ds_read_b64_tr_b16 v[164:165], v32 offset:0
    ds_read_b64_tr_b16 v[166:167], v32 offset:2048
    ds_read_b64_tr_b16 v[168:169], v33 offset:0
    ds_read_b64_tr_b16 v[170:171], v33 offset:2048
    ds_read_b64_tr_b16 v[172:173], v34 offset:0
    ds_read_b64_tr_b16 v[174:175], v34 offset:2048
    ds_read_b64_tr_b16 v[176:177], v35 offset:0
    ds_read_b64_tr_b16 v[178:179], v35 offset:2048
    ds_read_b64_tr_b16 v[180:181], v32 offset:16384
    ds_read_b64_tr_b16 v[182:183], v32 offset:18432
    ds_read_b64_tr_b16 v[184:185], v33 offset:16384
    ds_read_b64_tr_b16 v[186:187], v33 offset:18432
    ds_read_b64_tr_b16 v[188:189], v34 offset:16384
    ds_read_b64_tr_b16 v[190:191], v34 offset:18432
    ds_read_b64_tr_b16 v[192:193], v35 offset:16384
    ds_read_b64_tr_b16 v[194:195], v35 offset:18432
    ds_read_b64_tr_b16 v[196:197], v32 offset:32768
    ds_read_b64_tr_b16 v[198:199], v32 offset:34816
    ds_read_b64_tr_b16 v[200:201], v33 offset:32768
    ds_read_b64_tr_b16 v[202:203], v33 offset:34816
    ds_read_b64_tr_b16 v[204:205], v34 offset:32768
    ds_read_b64_tr_b16 v[206:207], v34 offset:34816
    ds_read_b64_tr_b16 v[208:209], v35 offset:32768
    ds_read_b64_tr_b16 v[210:211], v35 offset:34816
    ds_read_b64_tr_b16 v[212:213], v32 offset:49152
    ds_read_b64_tr_b16 v[214:215], v32 offset:51200
    ds_read_b64_tr_b16 v[216:217], v33 offset:49152
    ds_read_b64_tr_b16 v[218:219], v33 offset:51200
    ds_read_b64_tr_b16 v[220:221], v34 offset:49152
    ds_read_b64_tr_b16 v[222:223], v34 offset:51200
    ds_read_b64_tr_b16 v[224:225], v35 offset:49152
    ds_read_b64_tr_b16 v[226:227], v35 offset:51200
    s_waitcnt lgkmcnt(0)
    s_barrier
    s_add_u32 s28, s84, 0xd8000
    s_addc_u32 s29, s85, 0
    s_mov_b32 s30, 0x25000
    s_mov_b32 s31, 0x20000
    s_and_b32 s42, s10, 3
    s_lshr_b32 s43, s10, 2
    s_mul_i32 s17, s14, 66
    s_add_u32 s17, s17, 64
    s_add_u32 s17, s17, s43
    s_mul_i32 s17, s17, 33
    s_add_u32 s17, s17, s42
    s_lshl_b32 s17, s17, 10
    s_lshl_b32 s19, s10, 12
    v_mov_b64 v[228:229], 0
    v_mov_b64 v[230:231], 0
    v_mov_b64 v[232:233], 0
    v_mov_b64 v[234:235], 0
    v_mov_b64 v[236:237], 0
    v_mov_b64 v[238:239], 0
    v_mov_b64 v[240:241], 0
    v_mov_b64 v[242:243], 0
    v_mov_b64 v[244:245], 0
    v_mov_b64 v[246:247], 0
    v_mov_b32 v40, 0x3f803f80
    v_mov_b32 v41, 0x3f803f80
    v_mov_b32 v42, 0x3f803f80
    v_mov_b32 v43, 0x3f803f80
    v_and_b32 v8, 15, v2
    s_lshl_b32 s3, s43, 6
    s_add_u32 s3, s3, 135168
    v_lshl_add_u32 v44, v8, 2, s3
    s_waitcnt lgkmcnt(0)
    s_cmp_lg_u32 s10, 7
    s_cbranch_scc1 P4_ta
    v_and_b32 v8, 0xff, v252
    v_lshlrev_b32 v8, 7, v8
    v_lshrrev_b32 v9, 8, v252
    v_readfirstlane_b32 s3, v252
    v_cmp_lt_u32 vcc, 7, v9
    s_nop 0
    v_mov_b32 v10, s3
    v_cndmask_b32 v10, v252, v10, vcc
    v_and_b32 v8, 0xff, v10
    v_lshlrev_b32 v8, 7, v8
    v_lshrrev_b32 v9, 8, v10
    v_add_u32 v9, s86, v9
    s_mov_b32 s3, 0x400000
POLL_74:
    buffer_load_dword v10, v8, s[76:79], 0 offen sc1
    s_sub_u32 s3, s3, 1
    s_waitcnt vmcnt(0)
    v_sub_u32 v10, v10, v9
    v_cmp_lt_u32 vcc, 7, v10
    s_nop 0
    s_cbranch_vccz POLLE_75
    s_cmp_eq_u32 s3, 0
    s_cbranch_scc1 POLLE_75
    s_nop 0
    s_branch POLL_74
POLLE_75:
    s_mul_i32 s41, s14, 46464
    s_lshl_b32 s3, s15, 9
    s_add_u32 s41, s41, s3
    v_lshlrev_b32 v5, 2, v2
    buffer_load_dword v16, v5, s[36:39], s41 offen sc1
    s_add_u32 s41, s41, 4224
    buffer_load_dword v17, v5, s[36:39], s41 offen sc1
    s_add_u32 s41, s41, 4224
    buffer_load_dword v18, v5, s[36:39], s41 offen sc1
    s_add_u32 s41, s41, 4224
    buffer_load_dword v19, v5, s[36:39], s41 offen sc1
    s_add_u32 s41, s41, 4224
    buffer_load_dword v20, v5, s[36:39], s41 offen sc1
    s_add_u32 s41, s41, 4224
    buffer_load_dword v21, v5, s[36:39], s41 offen sc1
    s_add_u32 s41, s41, 4224
    buffer_load_dword v22, v5, s[36:39], s41 offen sc1
    s_add_u32 s41, s41, 4224
    buffer_load_dword v23, v5, s[36:39], s41 offen sc1
    s_add_u32 s41, s41, 4224
    buffer_load_dword v24, v5, s[36:39], s41 offen sc1
    s_add_u32 s41, s41, 4224
    buffer_load_dword v25, v5, s[36:39], s41 offen sc1
    s_add_u32 s41, s41, 4224
    buffer_load_dword v26, v5, s[36:39], s41 offen sc1
P4_ta:
    s_barrier
    buffer_load_dwordx4 v[64:67], v3, s[24:27], s17 offen sc1
    s_add_u32 s17, s17, 4096
    buffer_load_dwordx4 v[68:71], v3, s[24:27], s17 offen sc1
    s_add_u32 s17, s17, 4096
    buffer_load_dwordx4 v[72:75], v3, s[24:27], s17 offen sc1
    s_add_u32 s17, s17, 4096
    buffer_load_dwordx4 v[76:79], v3, s[24:27], s17 offen sc1
    s_add_u32 s17, s17, 4096
    buffer_load_dwordx4 v[80:83], v3, s[24:27], s17 offen sc1
    s_add_u32 s17, s17, 4096
    buffer_load_dwordx4 v[84:87], v3, s[24:27], s17 offen sc1
    s_add_u32 s17, s17, 4096
    buffer_load_dwordx4 v[88:91], v3, s[24:27], s17 offen sc1
    s_add_u32 s17, s17, 4096
    buffer_load_dwordx4 v[92:95], v3, s[24:27], s17 offen sc1
    s_add_u32 s17, s17, 4096
    s_cmp_lg_u32 s42, 0
    s_cbranch_scc1 P4_t1
    buffer_load_dwordx4 v[96:99], v3, s[24:27], s17 offen sc1
    s_add_u32 s17, s17, 4096
P4_t1:
    s_cmp_lg_u32 s10, 7
    s_cbranch_scc1 P4_t2
    s_waitcnt vmcnt(8)
    v_max3_f32 v27, v16, v17, v18
    v_max3_f32 v27, v27, v19, v20
    v_max3_f32 v27, v27, v21, v22
    v_max3_f32 v27, v27, v23, v24
    v_max3_f32 v27, v27, v25, v26
    v_add_u32 v5, 135168, v5
    v_sub_f32 v16, v27, v16
    v_sub_f32 v17, v27, v17
    v_sub_f32 v18, v27, v18
    v_sub_f32 v19, v27, v19
    v_sub_f32 v20, v27, v20
    v_sub_f32 v21, v27, v21
    v_sub_f32 v22, v27, v22
    v_sub_f32 v23, v27, v23
    v_sub_f32 v24, v27, v24
    v_sub_f32 v25, v27, v25
    v_sub_f32 v26, v27, v26
    v_cvt_u32_f32 v16, v16
    v_cvt_u32_f32 v17, v17
    v_cvt_u32_f32 v18, v18
    v_cvt_u32_f32 v19, v19
    v_cvt_u32_f32 v20, v20
    v_cvt_u32_f32 v21, v21
    v_cvt_u32_f32 v22, v22
    v_cvt_u32_f32 v23, v23
    v_cvt_u32_f32 v24, v24
    v_cvt_u32_f32 v25, v25
    v_cvt_u32_f32 v26, v26
    v_min_u32 v16, 255, v16
    v_min_u32 v17, 255, v17
    v_min_u32 v18, 255, v18
    v_min_u32 v19, 255, v19
    v_min_u32 v20, 255, v20
    v_min_u32 v21, 255, v21
    v_min_u32 v22, 255, v22
    v_min_u32 v23, 255, v23
    v_min_u32 v24, 255, v24
    v_min_u32 v25, 255, v25
    v_min_u32 v26, 255, v26
    v_mul_u32_u24 v16, 0x800080, v16
    v_mul_u32_u24 v17, 0x800080, v17
    v_mul_u32_u24 v18, 0x800080, v18
    v_mul_u32_u24 v19, 0x800080, v19
    v_mul_u32_u24 v20, 0x800080, v20
    v_mul_u32_u24 v21, 0x800080, v21
    v_mul_u32_u24 v22, 0x800080, v22
    v_mul_u32_u24 v23, 0x800080, v23
    v_mul_u32_u24 v24, 0x800080, v24
    v_mul_u32_u24 v25, 0x800080, v25
    v_mul_u32_u24 v26, 0x800080, v26
    ds_write_b32 v5, v16 offset:0
    ds_write_b32 v5, v17 offset:512
    ds_write_b32 v5, v18 offset:1024
    ds_write_b32 v5, v19 offset:1536
    ds_write_b32 v5, v20 offset:2048
    ds_write_b32 v5, v21 offset:2560
    ds_write_b32 v5, v22 offset:3072
    ds_write_b32 v5, v23 offset:3584
    ds_write_b32 v5, v24 offset:4096
    ds_write_b32 v5, v25 offset:4608
    ds_write_b32 v5, v26 offset:5120
    s_waitcnt lgkmcnt(0)
P4_t2:
    s_barrier
    s_add_u32 s41, s42, 0
    s_mul_i32 s41, s41, 43
    s_lshr_b32 s41, s41, 7
    s_min_u32 s41, s41, 10
    s_lshl_b32 s41, s41, 9
    v_add_u32 v9, s41, v44
    ds_read_b32 v52, v9
    s_add_u32 s41, s42, 4
    s_mul_i32 s41, s41, 43
    s_lshr_b32 s41, s41, 7
    s_min_u32 s41, s41, 10
    s_lshl_b32 s41, s41, 9
    v_add_u32 v9, s41, v44
    ds_read_b32 v53, v9
    s_add_u32 s41, s42, 8
    s_mul_i32 s41, s41, 43
    s_lshr_b32 s41, s41, 7
    s_min_u32 s41, s41, 10
    s_lshl_b32 s41, s41, 9
    v_add_u32 v9, s41, v44
    ds_read_b32 v54, v9
    s_add_u32 s41, s42, 12
    s_mul_i32 s41, s41, 43
    s_lshr_b32 s41, s41, 7
    s_min_u32 s41, s41, 10
    s_lshl_b32 s41, s41, 9
    v_add_u32 v9, s41, v44
    ds_read_b32 v55, v9
    s_add_u32 s41, s42, 16
    s_mul_i32 s41, s41, 43
    s_lshr_b32 s41, s41, 7
    s_min_u32 s41, s41, 10
    s_lshl_b32 s41, s41, 9
    v_add_u32 v9, s41, v44
    ds_read_b32 v56, v9
    s_add_u32 s41, s42, 20
    s_mul_i32 s41, s41, 43
    s_lshr_b32 s41, s41, 7
    s_min_u32 s41, s41, 10
    s_lshl_b32 s41, s41, 9
    v_add_u32 v9, s41, v44
    ds_read_b32 v57, v9
    s_add_u32 s41, s42, 24
    s_mul_i32 s41, s41, 43
    s_lshr_b32 s41, s41, 7
    s_min_u32 s41, s41, 10
    s_lshl_b32 s41, s41, 9
    v_add_u32 v9, s41, v44
    ds_read_b32 v58, v9
    s_add_u32 s41, s42, 28
    s_mul_i32 s41, s41, 43
    s_lshr_b32 s41, s41, 7
    s_min_u32 s41, s41, 10
    s_lshl_b32 s41, s41, 9
    v_add_u32 v9, s41, v44
    ds_read_b32 v59, v9
    s_add_u32 s41, s42, 32
    s_mul_i32 s41, s41, 43
    s_lshr_b32 s41, s41, 7
    s_min_u32 s41, s41, 10
    s_lshl_b32 s41, s41, 9
    v_add_u32 v9, s41, v44
    ds_read_b32 v60, v9
    s_waitcnt vmcnt(0) lgkmcnt(0)
    v_pk_sub_u16 v64, v64, v52 clamp
    v_pk_sub_u16 v65, v65, v52 clamp
    v_pk_sub_u16 v66, v66, v52 clamp
    v_pk_sub_u16 v67, v67, v52 clamp
    v_pk_sub_u16 v68, v68, v53 clamp
    v_pk_sub_u16 v69, v69, v53 clamp
    v_pk_sub_u16 v70, v70, v53 clamp
    v_pk_sub_u16 v71, v71, v53 clamp
    v_pk_sub_u16 v72, v72, v54 clamp
    v_pk_sub_u16 v73, v73, v54 clamp
    v_pk_sub_u16 v74, v74, v54 clamp
    v_pk_sub_u16 v75, v75, v54 clamp
    v_pk_sub_u16 v76, v76, v55 clamp
    v_pk_sub_u16 v77, v77, v55 clamp
    v_pk_sub_u16 v78, v78, v55 clamp
    v_pk_sub_u16 v79, v79, v55 clamp
    v_pk_sub_u16 v80, v80, v56 clamp
    v_pk_sub_u16 v81, v81, v56 clamp
    v_pk_sub_u16 v82, v82, v56 clamp
    v_pk_sub_u16 v83, v83, v56 clamp
    v_pk_sub_u16 v84, v84, v57 clamp
    v_pk_sub_u16 v85, v85, v57 clamp
    v_pk_sub_u16 v86, v86, v57 clamp
    v_pk_sub_u16 v87, v87, v57 clamp
    v_pk_sub_u16 v88, v88, v58 clamp
    v_pk_sub_u16 v89, v89, v58 clamp
    v_pk_sub_u16 v90, v90, v58 clamp
    v_pk_sub_u16 v91, v91, v58 clamp
    v_pk_sub_u16 v92, v92, v59 clamp
    v_pk_sub_u16 v93, v93, v59 clamp
    v_pk_sub_u16 v94, v94, v59 clamp
    v_pk_sub_u16 v95, v95, v59 clamp
    v_mfma_f32_16x16x32_bf16 v[228:231], v[100:103], v[64:67], v[228:231]
    v_mfma_f32_16x16x32_bf16 v[232:235], v[104:107], v[64:67], v[232:235]
    v_mfma_f32_16x16x32_bf16 v[236:239], v[108:111], v[64:67], v[236:239]
    v_mfma_f32_16x16x32_bf16 v[240:243], v[112:115], v[64:67], v[240:243]
    v_mfma_f32_16x16x32_bf16 v[244:247], v[40:43], v[64:67], v[244:247]
    v_mfma_f32_16x16x32_bf16 v[228:231], v[116:119], v[68:71], v[228:231]
    v_mfma_f32_16x16x32_bf16 v[232:235], v[120:123], v[68:71], v[232:235]
    v_mfma_f32_16x16x32_bf16 v[236:239], v[124:127], v[68:71], v[236:239]
    v_mfma_f32_16x16x32_bf16 v[240:243], v[128:131], v[68:71], v[240:243]
    v_mfma_f32_16x16x32_bf16 v[244:247], v[40:43], v[68:71], v[244:247]
    v_mfma_f32_16x16x32_bf16 v[228:231], v[132:135], v[72:75], v[228:231]
    v_mfma_f32_16x16x32_bf16 v[232:235], v[136:139], v[72:75], v[232:235]
    v_mfma_f32_16x16x32_bf16 v[236:239], v[140:143], v[72:75], v[236:239]
    v_mfma_f32_16x16x32_bf16 v[240:243], v[144:147], v[72:75], v[240:243]
    v_mfma_f32_16x16x32_bf16 v[244:247], v[40:43], v[72:75], v[244:247]
    v_mfma_f32_16x16x32_bf16 v[228:231], v[148:151], v[76:79], v[228:231]
    v_mfma_f32_16x16x32_bf16 v[232:235], v[152:155], v[76:79], v[232:235]
    v_mfma_f32_16x16x32_bf16 v[236:239], v[156:159], v[76:79], v[236:239]
    v_mfma_f32_16x16x32_bf16 v[240:243], v[160:163], v[76:79], v[240:243]
    v_mfma_f32_16x16x32_bf16 v[244:247], v[40:43], v[76:79], v[244:247]
    v_mfma_f32_16x16x32_bf16 v[228:231], v[164:167], v[80:83], v[228:231]
    v_mfma_f32_16x16x32_bf16 v[232:235], v[168:171], v[80:83], v[232:235]
    v_mfma_f32_16x16x32_bf16 v[236:239], v[172:175], v[80:83], v[236:239]
    v_mfma_f32_16x16x32_bf16 v[240:243], v[176:179], v[80:83], v[240:243]
    v_mfma_f32_16x16x32_bf16 v[244:247], v[40:43], v[80:83], v[244:247]
    v_mfma_f32_16x16x32_bf16 v[228:231], v[180:183], v[84:87], v[228:231]
    v_mfma_f32_16x16x32_bf16 v[232:235], v[184:187], v[84:87], v[232:235]
    v_mfma_f32_16x16x32_bf16 v[236:239], v[188:191], v[84:87], v[236:239]
    v_mfma_f32_16x16x32_bf16 v[240:243], v[192:195], v[84:87], v[240:243]
    v_mfma_f32_16x16x32_bf16 v[244:247], v[40:43], v[84:87], v[244:247]
    v_mfma_f32_16x16x32_bf16 v[228:231], v[196:199], v[88:91], v[228:231]
    v_mfma_f32_16x16x32_bf16 v[232:235], v[200:203], v[88:91], v[232:235]
    v_mfma_f32_16x16x32_bf16 v[236:239], v[204:207], v[88:91], v[236:239]
    v_mfma_f32_16x16x32_bf16 v[240:243], v[208:211], v[88:91], v[240:243]
    v_mfma_f32_16x16x32_bf16 v[244:247], v[40:43], v[88:91], v[244:247]
    v_mfma_f32_16x16x32_bf16 v[228:231], v[212:215], v[92:95], v[228:231]
    v_mfma_f32_16x16x32_bf16 v[232:235], v[216:219], v[92:95], v[232:235]
    v_mfma_f32_16x16x32_bf16 v[236:239], v[220:223], v[92:95], v[236:239]
    v_mfma_f32_16x16x32_bf16 v[240:243], v[224:227], v[92:95], v[240:243]
    v_mfma_f32_16x16x32_bf16 v[244:247], v[40:43], v[92:95], v[244:247]
    s_cmp_lg_u32 s42, 0
    s_cbranch_scc1 P4_t3
    v_pk_sub_u16 v96, v96, v60 clamp
    v_pk_sub_u16 v97, v97, v60 clamp
    v_pk_sub_u16 v98, v98, v60 clamp
    v_pk_sub_u16 v99, v99, v60 clamp
    s_nop 1
    v_mfma_f32_16x16x32_bf16 v[244:247], v[40:43], v[96:99], v[244:247]
P4_t3:
    v_add_u32 v7, s19, v3
    v_lshlrev_b32 v10, 2, v0
    ds_write_b128 v7, v[228:231] offset:0
    ds_write_b128 v7, v[232:235] offset:1024
    ds_write_b128 v7, v[236:239] offset:2048
    ds_write_b128 v7, v[240:243] offset:3072
    s_nop 1
    ds_write_b32 v10, v244 offset:32768
    s_lshl_b32 s3, s43, 10
    v_lshl_add_u32 v10, v2, 2, s3
    s_lshl_b32 s3, s43, 14
    s_lshl_b32 s41, s42, 11
    s_add_u32 s3, s3, s41
    v_add_u32 v7, s3, v3
    s_lshl_b32 s19, s14, 1
    s_add_u32 s19, s19, s43
    s_mul_i32 s19, s19, 37
    s_add_u32 s18, s19, 36
    s_lshl_b32 s18, s18, 10
    s_lshl_b32 s41, s16, 1
    s_add_u32 s19, s19, s41
    s_add_u32 s19, s19, s42
    s_lshl_b32 s19, s19, 10
    s_waitcnt lgkmcnt(0)
    s_barrier
    s_cmp_ge_u32 s42, 2
    s_cbranch_scc1 P4_c
    ds_read_b32 v48, v10 offset:32768
    ds_read_b32 v49, v10 offset:33024
    ds_read_b32 v50, v10 offset:33280
    ds_read_b32 v51, v10 offset:33536
    ds_read_b128 v[16:19], v7 offset:0
    ds_read_b128 v[20:23], v7 offset:1024
    ds_read_b128 v[24:27], v7 offset:4096
    ds_read_b128 v[28:31], v7 offset:5120
    ds_read_b128 v[32:35], v7 offset:8192
    ds_read_b128 v[36:39], v7 offset:9216
    ds_read_b128 v[40:43], v7 offset:12288
    ds_read_b128 v[44:47], v7 offset:13312
    s_waitcnt lgkmcnt(8)
    v_pk_add_f32 v[48:49], v[48:49], v[50:51]
    v_add_f32 v14, v48, v49
    v_rcp_f32 v14, v14
    s_waitcnt lgkmcnt(4)
    v_pk_add_f32 v[16:17], v[16:17], v[24:25]
    v_pk_add_f32 v[18:19], v[18:19], v[26:27]
    v_pk_add_f32 v[20:21], v[20:21], v[28:29]
    v_pk_add_f32 v[22:23], v[22:23], v[30:31]
    s_waitcnt lgkmcnt(2)
    v_pk_add_f32 v[16:17], v[16:17], v[32:33]
    v_pk_add_f32 v[18:19], v[18:19], v[34:35]
    v_pk_add_f32 v[20:21], v[20:21], v[36:37]
    v_pk_add_f32 v[22:23], v[22:23], v[38:39]
    s_waitcnt lgkmcnt(0)
    v_pk_add_f32 v[16:17], v[16:17], v[40:41]
    v_pk_add_f32 v[18:19], v[18:19], v[42:43]
    v_pk_add_f32 v[20:21], v[20:21], v[44:45]
    v_pk_add_f32 v[22:23], v[22:23], v[46:47]
    v_pk_mul_f32 v[16:17], v[16:17], v[14:15] op_sel_hi:[1,0]
    v_pk_mul_f32 v[18:19], v[18:19], v[14:15] op_sel_hi:[1,0]
    v_pk_mul_f32 v[20:21], v[20:21], v[14:15] op_sel_hi:[1,0]
    v_pk_mul_f32 v[22:23], v[22:23], v[14:15] op_sel_hi:[1,0]
    v_cvt_pk_bf16_f32 v8, v16, v17
    v_cvt_pk_bf16_f32 v9, v18, v19
    v_cvt_pk_bf16_f32 v10, v20, v21
    v_cvt_pk_bf16_f32 v11, v22, v23
    buffer_store_dwordx4 v[8:11], v3, s[28:31], s19 offen sc1
    s_or_b32 s3, s42, s16
    s_cmp_lg_u32 s3, 0
    s_cbranch_scc1 P4_c
    v_lshlrev_b32 v24, 16, v96
    v_and_b32 v25, s40, v96
    v_lshlrev_b32 v26, 16, v97
    v_and_b32 v27, s40, v97
    v_lshlrev_b32 v28, 16, v98
    v_and_b32 v29, s40, v98
    v_lshlrev_b32 v30, 16, v99
    v_and_b32 v31, s40, v99
    v_pk_mul_f32 v[24:25], v[24:25], v[14:15] op_sel_hi:[1,0]
    v_pk_mul_f32 v[26:27], v[26:27], v[14:15] op_sel_hi:[1,0]
    v_pk_mul_f32 v[28:29], v[28:29], v[14:15] op_sel_hi:[1,0]
    v_pk_mul_f32 v[30:31], v[30:31], v[14:15] op_sel_hi:[1,0]
    v_cvt_pk_bf16_f32 v32, v24, v25
    v_cvt_pk_bf16_f32 v33, v26, v27
    v_cvt_pk_bf16_f32 v34, v28, v29
    v_cvt_pk_bf16_f32 v35, v30, v31
    buffer_store_dwordx4 v[32:35], v3, s[28:31], s18 offen sc1
P4_c:
    s_mov_b32 s20, s54
    s_mov_b32 s21, s55
    s_mov_b32 s22, 0x288000
    s_mov_b32 s23, 0x20000
    s_add_u32 s28, s84, 0x6c000
    s_addc_u32 s29, s85, 0
    s_mov_b32 s30, 0x24000
    s_mov_b32 s31, 0x20000
    s_add_u32 s32, s84, 0x20000
    s_addc_u32 s33, s85, 0
    s_mov_b32 s34, 0x2400
    s_mov_b32 s35, 0x20000
    s_mov_b32 s44, s6
    s_mov_b32 s45, s7
    s_mov_b32 s46, 0x24000
    s_mov_b32 s47, 0x20000
    s_add_u32 s48, s52, 0x480000
    s_addc_u32 s49, s53, 0
    s_mov_b32 s50, 0x24000
    s_mov_b32 s51, 0x20000
    v_lshrrev_b32 v4, 3, v2
    v_mul_u32_u24 v4, 2304, v4
    v_lshrrev_b32 v5, 4, v2
    v_lshlrev_b32 v5, 1, v5
    v_and_b32 v6, 7, v2
    v_xor_b32 v5, v5, v6
    v_lshl_add_u32 v4, v5, 4, v4
    s_mul_i32 s17, s10, 110592
    s_lshl_b32 s18, s16, 7
    s_add_u32 s17, s17, s18
    s_mul_i32 s41, s10, 18432
    s_mov_b32 m0, s41
    s_barrier
    buffer_load_dwordx4 v4, s[20:23], s17 offen lds
    s_add_u32 m0, m0, 1024
    s_add_u32 s17, s17, 18432
    buffer_load_dwordx4 v4, s[20:23], s17 offen lds
    s_add_u32 m0, m0, 1024
    s_add_u32 s17, s17, 18432
    buffer_load_dwordx4 v4, s[20:23], s17 offen lds
    s_add_u32 m0, m0, 1024
    s_add_u32 s17, s17, 18432
    buffer_load_dwordx4 v4, s[20:23], s17 offen lds
    s_add_u32 m0, m0, 1024
    s_add_u32 s17, s17, 18432
    buffer_load_dwordx4 v4, s[20:23], s17 offen lds
    s_add_u32 m0, m0, 1024
    s_add_u32 s17, s17, 18432
    buffer_load_dwordx4 v4, s[20:23], s17 offen lds
    s_add_u32 m0, m0, 1024
    s_add_u32 s17, s17, 792576
    buffer_load_dwordx4 v4, s[20:23], s17 offen lds
    s_add_u32 m0, m0, 1024
    s_add_u32 s17, s17, 18432
    buffer_load_dwordx4 v4, s[20:23], s17 offen lds
    s_add_u32 m0, m0, 1024
    s_add_u32 s17, s17, 18432
    buffer_load_dwordx4 v4, s[20:23], s17 offen lds
    s_add_u32 m0, m0, 1024
    s_add_u32 s17, s17, 18432
    buffer_load_dwordx4 v4, s[20:23], s17 offen lds
    s_add_u32 m0, m0, 1024
    s_add_u32 s17, s17, 18432
    buffer_load_dwordx4 v4, s[20:23], s17 offen lds
    s_add_u32 m0, m0, 1024
    s_add_u32 s17, s17, 18432
    buffer_load_dwordx4 v4, s[20:23], s17 offen lds
    s_add_u32 m0, m0, 1024
    s_add_u32 s17, s17, 792576
    buffer_load_dwordx4 v4, s[20:23], s17 offen lds
    s_add_u32 m0, m0, 1024
    s_add_u32 s17, s17, 18432
    buffer_load_dwordx4 v4, s[20:23], s17 offen lds
    s_add_u32 m0, m0, 1024
    s_add_u32 s17, s17, 18432
    buffer_load_dwordx4 v4, s[20:23], s17 offen lds
    s_add_u32 m0, m0, 1024
    s_add_u32 s17, s17, 18432
    buffer_load_dwordx4 v4, s[20:23], s17 offen lds
    s_add_u32 m0, m0, 1024
    s_add_u32 s17, s17, 18432
    buffer_load_dwordx4 v4, s[20:23], s17 offen lds
    s_add_u32 m0, m0, 1024
    s_add_u32 s17, s17, 18432
    buffer_load_dwordx4 v4, s[20:23], s17 offen lds
    s_add_u32 m0, m0, 1024
    s_add_u32 s17, s17, 792576
    s_cmp_lg_u32 s10, 7
    s_cbranch_scc1 P4_c0
    v_and_b32 v8, 0xff, v252
    v_lshlrev_b32 v8, 7, v8
    v_lshrrev_b32 v9, 8, v252
    v_and_b32 v9, 7, v9
    v_add_u32 v9, s86, v9
    s_mov_b32 s3, 0x400000
POLL_76:
    buffer_load_dword v10, v8, s[76:79], 0 offen sc1
    s_sub_u32 s3, s3, 1
    s_waitcnt vmcnt(0)
    v_sub_u32 v10, v10, v9
    v_cmp_lt_u32 vcc, 7, v10
    s_nop 0
    s_cbranch_vccz POLLE_77
    s_cmp_eq_u32 s3, 0
    s_cbranch_scc1 POLLE_77
    s_nop 0
    s_branch POLL_76
POLLE_77:
P4_c0:
    v_lshrrev_b32 v4, 2, v2
    v_lshlrev_b32 v4, 7, v4
    v_and_b32 v5, 1, v2
    v_lshl_add_u32 v4, v5, 4, v4
    v_add_u32 v4, s41, v4
    v_bfe_u32 v5, v2, 3, 2
    v_bfe_u32 v6, v2, 1, 1
    v_xor_b32 v5, v5, v6
    v_lshl_add_u32 v4, v5, 5, v4
    v_xor_b32 v5, 64, v4
    v_and_b32 v12, 15, v2
    v_mul_u32_u24 v12, 2304, v12
    v_lshrrev_b32 v13, 4, v2
    v_lshlrev_b32 v13, 4, v13
    v_add_u32 v12, v12, v13
    s_and_b32 s42, s10, 1
    s_bfe_u32 s43, s10, 0x10001
    s_lshl_b32 s3, s42, 6
    s_add_u32 s18, s18, s3
    s_lshl_b32 s62, s14, 1
    s_add_u32 s62, s62, s43
    s_mul_i32 s62, s62, 36864
    s_add_u32 s62, s62, s18
    s_mul_i32 s63, s14, 2304
    s_add_u32 s63, s63, s18
    s_add_u32 s63, s63, 4608
    s_mul_i32 s17, s14, 73728
    s_mul_i32 s3, s10, 1536
    s_add_u32 s17, s17, s3
    v_add_u32 v7, 36864, v3
    v_lshlrev_b32 v14, 3, v2
    v_add_u32 v15, 36864, v14
    s_mov_b32 s61, 7
    s_waitcnt vmcnt(0)
    ds_read_b64_tr_b16 v[100:101], v4 offset:0
    ds_read_b64_tr_b16 v[102:103], v4 offset:2048
    ds_read_b64_tr_b16 v[104:105], v4 offset:4096
    ds_read_b64_tr_b16 v[106:107], v4 offset:8
    ds_read_b64_tr_b16 v[108:109], v4 offset:2056
    ds_read_b64_tr_b16 v[110:111], v4 offset:4104
    ds_read_b64_tr_b16 v[112:113], v5 offset:0
    ds_read_b64_tr_b16 v[114:115], v5 offset:2048
    ds_read_b64_tr_b16 v[116:117], v5 offset:4096
    ds_read_b64_tr_b16 v[118:119], v5 offset:8
    ds_read_b64_tr_b16 v[120:121], v5 offset:2056
    ds_read_b64_tr_b16 v[122:123], v5 offset:4104
    ds_read_b64_tr_b16 v[124:125], v4 offset:6144
    ds_read_b64_tr_b16 v[126:127], v4 offset:8192
    ds_read_b64_tr_b16 v[128:129], v4 offset:10240
    ds_read_b64_tr_b16 v[130:131], v4 offset:6152
    ds_read_b64_tr_b16 v[132:133], v4 offset:8200
    ds_read_b64_tr_b16 v[134:135], v4 offset:10248
    ds_read_b64_tr_b16 v[136:137], v5 offset:6144
    ds_read_b64_tr_b16 v[138:139], v5 offset:8192
    ds_read_b64_tr_b16 v[140:141], v5 offset:10240
    ds_read_b64_tr_b16 v[142:143], v5 offset:6152
    ds_read_b64_tr_b16 v[144:145], v5 offset:8200
    ds_read_b64_tr_b16 v[146:147], v5 offset:10248
    ds_read_b64_tr_b16 v[148:149], v4 offset:12288
    ds_read_b64_tr_b16 v[150:151], v4 offset:14336
    ds_read_b64_tr_b16 v[152:153], v4 offset:16384
    ds_read_b64_tr_b16 v[154:155], v4 offset:12296
    ds_read_b64_tr_b16 v[156:157], v4 offset:14344
    ds_read_b64_tr_b16 v[158:159], v4 offset:16392
    ds_read_b64_tr_b16 v[160:161], v5 offset:12288
    ds_read_b64_tr_b16 v[162:163], v5 offset:14336
    ds_read_b64_tr_b16 v[164:165], v5 offset:16384
    ds_read_b64_tr_b16 v[166:167], v5 offset:12296
    ds_read_b64_tr_b16 v[168:169], v5 offset:14344
    ds_read_b64_tr_b16 v[170:171], v5 offset:16392
    v_mov_b64 v[176:177], 0
    v_mov_b64 v[178:179], 0
    v_mov_b64 v[180:181], 0
    v_mov_b64 v[182:183], 0
    v_mov_b64 v[184:185], 0
    v_mov_b64 v[186:187], 0
    v_mov_b64 v[188:189], 0
    v_mov_b64 v[190:191], 0
    v_mov_b64 v[192:193], 0
    v_mov_b64 v[194:195], 0
    v_mov_b64 v[196:197], 0
    v_mov_b64 v[198:199], 0
    v_mov_b64 v[200:201], 0
    v_mov_b64 v[202:203], 0
    v_mov_b64 v[204:205], 0
    v_mov_b64 v[206:207], 0
    v_mov_b32 v16, -1
    v_mov_b32 v28, -1
    v_mov_b32 v40, -1
    s_waitcnt lgkmcnt(0)
    s_barrier
    buffer_load_dwordx4 v[208:211], v12, s[44:47], s62 offen
    buffer_load_dwordx4 v[212:215], v13, s[32:35], s63 offen sc1
    s_mov_b32 s64, 0x200000
    s_mov_b32 s65, s61
    s_bcnt1_i32_b32 s3, s61
    s_sub_u32 s3, s3, 1
    v_lshrrev_b32 v11, 1, v2
    v_min_u32 v11, s3, v11
    v_mul_u32_u24 v11, 12288, v11
    v_and_b32 v8, 1, v2
    v_mul_u32_u24 v8, 36864, v8
    v_add_u32 v11, v11, v8
P4_c3:
    buffer_load_dword v8, v11, s[28:31], s17 offen offset:1020 sc1
    s_mov_b32 s60, 0
    s_waitcnt vmcnt(0)
    v_cmp_eq_u32 vcc, -1, v8
    s_cmp_le_i32 s64, 1
    s_cselect_b32 s70, 0, vcc_lo
    s_and_b32 s3, s70, 63
    s_bcnt1_i32_b32 s3, s3
    s_cmp_le_u32 s3, 2
    s_cselect_b32 s70, 0, s70
    s_bitcmp1_b32 s65, 0
    s_cbranch_scc0 P4_cl0
    s_bfe_u32 s3, s70, 0x20000
    s_cbranch_scc1 P4_cl0
    s_add_u32 s19, s17, 0
    s_mov_b32 s60, 1
    buffer_load_dwordx4 v[16:19], v3, s[28:31], s19 offen sc1
    buffer_load_dwordx2 v[24:25], v14, s[28:31], s19 offen offset:1024 sc1
    buffer_load_dwordx4 v[20:23], v7, s[28:31], s19 offen sc1
    buffer_load_dwordx2 v[26:27], v15, s[28:31], s19 offen offset:1024 sc1
P4_cl0:
    s_bitcmp1_b32 s65, 1
    s_cbranch_scc0 P4_cl1
    s_bfe_u32 s3, s70, 0x20002
    s_cbranch_scc1 P4_cl1
    s_add_u32 s19, s17, 12288
    s_mov_b32 s60, 1
    buffer_load_dwordx4 v[28:31], v3, s[28:31], s19 offen sc1
    buffer_load_dwordx2 v[36:37], v14, s[28:31], s19 offen offset:1024 sc1
    buffer_load_dwordx4 v[32:35], v7, s[28:31], s19 offen sc1
    buffer_load_dwordx2 v[38:39], v15, s[28:31], s19 offen offset:1024 sc1
P4_cl1:
    s_bitcmp1_b32 s65, 2
    s_cbranch_scc0 P4_cl2
    s_bfe_u32 s3, s70, 0x20004
    s_cbranch_scc1 P4_cl2
    s_add_u32 s19, s17, 24576
    s_mov_b32 s60, 1
    buffer_load_dwordx4 v[40:43], v3, s[28:31], s19 offen sc1
    buffer_load_dwordx2 v[48:49], v14, s[28:31], s19 offen offset:1024 sc1
    buffer_load_dwordx4 v[44:47], v7, s[28:31], s19 offen sc1
    buffer_load_dwordx2 v[50:51], v15, s[28:31], s19 offen offset:1024 sc1
P4_cl2:
    s_sub_u32 s64, s64, 1
    s_cmp_lg_u32 s60, 0
    s_cbranch_scc1 P4_c4
    s_sleep 1
    s_branch P4_c3
P4_c4:
    s_mov_b32 s65, 0
    s_waitcnt vmcnt(0)
    v_max_u32 v8, v16, v17
    v_max3_u32 v8, v8, v18, v19
    v_max3_u32 v8, v8, v20, v21
    v_max3_u32 v8, v8, v22, v23
    v_max3_u32 v8, v8, v24, v25
    v_max3_u32 v8, v8, v26, v27
    v_max_u32 v9, v28, v29
    v_max3_u32 v9, v9, v30, v31
    v_max3_u32 v9, v9, v32, v33
    v_max3_u32 v9, v9, v34, v35
    v_max3_u32 v9, v9, v36, v37
    v_max3_u32 v9, v9, v38, v39
    v_max_u32 v10, v40, v41
    v_max3_u32 v10, v10, v42, v43
    v_max3_u32 v10, v10, v44, v45
    v_max3_u32 v10, v10, v46, v47
    v_max3_u32 v10, v10, v48, v49
    v_max3_u32 v10, v10, v50, v51
    v_cmp_eq_u32 s[66:67], -1, v8
    v_cmp_eq_u32 s[68:69], -1, v9
    v_cmp_eq_u32 s[70:71], -1, v10
    s_cmp_lg_u64 s[66:67], 0
    s_cselect_b32 s3, 1, 0
    s_or_b32 s65, s65, s3
    s_cmp_lg_u64 s[68:69], 0
    s_cselect_b32 s3, 2, 0
    s_or_b32 s65, s65, s3
    s_cmp_lg_u64 s[70:71], 0
    s_cselect_b32 s3, 4, 0
    s_or_b32 s65, s65, s3
    s_cbranch_scc0 P4_c6
    s_cmp_gt_i32 s64, 0
    s_cbranch_scc1 P4_c3
P4_c6:
    v_mfma_f32_16x16x32_bf16 v[176:179], v[100:103], v[16:19], v[176:179]
    v_mfma_f32_16x16x32_bf16 v[180:183], v[106:109], v[16:19], v[180:183]
    v_mfma_f32_16x16x32_bf16 v[184:187], v[112:115], v[16:19], v[184:187]
    v_mfma_f32_16x16x32_bf16 v[188:191], v[118:121], v[16:19], v[188:191]
    v_mfma_f32_16x16x32_bf16 v[192:195], v[100:103], v[20:23], v[192:195]
    v_mfma_f32_16x16x32_bf16 v[196:199], v[106:109], v[20:23], v[196:199]
    v_mfma_f32_16x16x32_bf16 v[200:203], v[112:115], v[20:23], v[200:203]
    v_mfma_f32_16x16x32_bf16 v[204:207], v[118:121], v[20:23], v[204:207]
    v_mfma_f32_16x16x16_bf16 v[176:179], v[104:105], v[24:25], v[176:179]
    v_mfma_f32_16x16x16_bf16 v[180:183], v[110:111], v[24:25], v[180:183]
    v_mfma_f32_16x16x16_bf16 v[184:187], v[116:117], v[24:25], v[184:187]
    v_mfma_f32_16x16x16_bf16 v[188:191], v[122:123], v[24:25], v[188:191]
    v_mfma_f32_16x16x16_bf16 v[192:195], v[104:105], v[26:27], v[192:195]
    v_mfma_f32_16x16x16_bf16 v[196:199], v[110:111], v[26:27], v[196:199]
    v_mfma_f32_16x16x16_bf16 v[200:203], v[116:117], v[26:27], v[200:203]
    v_mfma_f32_16x16x16_bf16 v[204:207], v[122:123], v[26:27], v[204:207]
    v_mfma_f32_16x16x32_bf16 v[176:179], v[124:127], v[28:31], v[176:179]
    v_mfma_f32_16x16x32_bf16 v[180:183], v[130:133], v[28:31], v[180:183]
    v_mfma_f32_16x16x32_bf16 v[184:187], v[136:139], v[28:31], v[184:187]
    v_mfma_f32_16x16x32_bf16 v[188:191], v[142:145], v[28:31], v[188:191]
    v_mfma_f32_16x16x32_bf16 v[192:195], v[124:127], v[32:35], v[192:195]
    v_mfma_f32_16x16x32_bf16 v[196:199], v[130:133], v[32:35], v[196:199]
    v_mfma_f32_16x16x32_bf16 v[200:203], v[136:139], v[32:35], v[200:203]
    v_mfma_f32_16x16x32_bf16 v[204:207], v[142:145], v[32:35], v[204:207]
    v_mfma_f32_16x16x16_bf16 v[176:179], v[128:129], v[36:37], v[176:179]
    v_mfma_f32_16x16x16_bf16 v[180:183], v[134:135], v[36:37], v[180:183]
    v_mfma_f32_16x16x16_bf16 v[184:187], v[140:141], v[36:37], v[184:187]
    v_mfma_f32_16x16x16_bf16 v[188:191], v[146:147], v[36:37], v[188:191]
    v_mfma_f32_16x16x16_bf16 v[192:195], v[128:129], v[38:39], v[192:195]
    v_mfma_f32_16x16x16_bf16 v[196:199], v[134:135], v[38:39], v[196:199]
    v_mfma_f32_16x16x16_bf16 v[200:203], v[140:141], v[38:39], v[200:203]
    v_mfma_f32_16x16x16_bf16 v[204:207], v[146:147], v[38:39], v[204:207]
    v_mfma_f32_16x16x32_bf16 v[176:179], v[148:151], v[40:43], v[176:179]
    v_mfma_f32_16x16x32_bf16 v[180:183], v[154:157], v[40:43], v[180:183]
    v_mfma_f32_16x16x32_bf16 v[184:187], v[160:163], v[40:43], v[184:187]
    v_mfma_f32_16x16x32_bf16 v[188:191], v[166:169], v[40:43], v[188:191]
    v_mfma_f32_16x16x32_bf16 v[192:195], v[148:151], v[44:47], v[192:195]
    v_mfma_f32_16x16x32_bf16 v[196:199], v[154:157], v[44:47], v[196:199]
    v_mfma_f32_16x16x32_bf16 v[200:203], v[160:163], v[44:47], v[200:203]
    v_mfma_f32_16x16x32_bf16 v[204:207], v[166:169], v[44:47], v[204:207]
    v_mfma_f32_16x16x16_bf16 v[176:179], v[152:153], v[48:49], v[176:179]
    v_mfma_f32_16x16x16_bf16 v[180:183], v[158:159], v[48:49], v[180:183]
    v_mfma_f32_16x16x16_bf16 v[184:187], v[164:165], v[48:49], v[184:187]
    v_mfma_f32_16x16x16_bf16 v[188:191], v[170:171], v[48:49], v[188:191]
    v_mfma_f32_16x16x16_bf16 v[192:195], v[152:153], v[50:51], v[192:195]
    v_mfma_f32_16x16x16_bf16 v[196:199], v[158:159], v[50:51], v[196:199]
    v_mfma_f32_16x16x16_bf16 v[200:203], v[164:165], v[50:51], v[200:203]
    v_mfma_f32_16x16x16_bf16 v[204:207], v[170:171], v[50:51], v[204:207]
    s_lshl_b32 s19, s10, 13
    v_add_u32 v7, s19, v3
    v_lshlrev_b32 v216, 16, v208
    v_and_b32 v217, s40, v208
    v_lshlrev_b32 v218, 16, v209
    v_and_b32 v219, s40, v209
    v_lshlrev_b32 v220, 16, v210
    v_and_b32 v221, s40, v210
    v_lshlrev_b32 v222, 16, v211
    v_and_b32 v223, s40, v211
    v_lshlrev_b32 v224, 16, v212
    v_and_b32 v225, s40, v212
    v_lshlrev_b32 v226, 16, v213
    v_and_b32 v227, s40, v213
    v_lshlrev_b32 v228, 16, v214
    v_and_b32 v229, s40, v214
    v_lshlrev_b32 v230, 16, v215
    v_and_b32 v231, s40, v215
    ds_write_b128 v7, v[176:179] offset:0
    ds_write_b128 v7, v[180:183] offset:1024
    ds_write_b128 v7, v[184:187] offset:2048
    ds_write_b128 v7, v[188:191] offset:3072
    ds_write_b128 v7, v[192:195] offset:4096
    ds_write_b128 v7, v[196:199] offset:5120
    ds_write_b128 v7, v[200:203] offset:6144
    ds_write_b128 v7, v[204:207] offset:7168
    s_lshl_b32 s19, s10, 11
    v_add_u32 v7, s19, v3
    s_waitcnt lgkmcnt(0)
    s_barrier
    s_cmp_ge_u32 s10, 4
    s_cbranch_scc1 P4_done
    ds_read_b128 v[16:19], v7 offset:0
    ds_read_b128 v[20:23], v7 offset:1024
    ds_read_b128 v[24:27], v7 offset:8192
    ds_read_b128 v[28:31], v7 offset:9216
    ds_read_b128 v[32:35], v7 offset:16384
    ds_read_b128 v[36:39], v7 offset:17408
    ds_read_b128 v[40:43], v7 offset:24576
    ds_read_b128 v[44:47], v7 offset:25600
    ds_read_b128 v[48:51], v7 offset:32768
    ds_read_b128 v[52:55], v7 offset:33792
    ds_read_b128 v[56:59], v7 offset:40960
    ds_read_b128 v[60:63], v7 offset:41984
    ds_read_b128 v[64:67], v7 offset:49152
    ds_read_b128 v[68:71], v7 offset:50176
    ds_read_b128 v[72:75], v7 offset:57344
    ds_read_b128 v[76:79], v7 offset:58368
    s_waitcnt lgkmcnt(12)
    v_pk_add_f32 v[16:17], v[16:17], v[24:25]
    v_pk_add_f32 v[18:19], v[18:19], v[26:27]
    v_pk_add_f32 v[20:21], v[20:21], v[28:29]
    v_pk_add_f32 v[22:23], v[22:23], v[30:31]
    s_waitcnt lgkmcnt(10)
    v_pk_add_f32 v[16:17], v[16:17], v[32:33]
    v_pk_add_f32 v[18:19], v[18:19], v[34:35]
    v_pk_add_f32 v[20:21], v[20:21], v[36:37]
    v_pk_add_f32 v[22:23], v[22:23], v[38:39]
    s_waitcnt lgkmcnt(8)
    v_pk_add_f32 v[16:17], v[16:17], v[40:41]
    v_pk_add_f32 v[18:19], v[18:19], v[42:43]
    v_pk_add_f32 v[20:21], v[20:21], v[44:45]
    v_pk_add_f32 v[22:23], v[22:23], v[46:47]
    s_waitcnt lgkmcnt(6)
    v_pk_add_f32 v[16:17], v[16:17], v[48:49]
    v_pk_add_f32 v[18:19], v[18:19], v[50:51]
    v_pk_add_f32 v[20:21], v[20:21], v[52:53]
    v_pk_add_f32 v[22:23], v[22:23], v[54:55]
    s_waitcnt lgkmcnt(4)
    v_pk_add_f32 v[16:17], v[16:17], v[56:57]
    v_pk_add_f32 v[18:19], v[18:19], v[58:59]
    v_pk_add_f32 v[20:21], v[20:21], v[60:61]
    v_pk_add_f32 v[22:23], v[22:23], v[62:63]
    s_waitcnt lgkmcnt(2)
    v_pk_add_f32 v[16:17], v[16:17], v[64:65]
    v_pk_add_f32 v[18:19], v[18:19], v[66:67]
    v_pk_add_f32 v[20:21], v[20:21], v[68:69]
    v_pk_add_f32 v[22:23], v[22:23], v[70:71]
    s_waitcnt lgkmcnt(0)
    v_pk_add_f32 v[16:17], v[16:17], v[72:73]
    v_pk_add_f32 v[18:19], v[18:19], v[74:75]
    v_pk_add_f32 v[20:21], v[20:21], v[76:77]
    v_pk_add_f32 v[22:23], v[22:23], v[78:79]
    v_pk_fma_f32 v[216:217], v[16:17], v[224:225], v[216:217]
    v_pk_fma_f32 v[218:219], v[18:19], v[226:227], v[218:219]
    v_pk_fma_f32 v[220:221], v[20:21], v[228:229], v[220:221]
    v_pk_fma_f32 v[222:223], v[22:23], v[230:231], v[222:223]
    v_cvt_pk_bf16_f32 v208, v216, v217
    v_cvt_pk_bf16_f32 v209, v218, v219
    v_cvt_pk_bf16_f32 v210, v220, v221
    v_cvt_pk_bf16_f32 v211, v222, v223
    buffer_store_dwordx4 v[208:211], v12, s[48:51], s62 offen sc1
    s_endpgm
P4_ot:
    s_add_u32 s3, s16, 1
    s_bitcmp1_b32 s3, 1
    s_cbranch_scc0 P4_oa
    s_waitcnt lgkmcnt(0)
    s_load_dwordx2 s[4:5], s[0:1], 24
    s_lshr_b32 s16, s82, 16
    s_movk_i32 s19, 10923
    s_mul_i32 s18, s16, 96
    s_mul_i32 s41, s10, 3072
    s_and_b32 s42, s10, 3
    s_lshr_b32 s43, s10, 2
    v_add_u32 v4, 0, v2
    v_mul_lo_u32 v5, v4, s19
    v_lshrrev_b32 v5, 16, v5
    v_mul_u32_u24 v6, 6, v5
    v_sub_u32 v6, v4, v6
    v_mul_u32_u24 v5, 6912, v5
    v_lshl_add_u32 v8, v6, 4, v5
    v_add_u32 v4, 64, v2
    v_mul_lo_u32 v5, v4, s19
    v_lshrrev_b32 v5, 16, v5
    v_mul_u32_u24 v6, 6, v5
    v_sub_u32 v6, v4, v6
    v_mul_u32_u24 v5, 6912, v5
    v_lshl_add_u32 v9, v6, 4, v5
    v_subrev_u32 v9, 1024, v9
    v_add_u32 v4, 128, v2
    v_mul_lo_u32 v5, v4, s19
    v_lshrrev_b32 v5, 16, v5
    v_mul_u32_u24 v6, 6, v5
    v_sub_u32 v6, v4, v6
    v_mul_u32_u24 v5, 6912, v5
    v_lshl_add_u32 v10, v6, 4, v5
    v_subrev_u32 v10, 2048, v10
    v_lshrrev_b32 v4, 2, v2
    v_mul_u32_u24 v4, 96, v4
    v_and_b32 v5, 3, v2
    v_lshl_add_u32 v4, v5, 3, v4
    s_mul_i32 s3, s42, 3072
    v_add_u32 v4, s3, v4
    v_add_u32 v5, 61440, v4
    s_bfe_u32 s15, s80, 0x80008
    s_cmp_eq_u32 s15, 8
    s_cselect_b32 s15, 5, 4
    v_mov_b32 v12, 147464
    s_mov_b32 s3, 0x2000000
LW_78:
    ds_read_b32 v13, v12
    s_sub_u32 s3, s3, 1
    s_waitcnt lgkmcnt(0)
    v_cmp_le_u32 vcc, 6, v13
    s_cmp_eq_u32 s3, 0
    s_cbranch_scc1 LWE_79
    s_cbranch_vccnz LWE_79
    s_sleep 1
    s_branch LW_78
LWE_79:
    s_add_u32 s20, s4, 0x1200
    s_addc_u32 s21, s5, 0
    s_mov_b32 s22, 0x796e00
    s_mov_b32 s23, 0x20000
    s_add_u32 s24, s84, 0x48000
    s_addc_u32 s25, s85, 0
    s_mov_b32 s26, 0x24000
    s_mov_b32 s27, 0x20000
    s_mul_i32 s17, s10, 221184
    s_add_u32 s17, s17, s18
    s_add_u32 m0, s41, 0
    s_nop 0
    buffer_load_dwordx4 v8, s[20:23], s17 offen offset:0 lds
    buffer_load_dwordx4 v9, s[20:23], s17 offen offset:1024 lds
    buffer_load_dwordx4 v10, s[20:23], s17 offen offset:2048 lds
    s_add_u32 s17, s17, 1769472
    s_add_u32 m0, s41, 24576
    s_nop 0
    buffer_load_dwordx4 v8, s[20:23], s17 offen offset:0 lds
    buffer_load_dwordx4 v9, s[20:23], s17 offen offset:1024 lds
    buffer_load_dwordx4 v10, s[20:23], s17 offen offset:2048 lds
    s_add_u32 s17, s17, 1769472
    s_add_u32 m0, s41, 49152
    s_nop 0
    buffer_load_dwordx4 v8, s[20:23], s17 offen offset:0 lds
    buffer_load_dwordx4 v9, s[20:23], s17 offen offset:1024 lds
    buffer_load_dwordx4 v10, s[20:23], s17 offen offset:2048 lds
    s_add_u32 s17, s17, 1769472
    s_add_u32 m0, s41, 73728
    s_nop 0
    buffer_load_dwordx4 v8, s[20:23], s17 offen offset:0 lds
    buffer_load_dwordx4 v9, s[20:23], s17 offen offset:1024 lds
    buffer_load_dwordx4 v10, s[20:23], s17 offen offset:2048 lds
    s_add_u32 s17, s17, 1769472
    s_cmp_ge_u32 s10, 4
    s_cbranch_scc1 P4_o1
    s_add_u32 m0, s41, 98304
    s_nop 0
    buffer_load_dwordx4 v8, s[20:23], s17 offen offset:0 lds
    buffer_load_dwordx4 v9, s[20:23], s17 offen offset:1024 lds
    buffer_load_dwordx4 v10, s[20:23], s17 offen offset:2048 lds
    s_add_u32 s17, s17, 1769472
P4_o1:
    s_cmp_lt_u32 s10, 6
    s_cbranch_scc1 P4_o2
    v_and_b32 v12, 0xff, v252
    v_lshlrev_b32 v12, 7, v12
    v_lshrrev_b32 v13, 8, v252
    v_readfirstlane_b32 s3, v252
    v_cmp_lt_u32 vcc, 7, v13
    s_nop 0
    v_mov_b32 v14, s3
    v_cndmask_b32 v14, v252, v14, vcc
    v_and_b32 v12, 0xff, v14
    v_lshlrev_b32 v12, 7, v12
    v_lshrrev_b32 v13, 8, v14
    v_add_u32 v13, s86, v13
    s_mov_b32 s3, 0x400000
POLL_80:
    buffer_load_dword v14, v12, s[76:79], 0 offen sc1
    s_sub_u32 s3, s3, 1
    s_waitcnt vmcnt(0)
    v_sub_u32 v14, v14, v13
    v_cmp_lt_u32 vcc, 7, v14
    s_nop 0
    s_cbranch_vccz POLLE_81
    s_cmp_eq_u32 s3, 0
    s_cbranch_scc1 POLLE_81
    s_nop 0
    s_branch POLL_80
POLLE_81:
    s_sub_u32 s3, s10, 6
    s_mul_i32 s17, s3, 73728
    s_and_b32 s19, s18, 0xffffffc0
    s_add_u32 s17, s17, s19
    s_lshl_b32 s3, s3, 12
    s_add_u32 m0, s3, 110592
    v_lshrrev_b32 v6, 3, v2
    v_mul_u32_u24 v6, 2304, v6
    v_and_b32 v7, 7, v2
    v_lshl_add_u32 v6, v7, 4, v6
    buffer_load_dwordx4 v6, s[24:27], s17 offen offset:0 sc1 lds
    s_add_u32 s17, s17, 17408
    buffer_load_dwordx4 v6, s[24:27], s17 offen offset:1024 sc1 lds
    s_add_u32 s17, s17, 17408
    buffer_load_dwordx4 v6, s[24:27], s17 offen offset:2048 sc1 lds
    s_add_u32 s17, s17, 17408
    buffer_load_dwordx4 v6, s[24:27], s17 offen offset:3072 sc1 lds
    s_add_u32 s17, s17, 17408
P4_o2:
    s_lshl_b32 s3, s43, 12
    s_add_u32 s3, s3, 110592
    v_lshrrev_b32 v6, 2, v2
    v_lshlrev_b32 v6, 7, v6
    v_and_b32 v7, 3, v2
    v_lshl_add_u32 v6, v7, 4, v6
    v_add_u32 v6, s3, v6
    s_bitcmp1_b32 s16, 0
    s_cselect_b32 s3, 8, 0
    v_add_u32 v14, s3, v6
    s_cselect_b32 s3, 64, 8
    v_add_u32 v15, s3, v6
    s_cselect_b32 s3, 72, 64
    v_add_u32 v6, s3, v6
    s_waitcnt vmcnt(0)
    s_barrier
    ds_read_b64_tr_b16 v[100:101], v4 offset:0
    ds_read_b64_tr_b16 v[102:103], v4 offset:1536
    ds_read_b64_tr_b16 v[104:105], v4 offset:32
    ds_read_b64_tr_b16 v[106:107], v4 offset:1568
    ds_read_b64_tr_b16 v[108:109], v4 offset:64
    ds_read_b64_tr_b16 v[110:111], v4 offset:1600
    ds_read_b64_tr_b16 v[112:113], v4 offset:12288
    ds_read_b64_tr_b16 v[114:115], v4 offset:13824
    ds_read_b64_tr_b16 v[116:117], v4 offset:12320
    ds_read_b64_tr_b16 v[118:119], v4 offset:13856
    ds_read_b64_tr_b16 v[120:121], v4 offset:12352
    ds_read_b64_tr_b16 v[122:123], v4 offset:13888
    ds_read_b64_tr_b16 v[124:125], v4 offset:24576
    ds_read_b64_tr_b16 v[126:127], v4 offset:26112
    ds_read_b64_tr_b16 v[128:129], v4 offset:24608
    ds_read_b64_tr_b16 v[130:131], v4 offset:26144
    ds_read_b64_tr_b16 v[132:133], v4 offset:24640
    ds_read_b64_tr_b16 v[134:135], v4 offset:26176
    ds_read_b64_tr_b16 v[136:137], v4 offset:36864
    ds_read_b64_tr_b16 v[138:139], v4 offset:38400
    ds_read_b64_tr_b16 v[140:141], v4 offset:36896
    ds_read_b64_tr_b16 v[142:143], v4 offset:38432
    ds_read_b64_tr_b16 v[144:145], v4 offset:36928
    ds_read_b64_tr_b16 v[146:147], v4 offset:38464
    ds_read_b64_tr_b16 v[148:149], v4 offset:49152
    ds_read_b64_tr_b16 v[150:151], v4 offset:50688
    ds_read_b64_tr_b16 v[152:153], v4 offset:49184
    ds_read_b64_tr_b16 v[154:155], v4 offset:50720
    ds_read_b64_tr_b16 v[156:157], v4 offset:49216
    ds_read_b64_tr_b16 v[158:159], v4 offset:50752
    ds_read_b64_tr_b16 v[160:161], v5 offset:0
    ds_read_b64_tr_b16 v[162:163], v5 offset:1536
    ds_read_b64_tr_b16 v[164:165], v5 offset:32
    ds_read_b64_tr_b16 v[166:167], v5 offset:1568
    ds_read_b64_tr_b16 v[168:169], v5 offset:64
    ds_read_b64_tr_b16 v[170:171], v5 offset:1600
    ds_read_b64_tr_b16 v[172:173], v5 offset:12288
    ds_read_b64_tr_b16 v[174:175], v5 offset:13824
    ds_read_b64_tr_b16 v[176:177], v5 offset:12320
    ds_read_b64_tr_b16 v[178:179], v5 offset:13856
    ds_read_b64_tr_b16 v[180:181], v5 offset:12352
    ds_read_b64_tr_b16 v[182:183], v5 offset:13888
    ds_read_b64_tr_b16 v[184:185], v5 offset:24576
    ds_read_b64_tr_b16 v[186:187], v5 offset:26112
    ds_read_b64_tr_b16 v[188:189], v5 offset:24608
    ds_read_b64_tr_b16 v[190:191], v5 offset:26144
    ds_read_b64_tr_b16 v[192:193], v5 offset:24640
    ds_read_b64_tr_b16 v[194:195], v5 offset:26176
    ds_read_b64_tr_b16 v[196:197], v5 offset:36864
    ds_read_b64_tr_b16 v[198:199], v5 offset:38400
    ds_read_b64_tr_b16 v[200:201], v5 offset:36896
    ds_read_b64_tr_b16 v[202:203], v5 offset:38432
    ds_read_b64_tr_b16 v[204:205], v5 offset:36928
    ds_read_b64_tr_b16 v[206:207], v5 offset:38464
    ds_read_b64_tr_b16 v[208:209], v14 offset:0
    ds_read_b64_tr_b16 v[210:211], v14 offset:2048
    ds_read_b64_tr_b16 v[212:213], v15 offset:0
    ds_read_b64_tr_b16 v[214:215], v15 offset:2048
    ds_read_b64_tr_b16 v[216:217], v6 offset:0
    ds_read_b64_tr_b16 v[218:219], v6 offset:2048
    s_waitcnt lgkmcnt(0)
    s_barrier
P4_oa:
    s_add_u32 s24, s84, 0xd8000
    s_addc_u32 s25, s85, 0
    s_mov_b32 s26, 0x25000
    s_mov_b32 s27, 0x20000
    s_add_u32 s28, s84, 0x6c000
    s_addc_u32 s29, s85, 0
    s_mov_b32 s30, 0x24000
    s_mov_b32 s31, 0x20000
    s_and_b32 s42, s10, 3
    s_lshr_b32 s43, s10, 2
    s_lshl_b32 s65, s43, 1
    s_and_b32 s3, s42, 1
    s_add_u32 s65, s65, s3
    s_mul_i32 s72, s16, 1536
    s_mul_i32 s3, s65, 36864
    s_add_u32 s72, s72, s3
    v_lshlrev_b32 v14, 3, v2
    s_cmp_lg_u32 s10, 7
    s_cbranch_scc1 P4_o2c
    v_and_b32 v8, 0xff, v252
    v_lshlrev_b32 v8, 7, v8
    v_lshrrev_b32 v9, 8, v252
    v_and_b32 v9, 7, v9
    v_add_u32 v9, s86, v9
    s_mov_b32 s3, 0x400000
POLL_82:
    buffer_load_dword v10, v8, s[76:79], 0 offen sc1
    s_sub_u32 s3, s3, 1
    s_waitcnt vmcnt(0)
    v_sub_u32 v10, v10, v9
    v_cmp_lt_u32 vcc, 7, v10
    s_nop 0
    s_cbranch_vccz POLLE_83
    s_cmp_eq_u32 s3, 0
    s_cbranch_scc1 POLLE_83
    s_nop 0
    s_branch POLL_82
POLLE_83:
P4_o2c:
    v_mov_b64 v[220:221], 0
    v_mov_b64 v[222:223], 0
    v_mov_b64 v[224:225], 0
    v_mov_b64 v[226:227], 0
    v_mov_b64 v[228:229], 0
    v_mov_b64 v[230:231], 0
    v_mov_b64 v[232:233], 0
    v_mov_b64 v[234:235], 0
    v_mov_b64 v[236:237], 0
    v_mov_b64 v[238:239], 0
    v_mov_b64 v[240:241], 0
    v_mov_b64 v[242:243], 0
    v_mov_b64 v[88:89], 0
    v_mov_b64 v[90:91], 0
    v_mov_b64 v[92:93], 0
    v_mov_b64 v[94:95], 0
    v_mov_b32 v16, -1
    v_mov_b32 v24, -1
    v_mov_b32 v32, -1
    v_mov_b32 v40, -1
    v_mov_b32 v48, -1
    v_mov_b32 v56, -1
    v_mov_b32 v64, -1
    v_mov_b32 v72, -1
    v_mov_b32 v80, -1
    s_mul_i32 s17, s43, 75776
    s_lshl_b32 s3, s42, 10
    s_add_u32 s17, s17, s3
    v_add_u32 v7, 37888, v3
    s_movk_i32 s61, 0x1ff
    s_cmp_eq_u32 s42, 0
    s_cselect_b32 s61, 0x3ff, s61
    s_cselect_b32 s3, -1, 0
    v_mov_b32 v88, s3
    s_barrier
    s_mov_b32 s64, 0x200000
    s_mov_b32 s65, s61
    s_bcnt1_i32_b32 s3, s61
    s_sub_u32 s3, s3, 1
    v_lshrrev_b32 v11, 1, v2
    v_min_u32 v11, s3, v11
    v_mul_u32_u24 v11, 4096, v11
    v_and_b32 v8, 1, v2
    v_mul_u32_u24 v8, 37888, v8
    v_add_u32 v11, v11, v8
P4_b3:
    buffer_load_dword v8, v11, s[24:27], s17 offen offset:1020 sc1
    s_mov_b32 s60, 0
    s_waitcnt vmcnt(0)
    v_cmp_eq_u32 vcc, -1, v8
    s_cmp_le_i32 s64, 1
    s_cselect_b32 s70, 0, vcc_lo
    s_and_b32 s3, s70, 262143
    s_bcnt1_i32_b32 s3, s3
    s_cmp_le_u32 s3, 6
    s_cselect_b32 s70, 0, s70
    s_bitcmp1_b32 s65, 0
    s_cbranch_scc0 P4_bl0
    s_bfe_u32 s3, s70, 0x20000
    s_cbranch_scc1 P4_bl0
    s_add_u32 s19, s17, 0
    s_mov_b32 s60, 1
    buffer_load_dwordx4 v[16:19], v3, s[24:27], s19 offen sc1
    buffer_load_dwordx4 v[20:23], v7, s[24:27], s19 offen sc1
P4_bl0:
    s_bitcmp1_b32 s65, 1
    s_cbranch_scc0 P4_bl1
    s_bfe_u32 s3, s70, 0x20002
    s_cbranch_scc1 P4_bl1
    s_add_u32 s19, s17, 4096
    s_mov_b32 s60, 1
    buffer_load_dwordx4 v[24:27], v3, s[24:27], s19 offen sc1
    buffer_load_dwordx4 v[28:31], v7, s[24:27], s19 offen sc1
P4_bl1:
    s_bitcmp1_b32 s65, 2
    s_cbranch_scc0 P4_bl2
    s_bfe_u32 s3, s70, 0x20004
    s_cbranch_scc1 P4_bl2
    s_add_u32 s19, s17, 8192
    s_mov_b32 s60, 1
    buffer_load_dwordx4 v[32:35], v3, s[24:27], s19 offen sc1
    buffer_load_dwordx4 v[36:39], v7, s[24:27], s19 offen sc1
P4_bl2:
    s_bitcmp1_b32 s65, 3
    s_cbranch_scc0 P4_bl3
    s_bfe_u32 s3, s70, 0x20006
    s_cbranch_scc1 P4_bl3
    s_add_u32 s19, s17, 12288
    s_mov_b32 s60, 1
    buffer_load_dwordx4 v[40:43], v3, s[24:27], s19 offen sc1
    buffer_load_dwordx4 v[44:47], v7, s[24:27], s19 offen sc1
P4_bl3:
    s_bitcmp1_b32 s65, 4
    s_cbranch_scc0 P4_bl4
    s_bfe_u32 s3, s70, 0x20008
    s_cbranch_scc1 P4_bl4
    s_add_u32 s19, s17, 16384
    s_mov_b32 s60, 1
    buffer_load_dwordx4 v[48:51], v3, s[24:27], s19 offen sc1
    buffer_load_dwordx4 v[52:55], v7, s[24:27], s19 offen sc1
P4_bl4:
    s_bitcmp1_b32 s65, 5
    s_cbranch_scc0 P4_bl5
    s_bfe_u32 s3, s70, 0x2000a
    s_cbranch_scc1 P4_bl5
    s_add_u32 s19, s17, 20480
    s_mov_b32 s60, 1
    buffer_load_dwordx4 v[56:59], v3, s[24:27], s19 offen sc1
    buffer_load_dwordx4 v[60:63], v7, s[24:27], s19 offen sc1
P4_bl5:
    s_bitcmp1_b32 s65, 6
    s_cbranch_scc0 P4_bl6
    s_bfe_u32 s3, s70, 0x2000c
    s_cbranch_scc1 P4_bl6
    s_add_u32 s19, s17, 24576
    s_mov_b32 s60, 1
    buffer_load_dwordx4 v[64:67], v3, s[24:27], s19 offen sc1
    buffer_load_dwordx4 v[68:71], v7, s[24:27], s19 offen sc1
P4_bl6:
    s_bitcmp1_b32 s65, 7
    s_cbranch_scc0 P4_bl7
    s_bfe_u32 s3, s70, 0x2000e
    s_cbranch_scc1 P4_bl7
    s_add_u32 s19, s17, 28672
    s_mov_b32 s60, 1
    buffer_load_dwordx4 v[72:75], v3, s[24:27], s19 offen sc1
    buffer_load_dwordx4 v[76:79], v7, s[24:27], s19 offen sc1
P4_bl7:
    s_bitcmp1_b32 s65, 8
    s_cbranch_scc0 P4_bl8
    s_bfe_u32 s3, s70, 0x20010
    s_cbranch_scc1 P4_bl8
    s_add_u32 s19, s17, 32768
    s_mov_b32 s60, 1
    buffer_load_dwordx4 v[80:83], v3, s[24:27], s19 offen sc1
    buffer_load_dwordx4 v[84:87], v7, s[24:27], s19 offen sc1
P4_bl8:
    s_bitcmp1_b32 s65, 9
    s_cbranch_scc0 P4_bl9
    s_bfe_u32 s3, s70, 0x20012
    s_cbranch_scc1 P4_bl9
    s_add_u32 s19, s17, 36864
    s_mov_b32 s60, 1
    buffer_load_dwordx4 v[88:91], v3, s[24:27], s19 offen sc1
    buffer_load_dwordx4 v[92:95], v7, s[24:27], s19 offen sc1
P4_bl9:
    s_sub_u32 s64, s64, 1
    s_cmp_lg_u32 s60, 0
    s_cbranch_scc1 P4_b4
    s_sleep 1
    s_branch P4_b3
P4_b4:
    s_mov_b32 s65, 0
    s_waitcnt vmcnt(0)
    v_max_u32 v8, v16, v17
    v_max3_u32 v8, v8, v18, v19
    v_max3_u32 v8, v8, v20, v21
    v_max3_u32 v8, v8, v22, v23
    v_max_u32 v9, v24, v25
    v_max3_u32 v9, v9, v26, v27
    v_max3_u32 v9, v9, v28, v29
    v_max3_u32 v9, v9, v30, v31
    v_max_u32 v10, v32, v33
    v_max3_u32 v10, v10, v34, v35
    v_max3_u32 v10, v10, v36, v37
    v_max3_u32 v10, v10, v38, v39
    v_cmp_eq_u32 s[66:67], -1, v8
    v_cmp_eq_u32 s[68:69], -1, v9
    v_cmp_eq_u32 s[70:71], -1, v10
    s_cmp_lg_u64 s[66:67], 0
    s_cselect_b32 s3, 1, 0
    s_or_b32 s65, s65, s3
    s_cmp_lg_u64 s[68:69], 0
    s_cselect_b32 s3, 2, 0
    s_or_b32 s65, s65, s3
    s_cmp_lg_u64 s[70:71], 0
    s_cselect_b32 s3, 4, 0
    s_or_b32 s65, s65, s3
    v_max_u32 v8, v40, v41
    v_max3_u32 v8, v8, v42, v43
    v_max3_u32 v8, v8, v44, v45
    v_max3_u32 v8, v8, v46, v47
    v_max_u32 v9, v48, v49
    v_max3_u32 v9, v9, v50, v51
    v_max3_u32 v9, v9, v52, v53
    v_max3_u32 v9, v9, v54, v55
    v_max_u32 v10, v56, v57
    v_max3_u32 v10, v10, v58, v59
    v_max3_u32 v10, v10, v60, v61
    v_max3_u32 v10, v10, v62, v63
    v_cmp_eq_u32 s[66:67], -1, v8
    v_cmp_eq_u32 s[68:69], -1, v9
    v_cmp_eq_u32 s[70:71], -1, v10
    s_cmp_lg_u64 s[66:67], 0
    s_cselect_b32 s3, 8, 0
    s_or_b32 s65, s65, s3
    s_cmp_lg_u64 s[68:69], 0
    s_cselect_b32 s3, 16, 0
    s_or_b32 s65, s65, s3
    s_cmp_lg_u64 s[70:71], 0
    s_cselect_b32 s3, 32, 0
    s_or_b32 s65, s65, s3
    v_max_u32 v8, v64, v65
    v_max3_u32 v8, v8, v66, v67
    v_max3_u32 v8, v8, v68, v69
    v_max3_u32 v8, v8, v70, v71
    v_max_u32 v9, v72, v73
    v_max3_u32 v9, v9, v74, v75
    v_max3_u32 v9, v9, v76, v77
    v_max3_u32 v9, v9, v78, v79
    v_max_u32 v10, v80, v81
    v_max3_u32 v10, v10, v82, v83
    v_max3_u32 v10, v10, v84, v85
    v_max3_u32 v10, v10, v86, v87
    v_cmp_eq_u32 s[66:67], -1, v8
    v_cmp_eq_u32 s[68:69], -1, v9
    v_cmp_eq_u32 s[70:71], -1, v10
    s_cmp_lg_u64 s[66:67], 0
    s_cselect_b32 s3, 64, 0
    s_or_b32 s65, s65, s3
    s_cmp_lg_u64 s[68:69], 0
    s_cselect_b32 s3, 128, 0
    s_or_b32 s65, s65, s3
    s_cmp_lg_u64 s[70:71], 0
    s_cselect_b32 s3, 256, 0
    s_or_b32 s65, s65, s3
    v_max_u32 v8, v88, v89
    v_max3_u32 v8, v8, v90, v91
    v_max3_u32 v8, v8, v92, v93
    v_max3_u32 v8, v8, v94, v95
    v_cmp_eq_u32 s[66:67], -1, v8
    s_nop 0
    s_cmp_lg_u64 s[66:67], 0
    s_cselect_b32 s3, 512, 0
    s_or_b32 s65, s65, s3
    s_cbranch_scc0 P4_b6
    s_cmp_gt_i32 s64, 0
    s_cbranch_scc1 P4_b3
P4_b6:
    v_mfma_f32_16x16x32_bf16 v[220:223], v[100:103], v[16:19], v[220:223]
    v_mfma_f32_16x16x32_bf16 v[224:227], v[104:107], v[16:19], v[224:227]
    v_mfma_f32_16x16x32_bf16 v[228:231], v[108:111], v[16:19], v[228:231]
    v_mfma_f32_16x16x32_bf16 v[232:235], v[100:103], v[20:23], v[232:235]
    v_mfma_f32_16x16x32_bf16 v[236:239], v[104:107], v[20:23], v[236:239]
    v_mfma_f32_16x16x32_bf16 v[240:243], v[108:111], v[20:23], v[240:243]
    v_mfma_f32_16x16x32_bf16 v[220:223], v[112:115], v[24:27], v[220:223]
    v_mfma_f32_16x16x32_bf16 v[224:227], v[116:119], v[24:27], v[224:227]
    v_mfma_f32_16x16x32_bf16 v[228:231], v[120:123], v[24:27], v[228:231]
    v_mfma_f32_16x16x32_bf16 v[232:235], v[112:115], v[28:31], v[232:235]
    v_mfma_f32_16x16x32_bf16 v[236:239], v[116:119], v[28:31], v[236:239]
    v_mfma_f32_16x16x32_bf16 v[240:243], v[120:123], v[28:31], v[240:243]
    v_mfma_f32_16x16x32_bf16 v[220:223], v[124:127], v[32:35], v[220:223]
    v_mfma_f32_16x16x32_bf16 v[224:227], v[128:131], v[32:35], v[224:227]
    v_mfma_f32_16x16x32_bf16 v[228:231], v[132:135], v[32:35], v[228:231]
    v_mfma_f32_16x16x32_bf16 v[232:235], v[124:127], v[36:39], v[232:235]
    v_mfma_f32_16x16x32_bf16 v[236:239], v[128:131], v[36:39], v[236:239]
    v_mfma_f32_16x16x32_bf16 v[240:243], v[132:135], v[36:39], v[240:243]
    v_mfma_f32_16x16x32_bf16 v[220:223], v[136:139], v[40:43], v[220:223]
    v_mfma_f32_16x16x32_bf16 v[224:227], v[140:143], v[40:43], v[224:227]
    v_mfma_f32_16x16x32_bf16 v[228:231], v[144:147], v[40:43], v[228:231]
    v_mfma_f32_16x16x32_bf16 v[232:235], v[136:139], v[44:47], v[232:235]
    v_mfma_f32_16x16x32_bf16 v[236:239], v[140:143], v[44:47], v[236:239]
    v_mfma_f32_16x16x32_bf16 v[240:243], v[144:147], v[44:47], v[240:243]
    v_mfma_f32_16x16x32_bf16 v[220:223], v[148:151], v[48:51], v[220:223]
    v_mfma_f32_16x16x32_bf16 v[224:227], v[152:155], v[48:51], v[224:227]
    v_mfma_f32_16x16x32_bf16 v[228:231], v[156:159], v[48:51], v[228:231]
    v_mfma_f32_16x16x32_bf16 v[232:235], v[148:151], v[52:55], v[232:235]
    v_mfma_f32_16x16x32_bf16 v[236:239], v[152:155], v[52:55], v[236:239]
    v_mfma_f32_16x16x32_bf16 v[240:243], v[156:159], v[52:55], v[240:243]
    v_mfma_f32_16x16x32_bf16 v[220:223], v[160:163], v[56:59], v[220:223]
    v_mfma_f32_16x16x32_bf16 v[224:227], v[164:167], v[56:59], v[224:227]
    v_mfma_f32_16x16x32_bf16 v[228:231], v[168:171], v[56:59], v[228:231]
    v_mfma_f32_16x16x32_bf16 v[232:235], v[160:163], v[60:63], v[232:235]
    v_mfma_f32_16x16x32_bf16 v[236:239], v[164:167], v[60:63], v[236:239]
    v_mfma_f32_16x16x32_bf16 v[240:243], v[168:171], v[60:63], v[240:243]
    v_mfma_f32_16x16x32_bf16 v[220:223], v[172:175], v[64:67], v[220:223]
    v_mfma_f32_16x16x32_bf16 v[224:227], v[176:179], v[64:67], v[224:227]
    v_mfma_f32_16x16x32_bf16 v[228:231], v[180:183], v[64:67], v[228:231]
    v_mfma_f32_16x16x32_bf16 v[232:235], v[172:175], v[68:71], v[232:235]
    v_mfma_f32_16x16x32_bf16 v[236:239], v[176:179], v[68:71], v[236:239]
    v_mfma_f32_16x16x32_bf16 v[240:243], v[180:183], v[68:71], v[240:243]
    v_mfma_f32_16x16x32_bf16 v[220:223], v[184:187], v[72:75], v[220:223]
    v_mfma_f32_16x16x32_bf16 v[224:227], v[188:191], v[72:75], v[224:227]
    v_mfma_f32_16x16x32_bf16 v[228:231], v[192:195], v[72:75], v[228:231]
    v_mfma_f32_16x16x32_bf16 v[232:235], v[184:187], v[76:79], v[232:235]
    v_mfma_f32_16x16x32_bf16 v[236:239], v[188:191], v[76:79], v[236:239]
    v_mfma_f32_16x16x32_bf16 v[240:243], v[192:195], v[76:79], v[240:243]
    v_mfma_f32_16x16x32_bf16 v[220:223], v[196:199], v[80:83], v[220:223]
    v_mfma_f32_16x16x32_bf16 v[224:227], v[200:203], v[80:83], v[224:227]
    v_mfma_f32_16x16x32_bf16 v[228:231], v[204:207], v[80:83], v[228:231]
    v_mfma_f32_16x16x32_bf16 v[232:235], v[196:199], v[84:87], v[232:235]
    v_mfma_f32_16x16x32_bf16 v[236:239], v[200:203], v[84:87], v[236:239]
    v_mfma_f32_16x16x32_bf16 v[240:243], v[204:207], v[84:87], v[240:243]
    v_mfma_f32_16x16x32_bf16 v[220:223], v[208:211], v[88:91], v[220:223]
    v_mfma_f32_16x16x32_bf16 v[224:227], v[212:215], v[88:91], v[224:227]
    v_mfma_f32_16x16x32_bf16 v[228:231], v[216:219], v[88:91], v[228:231]
    v_mfma_f32_16x16x32_bf16 v[232:235], v[208:211], v[92:95], v[232:235]
    v_mfma_f32_16x16x32_bf16 v[236:239], v[212:215], v[92:95], v[236:239]
    v_mfma_f32_16x16x32_bf16 v[240:243], v[216:219], v[92:95], v[240:243]
    s_mul_i32 s19, s10, 6144
    v_add_u32 v7, s19, v3
    s_nop 0
    ds_write_b128 v7, v[220:223] offset:0
    ds_write_b128 v7, v[224:227] offset:1024
    ds_write_b128 v7, v[228:231] offset:2048
    ds_write_b128 v7, v[232:235] offset:3072
    ds_write_b128 v7, v[236:239] offset:4096
    ds_write_b128 v7, v[240:243] offset:5120
    s_mul_i32 s19, s43, 24576
    s_mul_i32 s3, s42, 3072
    s_add_u32 s19, s19, s3
    v_add_u32 v7, s19, v3
    s_waitcnt lgkmcnt(0)
    s_barrier
    s_cmp_ge_u32 s42, 2
    s_cbranch_scc1 P4_cx
    ds_read_b128 v[16:19], v7 offset:0
    ds_read_b128 v[20:23], v7 offset:1024
    ds_read_b128 v[24:27], v7 offset:2048
    ds_read_b128 v[28:31], v7 offset:6144
    ds_read_b128 v[32:35], v7 offset:7168
    ds_read_b128 v[36:39], v7 offset:8192
    ds_read_b128 v[40:43], v7 offset:12288
    ds_read_b128 v[44:47], v7 offset:13312
    ds_read_b128 v[48:51], v7 offset:14336
    ds_read_b128 v[52:55], v7 offset:18432
    ds_read_b128 v[56:59], v7 offset:19456
    ds_read_b128 v[60:63], v7 offset:20480
    s_waitcnt lgkmcnt(6)
    v_pk_add_f32 v[16:17], v[16:17], v[28:29]
    v_pk_add_f32 v[18:19], v[18:19], v[30:31]
    v_pk_add_f32 v[20:21], v[20:21], v[32:33]
    v_pk_add_f32 v[22:23], v[22:23], v[34:35]
    v_pk_add_f32 v[24:25], v[24:25], v[36:37]
    v_pk_add_f32 v[26:27], v[26:27], v[38:39]
    s_waitcnt lgkmcnt(3)
    v_pk_add_f32 v[16:17], v[16:17], v[40:41]
    v_pk_add_f32 v[18:19], v[18:19], v[42:43]
    v_pk_add_f32 v[20:21], v[20:21], v[44:45]
    v_pk_add_f32 v[22:23], v[22:23], v[46:47]
    v_pk_add_f32 v[24:25], v[24:25], v[48:49]
    v_pk_add_f32 v[26:27], v[26:27], v[50:51]
    s_waitcnt lgkmcnt(0)
    v_pk_add_f32 v[16:17], v[16:17], v[52:53]
    v_pk_add_f32 v[18:19], v[18:19], v[54:55]
    v_pk_add_f32 v[20:21], v[20:21], v[56:57]
    v_pk_add_f32 v[22:23], v[22:23], v[58:59]
    v_pk_add_f32 v[24:25], v[24:25], v[60:61]
    v_pk_add_f32 v[26:27], v[26:27], v[62:63]
    v_cvt_pk_bf16_f32 v220, v16, v17
    v_cvt_pk_bf16_f32 v221, v18, v19
    v_cvt_pk_bf16_f32 v222, v20, v21
    v_cvt_pk_bf16_f32 v223, v22, v23
    v_cvt_pk_bf16_f32 v224, v24, v25
    v_cvt_pk_bf16_f32 v225, v26, v27
    buffer_store_dwordx4 v[220:223], v3, s[28:31], s72 offen sc1
    buffer_store_dwordx2 v[224:225], v14, s[28:31], s72 offen offset:1024 sc1
    s_endpgm
P4_cx:
    s_cmp_lg_u32 s16, 0
    s_cbranch_scc1 P4_done
    s_cmp_lg_u32 s10, 2
    s_cbranch_scc1 P4_done
    v_lshlrev_b32 v8, 7, v2
    v_add_u32 v9, 8192, v8
    v_add_u32 v10, 16384, v8
    v_add_u32 v11, 24576, v8
    s_add_u32 s3, s86, 4
    v_mov_b32 v12, s3
    s_mov_b32 s3, 0x400000
POLL_84:
    buffer_load_dword v16, v8, s[76:79], 0 offen sc1
    buffer_load_dword v17, v9, s[76:79], 0 offen sc1
    buffer_load_dword v18, v10, s[76:79], 0 offen sc1
    buffer_load_dword v19, v11, s[76:79], 0 offen sc1
    s_sub_u32 s3, s3, 1
    s_waitcnt vmcnt(0)
    v_sub_u32 v16, v16, v12
    v_sub_u32 v17, v17, v12
    v_sub_u32 v18, v18, v12
    v_sub_u32 v19, v19, v12
    v_max_u32 v16, v16, v17
    v_max_u32 v16, v16, v18
    v_max_u32 v16, v16, v19
    v_cmp_lt_u32 vcc, 7, v16
    s_nop 0
    s_cbranch_vccz POLLE_85
    s_cmp_eq_u32 s3, 0
    s_cbranch_scc1 POLLE_85
    s_nop 0
    s_branch POLL_84
POLLE_85:
    v_mov_b32 v8, s86
    v_mov_b32 v9, 32768
    s_mov_b64 exec, 1
    buffer_store_dword v8, v9, s[76:79], 0 offen sc1
P4_done:
    s_endpgm
K_exit:
    s_endpgm
code_end:
.section .rodata,"a"
.p2align 7
main_tab:
.long 0x0,0x0,0x0,0xff0000,0x400,0x40300,0x400,0xff0101,0x5,0x600,0x60000,0xff0202,0x405,0x60600,0x60400,0xff0303
.long 0x9,0x10,0x10,0xff0404,0x409,0x40310,0x410,0xff0505,0xe,0x610,0x60010,0xff0606,0x40e,0x60610,0x60410,0xff0707
.long 0x100,0x100,0x10000,0xff0808,0x500,0x40400,0x10400,0xff0909,0x105,0x700,0x70000,0xff0a0a,0x505,0x60700,0x70400,0xff0b0b
.long 0x109,0x110,0x10010,0xff0c0c,0x509,0x40410,0x10410,0xff0d0d,0x10e,0x710,0x70010,0xff0e0e,0x50e,0x60710,0x70410,0xff0f0f
.long 0x200,0x200,0x20000,0xff1010,0x600,0x40500,0x20400,0xff1111,0x205,0x800,0x80000,0xff1212,0x605,0x60800,0x80400,0xff1313
.long 0x209,0x210,0x20010,0xff1414,0x609,0x40510,0x20410,0xff1515,0x20e,0x810,0x80010,0xff1616,0x60e,0x60810,0x80410,0xff1717
.long 0x300,0x300,0x30000,0xff1818,0x700,0x60000,0x30400,0xff1919,0x305,0x900,0x90000,0xff1a1a,0x705,0x60900,0x90400,0xff1b1b
.long 0x309,0x310,0x30010,0xff1c1c,0x709,0x60010,0x30410,0xff1d1d,0x30e,0x910,0x90010,0xff1e1e,0x70e,0x60910,0x90410,0xff1f1f
.long 0x1,0x400,0x40000,0xff2020,0x401,0x60100,0x40400,0xff2121,0x6,0xa00,0xa0000,0xff2222,0x406,0x60a00,0xa0400,0xff2323
.long 0xa,0x410,0x40010,0xff2424,0x40a,0x60110,0x40410,0xff2525,0xf,0xa10,0xa0010,0xff2626,0x40f,0x60a10,0xa0410,0xff2727
.long 0x101,0x500,0x50000,0xff2828,0x501,0x60200,0x50400,0xff2929,0x106,0x20600,0xb0000,0xff2a2a,0x506,0x80600,0xb0400,0xff2b2b
.long 0x10a,0x510,0x50010,0xff2c2c,0x50a,0x60210,0x50410,0xff2d2d,0x10f,0x20610,0xb0010,0xff2e2e,0x50f,0x80610,0xb0410,0xff2f2f
.long 0x201,0x20000,0x100,0xff3030,0x601,0x60300,0x500,0xff3131,0x206,0x20700,0x60100,0xff3232,0x606,0x80700,0x60500,0xff3333
.long 0x20a,0x20010,0x110,0xff3434,0x60a,0x60310,0x510,0xff3535,0x20f,0x20710,0x60110,0xff3636,0x60f,0x80710,0x60510,0xff3737
.long 0x301,0x20100,0x10100,0xff3838,0x701,0x60400,0x10500,0xff3939,0x306,0x20800,0x70100,0xff3a3a,0x706,0x80800,0x70500,0xff3b3b
.long 0x30a,0x20110,0x10110,0xff3c3c,0x70a,0x60410,0x10510,0xff3d3d,0x30f,0x20810,0x70110,0xff3e3e,0x70f,0x80810,0x70510,0xff3f3f
.long 0x2,0x20200,0x20100,0xff4040,0x402,0x60500,0x20500,0xff4141,0x7,0x20900,0x80100,0xff4242,0x407,0x80900,0x80500,0xff4343
.long 0xb,0x20210,0x20110,0xff4444,0x40b,0x60510,0x20510,0xff4545,0x10,0x20910,0x80110,0xff4646,0x410,0x80910,0x80510,0xff4747
.long 0x102,0x20300,0x30100,0xff4848,0x502,0x80000,0x30500,0xff4949,0x107,0x20a00,0x90100,0xff4a4a,0x507,0x80a00,0x90500,0xff4b4b
.long 0x10b,0x20310,0x30110,0xff4c4c,0x50b,0x80010,0x30510,0xff4d4d,0x110,0x20a10,0x90110,0xff4e4e,0x510,0x80a10,0x90510,0xff4f4f
.long 0x202,0x20400,0x40100,0xff5050,0x602,0x80100,0x40500,0xff5151,0x207,0x40600,0xa0100,0xff5252,0x607,0xa0001,0xa0500,0xff5353
.long 0x20b,0x20410,0x40110,0xff5454,0x60b,0x80110,0x40510,0xff5555,0x210,0x40610,0xa0110,0xff5656,0x610,0xa0011,0xa0510,0xff5757
.long 0x302,0x20500,0x50100,0xff5858,0x702,0x80200,0x50500,0xff5959,0x307,0x40700,0xb0100,0xff5a5a,0x707,0xa0201,0xb0500,0xff5b5b
.long 0x30b,0x20510,0x50110,0xff5c5c,0x70b,0x80210,0x50510,0xff5d5d,0x310,0x40710,0xb0110,0xff5e5e,0x710,0xa0211,0xb0510,0xff5f5f
.long 0x3,0x40000,0x200,0xff6060,0x403,0x80300,0x600,0xff6161,0x8,0x40800,0x60200,0xff6262,0x408,0xa0401,0x60600,0xff6363
.long 0xc,0x40010,0x210,0xff6464,0x40c,0x80310,0x610,0xff6565,0x11,0x40810,0x60210,0xff6666,0x411,0xa0411,0x60610,0xff6767
.long 0x103,0x40100,0x10200,0xff6868,0x503,0x80400,0x10600,0xff6969,0x108,0x40900,0x70200,0xff6a6a,0x508,0xa0601,0x70600,0xff6b6b
.long 0x10c,0x40110,0x10210,0xff6c6c,0x50c,0x80410,0x10610,0xff6d6d,0x111,0x40910,0x70210,0xff6e6e,0x511,0xa0611,0x70610,0xff6f6f
.long 0x203,0x40200,0x20200,0xff7070,0x603,0x80500,0x20600,0xff7171,0x208,0x40a00,0x80200,0xff7272,0x608,0xa0801,0x80600,0xff7373
.long 0x20c,0x40210,0x20210,0xff7474,0x60c,0x80510,0x20610,0xff7575,0x211,0x40a10,0x80210,0xff7676,0x611,0xa0811,0x80610,0xff7777
.long 0x303,0x3,0x90801,0xff7878,0x703,0x10003,0xb0811,0xff7979,0x308,0x20003,0xa0801,0xff7a7a,0x708,0xa0a02,0xf,0xff7b7b
.long 0x30c,0x30003,0xb0801,0xff7c7c,0x70c,0x40003,0xc0811,0xff7d7d,0x311,0x50003,0xc0801,0xff7e7e,0x711,0xa0a12,0xf,0xff7f7f
.long 0x4,0x60003,0xd0801,0x80ff,0x404,0x70003,0xd0811,0x181ff,0x204,0x80003,0xe0801,0x282ff,0x604,0x90003,0xe0811,0x383ff
.long 0xd,0xa0003,0xf0801,0x484ff,0x40d,0xb0003,0xf0811,0x585ff,0x20d,0xc0003,0x100801,0x686ff,0x60d,0xd0003,0x100811,0x787ff
.long 0x104,0xe0003,0x110801,0x888ff,0x504,0xf0003,0x110811,0x989ff,0x304,0x100003,0x811,0xa8aff,0x704,0x110003,0xf,0xb8bff
.long 0x10d,0x114,0xf,0xc8cff,0x50d,0xf,0x90811,0xd8dff,0x30d,0xf,0x80801,0xe8eff,0x70d,0xf,0xa0811,0xf8fff
.long 0x10012,0xf,0x30200,0x1090ff,0x40412,0xf,0x30600,0x1191ff,0x70014,0xf,0x90200,0x1292ff,0x1c0414,0xf,0x90600,0x1393ff
.long 0x1f0016,0xf,0x30210,0x1494ff,0x220416,0xf,0x30610,0x1595ff,0x370018,0xf,0x90210,0x1696ff,0x3a0418,0xf,0x90610,0x1797ff
.long 0x20112,0xf,0x40200,0x1898ff,0x50512,0xf,0x40600,0x1999ff,0x80114,0xf,0xa0200,0x1a9aff,0x1d0514,0xf,0xa0600,0x1b9bff
.long 0x200116,0xf,0x40210,0x1c9cff,0x230516,0xf,0x40610,0x1d9dff,0x380118,0xf,0xa0210,0x1e9eff,0x3b0518,0xf,0xa0610,0x1f9fff
.long 0x30212,0xf,0x50200,0x20a0ff,0x60612,0xf,0x50600,0x21a1ff,0x90214,0xf,0xb0200,0x22a2ff,0x1e0614,0xf,0xb0600,0x23a3ff
.long 0x210216,0xf,0x50210,0x24a4ff,0x240616,0xf,0x50610,0x25a5ff,0x390218,0xf,0xb0210,0x26a6ff,0x3c0618,0xf,0xb0610,0x27a7ff
.long 0xa0312,0xf,0x300,0x28a8ff,0xd0712,0xf,0x700,0x29a9ff,0x100314,0xf,0x60300,0x2aaaff,0x250714,0xf,0x60700,0x2babff
.long 0x280316,0xf,0x310,0x2cacff,0x2b0716,0xf,0x710,0x2dadff,0x400318,0xf,0x60310,0x2eaeff,0x430718,0xf,0x60710,0x2fafff
.long 0xb0013,0xf,0x10300,0x30b0ff,0xe0413,0xf,0x10700,0x31b1ff,0x110015,0xf,0x70300,0x32b2ff,0x260415,0xf,0x70700,0x33b3ff
.long 0x290017,0xf,0x10310,0x34b4ff,0x2c0417,0xf,0x10710,0x35b5ff,0x410019,0xf,0x70310,0x36b6ff,0x440419,0xf,0x70710,0x37b7ff
.long 0xc0113,0xf,0x20300,0x38b8ff,0xf0513,0xf,0x20700,0x39b9ff,0x120115,0xf,0x80300,0x3abaff,0x270515,0xf,0x80700,0x3bbbff
.long 0x2a0117,0xf,0x20310,0x3cbcff,0x2d0517,0xf,0x20710,0x3dbdff,0x420119,0xf,0x80310,0x3ebeff,0x450519,0xf,0x80710,0x3fbfff
.long 0x130213,0xf,0x30300,0x40c0ff,0x160613,0xf,0x30700,0x41c1ff,0x190215,0xf,0x90300,0x42c2ff,0x2e0615,0xf,0x90700,0x43c3ff
.long 0x310217,0xf,0x30310,0x44c4ff,0x340617,0xf,0x30710,0x45c5ff,0x490219,0xf,0x90310,0x46c6ff,0x4c0619,0xf,0x90710,0x47c7ff
.long 0x140313,0xf,0x40300,0x48c8ff,0x170713,0xf,0x40700,0x49c9ff,0x1a0315,0xf,0xa0300,0x4acaff,0x2f0715,0xf,0xa0700,0x4bcbff
.long 0x320317,0xf,0x40310,0x4cccff,0x350717,0xf,0x40710,0x4dcdff,0x4a0319,0xf,0xa0310,0x4eceff,0x4d0719,0xf,0xa0710,0x4fcfff
.long 0x15001a,0xf,0x50300,0x50d0ff,0x18041a,0xf,0x50700,0x51d1ff,0x1b011a,0xf,0xb0300,0x52d2ff,0x30051a,0xf,0xb0700,0x53d3ff
.long 0x33021a,0xf,0x50310,0x54d4ff,0x36061a,0xf,0x50710,0x55d5ff,0x4b031a,0xf,0xb0310,0x56d6ff,0x4e071a,0xf,0xb0710,0x57d7ff
.long 0x5e000800,0xf,0x801,0x58ffff,0x5f000801,0xf,0x10811,0x59ffff,0x806,0x4,0x10002,0x5affff,0x807,0x404,0x50002,0x5bffff
.long 0x808,0x804,0x90002,0x5cffff,0x809,0x214,0xd0002,0x5dffff,0x80a,0x514,0x110002,0x5effff,0x80b,0x814,0x150002,0x5fffff
.long 0x60000802,0xf,0x10801,0x60ffff,0x61000803,0xf,0x20811,0x61ffff,0x80c,0x104,0x2,0x62ffff,0x80d,0x504,0x40002,0x63ffff
.long 0x80e,0x904,0x80002,0x64ffff,0x80f,0x314,0xc0002,0x65ffff,0x810,0x614,0x100002,0x66ffff,0x811,0x914,0x140002,0x67ffff
.long 0x62000804,0xf,0x20801,0x68ffff,0x63000805,0xf,0x30811,0x69ffff,0x812,0x204,0x30002,0x6affff,0x813,0x604,0x70002,0x6bffff
.long 0x814,0xa04,0xb0002,0x6cffff,0x815,0x414,0xf0002,0x6dffff,0x816,0x714,0x130002,0x6effff,0x817,0xa14,0x170002,0x6fffff
.long 0xc9000903,0xf,0x30801,0x70ff83,0x8c3d0904,0xf,0x40811,0x71ffff,0x818,0x304,0x20002,0x72ffff,0x819,0x704,0x60002,0x73ffff
.long 0x81a,0x14,0xa0002,0x74ffff,0xc0000900,0xf,0xe0002,0x75ff80,0xc3000901,0xf,0x120002,0x76ff81,0xc6000902,0xf,0x160002,0x77ff82
.long 0x8e3e0905,0xf,0x40801,0x78ffff,0x903f0906,0xf,0x50811,0x79ffff,0x92460907,0xf,0x50801,0x7affff,0x94470908,0xf,0x60811,0x7bffff
.long 0x96480909,0xf,0x60801,0x7cffff,0x984f090a,0xf,0x70811,0x7dffff,0x9a50090b,0xf,0x70801,0x7effff,0x9c51090c,0xf,0x80811,0x7fffff
.p2align 7
dep_tab:
.long 0x2010200,0x2030202,0x2050204,0x2070206,0x2090208,0x20b020a,0x20d020c,0x20f020e,0x2000200,0x2000200,0x2000200,0x2000200,0x2000200,0x2000200,0x2000200,0x2000200
.long 0x2000200,0x2000200,0x2000200,0x2000200,0x2000200,0x2000200,0x2000200,0x2000200,0x2000200,0x2000200,0x2000200,0x2000200,0x2000200,0x2000200,0x2000200,0x2000200
.long 0x4240404,0x4640444,0x4060484,0x4460426,0x4000466,0x4400420,0x4800460,0x4220402,0x4620442,0x4040404,0x4040404,0x4040404,0x4040404,0x4040404,0x4040404,0x4040404
.long 0x4040404,0x4040404,0x4040404,0x4040404,0x4040404,0x4040404,0x4040404,0x4040404,0x4040404,0x4040404,0x4040404,0x4040404,0x4040404,0x4040404,0x4040404,0x4040404
.long 0x6020600,0x60a0608,0x6120610,0x61a0618,0x6220620,0x4900628,0x4a00498,0x67804a8,0x4f50679,0x6000600,0x6000600,0x6000600,0x6000600,0x6000600,0x6000600,0x6000600
.long 0x6000600,0x6000600,0x6000600,0x6000600,0x6000600,0x6000600,0x6000600,0x6000600,0x6000600,0x6000600,0x6000600,0x6000600,0x6000600,0x6000600,0x6000600,0x6000600
.long 0x2410240,0x2430242,0x2450244,0x2470246,0x2490248,0x24b024a,0x24d024c,0x24f024e,0x2400240,0x2400240,0x2400240,0x2400240,0x2400240,0x2400240,0x2400240,0x2400240
.long 0x2400240,0x2400240,0x2400240,0x2400240,0x2400240,0x2400240,0x2400240,0x2400240,0x2400240,0x2400240,0x2400240,0x2400240,0x2400240,0x2400240,0x2400240,0x2400240
.long 0x42c040c,0x46c044c,0x40e048c,0x44e042e,0x408046e,0x4480428,0x4880468,0x42a040a,0x46a044a,0x4300410,0x4700450,0x4120482,0x4520432,0x40c0472,0x40c040c,0x40c040c
.long 0x40c040c,0x40c040c,0x40c040c,0x40c040c,0x40c040c,0x40c040c,0x40c040c,0x40c040c,0x40c040c,0x40c040c,0x40c040c,0x40c040c,0x40c040c,0x40c040c,0x40c040c,0x40c040c
.long 0x6030601,0x60b0609,0x6130611,0x61b0619,0x6230621,0x6310629,0x6410639,0x65a0652,0x6620660,0x66a0668,0x6720670,0x4980490,0x4a804a0,0x6790678,0x60104f5,0x6010601
.long 0x6010601,0x6010601,0x6010601,0x6010601,0x6010601,0x6010601,0x6010601,0x6010601,0x6010601,0x6010601,0x6010601,0x6010601,0x6010601,0x6010601,0x6010601,0x6010601
.long 0x2010200,0x2030202,0x2050204,0x2070206,0x2090208,0x20b020a,0x20d020c,0x20f020e,0x2000200,0x2000200,0x2000200,0x2000200,0x2000200,0x2000200,0x2000200,0x2000200
.long 0x2000200,0x2000200,0x2000200,0x2000200,0x2000200,0x2000200,0x2000200,0x2000200,0x2000200,0x2000200,0x2000200,0x2000200,0x2000200,0x2000200,0x2000200,0x2000200
.long 0x4340414,0x4740454,0x4160486,0x4560436,0x4000476,0x4400420,0x4800460,0x4220402,0x4620442,0x4140414,0x4140414,0x4140414,0x4140414,0x4140414,0x4140414,0x4140414
.long 0x4140414,0x4140414,0x4140414,0x4140414,0x4140414,0x4140414,0x4140414,0x4140414,0x4140414,0x4140414,0x4140414,0x4140414,0x4140414,0x4140414,0x4140414,0x4140414
.long 0x6020600,0x60a0608,0x6120610,0x61a0618,0x6220620,0x4940628,0x49c04b4,0x4a404bc,0x4ac04c4,0x68304cc,0x4f00684,0x6000600,0x6000600,0x6000600,0x6000600,0x6000600
.long 0x6000600,0x6000600,0x6000600,0x6000600,0x6000600,0x6000600,0x6000600,0x6000600,0x6000600,0x6000600,0x6000600,0x6000600,0x6000600,0x6000600,0x6000600,0x6000600
.long 0x2410240,0x2430242,0x2450244,0x2470246,0x2490248,0x24b024a,0x24d024c,0x24f024e,0x2400240,0x2400240,0x2400240,0x2400240,0x2400240,0x2400240,0x2400240,0x2400240
.long 0x2400240,0x2400240,0x2400240,0x2400240,0x2400240,0x2400240,0x2400240,0x2400240,0x2400240,0x2400240,0x2400240,0x2400240,0x2400240,0x2400240,0x2400240,0x2400240
.long 0x4340414,0x4740454,0x4160486,0x4560436,0x4100476,0x4500430,0x4820470,0x4320412,0x4720452,0x4140414,0x4140414,0x4140414,0x4140414,0x4140414,0x4140414,0x4140414
.long 0x4140414,0x4140414,0x4140414,0x4140414,0x4140414,0x4140414,0x4140414,0x4140414,0x4140414,0x4140414,0x4140414,0x4140414,0x4140414,0x4140414,0x4140414,0x4140414
.long 0x6030601,0x60b0609,0x6130611,0x61b0619,0x6230621,0x6310629,0x6410639,0x65a0652,0x6620660,0x66a0668,0x6720670,0x4b40494,0x4bc049c,0x4c404a4,0x4cc04ac,0x6840683
.long 0x60104f0,0x6010601,0x6010601,0x6010601,0x6010601,0x6010601,0x6010601,0x6010601,0x6010601,0x6010601,0x6010601,0x6010601,0x6010601,0x6010601,0x6010601,0x6010601
.long 0x2010200,0x2030202,0x2050204,0x2070206,0x2090208,0x20b020a,0x20d020c,0x20f020e,0x2000200,0x2000200,0x2000200,0x2000200,0x2000200,0x2000200,0x2000200,0x2000200
.long 0x2000200,0x2000200,0x2000200,0x2000200,0x2000200,0x2000200,0x2000200,0x2000200,0x2000200,0x2000200,0x2000200,0x2000200,0x2000200,0x2000200,0x2000200,0x2000200
.long 0x4250405,0x4650445,0x4070485,0x4470427,0x4010467,0x4410421,0x4810461,0x4230403,0x4630443,0x4050405,0x4050405,0x4050405,0x4050405,0x4050405,0x4050405,0x4050405
.long 0x4050405,0x4050405,0x4050405,0x4050405,0x4050405,0x4050405,0x4050405,0x4050405,0x4050405,0x4050405,0x4050405,0x4050405,0x4050405,0x4050405,0x4050405,0x4050405
.long 0x6060604,0x60e060c,0x6160614,0x61e061c,0x6260624,0x491062c,0x4a10499,0x67804a9,0x4f50679,0x6040604,0x6040604,0x6040604,0x6040604,0x6040604,0x6040604,0x6040604
.long 0x6040604,0x6040604,0x6040604,0x6040604,0x6040604,0x6040604,0x6040604,0x6040604,0x6040604,0x6040604,0x6040604,0x6040604,0x6040604,0x6040604,0x6040604,0x6040604
.long 0x2410240,0x2430242,0x2450244,0x2470246,0x2490248,0x24b024a,0x24d024c,0x24f024e,0x2400240,0x2400240,0x2400240,0x2400240,0x2400240,0x2400240,0x2400240,0x2400240
.long 0x2400240,0x2400240,0x2400240,0x2400240,0x2400240,0x2400240,0x2400240,0x2400240,0x2400240,0x2400240,0x2400240,0x2400240,0x2400240,0x2400240,0x2400240,0x2400240
.long 0x42d040d,0x46d044d,0x40f048d,0x44f042f,0x409046f,0x4490429,0x4890469,0x42b040b,0x46b044b,0x4310411,0x4710451,0x4130483,0x4530433,0x40d0473,0x40d040d,0x40d040d
.long 0x40d040d,0x40d040d,0x40d040d,0x40d040d,0x40d040d,0x40d040d,0x40d040d,0x40d040d,0x40d040d,0x40d040d,0x40d040d,0x40d040d,0x40d040d,0x40d040d,0x40d040d,0x40d040d
.long 0x6070605,0x60f060d,0x6170615,0x61f061d,0x6270625,0x635062d,0x645063d,0x65e0656,0x6660664,0x66e066c,0x6760674,0x4990491,0x4a904a1,0x6790678,0x60504f5,0x6050605
.long 0x6050605,0x6050605,0x6050605,0x6050605,0x6050605,0x6050605,0x6050605,0x6050605,0x6050605,0x6050605,0x6050605,0x6050605,0x6050605,0x6050605,0x6050605,0x6050605
.long 0x2010200,0x2030202,0x2050204,0x2070206,0x2090208,0x20b020a,0x20d020c,0x20f020e,0x2000200,0x2000200,0x2000200,0x2000200,0x2000200,0x2000200,0x2000200,0x2000200
.long 0x2000200,0x2000200,0x2000200,0x2000200,0x2000200,0x2000200,0x2000200,0x2000200,0x2000200,0x2000200,0x2000200,0x2000200,0x2000200,0x2000200,0x2000200,0x2000200
.long 0x4350415,0x4750455,0x4170487,0x4570437,0x4010477,0x4410421,0x4810461,0x4230403,0x4630443,0x4150415,0x4150415,0x4150415,0x4150415,0x4150415,0x4150415,0x4150415
.long 0x4150415,0x4150415,0x4150415,0x4150415,0x4150415,0x4150415,0x4150415,0x4150415,0x4150415,0x4150415,0x4150415,0x4150415,0x4150415,0x4150415,0x4150415,0x4150415
.long 0x6060604,0x60e060c,0x6160614,0x61e061c,0x6260624,0x495062c,0x49d04b5,0x4a504bd,0x4ad04c5,0x68304cd,0x4f00684,0x6040604,0x6040604,0x6040604,0x6040604,0x6040604
.long 0x6040604,0x6040604,0x6040604,0x6040604,0x6040604,0x6040604,0x6040604,0x6040604,0x6040604,0x6040604,0x6040604,0x6040604,0x6040604,0x6040604,0x6040604,0x6040604
.long 0x2410240,0x2430242,0x2450244,0x2470246,0x2490248,0x24b024a,0x24d024c,0x24f024e,0x2400240,0x2400240,0x2400240,0x2400240,0x2400240,0x2400240,0x2400240,0x2400240
.long 0x2400240,0x2400240,0x2400240,0x2400240,0x2400240,0x2400240,0x2400240,0x2400240,0x2400240,0x2400240,0x2400240,0x2400240,0x2400240,0x2400240,0x2400240,0x2400240
.long 0x4350415,0x4750455,0x4170487,0x4570437,0x4110477,0x4510431,0x4830471,0x4330413,0x4730453,0x4150415,0x4150415,0x4150415,0x4150415,0x4150415,0x4150415,0x4150415
.long 0x4150415,0x4150415,0x4150415,0x4150415,0x4150415,0x4150415,0x4150415,0x4150415,0x4150415,0x4150415,0x4150415,0x4150415,0x4150415,0x4150415,0x4150415,0x4150415
.long 0x6070605,0x60f060d,0x6170615,0x61f061d,0x6270625,0x635062d,0x645063d,0x65e0656,0x6660664,0x66e066c,0x6760674,0x4b50495,0x4bd049d,0x4c504a5,0x4cd04ad,0x6840683
.long 0x60504f0,0x6050605,0x6050605,0x6050605,0x6050605,0x6050605,0x6050605,0x6050605,0x6050605,0x6050605,0x6050605,0x6050605,0x6050605,0x6050605,0x6050605,0x6050605
.long 0x2110210,0x2130212,0x2150214,0x2170216,0x2190218,0x21b021a,0x21d021c,0x21f021e,0x2100210,0x2100210,0x2100210,0x2100210,0x2100210,0x2100210,0x2100210,0x2100210
.long 0x2100210,0x2100210,0x2100210,0x2100210,0x2100210,0x2100210,0x2100210,0x2100210,0x2100210,0x2100210,0x2100210,0x2100210,0x2100210,0x2100210,0x2100210,0x2100210
.long 0x4240404,0x4640444,0x4060484,0x4460426,0x4000466,0x4400420,0x4800460,0x4220402,0x4620442,0x4040404,0x4040404,0x4040404,0x4040404,0x4040404,0x4040404,0x4040404
.long 0x4040404,0x4040404,0x4040404,0x4040404,0x4040404,0x4040404,0x4040404,0x4040404,0x4040404,0x4040404,0x4040404,0x4040404,0x4040404,0x4040404,0x4040404,0x4040404
.long 0x6020600,0x60a0608,0x6120610,0x61a0618,0x6220620,0x4900628,0x49804b0,0x4a004b8,0x4a804c0,0x67904c8,0x4f5067a,0x6000600,0x6000600,0x6000600,0x6000600,0x6000600
.long 0x6000600,0x6000600,0x6000600,0x6000600,0x6000600,0x6000600,0x6000600,0x6000600,0x6000600,0x6000600,0x6000600,0x6000600,0x6000600,0x6000600,0x6000600,0x6000600
.long 0x2510250,0x2530252,0x2550254,0x2570256,0x2590258,0x25b025a,0x25d025c,0x25f025e,0x2500250,0x2500250,0x2500250,0x2500250,0x2500250,0x2500250,0x2500250,0x2500250
.long 0x2500250,0x2500250,0x2500250,0x2500250,0x2500250,0x2500250,0x2500250,0x2500250,0x2500250,0x2500250,0x2500250,0x2500250,0x2500250,0x2500250,0x2500250,0x2500250
.long 0x42c040c,0x46c044c,0x40e048c,0x44e042e,0x408046e,0x4480428,0x4880468,0x42a040a,0x46a044a,0x4300410,0x4700450,0x4120482,0x4520432,0x40c0472,0x40c040c,0x40c040c
.long 0x40c040c,0x40c040c,0x40c040c,0x40c040c,0x40c040c,0x40c040c,0x40c040c,0x40c040c,0x40c040c,0x40c040c,0x40c040c,0x40c040c,0x40c040c,0x40c040c,0x40c040c,0x40c040c
.long 0x6030601,0x60b0609,0x6130611,0x61b0619,0x6230621,0x6310629,0x6410639,0x65a0652,0x6620660,0x66a0668,0x6720670,0x4b00490,0x4b80498,0x4c004a0,0x4c804a8,0x67a0679
.long 0x60104f5,0x6010601,0x6010601,0x6010601,0x6010601,0x6010601,0x6010601,0x6010601,0x6010601,0x6010601,0x6010601,0x6010601,0x6010601,0x6010601,0x6010601,0x6010601
.long 0x2110210,0x2130212,0x2150214,0x2170216,0x2190218,0x21b021a,0x21d021c,0x21f021e,0x2100210,0x2100210,0x2100210,0x2100210,0x2100210,0x2100210,0x2100210,0x2100210
.long 0x2100210,0x2100210,0x2100210,0x2100210,0x2100210,0x2100210,0x2100210,0x2100210,0x2100210,0x2100210,0x2100210,0x2100210,0x2100210,0x2100210,0x2100210,0x2100210
.long 0x4340414,0x4740454,0x4160486,0x4560436,0x4000476,0x4400420,0x4800460,0x4220402,0x4620442,0x4140414,0x4140414,0x4140414,0x4140414,0x4140414,0x4140414,0x4140414
.long 0x4140414,0x4140414,0x4140414,0x4140414,0x4140414,0x4140414,0x4140414,0x4140414,0x4140414,0x4140414,0x4140414,0x4140414,0x4140414,0x4140414,0x4140414,0x4140414
.long 0x6020600,0x60a0608,0x6120610,0x61a0618,0x6220620,0x4b40628,0x4c404bc,0x68404cc,0x4f00685,0x6000600,0x6000600,0x6000600,0x6000600,0x6000600,0x6000600,0x6000600
.long 0x6000600,0x6000600,0x6000600,0x6000600,0x6000600,0x6000600,0x6000600,0x6000600,0x6000600,0x6000600,0x6000600,0x6000600,0x6000600,0x6000600,0x6000600,0x6000600
.long 0x2510250,0x2530252,0x2550254,0x2570256,0x2590258,0x25b025a,0x25d025c,0x25f025e,0x2500250,0x2500250,0x2500250,0x2500250,0x2500250,0x2500250,0x2500250,0x2500250
.long 0x2500250,0x2500250,0x2500250,0x2500250,0x2500250,0x2500250,0x2500250,0x2500250,0x2500250,0x2500250,0x2500250,0x2500250,0x2500250,0x2500250,0x2500250,0x2500250
.long 0x4340414,0x4740454,0x4160486,0x4560436,0x4100476,0x4500430,0x4820470,0x4320412,0x4720452,0x4140414,0x4140414,0x4140414,0x4140414,0x4140414,0x4140414,0x4140414
.long 0x4140414,0x4140414,0x4140414,0x4140414,0x4140414,0x4140414,0x4140414,0x4140414,0x4140414,0x4140414,0x4140414,0x4140414,0x4140414,0x4140414,0x4140414,0x4140414
.long 0x6030601,0x60b0609,0x6130611,0x61b0619,0x6230621,0x6310629,0x6410639,0x65a0652,0x6620660,0x66a0668,0x6720670,0x4bc04b4,0x4cc04c4,0x6850684,0x60104f0,0x6010601
.long 0x6010601,0x6010601,0x6010601,0x6010601,0x6010601,0x6010601,0x6010601,0x6010601,0x6010601,0x6010601,0x6010601,0x6010601,0x6010601,0x6010601,0x6010601,0x6010601
.long 0x2110210,0x2130212,0x2150214,0x2170216,0x2190218,0x21b021a,0x21d021c,0x21f021e,0x2100210,0x2100210,0x2100210,0x2100210,0x2100210,0x2100210,0x2100210,0x2100210
.long 0x2100210,0x2100210,0x2100210,0x2100210,0x2100210,0x2100210,0x2100210,0x2100210,0x2100210,0x2100210,0x2100210,0x2100210,0x2100210,0x2100210,0x2100210,0x2100210
.long 0x4250405,0x4650445,0x4070485,0x4470427,0x4010467,0x4410421,0x4810461,0x4230403,0x4630443,0x4050405,0x4050405,0x4050405,0x4050405,0x4050405,0x4050405,0x4050405
.long 0x4050405,0x4050405,0x4050405,0x4050405,0x4050405,0x4050405,0x4050405,0x4050405,0x4050405,0x4050405,0x4050405,0x4050405,0x4050405,0x4050405,0x4050405,0x4050405
.long 0x6060604,0x60e060c,0x6160614,0x61e061c,0x6260624,0x491062c,0x49904b1,0x4a104b9,0x4a904c1,0x67904c9,0x4f5067a,0x6040604,0x6040604,0x6040604,0x6040604,0x6040604
.long 0x6040604,0x6040604,0x6040604,0x6040604,0x6040604,0x6040604,0x6040604,0x6040604,0x6040604,0x6040604,0x6040604,0x6040604,0x6040604,0x6040604,0x6040604,0x6040604
.long 0x2510250,0x2530252,0x2550254,0x2570256,0x2590258,0x25b025a,0x25d025c,0x25f025e,0x2500250,0x2500250,0x2500250,0x2500250,0x2500250,0x2500250,0x2500250,0x2500250
.long 0x2500250,0x2500250,0x2500250,0x2500250,0x2500250,0x2500250,0x2500250,0x2500250,0x2500250,0x2500250,0x2500250,0x2500250,0x2500250,0x2500250,0x2500250,0x2500250
.long 0x42d040d,0x46d044d,0x40f048d,0x44f042f,0x409046f,0x4490429,0x4890469,0x42b040b,0x46b044b,0x4310411,0x4710451,0x4130483,0x4530433,0x40d0473,0x40d040d,0x40d040d
.long 0x40d040d,0x40d040d,0x40d040d,0x40d040d,0x40d040d,0x40d040d,0x40d040d,0x40d040d,0x40d040d,0x40d040d,0x40d040d,0x40d040d,0x40d040d,0x40d040d,0x40d040d,0x40d040d
.long 0x6070605,0x60f060d,0x6170615,0x61f061d,0x6270625,0x635062d,0x645063d,0x65e0656,0x6660664,0x66e066c,0x6760674,0x4b10491,0x4b90499,0x4c104a1,0x4c904a9,0x67a0679
.long 0x60504f5,0x6050605,0x6050605,0x6050605,0x6050605,0x6050605,0x6050605,0x6050605,0x6050605,0x6050605,0x6050605,0x6050605,0x6050605,0x6050605,0x6050605,0x6050605
.long 0x2110210,0x2130212,0x2150214,0x2170216,0x2190218,0x21b021a,0x21d021c,0x21f021e,0x2100210,0x2100210,0x2100210,0x2100210,0x2100210,0x2100210,0x2100210,0x2100210
.long 0x2100210,0x2100210,0x2100210,0x2100210,0x2100210,0x2100210,0x2100210,0x2100210,0x2100210,0x2100210,0x2100210,0x2100210,0x2100210,0x2100210,0x2100210,0x2100210
.long 0x4350415,0x4750455,0x4170487,0x4570437,0x4010477,0x4410421,0x4810461,0x4230403,0x4630443,0x4150415,0x4150415,0x4150415,0x4150415,0x4150415,0x4150415,0x4150415
.long 0x4150415,0x4150415,0x4150415,0x4150415,0x4150415,0x4150415,0x4150415,0x4150415,0x4150415,0x4150415,0x4150415,0x4150415,0x4150415,0x4150415,0x4150415,0x4150415
.long 0x6060604,0x60e060c,0x6160614,0x61e061c,0x6260624,0x4b5062c,0x4c504bd,0x68404cd,0x4f00685,0x6040604,0x6040604,0x6040604,0x6040604,0x6040604,0x6040604,0x6040604
.long 0x6040604,0x6040604,0x6040604,0x6040604,0x6040604,0x6040604,0x6040604,0x6040604,0x6040604,0x6040604,0x6040604,0x6040604,0x6040604,0x6040604,0x6040604,0x6040604
.long 0x2510250,0x2530252,0x2550254,0x2570256,0x2590258,0x25b025a,0x25d025c,0x25f025e,0x2500250,0x2500250,0x2500250,0x2500250,0x2500250,0x2500250,0x2500250,0x2500250
.long 0x2500250,0x2500250,0x2500250,0x2500250,0x2500250,0x2500250,0x2500250,0x2500250,0x2500250,0x2500250,0x2500250,0x2500250,0x2500250,0x2500250,0x2500250,0x2500250
.long 0x4350415,0x4750455,0x4170487,0x4570437,0x4110477,0x4510431,0x4830471,0x4330413,0x4730453,0x4150415,0x4150415,0x4150415,0x4150415,0x4150415,0x4150415,0x4150415
.long 0x4150415,0x4150415,0x4150415,0x4150415,0x4150415,0x4150415,0x4150415,0x4150415,0x4150415,0x4150415,0x4150415,0x4150415,0x4150415,0x4150415,0x4150415,0x4150415
.long 0x6070605,0x60f060d,0x6170615,0x61f061d,0x6270625,0x635062d,0x645063d,0x65e0656,0x6660664,0x66e066c,0x6760674,0x4bd04b5,0x4cd04c5,0x6850684,0x60504f0,0x6050605
.long 0x6050605,0x6050605,0x6050605,0x6050605,0x6050605,0x6050605,0x6050605,0x6050605,0x6050605,0x6050605,0x6050605,0x6050605,0x6050605,0x6050605,0x6050605,0x6050605
.long 0x2210220,0x2230222,0x2250224,0x2270226,0x2290228,0x22b022a,0x22d022c,0x22f022e,0x2200220,0x2200220,0x2200220,0x2200220,0x2200220,0x2200220,0x2200220,0x2200220
.long 0x2200220,0x2200220,0x2200220,0x2200220,0x2200220,0x2200220,0x2200220,0x2200220,0x2200220,0x2200220,0x2200220,0x2200220,0x2200220,0x2200220,0x2200220,0x2200220
.long 0x4240404,0x4640444,0x4060484,0x4460426,0x40c0466,0x44c042c,0x48c046c,0x42e040e,0x46e044e,0x4200400,0x4600440,0x4020480,0x4420422,0x4040462,0x4040404,0x4040404
.long 0x4040404,0x4040404,0x4040404,0x4040404,0x4040404,0x4040404,0x4040404,0x4040404,0x4040404,0x4040404,0x4040404,0x4040404,0x4040404,0x4040404,0x4040404,0x4040404
.long 0x6020600,0x60a0608,0x6120610,0x61a0618,0x6220620,0x4b00628,0x4b80492,0x4c0049a,0x4c804a2,0x67c04aa,0x4f6067d,0x6000600,0x6000600,0x6000600,0x6000600,0x6000600
.long 0x6000600,0x6000600,0x6000600,0x6000600,0x6000600,0x6000600,0x6000600,0x6000600,0x6000600,0x6000600,0x6000600,0x6000600,0x6000600,0x6000600,0x6000600,0x6000600
.long 0x2610260,0x2630262,0x2650264,0x2670266,0x2690268,0x26b026a,0x26d026c,0x26f026e,0x2600260,0x2600260,0x2600260,0x2600260,0x2600260,0x2600260,0x2600260,0x2600260
.long 0x2600260,0x2600260,0x2600260,0x2600260,0x2600260,0x2600260,0x2600260,0x2600260,0x2600260,0x2600260,0x2600260,0x2600260,0x2600260,0x2600260,0x2600260,0x2600260
.long 0x42c040c,0x46c044c,0x40e048c,0x44e042e,0x414046e,0x4540434,0x4860474,0x4360416,0x4760456,0x4280408,0x4680448,0x40a0488,0x44a042a,0x410046a,0x4500430,0x4820470
.long 0x4320412,0x4720452,0x40c040c,0x40c040c,0x40c040c,0x40c040c,0x40c040c,0x40c040c,0x40c040c,0x40c040c,0x40c040c,0x40c040c,0x40c040c,0x40c040c,0x40c040c,0x40c040c
.long 0x6030601,0x60b0609,0x6130611,0x61b0619,0x6230621,0x6310629,0x6410639,0x65a0652,0x6620660,0x66a0668,0x6720670,0x49204b0,0x49a04b8,0x4a204c0,0x4aa04c8,0x67d067c
.long 0x60104f6,0x6010601,0x6010601,0x6010601,0x6010601,0x6010601,0x6010601,0x6010601,0x6010601,0x6010601,0x6010601,0x6010601,0x6010601,0x6010601,0x6010601,0x6010601
.long 0x2210220,0x2230222,0x2250224,0x2270226,0x2290228,0x22b022a,0x22d022c,0x22f022e,0x2200220,0x2200220,0x2200220,0x2200220,0x2200220,0x2200220,0x2200220,0x2200220
.long 0x2200220,0x2200220,0x2200220,0x2200220,0x2200220,0x2200220,0x2200220,0x2200220,0x2200220,0x2200220,0x2200220,0x2200220,0x2200220,0x2200220,0x2200220,0x2200220
.long 0x43c041c,0x47c045c,0x41e048e,0x45e043e,0x400047e,0x4400420,0x4800460,0x4220402,0x4620442,0x41c041c,0x41c041c,0x41c041c,0x41c041c,0x41c041c,0x41c041c,0x41c041c
.long 0x41c041c,0x41c041c,0x41c041c,0x41c041c,0x41c041c,0x41c041c,0x41c041c,0x41c041c,0x41c041c,0x41c041c,0x41c041c,0x41c041c,0x41c041c,0x41c041c,0x41c041c,0x41c041c
.long 0x6020600,0x60a0608,0x6120610,0x61a0618,0x6220620,0x4960628,0x4a6049e,0x68604ae,0x4f10687,0x6000600,0x6000600,0x6000600,0x6000600,0x6000600,0x6000600,0x6000600
.long 0x6000600,0x6000600,0x6000600,0x6000600,0x6000600,0x6000600,0x6000600,0x6000600,0x6000600,0x6000600,0x6000600,0x6000600,0x6000600,0x6000600,0x6000600,0x6000600
.long 0x2610260,0x2630262,0x2650264,0x2670266,0x2690268,0x26b026a,0x26d026c,0x26f026e,0x2600260,0x2600260,0x2600260,0x2600260,0x2600260,0x2600260,0x2600260,0x2600260
.long 0x2600260,0x2600260,0x2600260,0x2600260,0x2600260,0x2600260,0x2600260,0x2600260,0x2600260,0x2600260,0x2600260,0x2600260,0x2600260,0x2600260,0x2600260,0x2600260
.long 0x43c041c,0x47c045c,0x41e048e,0x45e043e,0x410047e,0x4500430,0x4820470,0x4320412,0x4720452,0x41c041c,0x41c041c,0x41c041c,0x41c041c,0x41c041c,0x41c041c,0x41c041c
.long 0x41c041c,0x41c041c,0x41c041c,0x41c041c,0x41c041c,0x41c041c,0x41c041c,0x41c041c,0x41c041c,0x41c041c,0x41c041c,0x41c041c,0x41c041c,0x41c041c,0x41c041c,0x41c041c
.long 0x6030601,0x60b0609,0x6130611,0x61b0619,0x6230621,0x6310629,0x6410639,0x65a0652,0x6620660,0x66a0668,0x6720670,0x49e0496,0x4ae04a6,0x6870686,0x60104f1,0x6010601
.long 0x6010601,0x6010601,0x6010601,0x6010601,0x6010601,0x6010601,0x6010601,0x6010601,0x6010601,0x6010601,0x6010601,0x6010601,0x6010601,0x6010601,0x6010601,0x6010601
.long 0x2210220,0x2230222,0x2250224,0x2270226,0x2290228,0x22b022a,0x22d022c,0x22f022e,0x2200220,0x2200220,0x2200220,0x2200220,0x2200220,0x2200220,0x2200220,0x2200220
.long 0x2200220,0x2200220,0x2200220,0x2200220,0x2200220,0x2200220,0x2200220,0x2200220,0x2200220,0x2200220,0x2200220,0x2200220,0x2200220,0x2200220,0x2200220,0x2200220
.long 0x4250405,0x4650445,0x4070485,0x4470427,0x40d0467,0x44d042d,0x48d046d,0x42f040f,0x46f044f,0x4210401,0x4610441,0x4030481,0x4430423,0x4050463,0x4050405,0x4050405
.long 0x4050405,0x4050405,0x4050405,0x4050405,0x4050405,0x4050405,0x4050405,0x4050405,0x4050405,0x4050405,0x4050405,0x4050405,0x4050405,0x4050405,0x4050405,0x4050405
.long 0x6060604,0x60e060c,0x6160614,0x61e061c,0x6260624,0x4b1062c,0x4b90493,0x4c1049b,0x4c904a3,0x67c04ab,0x4f6067d,0x6040604,0x6040604,0x6040604,0x6040604,0x6040604
.long 0x6040604,0x6040604,0x6040604,0x6040604,0x6040604,0x6040604,0x6040604,0x6040604,0x6040604,0x6040604,0x6040604,0x6040604,0x6040604,0x6040604,0x6040604,0x6040604
.long 0x2610260,0x2630262,0x2650264,0x2670266,0x2690268,0x26b026a,0x26d026c,0x26f026e,0x2600260,0x2600260,0x2600260,0x2600260,0x2600260,0x2600260,0x2600260,0x2600260
.long 0x2600260,0x2600260,0x2600260,0x2600260,0x2600260,0x2600260,0x2600260,0x2600260,0x2600260,0x2600260,0x2600260,0x2600260,0x2600260,0x2600260,0x2600260,0x2600260
.long 0x42d040d,0x46d044d,0x40f048d,0x44f042f,0x415046f,0x4550435,0x4870475,0x4370417,0x4770457,0x4290409,0x4690449,0x40b0489,0x44b042b,0x411046b,0x4510431,0x4830471
.long 0x4330413,0x4730453,0x40d040d,0x40d040d,0x40d040d,0x40d040d,0x40d040d,0x40d040d,0x40d040d,0x40d040d,0x40d040d,0x40d040d,0x40d040d,0x40d040d,0x40d040d,0x40d040d
.long 0x6070605,0x60f060d,0x6170615,0x61f061d,0x6270625,0x635062d,0x645063d,0x65e0656,0x6660664,0x66e066c,0x6760674,0x49304b1,0x49b04b9,0x4a304c1,0x4ab04c9,0x67d067c
.long 0x60504f6,0x6050605,0x6050605,0x6050605,0x6050605,0x6050605,0x6050605,0x6050605,0x6050605,0x6050605,0x6050605,0x6050605,0x6050605,0x6050605,0x6050605,0x6050605
.long 0x2210220,0x2230222,0x2250224,0x2270226,0x2290228,0x22b022a,0x22d022c,0x22f022e,0x2200220,0x2200220,0x2200220,0x2200220,0x2200220,0x2200220,0x2200220,0x2200220
.long 0x2200220,0x2200220,0x2200220,0x2200220,0x2200220,0x2200220,0x2200220,0x2200220,0x2200220,0x2200220,0x2200220,0x2200220,0x2200220,0x2200220,0x2200220,0x2200220
.long 0x43d041d,0x47d045d,0x41f048f,0x45f043f,0x401047f,0x4410421,0x4810461,0x4230403,0x4630443,0x41d041d,0x41d041d,0x41d041d,0x41d041d,0x41d041d,0x41d041d,0x41d041d
.long 0x41d041d,0x41d041d,0x41d041d,0x41d041d,0x41d041d,0x41d041d,0x41d041d,0x41d041d,0x41d041d,0x41d041d,0x41d041d,0x41d041d,0x41d041d,0x41d041d,0x41d041d,0x41d041d
.long 0x6060604,0x60e060c,0x6160614,0x61e061c,0x6260624,0x497062c,0x4a7049f,0x68604af,0x4f10687,0x6040604,0x6040604,0x6040604,0x6040604,0x6040604,0x6040604,0x6040604
.long 0x6040604,0x6040604,0x6040604,0x6040604,0x6040604,0x6040604,0x6040604,0x6040604,0x6040604,0x6040604,0x6040604,0x6040604,0x6040604,0x6040604,0x6040604,0x6040604
.long 0x2610260,0x2630262,0x2650264,0x2670266,0x2690268,0x26b026a,0x26d026c,0x26f026e,0x2600260,0x2600260,0x2600260,0x2600260,0x2600260,0x2600260,0x2600260,0x2600260
.long 0x2600260,0x2600260,0x2600260,0x2600260,0x2600260,0x2600260,0x2600260,0x2600260,0x2600260,0x2600260,0x2600260,0x2600260,0x2600260,0x2600260,0x2600260,0x2600260
.long 0x43d041d,0x47d045d,0x41f048f,0x45f043f,0x411047f,0x4510431,0x4830471,0x4330413,0x4730453,0x41d041d,0x41d041d,0x41d041d,0x41d041d,0x41d041d,0x41d041d,0x41d041d
.long 0x41d041d,0x41d041d,0x41d041d,0x41d041d,0x41d041d,0x41d041d,0x41d041d,0x41d041d,0x41d041d,0x41d041d,0x41d041d,0x41d041d,0x41d041d,0x41d041d,0x41d041d,0x41d041d
.long 0x6070605,0x60f060d,0x6170615,0x61f061d,0x6270625,0x635062d,0x645063d,0x65e0656,0x6660664,0x66e066c,0x6760674,0x49f0497,0x4af04a7,0x6870686,0x60504f1,0x6050605
.long 0x6050605,0x6050605,0x6050605,0x6050605,0x6050605,0x6050605,0x6050605,0x6050605,0x6050605,0x6050605,0x6050605,0x6050605,0x6050605,0x6050605,0x6050605,0x6050605
.long 0x2310230,0x2330232,0x2350234,0x2370236,0x2390238,0x23b023a,0x23d023c,0x23f023e,0x2300230,0x2300230,0x2300230,0x2300230,0x2300230,0x2300230,0x2300230,0x2300230
.long 0x2300230,0x2300230,0x2300230,0x2300230,0x2300230,0x2300230,0x2300230,0x2300230,0x2300230,0x2300230,0x2300230,0x2300230,0x2300230,0x2300230,0x2300230,0x2300230
.long 0x42c040c,0x46c044c,0x40e048c,0x44e042e,0x400046e,0x4400420,0x4800460,0x4220402,0x4620442,0x40c040c,0x40c040c,0x40c040c,0x40c040c,0x40c040c,0x40c040c,0x40c040c
.long 0x40c040c,0x40c040c,0x40c040c,0x40c040c,0x40c040c,0x40c040c,0x40c040c,0x40c040c,0x40c040c,0x40c040c,0x40c040c,0x40c040c,0x40c040c,0x40c040c,0x40c040c,0x40c040c
.long 0x6020600,0x60a0608,0x6120610,0x61a0618,0x6220620,0x4920628,0x4a2049a,0x67d04aa,0x4f6067e,0x6000600,0x6000600,0x6000600,0x6000600,0x6000600,0x6000600,0x6000600
.long 0x6000600,0x6000600,0x6000600,0x6000600,0x6000600,0x6000600,0x6000600,0x6000600,0x6000600,0x6000600,0x6000600,0x6000600,0x6000600,0x6000600,0x6000600,0x6000600
.long 0x2710270,0x2730272,0x2750274,0x2770276,0x2790278,0x27b027a,0x27d027c,0x27f027e,0x2700270,0x2700270,0x2700270,0x2700270,0x2700270,0x2700270,0x2700270,0x2700270
.long 0x2700270,0x2700270,0x2700270,0x2700270,0x2700270,0x2700270,0x2700270,0x2700270,0x2700270,0x2700270,0x2700270,0x2700270,0x2700270,0x2700270,0x2700270,0x2700270
.long 0x4240404,0x4640444,0x4060484,0x4460426,0x4100466,0x4500430,0x4820470,0x4320412,0x4720452,0x4040404,0x4040404,0x4040404,0x4040404,0x4040404,0x4040404,0x4040404
.long 0x4040404,0x4040404,0x4040404,0x4040404,0x4040404,0x4040404,0x4040404,0x4040404,0x4040404,0x4040404,0x4040404,0x4040404,0x4040404,0x4040404,0x4040404,0x4040404
.long 0x6030601,0x60b0609,0x6130611,0x61b0619,0x6230621,0x6310629,0x6410639,0x65a0652,0x6620660,0x66a0668,0x6720670,0x49a0492,0x4aa04a2,0x67e067d,0x60104f6,0x6010601
.long 0x6010601,0x6010601,0x6010601,0x6010601,0x6010601,0x6010601,0x6010601,0x6010601,0x6010601,0x6010601,0x6010601,0x6010601,0x6010601,0x6010601,0x6010601,0x6010601
.long 0x2310230,0x2330232,0x2350234,0x2370236,0x2390238,0x23b023a,0x23d023c,0x23f023e,0x2300230,0x2300230,0x2300230,0x2300230,0x2300230,0x2300230,0x2300230,0x2300230
.long 0x2300230,0x2300230,0x2300230,0x2300230,0x2300230,0x2300230,0x2300230,0x2300230,0x2300230,0x2300230,0x2300230,0x2300230,0x2300230,0x2300230,0x2300230,0x2300230
.long 0x43c041c,0x47c045c,0x41e048e,0x45e043e,0x400047e,0x4400420,0x4800460,0x4220402,0x4620442,0x41c041c,0x41c041c,0x41c041c,0x41c041c,0x41c041c,0x41c041c,0x41c041c
.long 0x41c041c,0x41c041c,0x41c041c,0x41c041c,0x41c041c,0x41c041c,0x41c041c,0x41c041c,0x41c041c,0x41c041c,0x41c041c,0x41c041c,0x41c041c,0x41c041c,0x41c041c,0x41c041c
.long 0x6020600,0x60a0608,0x6120610,0x61a0618,0x6220620,0x4960628,0x49e04b6,0x4a604be,0x4ae04c6,0x68704ce,0x4f10688,0x60004f8,0x6000600,0x6000600,0x6000600,0x6000600
.long 0x6000600,0x6000600,0x6000600,0x6000600,0x6000600,0x6000600,0x6000600,0x6000600,0x6000600,0x6000600,0x6000600,0x6000600,0x6000600,0x6000600,0x6000600,0x6000600
.long 0x2710270,0x2730272,0x2750274,0x2770276,0x2790278,0x27b027a,0x27d027c,0x27f027e,0x2700270,0x2700270,0x2700270,0x2700270,0x2700270,0x2700270,0x2700270,0x2700270
.long 0x2700270,0x2700270,0x2700270,0x2700270,0x2700270,0x2700270,0x2700270,0x2700270,0x2700270,0x2700270,0x2700270,0x2700270,0x2700270,0x2700270,0x2700270,0x2700270
.long 0x43c041c,0x47c045c,0x41e048e,0x45e043e,0x410047e,0x4500430,0x4820470,0x4320412,0x4720452,0x41c041c,0x41c041c,0x41c041c,0x41c041c,0x41c041c,0x41c041c,0x41c041c
.long 0x41c041c,0x41c041c,0x41c041c,0x41c041c,0x41c041c,0x41c041c,0x41c041c,0x41c041c,0x41c041c,0x41c041c,0x41c041c,0x41c041c,0x41c041c,0x41c041c,0x41c041c,0x41c041c
.long 0x6030601,0x60b0609,0x6130611,0x61b0619,0x6230621,0x6310629,0x6410639,0x65a0652,0x6620660,0x66a0668,0x6720670,0x4b60496,0x4be049e,0x4c604a6,0x4ce04ae,0x6880687
.long 0x4f804f1,0x6010601,0x6010601,0x6010601,0x6010601,0x6010601,0x6010601,0x6010601,0x6010601,0x6010601,0x6010601,0x6010601,0x6010601,0x6010601,0x6010601,0x6010601
.long 0x2310230,0x2330232,0x2350234,0x2370236,0x2390238,0x23b023a,0x23d023c,0x23f023e,0x2300230,0x2300230,0x2300230,0x2300230,0x2300230,0x2300230,0x2300230,0x2300230
.long 0x2300230,0x2300230,0x2300230,0x2300230,0x2300230,0x2300230,0x2300230,0x2300230,0x2300230,0x2300230,0x2300230,0x2300230,0x2300230,0x2300230,0x2300230,0x2300230
.long 0x42d040d,0x46d044d,0x40f048d,0x44f042f,0x401046f,0x4410421,0x4810461,0x4230403,0x4630443,0x40d040d,0x40d040d,0x40d040d,0x40d040d,0x40d040d,0x40d040d,0x40d040d
.long 0x40d040d,0x40d040d,0x40d040d,0x40d040d,0x40d040d,0x40d040d,0x40d040d,0x40d040d,0x40d040d,0x40d040d,0x40d040d,0x40d040d,0x40d040d,0x40d040d,0x40d040d,0x40d040d
.long 0x6060604,0x60e060c,0x6160614,0x61e061c,0x6260624,0x493062c,0x4a3049b,0x67d04ab,0x4f6067e,0x6040604,0x6040604,0x6040604,0x6040604,0x6040604,0x6040604,0x6040604
.long 0x6040604,0x6040604,0x6040604,0x6040604,0x6040604,0x6040604,0x6040604,0x6040604,0x6040604,0x6040604,0x6040604,0x6040604,0x6040604,0x6040604,0x6040604,0x6040604
.long 0x2710270,0x2730272,0x2750274,0x2770276,0x2790278,0x27b027a,0x27d027c,0x27f027e,0x2700270,0x2700270,0x2700270,0x2700270,0x2700270,0x2700270,0x2700270,0x2700270
.long 0x2700270,0x2700270,0x2700270,0x2700270,0x2700270,0x2700270,0x2700270,0x2700270,0x2700270,0x2700270,0x2700270,0x2700270,0x2700270,0x2700270,0x2700270,0x2700270
.long 0x4250405,0x4650445,0x4070485,0x4470427,0x4110467,0x4510431,0x4830471,0x4330413,0x4730453,0x4050405,0x4050405,0x4050405,0x4050405,0x4050405,0x4050405,0x4050405
.long 0x4050405,0x4050405,0x4050405,0x4050405,0x4050405,0x4050405,0x4050405,0x4050405,0x4050405,0x4050405,0x4050405,0x4050405,0x4050405,0x4050405,0x4050405,0x4050405
.long 0x6070605,0x60f060d,0x6170615,0x61f061d,0x6270625,0x635062d,0x645063d,0x65e0656,0x6660664,0x66e066c,0x6760674,0x49b0493,0x4ab04a3,0x67e067d,0x60504f6,0x6050605
.long 0x6050605,0x6050605,0x6050605,0x6050605,0x6050605,0x6050605,0x6050605,0x6050605,0x6050605,0x6050605,0x6050605,0x6050605,0x6050605,0x6050605,0x6050605,0x6050605
.long 0x2310230,0x2330232,0x2350234,0x2370236,0x2390238,0x23b023a,0x23d023c,0x23f023e,0x2300230,0x2300230,0x2300230,0x2300230,0x2300230,0x2300230,0x2300230,0x2300230
.long 0x2300230,0x2300230,0x2300230,0x2300230,0x2300230,0x2300230,0x2300230,0x2300230,0x2300230,0x2300230,0x2300230,0x2300230,0x2300230,0x2300230,0x2300230,0x2300230
.long 0x43d041d,0x47d045d,0x41f048f,0x45f043f,0x401047f,0x4410421,0x4810461,0x4230403,0x4630443,0x41d041d,0x41d041d,0x41d041d,0x41d041d,0x41d041d,0x41d041d,0x41d041d
.long 0x41d041d,0x41d041d,0x41d041d,0x41d041d,0x41d041d,0x41d041d,0x41d041d,0x41d041d,0x41d041d,0x41d041d,0x41d041d,0x41d041d,0x41d041d,0x41d041d,0x41d041d,0x41d041d
.long 0x6060604,0x60e060c,0x6160614,0x61e061c,0x6260624,0x497062c,0x49f04b7,0x4a704bf,0x4af04c7,0x68704cf,0x4f10688,0x60404f8,0x6040604,0x6040604,0x6040604,0x6040604
.long 0x6040604,0x6040604,0x6040604,0x6040604,0x6040604,0x6040604,0x6040604,0x6040604,0x6040604,0x6040604,0x6040604,0x6040604,0x6040604,0x6040604,0x6040604,0x6040604
.long 0x2710270,0x2730272,0x2750274,0x2770276,0x2790278,0x27b027a,0x27d027c,0x27f027e,0x2700270,0x2700270,0x2700270,0x2700270,0x2700270,0x2700270,0x2700270,0x2700270
.long 0x2700270,0x2700270,0x2700270,0x2700270,0x2700270,0x2700270,0x2700270,0x2700270,0x2700270,0x2700270,0x2700270,0x2700270,0x2700270,0x2700270,0x2700270,0x2700270
.long 0x43d041d,0x47d045d,0x41f048f,0x45f043f,0x411047f,0x4510431,0x4830471,0x4330413,0x4730453,0x41d041d,0x41d041d,0x41d041d,0x41d041d,0x41d041d,0x41d041d,0x41d041d
.long 0x41d041d,0x41d041d,0x41d041d,0x41d041d,0x41d041d,0x41d041d,0x41d041d,0x41d041d,0x41d041d,0x41d041d,0x41d041d,0x41d041d,0x41d041d,0x41d041d,0x41d041d,0x41d041d
.long 0x6070605,0x60f060d,0x6170615,0x61f061d,0x6270625,0x635062d,0x645063d,0x65e0656,0x6660664,0x66e066c,0x6760674,0x4b70497,0x4bf049f,0x4c704a7,0x4cf04af,0x6880687
.long 0x4f804f1,0x6050605,0x6050605,0x6050605,0x6050605,0x6050605,0x6050605,0x6050605,0x6050605,0x6050605,0x6050605,0x6050605,0x6050605,0x6050605,0x6050605,0x6050605
.long 0x2010200,0x2030202,0x2050204,0x2070206,0x2090208,0x20b020a,0x20d020c,0x20f020e,0x2000200,0x2000200,0x2000200,0x2000200,0x2000200,0x2000200,0x2000200,0x2000200
.long 0x2000200,0x2000200,0x2000200,0x2000200,0x2000200,0x2000200,0x2000200,0x2000200,0x2000200,0x2000200,0x2000200,0x2000200,0x2000200,0x2000200,0x2000200,0x2000200
.long 0x42c040c,0x46c044c,0x40e048c,0x44e042e,0x400046e,0x4400420,0x4800460,0x4220402,0x4620442,0x40c040c,0x40c040c,0x40c040c,0x40c040c,0x40c040c,0x40c040c,0x40c040c
.long 0x40c040c,0x40c040c,0x40c040c,0x40c040c,0x40c040c,0x40c040c,0x40c040c,0x40c040c,0x40c040c,0x40c040c,0x40c040c,0x40c040c,0x40c040c,0x40c040c,0x40c040c,0x40c040c
.long 0x6020600,0x60a0608,0x6120610,0x61a0618,0x6220620,0x4b20628,0x4c204ba,0x68004ca,0x4f70681,0x6000600,0x6000600,0x6000600,0x6000600,0x6000600,0x6000600,0x6000600
.long 0x6000600,0x6000600,0x6000600,0x6000600,0x6000600,0x6000600,0x6000600,0x6000600,0x6000600,0x6000600,0x6000600,0x6000600,0x6000600,0x6000600,0x6000600,0x6000600
.long 0x2410240,0x2430242,0x2450244,0x2470246,0x2490248,0x24b024a,0x24d024c,0x24f024e,0x2400240,0x2400240,0x2400240,0x2400240,0x2400240,0x2400240,0x2400240,0x2400240
.long 0x2400240,0x2400240,0x2400240,0x2400240,0x2400240,0x2400240,0x2400240,0x2400240,0x2400240,0x2400240,0x2400240,0x2400240,0x2400240,0x2400240,0x2400240,0x2400240
.long 0x4240404,0x4640444,0x4060484,0x4460426,0x4100466,0x4500430,0x4820470,0x4320412,0x4720452,0x4040404,0x4040404,0x4040404,0x4040404,0x4040404,0x4040404,0x4040404
.long 0x4040404,0x4040404,0x4040404,0x4040404,0x4040404,0x4040404,0x4040404,0x4040404,0x4040404,0x4040404,0x4040404,0x4040404,0x4040404,0x4040404,0x4040404,0x4040404
.long 0x6030601,0x60b0609,0x6130611,0x61b0619,0x6230621,0x6310629,0x6410639,0x65a0652,0x6620660,0x66a0668,0x6720670,0x4ba04b2,0x4ca04c2,0x6810680,0x60104f7,0x6010601
.long 0x6010601,0x6010601,0x6010601,0x6010601,0x6010601,0x6010601,0x6010601,0x6010601,0x6010601,0x6010601,0x6010601,0x6010601,0x6010601,0x6010601,0x6010601,0x6010601
.long 0x2010200,0x2030202,0x2050204,0x2070206,0x2090208,0x20b020a,0x20d020c,0x20f020e,0x2000200,0x2000200,0x2000200,0x2000200,0x2000200,0x2000200,0x2000200,0x2000200
.long 0x2000200,0x2000200,0x2000200,0x2000200,0x2000200,0x2000200,0x2000200,0x2000200,0x2000200,0x2000200,0x2000200,0x2000200,0x2000200,0x2000200,0x2000200,0x2000200
.long 0x43c041c,0x47c045c,0x41e048e,0x45e043e,0x4dd047e,0x4df04de,0x4e304e2,0x4e504e4,0x4e704e6,0x4200400,0x4600440,0x4020480,0x4420422,0x41c0462,0x41c041c,0x41c041c
.long 0x41c041c,0x41c041c,0x41c041c,0x41c041c,0x41c041c,0x41c041c,0x41c041c,0x41c041c,0x41c041c,0x41c041c,0x41c041c,0x41c041c,0x41c041c,0x41c041c,0x41c041c,0x41c041c
.long 0x6020600,0x60a0608,0x6120610,0x61a0618,0x6220620,0x4b60628,0x4be04d0,0x4c604d2,0x4ce04d4,0x68904d6,0x4f8068a,0x60004f9,0x6000600,0x6000600,0x6000600,0x6000600
.long 0x6000600,0x6000600,0x6000600,0x6000600,0x6000600,0x6000600,0x6000600,0x6000600,0x6000600,0x6000600,0x6000600,0x6000600,0x6000600,0x6000600,0x6000600,0x6000600
.long 0x2410240,0x2430242,0x2450244,0x2470246,0x2490248,0x24b024a,0x24d024c,0x24f024e,0x2400240,0x2400240,0x2400240,0x2400240,0x2400240,0x2400240,0x2400240,0x2400240
.long 0x2400240,0x2400240,0x2400240,0x2400240,0x2400240,0x2400240,0x2400240,0x2400240,0x2400240,0x2400240,0x2400240,0x2400240,0x2400240,0x2400240,0x2400240,0x2400240
.long 0x43c041c,0x47c045c,0x41e048e,0x45e043e,0x4dd047e,0x4df04de,0x4e304e2,0x4e504e4,0x4e704e6,0x4300410,0x4700450,0x4120482,0x4520432,0x41c0472,0x41c041c,0x41c041c
.long 0x41c041c,0x41c041c,0x41c041c,0x41c041c,0x41c041c,0x41c041c,0x41c041c,0x41c041c,0x41c041c,0x41c041c,0x41c041c,0x41c041c,0x41c041c,0x41c041c,0x41c041c,0x41c041c
.long 0x6030601,0x60b0609,0x6130611,0x61b0619,0x6230621,0x6310629,0x6410639,0x65a0652,0x6620660,0x66a0668,0x6720670,0x4d004b6,0x4d204be,0x4d404c6,0x4d604ce,0x68a0689
.long 0x4f904f8,0x6010601,0x6010601,0x6010601,0x6010601,0x6010601,0x6010601,0x6010601,0x6010601,0x6010601,0x6010601,0x6010601,0x6010601,0x6010601,0x6010601,0x6010601
.long 0x2010200,0x2030202,0x2050204,0x2070206,0x2090208,0x20b020a,0x20d020c,0x20f020e,0x2000200,0x2000200,0x2000200,0x2000200,0x2000200,0x2000200,0x2000200,0x2000200
.long 0x2000200,0x2000200,0x2000200,0x2000200,0x2000200,0x2000200,0x2000200,0x2000200,0x2000200,0x2000200,0x2000200,0x2000200,0x2000200,0x2000200,0x2000200,0x2000200
.long 0x42d040d,0x46d044d,0x40f048d,0x44f042f,0x401046f,0x4410421,0x4810461,0x4230403,0x4630443,0x40d040d,0x40d040d,0x40d040d,0x40d040d,0x40d040d,0x40d040d,0x40d040d
.long 0x40d040d,0x40d040d,0x40d040d,0x40d040d,0x40d040d,0x40d040d,0x40d040d,0x40d040d,0x40d040d,0x40d040d,0x40d040d,0x40d040d,0x40d040d,0x40d040d,0x40d040d,0x40d040d
.long 0x6060604,0x60e060c,0x6160614,0x61e061c,0x6260624,0x4b3062c,0x4c304bb,0x68004cb,0x4f70681,0x6040604,0x6040604,0x6040604,0x6040604,0x6040604,0x6040604,0x6040604
.long 0x6040604,0x6040604,0x6040604,0x6040604,0x6040604,0x6040604,0x6040604,0x6040604,0x6040604,0x6040604,0x6040604,0x6040604,0x6040604,0x6040604,0x6040604,0x6040604
.long 0x2410240,0x2430242,0x2450244,0x2470246,0x2490248,0x24b024a,0x24d024c,0x24f024e,0x2400240,0x2400240,0x2400240,0x2400240,0x2400240,0x2400240,0x2400240,0x2400240
.long 0x2400240,0x2400240,0x2400240,0x2400240,0x2400240,0x2400240,0x2400240,0x2400240,0x2400240,0x2400240,0x2400240,0x2400240,0x2400240,0x2400240,0x2400240,0x2400240
.long 0x4250405,0x4650445,0x4070485,0x4470427,0x4110467,0x4510431,0x4830471,0x4330413,0x4730453,0x4050405,0x4050405,0x4050405,0x4050405,0x4050405,0x4050405,0x4050405
.long 0x4050405,0x4050405,0x4050405,0x4050405,0x4050405,0x4050405,0x4050405,0x4050405,0x4050405,0x4050405,0x4050405,0x4050405,0x4050405,0x4050405,0x4050405,0x4050405
.long 0x6070605,0x60f060d,0x6170615,0x61f061d,0x6270625,0x635062d,0x645063d,0x65e0656,0x6660664,0x66e066c,0x6760674,0x4bb04b3,0x4cb04c3,0x6810680,0x60504f7,0x6050605
.long 0x6050605,0x6050605,0x6050605,0x6050605,0x6050605,0x6050605,0x6050605,0x6050605,0x6050605,0x6050605,0x6050605,0x6050605,0x6050605,0x6050605,0x6050605,0x6050605
.long 0x2010200,0x2030202,0x2050204,0x2070206,0x2090208,0x20b020a,0x20d020c,0x20f020e,0x2000200,0x2000200,0x2000200,0x2000200,0x2000200,0x2000200,0x2000200,0x2000200
.long 0x2000200,0x2000200,0x2000200,0x2000200,0x2000200,0x2000200,0x2000200,0x2000200,0x2000200,0x2000200,0x2000200,0x2000200,0x2000200,0x2000200,0x2000200,0x2000200
.long 0x43d041d,0x47d045d,0x41f048f,0x45f043f,0x4dd047f,0x4df04de,0x4e304e2,0x4e504e4,0x4e704e6,0x4210401,0x4610441,0x4030481,0x4430423,0x41d0463,0x41d041d,0x41d041d
.long 0x41d041d,0x41d041d,0x41d041d,0x41d041d,0x41d041d,0x41d041d,0x41d041d,0x41d041d,0x41d041d,0x41d041d,0x41d041d,0x41d041d,0x41d041d,0x41d041d,0x41d041d,0x41d041d
.long 0x6060604,0x60e060c,0x6160614,0x61e061c,0x6260624,0x4b7062c,0x4bf04d1,0x4c704d3,0x4cf04d5,0x68904d7,0x4f8068a,0x60404f9,0x6040604,0x6040604,0x6040604,0x6040604
.long 0x6040604,0x6040604,0x6040604,0x6040604,0x6040604,0x6040604,0x6040604,0x6040604,0x6040604,0x6040604,0x6040604,0x6040604,0x6040604,0x6040604,0x6040604,0x6040604
.long 0x2410240,0x2430242,0x2450244,0x2470246,0x2490248,0x24b024a,0x24d024c,0x24f024e,0x2400240,0x2400240,0x2400240,0x2400240,0x2400240,0x2400240,0x2400240,0x2400240
.long 0x2400240,0x2400240,0x2400240,0x2400240,0x2400240,0x2400240,0x2400240,0x2400240,0x2400240,0x2400240,0x2400240,0x2400240,0x2400240,0x2400240,0x2400240,0x2400240
.long 0x43d041d,0x47d045d,0x41f048f,0x45f043f,0x4dd047f,0x4df04de,0x4e304e2,0x4e504e4,0x4e704e6,0x4310411,0x4710451,0x4130483,0x4530433,0x41d0473,0x41d041d,0x41d041d
.long 0x41d041d,0x41d041d,0x41d041d,0x41d041d,0x41d041d,0x41d041d,0x41d041d,0x41d041d,0x41d041d,0x41d041d,0x41d041d,0x41d041d,0x41d041d,0x41d041d,0x41d041d,0x41d041d
.long 0x6070605,0x60f060d,0x6170615,0x61f061d,0x6270625,0x635062d,0x645063d,0x65e0656,0x6660664,0x66e066c,0x6760674,0x4d104b7,0x4d304bf,0x4d504c7,0x4d704cf,0x68a0689
.long 0x4f904f8,0x6050605,0x6050605,0x6050605,0x6050605,0x6050605,0x6050605,0x6050605,0x6050605,0x6050605,0x6050605,0x6050605,0x6050605,0x6050605,0x6050605,0x6050605
.long 0x2110210,0x2130212,0x2150214,0x2170216,0x2190218,0x21b021a,0x21d021c,0x21f021e,0x2100210,0x2100210,0x2100210,0x2100210,0x2100210,0x2100210,0x2100210,0x2100210
.long 0x2100210,0x2100210,0x2100210,0x2100210,0x2100210,0x2100210,0x2100210,0x2100210,0x2100210,0x2100210,0x2100210,0x2100210,0x2100210,0x2100210,0x2100210,0x2100210
.long 0x42c040c,0x46c044c,0x40e048c,0x44e042e,0x414046e,0x4540434,0x4860474,0x4360416,0x4760456,0x4200400,0x4600440,0x4020480,0x4420422,0x40c0462,0x40c040c,0x40c040c
.long 0x40c040c,0x40c040c,0x40c040c,0x40c040c,0x40c040c,0x40c040c,0x40c040c,0x40c040c,0x40c040c,0x40c040c,0x40c040c,0x40c040c,0x40c040c,0x40c040c,0x40c040c,0x40c040c
.long 0x6020600,0x60a0608,0x6120610,0x61a0618,0x6220620,0x4b20628,0x4ba0494,0x4c2049c,0x4ca04a4,0x68104ac,0x4f70682,0x6000600,0x6000600,0x6000600,0x6000600,0x6000600
.long 0x6000600,0x6000600,0x6000600,0x6000600,0x6000600,0x6000600,0x6000600,0x6000600,0x6000600,0x6000600,0x6000600,0x6000600,0x6000600,0x6000600,0x6000600,0x6000600
.long 0x2510250,0x2530252,0x2550254,0x2570256,0x2590258,0x25b025a,0x25d025c,0x25f025e,0x2500250,0x2500250,0x2500250,0x2500250,0x2500250,0x2500250,0x2500250,0x2500250
.long 0x2500250,0x2500250,0x2500250,0x2500250,0x2500250,0x2500250,0x2500250,0x2500250,0x2500250,0x2500250,0x2500250,0x2500250,0x2500250,0x2500250,0x2500250,0x2500250
.long 0x4240404,0x4640444,0x4060484,0x4460426,0x40c0466,0x44c042c,0x48c046c,0x42e040e,0x46e044e,0x4300410,0x4700450,0x4120482,0x4520432,0x4040472,0x4040404,0x4040404
.long 0x4040404,0x4040404,0x4040404,0x4040404,0x4040404,0x4040404,0x4040404,0x4040404,0x4040404,0x4040404,0x4040404,0x4040404,0x4040404,0x4040404,0x4040404,0x4040404
.long 0x6030601,0x60b0609,0x6130611,0x61b0619,0x6230621,0x6310629,0x6410639,0x65a0652,0x6620660,0x66a0668,0x6720670,0x49404b2,0x49c04ba,0x4a404c2,0x4ac04ca,0x6820681
.long 0x60104f7,0x6010601,0x6010601,0x6010601,0x6010601,0x6010601,0x6010601,0x6010601,0x6010601,0x6010601,0x6010601,0x6010601,0x6010601,0x6010601,0x6010601,0x6010601
.long 0x2110210,0x2130212,0x2150214,0x2170216,0x2190218,0x21b021a,0x21d021c,0x21f021e,0x2100210,0x2100210,0x2100210,0x2100210,0x2100210,0x2100210,0x2100210,0x2100210
.long 0x2100210,0x2100210,0x2100210,0x2100210,0x2100210,0x2100210,0x2100210,0x2100210,0x2100210,0x2100210,0x2100210,0x2100210,0x2100210,0x2100210,0x2100210,0x2100210
.long 0x4340414,0x4740454,0x4160486,0x4560436,0x4000476,0x4400420,0x4800460,0x4220402,0x4620442,0x4280408,0x4680448,0x40a0488,0x44a042a,0x414046a,0x4140414,0x4140414
.long 0x4140414,0x4140414,0x4140414,0x4140414,0x4140414,0x4140414,0x4140414,0x4140414,0x4140414,0x4140414,0x4140414,0x4140414,0x4140414,0x4140414,0x4140414,0x4140414
.long 0x6020600,0x60a0608,0x6120610,0x61a0618,0x6220620,0x4d00628,0x4d404d2,0x68a04d6,0x4f9068b,0x6000600,0x6000600,0x6000600,0x6000600,0x6000600,0x6000600,0x6000600
.long 0x6000600,0x6000600,0x6000600,0x6000600,0x6000600,0x6000600,0x6000600,0x6000600,0x6000600,0x6000600,0x6000600,0x6000600,0x6000600,0x6000600,0x6000600,0x6000600
.long 0x2510250,0x2530252,0x2550254,0x2570256,0x2590258,0x25b025a,0x25d025c,0x25f025e,0x2500250,0x2500250,0x2500250,0x2500250,0x2500250,0x2500250,0x2500250,0x2500250
.long 0x2500250,0x2500250,0x2500250,0x2500250,0x2500250,0x2500250,0x2500250,0x2500250,0x2500250,0x2500250,0x2500250,0x2500250,0x2500250,0x2500250,0x2500250,0x2500250
.long 0x4340414,0x4740454,0x4160486,0x4560436,0x4180476,0x4580438,0x48a0478,0x43a041a,0x47a045a,0x4140414,0x4140414,0x4140414,0x4140414,0x4140414,0x4140414,0x4140414
.long 0x4140414,0x4140414,0x4140414,0x4140414,0x4140414,0x4140414,0x4140414,0x4140414,0x4140414,0x4140414,0x4140414,0x4140414,0x4140414,0x4140414,0x4140414,0x4140414
.long 0x6030601,0x60b0609,0x6130611,0x61b0619,0x6230621,0x6310629,0x6410639,0x65a0652,0x6620660,0x66a0668,0x6720670,0x4d204d0,0x4d604d4,0x68b068a,0x60104f9,0x6010601
.long 0x6010601,0x6010601,0x6010601,0x6010601,0x6010601,0x6010601,0x6010601,0x6010601,0x6010601,0x6010601,0x6010601,0x6010601,0x6010601,0x6010601,0x6010601,0x6010601
.long 0x2110210,0x2130212,0x2150214,0x2170216,0x2190218,0x21b021a,0x21d021c,0x21f021e,0x2100210,0x2100210,0x2100210,0x2100210,0x2100210,0x2100210,0x2100210,0x2100210
.long 0x2100210,0x2100210,0x2100210,0x2100210,0x2100210,0x2100210,0x2100210,0x2100210,0x2100210,0x2100210,0x2100210,0x2100210,0x2100210,0x2100210,0x2100210,0x2100210
.long 0x42d040d,0x46d044d,0x40f048d,0x44f042f,0x415046f,0x4550435,0x4870475,0x4370417,0x4770457,0x4210401,0x4610441,0x4030481,0x4430423,0x40d0463,0x40d040d,0x40d040d
.long 0x40d040d,0x40d040d,0x40d040d,0x40d040d,0x40d040d,0x40d040d,0x40d040d,0x40d040d,0x40d040d,0x40d040d,0x40d040d,0x40d040d,0x40d040d,0x40d040d,0x40d040d,0x40d040d
.long 0x6060604,0x60e060c,0x6160614,0x61e061c,0x6260624,0x4b3062c,0x4bb0495,0x4c3049d,0x4cb04a5,0x68104ad,0x4f70682,0x6040604,0x6040604,0x6040604,0x6040604,0x6040604
.long 0x6040604,0x6040604,0x6040604,0x6040604,0x6040604,0x6040604,0x6040604,0x6040604,0x6040604,0x6040604,0x6040604,0x6040604,0x6040604,0x6040604,0x6040604,0x6040604
.long 0x2510250,0x2530252,0x2550254,0x2570256,0x2590258,0x25b025a,0x25d025c,0x25f025e,0x2500250,0x2500250,0x2500250,0x2500250,0x2500250,0x2500250,0x2500250,0x2500250
.long 0x2500250,0x2500250,0x2500250,0x2500250,0x2500250,0x2500250,0x2500250,0x2500250,0x2500250,0x2500250,0x2500250,0x2500250,0x2500250,0x2500250,0x2500250,0x2500250
.long 0x4250405,0x4650445,0x4070485,0x4470427,0x40d0467,0x44d042d,0x48d046d,0x42f040f,0x46f044f,0x4310411,0x4710451,0x4130483,0x4530433,0x4050473,0x4050405,0x4050405
.long 0x4050405,0x4050405,0x4050405,0x4050405,0x4050405,0x4050405,0x4050405,0x4050405,0x4050405,0x4050405,0x4050405,0x4050405,0x4050405,0x4050405,0x4050405,0x4050405
.long 0x6070605,0x60f060d,0x6170615,0x61f061d,0x6270625,0x635062d,0x645063d,0x65e0656,0x6660664,0x66e066c,0x6760674,0x49504b3,0x49d04bb,0x4a504c3,0x4ad04cb,0x6820681
.long 0x60504f7,0x6050605,0x6050605,0x6050605,0x6050605,0x6050605,0x6050605,0x6050605,0x6050605,0x6050605,0x6050605,0x6050605,0x6050605,0x6050605,0x6050605,0x6050605
.long 0x2110210,0x2130212,0x2150214,0x2170216,0x2190218,0x21b021a,0x21d021c,0x21f021e,0x2100210,0x2100210,0x2100210,0x2100210,0x2100210,0x2100210,0x2100210,0x2100210
.long 0x2100210,0x2100210,0x2100210,0x2100210,0x2100210,0x2100210,0x2100210,0x2100210,0x2100210,0x2100210,0x2100210,0x2100210,0x2100210,0x2100210,0x2100210,0x2100210
.long 0x4350415,0x4750455,0x4170487,0x4570437,0x4010477,0x4410421,0x4810461,0x4230403,0x4630443,0x4290409,0x4690449,0x40b0489,0x44b042b,0x415046b,0x4150415,0x4150415
.long 0x4150415,0x4150415,0x4150415,0x4150415,0x4150415,0x4150415,0x4150415,0x4150415,0x4150415,0x4150415,0x4150415,0x4150415,0x4150415,0x4150415,0x4150415,0x4150415
.long 0x6060604,0x60e060c,0x6160614,0x61e061c,0x6260624,0x4d1062c,0x4d504d3,0x68a04d7,0x4f9068b,0x6040604,0x6040604,0x6040604,0x6040604,0x6040604,0x6040604,0x6040604
.long 0x6040604,0x6040604,0x6040604,0x6040604,0x6040604,0x6040604,0x6040604,0x6040604,0x6040604,0x6040604,0x6040604,0x6040604,0x6040604,0x6040604,0x6040604,0x6040604
.long 0x2510250,0x2530252,0x2550254,0x2570256,0x2590258,0x25b025a,0x25d025c,0x25f025e,0x2500250,0x2500250,0x2500250,0x2500250,0x2500250,0x2500250,0x2500250,0x2500250
.long 0x2500250,0x2500250,0x2500250,0x2500250,0x2500250,0x2500250,0x2500250,0x2500250,0x2500250,0x2500250,0x2500250,0x2500250,0x2500250,0x2500250,0x2500250,0x2500250
.long 0x4350415,0x4750455,0x4170487,0x4570437,0x4190477,0x4590439,0x48b0479,0x43b041b,0x47b045b,0x4150415,0x4150415,0x4150415,0x4150415,0x4150415,0x4150415,0x4150415
.long 0x4150415,0x4150415,0x4150415,0x4150415,0x4150415,0x4150415,0x4150415,0x4150415,0x4150415,0x4150415,0x4150415,0x4150415,0x4150415,0x4150415,0x4150415,0x4150415
.long 0x6070605,0x60f060d,0x6170615,0x61f061d,0x6270625,0x635062d,0x645063d,0x65e0656,0x6660664,0x66e066c,0x6760674,0x4d304d1,0x4d704d5,0x68b068a,0x60504f9,0x6050605
.long 0x6050605,0x6050605,0x6050605,0x6050605,0x6050605,0x6050605,0x6050605,0x6050605,0x6050605,0x6050605,0x6050605,0x6050605,0x6050605,0x6050605,0x6050605,0x6050605
.long 0x2210220,0x2230222,0x2250224,0x2270226,0x2290228,0x22b022a,0x22d022c,0x22f022e,0x2200220,0x2200220,0x2200220,0x2200220,0x2200220,0x2200220,0x2200220,0x2200220
.long 0x2200220,0x2200220,0x2200220,0x2200220,0x2200220,0x2200220,0x2200220,0x2200220,0x2200220,0x2200220,0x2200220,0x2200220,0x2200220,0x2200220,0x2200220,0x2200220
.long 0x4240404,0x4640444,0x4060484,0x4460426,0x4000466,0x4400420,0x4800460,0x4220402,0x4620442,0x4280408,0x4680448,0x40a0488,0x44a042a,0x404046a,0x4040404,0x4040404
.long 0x4040404,0x4040404,0x4040404,0x4040404,0x4040404,0x4040404,0x4040404,0x4040404,0x4040404,0x4040404,0x4040404,0x4040404,0x4040404,0x4040404,0x4040404,0x4040404
.long 0x6020600,0x60a0608,0x6120610,0x61a0618,0x6220620,0x62a0628,0x6320630,0x63a0638,0x6420640,0x64a0648,0x6580650,0x4980490,0x4a804a0,0x6790678,0x60004f5,0x6000600
.long 0x6000600,0x6000600,0x6000600,0x6000600,0x6000600,0x6000600,0x6000600,0x6000600,0x6000600,0x6000600,0x6000600,0x6000600,0x6000600,0x6000600,0x6000600,0x6000600
.long 0x2610260,0x2630262,0x2650264,0x2670266,0x2690268,0x26b026a,0x26d026c,0x26f026e,0x2600260,0x2600260,0x2600260,0x2600260,0x2600260,0x2600260,0x2600260,0x2600260
.long 0x2600260,0x2600260,0x2600260,0x2600260,0x2600260,0x2600260,0x2600260,0x2600260,0x2600260,0x2600260,0x2600260,0x2600260,0x2600260,0x2600260,0x2600260,0x2600260
.long 0x42c040c,0x46c044c,0x40e048c,0x44e042e,0x410046e,0x4500430,0x4820470,0x4320412,0x4720452,0x40c040c,0x40c040c,0x40c040c,0x40c040c,0x40c040c,0x40c040c,0x40c040c
.long 0x40c040c,0x40c040c,0x40c040c,0x40c040c,0x40c040c,0x40c040c,0x40c040c,0x40c040c,0x40c040c,0x40c040c,0x40c040c,0x40c040c,0x40c040c,0x40c040c,0x40c040c,0x40c040c
.long 0x60b0603,0x6190613,0x621061b,0x6290623,0x6390631,0x4900641,0x4a00498,0x67804a8,0x4f50679,0x6030603,0x6030603,0x6030603,0x6030603,0x6030603,0x6030603,0x6030603
.long 0x6030603,0x6030603,0x6030603,0x6030603,0x6030603,0x6030603,0x6030603,0x6030603,0x6030603,0x6030603,0x6030603,0x6030603,0x6030603,0x6030603,0x6030603,0x6030603
.long 0x2210220,0x2230222,0x2250224,0x2270226,0x2290228,0x22b022a,0x22d022c,0x22f022e,0x2200220,0x2200220,0x2200220,0x2200220,0x2200220,0x2200220,0x2200220,0x2200220
.long 0x2200220,0x2200220,0x2200220,0x2200220,0x2200220,0x2200220,0x2200220,0x2200220,0x2200220,0x2200220,0x2200220,0x2200220,0x2200220,0x2200220,0x2200220,0x2200220
.long 0x4340414,0x4740454,0x4160486,0x4560436,0x4000476,0x4400420,0x4800460,0x4220402,0x4620442,0x4280408,0x4680448,0x40a0488,0x44a042a,0x414046a,0x4140414,0x4140414
.long 0x4140414,0x4140414,0x4140414,0x4140414,0x4140414,0x4140414,0x4140414,0x4140414,0x4140414,0x4140414,0x4140414,0x4140414,0x4140414,0x4140414,0x4140414,0x4140414
.long 0x6020600,0x60a0608,0x6120610,0x61a0618,0x6220620,0x62a0628,0x6320630,0x63a0638,0x6420640,0x64a0648,0x6580650,0x4b40494,0x4bc049c,0x4c404a4,0x4cc04ac,0x6840683
.long 0x60004f0,0x6000600,0x6000600,0x6000600,0x6000600,0x6000600,0x6000600,0x6000600,0x6000600,0x6000600,0x6000600,0x6000600,0x6000600,0x6000600,0x6000600,0x6000600
.long 0x2610260,0x2630262,0x2650264,0x2670266,0x2690268,0x26b026a,0x26d026c,0x26f026e,0x2600260,0x2600260,0x2600260,0x2600260,0x2600260,0x2600260,0x2600260,0x2600260
.long 0x2600260,0x2600260,0x2600260,0x2600260,0x2600260,0x2600260,0x2600260,0x2600260,0x2600260,0x2600260,0x2600260,0x2600260,0x2600260,0x2600260,0x2600260,0x2600260
.long 0x4340414,0x4740454,0x4160486,0x4560436,0x4180476,0x4580438,0x48a0478,0x43a041a,0x47a045a,0x4140414,0x4140414,0x4140414,0x4140414,0x4140414,0x4140414,0x4140414
.long 0x4140414,0x4140414,0x4140414,0x4140414,0x4140414,0x4140414,0x4140414,0x4140414,0x4140414,0x4140414,0x4140414,0x4140414,0x4140414,0x4140414,0x4140414,0x4140414
.long 0x60b0603,0x6190613,0x621061b,0x6290623,0x6390631,0x4940641,0x49c04b4,0x4a404bc,0x4ac04c4,0x68304cc,0x4f00684,0x6030603,0x6030603,0x6030603,0x6030603,0x6030603
.long 0x6030603,0x6030603,0x6030603,0x6030603,0x6030603,0x6030603,0x6030603,0x6030603,0x6030603,0x6030603,0x6030603,0x6030603,0x6030603,0x6030603,0x6030603,0x6030603
.long 0x2210220,0x2230222,0x2250224,0x2270226,0x2290228,0x22b022a,0x22d022c,0x22f022e,0x2200220,0x2200220,0x2200220,0x2200220,0x2200220,0x2200220,0x2200220,0x2200220
.long 0x2200220,0x2200220,0x2200220,0x2200220,0x2200220,0x2200220,0x2200220,0x2200220,0x2200220,0x2200220,0x2200220,0x2200220,0x2200220,0x2200220,0x2200220,0x2200220
.long 0x4250405,0x4650445,0x4070485,0x4470427,0x4010467,0x4410421,0x4810461,0x4230403,0x4630443,0x4290409,0x4690449,0x40b0489,0x44b042b,0x405046b,0x4050405,0x4050405
.long 0x4050405,0x4050405,0x4050405,0x4050405,0x4050405,0x4050405,0x4050405,0x4050405,0x4050405,0x4050405,0x4050405,0x4050405,0x4050405,0x4050405,0x4050405,0x4050405
.long 0x6060604,0x60e060c,0x6160614,0x61e061c,0x6260624,0x62e062c,0x6360634,0x63e063c,0x6460644,0x64e064c,0x65c0654,0x4990491,0x4a904a1,0x6790678,0x60404f5,0x6040604
.long 0x6040604,0x6040604,0x6040604,0x6040604,0x6040604,0x6040604,0x6040604,0x6040604,0x6040604,0x6040604,0x6040604,0x6040604,0x6040604,0x6040604,0x6040604,0x6040604
.long 0x2610260,0x2630262,0x2650264,0x2670266,0x2690268,0x26b026a,0x26d026c,0x26f026e,0x2600260,0x2600260,0x2600260,0x2600260,0x2600260,0x2600260,0x2600260,0x2600260
.long 0x2600260,0x2600260,0x2600260,0x2600260,0x2600260,0x2600260,0x2600260,0x2600260,0x2600260,0x2600260,0x2600260,0x2600260,0x2600260,0x2600260,0x2600260,0x2600260
.long 0x42d040d,0x46d044d,0x40f048d,0x44f042f,0x411046f,0x4510431,0x4830471,0x4330413,0x4730453,0x40d040d,0x40d040d,0x40d040d,0x40d040d,0x40d040d,0x40d040d,0x40d040d
.long 0x40d040d,0x40d040d,0x40d040d,0x40d040d,0x40d040d,0x40d040d,0x40d040d,0x40d040d,0x40d040d,0x40d040d,0x40d040d,0x40d040d,0x40d040d,0x40d040d,0x40d040d,0x40d040d
.long 0x60f0607,0x61d0617,0x625061f,0x62d0627,0x63d0635,0x4910645,0x4a10499,0x67804a9,0x4f50679,0x6070607,0x6070607,0x6070607,0x6070607,0x6070607,0x6070607,0x6070607
.long 0x6070607,0x6070607,0x6070607,0x6070607,0x6070607,0x6070607,0x6070607,0x6070607,0x6070607,0x6070607,0x6070607,0x6070607,0x6070607,0x6070607,0x6070607,0x6070607
.long 0x2210220,0x2230222,0x2250224,0x2270226,0x2290228,0x22b022a,0x22d022c,0x22f022e,0x2200220,0x2200220,0x2200220,0x2200220,0x2200220,0x2200220,0x2200220,0x2200220
.long 0x2200220,0x2200220,0x2200220,0x2200220,0x2200220,0x2200220,0x2200220,0x2200220,0x2200220,0x2200220,0x2200220,0x2200220,0x2200220,0x2200220,0x2200220,0x2200220
.long 0x4350415,0x4750455,0x4170487,0x4570437,0x4010477,0x4410421,0x4810461,0x4230403,0x4630443,0x4290409,0x4690449,0x40b0489,0x44b042b,0x415046b,0x4150415,0x4150415
.long 0x4150415,0x4150415,0x4150415,0x4150415,0x4150415,0x4150415,0x4150415,0x4150415,0x4150415,0x4150415,0x4150415,0x4150415,0x4150415,0x4150415,0x4150415,0x4150415
.long 0x6060604,0x60e060c,0x6160614,0x61e061c,0x6260624,0x62e062c,0x6360634,0x63e063c,0x6460644,0x64e064c,0x65c0654,0x4b50495,0x4bd049d,0x4c504a5,0x4cd04ad,0x6840683
.long 0x60404f0,0x6040604,0x6040604,0x6040604,0x6040604,0x6040604,0x6040604,0x6040604,0x6040604,0x6040604,0x6040604,0x6040604,0x6040604,0x6040604,0x6040604,0x6040604
.long 0x2610260,0x2630262,0x2650264,0x2670266,0x2690268,0x26b026a,0x26d026c,0x26f026e,0x2600260,0x2600260,0x2600260,0x2600260,0x2600260,0x2600260,0x2600260,0x2600260
.long 0x2600260,0x2600260,0x2600260,0x2600260,0x2600260,0x2600260,0x2600260,0x2600260,0x2600260,0x2600260,0x2600260,0x2600260,0x2600260,0x2600260,0x2600260,0x2600260
.long 0x4350415,0x4750455,0x4170487,0x4570437,0x4190477,0x4590439,0x48b0479,0x43b041b,0x47b045b,0x4150415,0x4150415,0x4150415,0x4150415,0x4150415,0x4150415,0x4150415
.long 0x4150415,0x4150415,0x4150415,0x4150415,0x4150415,0x4150415,0x4150415,0x4150415,0x4150415,0x4150415,0x4150415,0x4150415,0x4150415,0x4150415,0x4150415,0x4150415
.long 0x60f0607,0x61d0617,0x625061f,0x62d0627,0x63d0635,0x4950645,0x49d04b5,0x4a504bd,0x4ad04c5,0x68304cd,0x4f00684,0x6070607,0x6070607,0x6070607,0x6070607,0x6070607
.long 0x6070607,0x6070607,0x6070607,0x6070607,0x6070607,0x6070607,0x6070607,0x6070607,0x6070607,0x6070607,0x6070607,0x6070607,0x6070607,0x6070607,0x6070607,0x6070607
.long 0x2310230,0x2330232,0x2350234,0x2370236,0x2390238,0x23b023a,0x23d023c,0x23f023e,0x2300230,0x2300230,0x2300230,0x2300230,0x2300230,0x2300230,0x2300230,0x2300230
.long 0x2300230,0x2300230,0x2300230,0x2300230,0x2300230,0x2300230,0x2300230,0x2300230,0x2300230,0x2300230,0x2300230,0x2300230,0x2300230,0x2300230,0x2300230,0x2300230
.long 0x4240404,0x4640444,0x4060484,0x4460426,0x4000466,0x4400420,0x4800460,0x4220402,0x4620442,0x4280408,0x4680448,0x40a0488,0x44a042a,0x404046a,0x4040404,0x4040404
.long 0x4040404,0x4040404,0x4040404,0x4040404,0x4040404,0x4040404,0x4040404,0x4040404,0x4040404,0x4040404,0x4040404,0x4040404,0x4040404,0x4040404,0x4040404,0x4040404
.long 0x6020600,0x60a0608,0x6120610,0x61a0618,0x6220620,0x62a0628,0x6320630,0x63a0638,0x6420640,0x64a0648,0x6580650,0x4b00490,0x4b80498,0x4c004a0,0x4c804a8,0x67a0679
.long 0x60004f5,0x6000600,0x6000600,0x6000600,0x6000600,0x6000600,0x6000600,0x6000600,0x6000600,0x6000600,0x6000600,0x6000600,0x6000600,0x6000600,0x6000600,0x6000600
.long 0x2710270,0x2730272,0x2750274,0x2770276,0x2790278,0x27b027a,0x27d027c,0x27f027e,0x2700270,0x2700270,0x2700270,0x2700270,0x2700270,0x2700270,0x2700270,0x2700270
.long 0x2700270,0x2700270,0x2700270,0x2700270,0x2700270,0x2700270,0x2700270,0x2700270,0x2700270,0x2700270,0x2700270,0x2700270,0x2700270,0x2700270,0x2700270,0x2700270
.long 0x42c040c,0x46c044c,0x40e048c,0x44e042e,0x410046e,0x4500430,0x4820470,0x4320412,0x4720452,0x40c040c,0x40c040c,0x40c040c,0x40c040c,0x40c040c,0x40c040c,0x40c040c
.long 0x40c040c,0x40c040c,0x40c040c,0x40c040c,0x40c040c,0x40c040c,0x40c040c,0x40c040c,0x40c040c,0x40c040c,0x40c040c,0x40c040c,0x40c040c,0x40c040c,0x40c040c,0x40c040c
.long 0x60b0603,0x6190613,0x621061b,0x6290623,0x6390631,0x4900641,0x49804b0,0x4a004b8,0x4a804c0,0x67904c8,0x4f5067a,0x6030603,0x6030603,0x6030603,0x6030603,0x6030603
.long 0x6030603,0x6030603,0x6030603,0x6030603,0x6030603,0x6030603,0x6030603,0x6030603,0x6030603,0x6030603,0x6030603,0x6030603,0x6030603,0x6030603,0x6030603,0x6030603
.long 0x2310230,0x2330232,0x2350234,0x2370236,0x2390238,0x23b023a,0x23d023c,0x23f023e,0x2300230,0x2300230,0x2300230,0x2300230,0x2300230,0x2300230,0x2300230,0x2300230
.long 0x2300230,0x2300230,0x2300230,0x2300230,0x2300230,0x2300230,0x2300230,0x2300230,0x2300230,0x2300230,0x2300230,0x2300230,0x2300230,0x2300230,0x2300230,0x2300230
.long 0x43c041c,0x47c045c,0x41e048e,0x45e043e,0x400047e,0x4400420,0x4800460,0x4220402,0x4620442,0x4280408,0x4680448,0x40a0488,0x44a042a,0x41c046a,0x41c041c,0x41c041c
.long 0x41c041c,0x41c041c,0x41c041c,0x41c041c,0x41c041c,0x41c041c,0x41c041c,0x41c041c,0x41c041c,0x41c041c,0x41c041c,0x41c041c,0x41c041c,0x41c041c,0x41c041c,0x41c041c
.long 0x6020600,0x60a0608,0x6120610,0x61a0618,0x6220620,0x62a0628,0x6320630,0x63a0638,0x6420640,0x64a0648,0x6580650,0x4bc04b4,0x4cc04c4,0x6850684,0x60004f0,0x6000600
.long 0x6000600,0x6000600,0x6000600,0x6000600,0x6000600,0x6000600,0x6000600,0x6000600,0x6000600,0x6000600,0x6000600,0x6000600,0x6000600,0x6000600,0x6000600,0x6000600
.long 0x2710270,0x2730272,0x2750274,0x2770276,0x2790278,0x27b027a,0x27d027c,0x27f027e,0x2700270,0x2700270,0x2700270,0x2700270,0x2700270,0x2700270,0x2700270,0x2700270
.long 0x2700270,0x2700270,0x2700270,0x2700270,0x2700270,0x2700270,0x2700270,0x2700270,0x2700270,0x2700270,0x2700270,0x2700270,0x2700270,0x2700270,0x2700270,0x2700270
.long 0x43c041c,0x47c045c,0x41e048e,0x45e043e,0x418047e,0x4580438,0x48a0478,0x43a041a,0x47a045a,0x41c041c,0x41c041c,0x41c041c,0x41c041c,0x41c041c,0x41c041c,0x41c041c
.long 0x41c041c,0x41c041c,0x41c041c,0x41c041c,0x41c041c,0x41c041c,0x41c041c,0x41c041c,0x41c041c,0x41c041c,0x41c041c,0x41c041c,0x41c041c,0x41c041c,0x41c041c,0x41c041c
.long 0x60b0603,0x6190613,0x621061b,0x6290623,0x6390631,0x4b40641,0x4c404bc,0x68404cc,0x4f00685,0x6030603,0x6030603,0x6030603,0x6030603,0x6030603,0x6030603,0x6030603
.long 0x6030603,0x6030603,0x6030603,0x6030603,0x6030603,0x6030603,0x6030603,0x6030603,0x6030603,0x6030603,0x6030603,0x6030603,0x6030603,0x6030603,0x6030603,0x6030603
.long 0x2310230,0x2330232,0x2350234,0x2370236,0x2390238,0x23b023a,0x23d023c,0x23f023e,0x2300230,0x2300230,0x2300230,0x2300230,0x2300230,0x2300230,0x2300230,0x2300230
.long 0x2300230,0x2300230,0x2300230,0x2300230,0x2300230,0x2300230,0x2300230,0x2300230,0x2300230,0x2300230,0x2300230,0x2300230,0x2300230,0x2300230,0x2300230,0x2300230
.long 0x4250405,0x4650445,0x4070485,0x4470427,0x4010467,0x4410421,0x4810461,0x4230403,0x4630443,0x4290409,0x4690449,0x40b0489,0x44b042b,0x405046b,0x4050405,0x4050405
.long 0x4050405,0x4050405,0x4050405,0x4050405,0x4050405,0x4050405,0x4050405,0x4050405,0x4050405,0x4050405,0x4050405,0x4050405,0x4050405,0x4050405,0x4050405,0x4050405
.long 0x6060604,0x60e060c,0x6160614,0x61e061c,0x6260624,0x62e062c,0x6360634,0x63e063c,0x6460644,0x64e064c,0x65c0654,0x4b10491,0x4b90499,0x4c104a1,0x4c904a9,0x67a0679
.long 0x60404f5,0x6040604,0x6040604,0x6040604,0x6040604,0x6040604,0x6040604,0x6040604,0x6040604,0x6040604,0x6040604,0x6040604,0x6040604,0x6040604,0x6040604,0x6040604
.long 0x2710270,0x2730272,0x2750274,0x2770276,0x2790278,0x27b027a,0x27d027c,0x27f027e,0x2700270,0x2700270,0x2700270,0x2700270,0x2700270,0x2700270,0x2700270,0x2700270
.long 0x2700270,0x2700270,0x2700270,0x2700270,0x2700270,0x2700270,0x2700270,0x2700270,0x2700270,0x2700270,0x2700270,0x2700270,0x2700270,0x2700270,0x2700270,0x2700270
.long 0x42d040d,0x46d044d,0x40f048d,0x44f042f,0x411046f,0x4510431,0x4830471,0x4330413,0x4730453,0x40d040d,0x40d040d,0x40d040d,0x40d040d,0x40d040d,0x40d040d,0x40d040d
.long 0x40d040d,0x40d040d,0x40d040d,0x40d040d,0x40d040d,0x40d040d,0x40d040d,0x40d040d,0x40d040d,0x40d040d,0x40d040d,0x40d040d,0x40d040d,0x40d040d,0x40d040d,0x40d040d
.long 0x60f0607,0x61d0617,0x625061f,0x62d0627,0x63d0635,0x4910645,0x49904b1,0x4a104b9,0x4a904c1,0x67904c9,0x4f5067a,0x6070607,0x6070607,0x6070607,0x6070607,0x6070607
.long 0x6070607,0x6070607,0x6070607,0x6070607,0x6070607,0x6070607,0x6070607,0x6070607,0x6070607,0x6070607,0x6070607,0x6070607,0x6070607,0x6070607,0x6070607,0x6070607
.long 0x2310230,0x2330232,0x2350234,0x2370236,0x2390238,0x23b023a,0x23d023c,0x23f023e,0x2300230,0x2300230,0x2300230,0x2300230,0x2300230,0x2300230,0x2300230,0x2300230
.long 0x2300230,0x2300230,0x2300230,0x2300230,0x2300230,0x2300230,0x2300230,0x2300230,0x2300230,0x2300230,0x2300230,0x2300230,0x2300230,0x2300230,0x2300230,0x2300230
.long 0x43d041d,0x47d045d,0x41f048f,0x45f043f,0x401047f,0x4410421,0x4810461,0x4230403,0x4630443,0x4290409,0x4690449,0x40b0489,0x44b042b,0x41d046b,0x41d041d,0x41d041d
.long 0x41d041d,0x41d041d,0x41d041d,0x41d041d,0x41d041d,0x41d041d,0x41d041d,0x41d041d,0x41d041d,0x41d041d,0x41d041d,0x41d041d,0x41d041d,0x41d041d,0x41d041d,0x41d041d
.long 0x6060604,0x60e060c,0x6160614,0x61e061c,0x6260624,0x62e062c,0x6360634,0x63e063c,0x6460644,0x64e064c,0x65c0654,0x4bd04b5,0x4cd04c5,0x6850684,0x60404f0,0x6040604
.long 0x6040604,0x6040604,0x6040604,0x6040604,0x6040604,0x6040604,0x6040604,0x6040604,0x6040604,0x6040604,0x6040604,0x6040604,0x6040604,0x6040604,0x6040604,0x6040604
.long 0x2710270,0x2730272,0x2750274,0x2770276,0x2790278,0x27b027a,0x27d027c,0x27f027e,0x2700270,0x2700270,0x2700270,0x2700270,0x2700270,0x2700270,0x2700270,0x2700270
.long 0x2700270,0x2700270,0x2700270,0x2700270,0x2700270,0x2700270,0x2700270,0x2700270,0x2700270,0x2700270,0x2700270,0x2700270,0x2700270,0x2700270,0x2700270,0x2700270
.long 0x43d041d,0x47d045d,0x41f048f,0x45f043f,0x419047f,0x4590439,0x48b0479,0x43b041b,0x47b045b,0x41d041d,0x41d041d,0x41d041d,0x41d041d,0x41d041d,0x41d041d,0x41d041d
.long 0x41d041d,0x41d041d,0x41d041d,0x41d041d,0x41d041d,0x41d041d,0x41d041d,0x41d041d,0x41d041d,0x41d041d,0x41d041d,0x41d041d,0x41d041d,0x41d041d,0x41d041d,0x41d041d
.long 0x60f0607,0x61d0617,0x625061f,0x62d0627,0x63d0635,0x4b50645,0x4c504bd,0x68404cd,0x4f00685,0x6070607,0x6070607,0x6070607,0x6070607,0x6070607,0x6070607,0x6070607
.long 0x6070607,0x6070607,0x6070607,0x6070607,0x6070607,0x6070607,0x6070607,0x6070607,0x6070607,0x6070607,0x6070607,0x6070607,0x6070607,0x6070607,0x6070607,0x6070607
.long 0x2010200,0x2030202,0x2050204,0x2070206,0x2090208,0x20b020a,0x20d020c,0x20f020e,0x2000200,0x2000200,0x2000200,0x2000200,0x2000200,0x2000200,0x2000200,0x2000200
.long 0x2000200,0x2000200,0x2000200,0x2000200,0x2000200,0x2000200,0x2000200,0x2000200,0x2000200,0x2000200,0x2000200,0x2000200,0x2000200,0x2000200,0x2000200,0x2000200
.long 0x4240404,0x4640444,0x4060484,0x4460426,0x40c0466,0x44c042c,0x48c046c,0x42e040e,0x46e044e,0x4200400,0x4600440,0x4020480,0x4420422,0x4080462,0x4480428,0x4880468
.long 0x42a040a,0x46a044a,0x4040404,0x4040404,0x4040404,0x4040404,0x4040404,0x4040404,0x4040404,0x4040404,0x4040404,0x4040404,0x4040404,0x4040404,0x4040404,0x4040404
.long 0x6020600,0x60a0608,0x6120610,0x61a0618,0x6220620,0x62a0628,0x6320630,0x63a0638,0x6420640,0x64a0648,0x6580650,0x49204b0,0x49a04b8,0x4a204c0,0x4aa04c8,0x67d067c
.long 0x60004f6,0x6000600,0x6000600,0x6000600,0x6000600,0x6000600,0x6000600,0x6000600,0x6000600,0x6000600,0x6000600,0x6000600,0x6000600,0x6000600,0x6000600,0x6000600
.long 0x2410240,0x2430242,0x2450244,0x2470246,0x2490248,0x24b024a,0x24d024c,0x24f024e,0x2400240,0x2400240,0x2400240,0x2400240,0x2400240,0x2400240,0x2400240,0x2400240
.long 0x2400240,0x2400240,0x2400240,0x2400240,0x2400240,0x2400240,0x2400240,0x2400240,0x2400240,0x2400240,0x2400240,0x2400240,0x2400240,0x2400240,0x2400240,0x2400240
.long 0x42c040c,0x46c044c,0x40e048c,0x44e042e,0x414046e,0x4540434,0x4860474,0x4360416,0x4760456,0x4300410,0x4700450,0x4120482,0x4520432,0x40c0472,0x40c040c,0x40c040c
.long 0x40c040c,0x40c040c,0x40c040c,0x40c040c,0x40c040c,0x40c040c,0x40c040c,0x40c040c,0x40c040c,0x40c040c,0x40c040c,0x40c040c,0x40c040c,0x40c040c,0x40c040c,0x40c040c
.long 0x60b0603,0x6190613,0x621061b,0x6290623,0x6390631,0x4b00641,0x4b80492,0x4c0049a,0x4c804a2,0x67c04aa,0x4f6067d,0x6030603,0x6030603,0x6030603,0x6030603,0x6030603
.long 0x6030603,0x6030603,0x6030603,0x6030603,0x6030603,0x6030603,0x6030603,0x6030603,0x6030603,0x6030603,0x6030603,0x6030603,0x6030603,0x6030603,0x6030603,0x6030603
.long 0x2010200,0x2030202,0x2050204,0x2070206,0x2090208,0x20b020a,0x20d020c,0x20f020e,0x2000200,0x2000200,0x2000200,0x2000200,0x2000200,0x2000200,0x2000200,0x2000200
.long 0x2000200,0x2000200,0x2000200,0x2000200,0x2000200,0x2000200,0x2000200,0x2000200,0x2000200,0x2000200,0x2000200,0x2000200,0x2000200,0x2000200,0x2000200,0x2000200
.long 0x43c041c,0x47c045c,0x41e048e,0x45e043e,0x400047e,0x4400420,0x4800460,0x4220402,0x4620442,0x4280408,0x4680448,0x40a0488,0x44a042a,0x41c046a,0x41c041c,0x41c041c
.long 0x41c041c,0x41c041c,0x41c041c,0x41c041c,0x41c041c,0x41c041c,0x41c041c,0x41c041c,0x41c041c,0x41c041c,0x41c041c,0x41c041c,0x41c041c,0x41c041c,0x41c041c,0x41c041c
.long 0x6020600,0x60a0608,0x6120610,0x61a0618,0x6220620,0x62a0628,0x6320630,0x63a0638,0x6420640,0x64a0648,0x6580650,0x49e0496,0x4ae04a6,0x6870686,0x60004f1,0x6000600
.long 0x6000600,0x6000600,0x6000600,0x6000600,0x6000600,0x6000600,0x6000600,0x6000600,0x6000600,0x6000600,0x6000600,0x6000600,0x6000600,0x6000600,0x6000600,0x6000600
.long 0x2410240,0x2430242,0x2450244,0x2470246,0x2490248,0x24b024a,0x24d024c,0x24f024e,0x2400240,0x2400240,0x2400240,0x2400240,0x2400240,0x2400240,0x2400240,0x2400240
.long 0x2400240,0x2400240,0x2400240,0x2400240,0x2400240,0x2400240,0x2400240,0x2400240,0x2400240,0x2400240,0x2400240,0x2400240,0x2400240,0x2400240,0x2400240,0x2400240
.long 0x43c041c,0x47c045c,0x41e048e,0x45e043e,0x418047e,0x4580438,0x48a0478,0x43a041a,0x47a045a,0x41c041c,0x41c041c,0x41c041c,0x41c041c,0x41c041c,0x41c041c,0x41c041c
.long 0x41c041c,0x41c041c,0x41c041c,0x41c041c,0x41c041c,0x41c041c,0x41c041c,0x41c041c,0x41c041c,0x41c041c,0x41c041c,0x41c041c,0x41c041c,0x41c041c,0x41c041c,0x41c041c
.long 0x60b0603,0x6190613,0x621061b,0x6290623,0x6390631,0x4960641,0x4a6049e,0x68604ae,0x4f10687,0x6030603,0x6030603,0x6030603,0x6030603,0x6030603,0x6030603,0x6030603
.long 0x6030603,0x6030603,0x6030603,0x6030603,0x6030603,0x6030603,0x6030603,0x6030603,0x6030603,0x6030603,0x6030603,0x6030603,0x6030603,0x6030603,0x6030603,0x6030603
.long 0x2010200,0x2030202,0x2050204,0x2070206,0x2090208,0x20b020a,0x20d020c,0x20f020e,0x2000200,0x2000200,0x2000200,0x2000200,0x2000200,0x2000200,0x2000200,0x2000200
.long 0x2000200,0x2000200,0x2000200,0x2000200,0x2000200,0x2000200,0x2000200,0x2000200,0x2000200,0x2000200,0x2000200,0x2000200,0x2000200,0x2000200,0x2000200,0x2000200
.long 0x4250405,0x4650445,0x4070485,0x4470427,0x40d0467,0x44d042d,0x48d046d,0x42f040f,0x46f044f,0x4210401,0x4610441,0x4030481,0x4430423,0x4090463,0x4490429,0x4890469
.long 0x42b040b,0x46b044b,0x4050405,0x4050405,0x4050405,0x4050405,0x4050405,0x4050405,0x4050405,0x4050405,0x4050405,0x4050405,0x4050405,0x4050405,0x4050405,0x4050405
.long 0x6060604,0x60e060c,0x6160614,0x61e061c,0x6260624,0x62e062c,0x6360634,0x63e063c,0x6460644,0x64e064c,0x65c0654,0x49304b1,0x49b04b9,0x4a304c1,0x4ab04c9,0x67d067c
.long 0x60404f6,0x6040604,0x6040604,0x6040604,0x6040604,0x6040604,0x6040604,0x6040604,0x6040604,0x6040604,0x6040604,0x6040604,0x6040604,0x6040604,0x6040604,0x6040604
.long 0x2410240,0x2430242,0x2450244,0x2470246,0x2490248,0x24b024a,0x24d024c,0x24f024e,0x2400240,0x2400240,0x2400240,0x2400240,0x2400240,0x2400240,0x2400240,0x2400240
.long 0x2400240,0x2400240,0x2400240,0x2400240,0x2400240,0x2400240,0x2400240,0x2400240,0x2400240,0x2400240,0x2400240,0x2400240,0x2400240,0x2400240,0x2400240,0x2400240
.long 0x42d040d,0x46d044d,0x40f048d,0x44f042f,0x415046f,0x4550435,0x4870475,0x4370417,0x4770457,0x4310411,0x4710451,0x4130483,0x4530433,0x40d0473,0x40d040d,0x40d040d
.long 0x40d040d,0x40d040d,0x40d040d,0x40d040d,0x40d040d,0x40d040d,0x40d040d,0x40d040d,0x40d040d,0x40d040d,0x40d040d,0x40d040d,0x40d040d,0x40d040d,0x40d040d,0x40d040d
.long 0x60f0607,0x61d0617,0x625061f,0x62d0627,0x63d0635,0x4b10645,0x4b90493,0x4c1049b,0x4c904a3,0x67c04ab,0x4f6067d,0x6070607,0x6070607,0x6070607,0x6070607,0x6070607
.long 0x6070607,0x6070607,0x6070607,0x6070607,0x6070607,0x6070607,0x6070607,0x6070607,0x6070607,0x6070607,0x6070607,0x6070607,0x6070607,0x6070607,0x6070607,0x6070607
.long 0x2010200,0x2030202,0x2050204,0x2070206,0x2090208,0x20b020a,0x20d020c,0x20f020e,0x2000200,0x2000200,0x2000200,0x2000200,0x2000200,0x2000200,0x2000200,0x2000200
.long 0x2000200,0x2000200,0x2000200,0x2000200,0x2000200,0x2000200,0x2000200,0x2000200,0x2000200,0x2000200,0x2000200,0x2000200,0x2000200,0x2000200,0x2000200,0x2000200
.long 0x43d041d,0x47d045d,0x41f048f,0x45f043f,0x401047f,0x4410421,0x4810461,0x4230403,0x4630443,0x4290409,0x4690449,0x40b0489,0x44b042b,0x41d046b,0x41d041d,0x41d041d
.long 0x41d041d,0x41d041d,0x41d041d,0x41d041d,0x41d041d,0x41d041d,0x41d041d,0x41d041d,0x41d041d,0x41d041d,0x41d041d,0x41d041d,0x41d041d,0x41d041d,0x41d041d,0x41d041d
.long 0x6060604,0x60e060c,0x6160614,0x61e061c,0x6260624,0x62e062c,0x6360634,0x63e063c,0x6460644,0x64e064c,0x65c0654,0x49f0497,0x4af04a7,0x6870686,0x60404f1,0x6040604
.long 0x6040604,0x6040604,0x6040604,0x6040604,0x6040604,0x6040604,0x6040604,0x6040604,0x6040604,0x6040604,0x6040604,0x6040604,0x6040604,0x6040604,0x6040604,0x6040604
.long 0x2410240,0x2430242,0x2450244,0x2470246,0x2490248,0x24b024a,0x24d024c,0x24f024e,0x2400240,0x2400240,0x2400240,0x2400240,0x2400240,0x2400240,0x2400240,0x2400240
.long 0x2400240,0x2400240,0x2400240,0x2400240,0x2400240,0x2400240,0x2400240,0x2400240,0x2400240,0x2400240,0x2400240,0x2400240,0x2400240,0x2400240,0x2400240,0x2400240
.long 0x43d041d,0x47d045d,0x41f048f,0x45f043f,0x419047f,0x4590439,0x48b0479,0x43b041b,0x47b045b,0x41d041d,0x41d041d,0x41d041d,0x41d041d,0x41d041d,0x41d041d,0x41d041d
.long 0x41d041d,0x41d041d,0x41d041d,0x41d041d,0x41d041d,0x41d041d,0x41d041d,0x41d041d,0x41d041d,0x41d041d,0x41d041d,0x41d041d,0x41d041d,0x41d041d,0x41d041d,0x41d041d
.long 0x60f0607,0x61d0617,0x625061f,0x62d0627,0x63d0635,0x4970645,0x4a7049f,0x68604af,0x4f10687,0x6070607,0x6070607,0x6070607,0x6070607,0x6070607,0x6070607,0x6070607
.long 0x6070607,0x6070607,0x6070607,0x6070607,0x6070607,0x6070607,0x6070607,0x6070607,0x6070607,0x6070607,0x6070607,0x6070607,0x6070607,0x6070607,0x6070607,0x6070607
.long 0x2110210,0x2130212,0x2150214,0x2170216,0x2190218,0x21b021a,0x21d021c,0x21f021e,0x2100210,0x2100210,0x2100210,0x2100210,0x2100210,0x2100210,0x2100210,0x2100210
.long 0x2100210,0x2100210,0x2100210,0x2100210,0x2100210,0x2100210,0x2100210,0x2100210,0x2100210,0x2100210,0x2100210,0x2100210,0x2100210,0x2100210,0x2100210,0x2100210
.long 0x42c040c,0x46c044c,0x40e048c,0x44e042e,0x400046e,0x4400420,0x4800460,0x4220402,0x4620442,0x4280408,0x4680448,0x40a0488,0x44a042a,0x40c046a,0x40c040c,0x40c040c
.long 0x40c040c,0x40c040c,0x40c040c,0x40c040c,0x40c040c,0x40c040c,0x40c040c,0x40c040c,0x40c040c,0x40c040c,0x40c040c,0x40c040c,0x40c040c,0x40c040c,0x40c040c,0x40c040c
.long 0x6020600,0x60a0608,0x6120610,0x61a0618,0x6220620,0x62a0628,0x6320630,0x63a0638,0x6420640,0x64a0648,0x6580650,0x49a0492,0x4aa04a2,0x67e067d,0x60004f6,0x6000600
.long 0x6000600,0x6000600,0x6000600,0x6000600,0x6000600,0x6000600,0x6000600,0x6000600,0x6000600,0x6000600,0x6000600,0x6000600,0x6000600,0x6000600,0x6000600,0x6000600
.long 0x2510250,0x2530252,0x2550254,0x2570256,0x2590258,0x25b025a,0x25d025c,0x25f025e,0x2500250,0x2500250,0x2500250,0x2500250,0x2500250,0x2500250,0x2500250,0x2500250
.long 0x2500250,0x2500250,0x2500250,0x2500250,0x2500250,0x2500250,0x2500250,0x2500250,0x2500250,0x2500250,0x2500250,0x2500250,0x2500250,0x2500250,0x2500250,0x2500250
.long 0x4240404,0x4640444,0x4060484,0x4460426,0x4180466,0x4580438,0x48a0478,0x43a041a,0x47a045a,0x4040404,0x4040404,0x4040404,0x4040404,0x4040404,0x4040404,0x4040404
.long 0x4040404,0x4040404,0x4040404,0x4040404,0x4040404,0x4040404,0x4040404,0x4040404,0x4040404,0x4040404,0x4040404,0x4040404,0x4040404,0x4040404,0x4040404,0x4040404
.long 0x60b0603,0x6190613,0x621061b,0x6290623,0x6390631,0x4920641,0x4a2049a,0x67d04aa,0x4f6067e,0x6030603,0x6030603,0x6030603,0x6030603,0x6030603,0x6030603,0x6030603
.long 0x6030603,0x6030603,0x6030603,0x6030603,0x6030603,0x6030603,0x6030603,0x6030603,0x6030603,0x6030603,0x6030603,0x6030603,0x6030603,0x6030603,0x6030603,0x6030603
.long 0x2110210,0x2130212,0x2150214,0x2170216,0x2190218,0x21b021a,0x21d021c,0x21f021e,0x2100210,0x2100210,0x2100210,0x2100210,0x2100210,0x2100210,0x2100210,0x2100210
.long 0x2100210,0x2100210,0x2100210,0x2100210,0x2100210,0x2100210,0x2100210,0x2100210,0x2100210,0x2100210,0x2100210,0x2100210,0x2100210,0x2100210,0x2100210,0x2100210
.long 0x43c041c,0x47c045c,0x41e048e,0x45e043e,0x4dd047e,0x4df04de,0x4e304e2,0x4e504e4,0x4e704e6,0x4200400,0x4600440,0x4020480,0x4420422,0x4080462,0x4480428,0x4880468
.long 0x42a040a,0x46a044a,0x41c041c,0x41c041c,0x41c041c,0x41c041c,0x41c041c,0x41c041c,0x41c041c,0x41c041c,0x41c041c,0x41c041c,0x41c041c,0x41c041c,0x41c041c,0x41c041c
.long 0x6020600,0x60a0608,0x6120610,0x61a0618,0x6220620,0x62a0628,0x6320630,0x63a0638,0x6420640,0x64a0648,0x6580650,0x4b60496,0x4be049e,0x4c604a6,0x4ce04ae,0x6880687
.long 0x4f804f1,0x6000600,0x6000600,0x6000600,0x6000600,0x6000600,0x6000600,0x6000600,0x6000600,0x6000600,0x6000600,0x6000600,0x6000600,0x6000600,0x6000600,0x6000600
.long 0x2510250,0x2530252,0x2550254,0x2570256,0x2590258,0x25b025a,0x25d025c,0x25f025e,0x2500250,0x2500250,0x2500250,0x2500250,0x2500250,0x2500250,0x2500250,0x2500250
.long 0x2500250,0x2500250,0x2500250,0x2500250,0x2500250,0x2500250,0x2500250,0x2500250,0x2500250,0x2500250,0x2500250,0x2500250,0x2500250,0x2500250,0x2500250,0x2500250
.long 0x43c041c,0x47c045c,0x41e048e,0x45e043e,0x4dd047e,0x4df04de,0x4e304e2,0x4e504e4,0x4e704e6,0x4380418,0x4780458,0x41a048a,0x45a043a,0x41c047a,0x41c041c,0x41c041c
.long 0x41c041c,0x41c041c,0x41c041c,0x41c041c,0x41c041c,0x41c041c,0x41c041c,0x41c041c,0x41c041c,0x41c041c,0x41c041c,0x41c041c,0x41c041c,0x41c041c,0x41c041c,0x41c041c
.long 0x60b0603,0x6190613,0x621061b,0x6290623,0x6390631,0x4960641,0x49e04b6,0x4a604be,0x4ae04c6,0x68704ce,0x4f10688,0x60304f8,0x6030603,0x6030603,0x6030603,0x6030603
.long 0x6030603,0x6030603,0x6030603,0x6030603,0x6030603,0x6030603,0x6030603,0x6030603,0x6030603,0x6030603,0x6030603,0x6030603,0x6030603,0x6030603,0x6030603,0x6030603
.long 0x2110210,0x2130212,0x2150214,0x2170216,0x2190218,0x21b021a,0x21d021c,0x21f021e,0x2100210,0x2100210,0x2100210,0x2100210,0x2100210,0x2100210,0x2100210,0x2100210
.long 0x2100210,0x2100210,0x2100210,0x2100210,0x2100210,0x2100210,0x2100210,0x2100210,0x2100210,0x2100210,0x2100210,0x2100210,0x2100210,0x2100210,0x2100210,0x2100210
.long 0x42d040d,0x46d044d,0x40f048d,0x44f042f,0x401046f,0x4410421,0x4810461,0x4230403,0x4630443,0x4290409,0x4690449,0x40b0489,0x44b042b,0x40d046b,0x40d040d,0x40d040d
.long 0x40d040d,0x40d040d,0x40d040d,0x40d040d,0x40d040d,0x40d040d,0x40d040d,0x40d040d,0x40d040d,0x40d040d,0x40d040d,0x40d040d,0x40d040d,0x40d040d,0x40d040d,0x40d040d
.long 0x6060604,0x60e060c,0x6160614,0x61e061c,0x6260624,0x62e062c,0x6360634,0x63e063c,0x6460644,0x64e064c,0x65c0654,0x49b0493,0x4ab04a3,0x67e067d,0x60404f6,0x6040604
.long 0x6040604,0x6040604,0x6040604,0x6040604,0x6040604,0x6040604,0x6040604,0x6040604,0x6040604,0x6040604,0x6040604,0x6040604,0x6040604,0x6040604,0x6040604,0x6040604
.long 0x2510250,0x2530252,0x2550254,0x2570256,0x2590258,0x25b025a,0x25d025c,0x25f025e,0x2500250,0x2500250,0x2500250,0x2500250,0x2500250,0x2500250,0x2500250,0x2500250
.long 0x2500250,0x2500250,0x2500250,0x2500250,0x2500250,0x2500250,0x2500250,0x2500250,0x2500250,0x2500250,0x2500250,0x2500250,0x2500250,0x2500250,0x2500250,0x2500250
.long 0x4250405,0x4650445,0x4070485,0x4470427,0x4190467,0x4590439,0x48b0479,0x43b041b,0x47b045b,0x4050405,0x4050405,0x4050405,0x4050405,0x4050405,0x4050405,0x4050405
.long 0x4050405,0x4050405,0x4050405,0x4050405,0x4050405,0x4050405,0x4050405,0x4050405,0x4050405,0x4050405,0x4050405,0x4050405,0x4050405,0x4050405,0x4050405,0x4050405
.long 0x60f0607,0x61d0617,0x625061f,0x62d0627,0x63d0635,0x4930645,0x4a3049b,0x67d04ab,0x4f6067e,0x6070607,0x6070607,0x6070607,0x6070607,0x6070607,0x6070607,0x6070607
.long 0x6070607,0x6070607,0x6070607,0x6070607,0x6070607,0x6070607,0x6070607,0x6070607,0x6070607,0x6070607,0x6070607,0x6070607,0x6070607,0x6070607,0x6070607,0x6070607
.long 0x2110210,0x2130212,0x2150214,0x2170216,0x2190218,0x21b021a,0x21d021c,0x21f021e,0x2100210,0x2100210,0x2100210,0x2100210,0x2100210,0x2100210,0x2100210,0x2100210
.long 0x2100210,0x2100210,0x2100210,0x2100210,0x2100210,0x2100210,0x2100210,0x2100210,0x2100210,0x2100210,0x2100210,0x2100210,0x2100210,0x2100210,0x2100210,0x2100210
.long 0x43d041d,0x47d045d,0x41f048f,0x45f043f,0x4dd047f,0x4df04de,0x4e304e2,0x4e504e4,0x4e704e6,0x4210401,0x4610441,0x4030481,0x4430423,0x4090463,0x4490429,0x4890469
.long 0x42b040b,0x46b044b,0x41d041d,0x41d041d,0x41d041d,0x41d041d,0x41d041d,0x41d041d,0x41d041d,0x41d041d,0x41d041d,0x41d041d,0x41d041d,0x41d041d,0x41d041d,0x41d041d
.long 0x6060604,0x60e060c,0x6160614,0x61e061c,0x6260624,0x62e062c,0x6360634,0x63e063c,0x6460644,0x64e064c,0x65c0654,0x4b70497,0x4bf049f,0x4c704a7,0x4cf04af,0x6880687
.long 0x4f804f1,0x6040604,0x6040604,0x6040604,0x6040604,0x6040604,0x6040604,0x6040604,0x6040604,0x6040604,0x6040604,0x6040604,0x6040604,0x6040604,0x6040604,0x6040604
.long 0x2510250,0x2530252,0x2550254,0x2570256,0x2590258,0x25b025a,0x25d025c,0x25f025e,0x2500250,0x2500250,0x2500250,0x2500250,0x2500250,0x2500250,0x2500250,0x2500250
.long 0x2500250,0x2500250,0x2500250,0x2500250,0x2500250,0x2500250,0x2500250,0x2500250,0x2500250,0x2500250,0x2500250,0x2500250,0x2500250,0x2500250,0x2500250,0x2500250
.long 0x43d041d,0x47d045d,0x41f048f,0x45f043f,0x4dd047f,0x4df04de,0x4e304e2,0x4e504e4,0x4e704e6,0x4390419,0x4790459,0x41b048b,0x45b043b,0x41d047b,0x41d041d,0x41d041d
.long 0x41d041d,0x41d041d,0x41d041d,0x41d041d,0x41d041d,0x41d041d,0x41d041d,0x41d041d,0x41d041d,0x41d041d,0x41d041d,0x41d041d,0x41d041d,0x41d041d,0x41d041d,0x41d041d
.long 0x60f0607,0x61d0617,0x625061f,0x62d0627,0x63d0635,0x4970645,0x49f04b7,0x4a704bf,0x4af04c7,0x68704cf,0x4f10688,0x60704f8,0x6070607,0x6070607,0x6070607,0x6070607
.long 0x6070607,0x6070607,0x6070607,0x6070607,0x6070607,0x6070607,0x6070607,0x6070607,0x6070607,0x6070607,0x6070607,0x6070607,0x6070607,0x6070607,0x6070607,0x6070607
.long 0x2210220,0x2230222,0x2250224,0x2270226,0x2290228,0x22b022a,0x22d022c,0x22f022e,0x2200220,0x2200220,0x2200220,0x2200220,0x2200220,0x2200220,0x2200220,0x2200220
.long 0x2200220,0x2200220,0x2200220,0x2200220,0x2200220,0x2200220,0x2200220,0x2200220,0x2200220,0x2200220,0x2200220,0x2200220,0x2200220,0x2200220,0x2200220,0x2200220
.long 0x42c040c,0x46c044c,0x40e048c,0x44e042e,0x400046e,0x4400420,0x4800460,0x4220402,0x4620442,0x4280408,0x4680448,0x40a0488,0x44a042a,0x40c046a,0x40c040c,0x40c040c
.long 0x40c040c,0x40c040c,0x40c040c,0x40c040c,0x40c040c,0x40c040c,0x40c040c,0x40c040c,0x40c040c,0x40c040c,0x40c040c,0x40c040c,0x40c040c,0x40c040c,0x40c040c,0x40c040c
.long 0x6020600,0x60a0608,0x6120610,0x61a0618,0x6220620,0x62a0628,0x6320630,0x63a0638,0x6420640,0x64a0648,0x6580650,0x4ba04b2,0x4ca04c2,0x6810680,0x60004f7,0x6000600
.long 0x6000600,0x6000600,0x6000600,0x6000600,0x6000600,0x6000600,0x6000600,0x6000600,0x6000600,0x6000600,0x6000600,0x6000600,0x6000600,0x6000600,0x6000600,0x6000600
.long 0x2610260,0x2630262,0x2650264,0x2670266,0x2690268,0x26b026a,0x26d026c,0x26f026e,0x2600260,0x2600260,0x2600260,0x2600260,0x2600260,0x2600260,0x2600260,0x2600260
.long 0x2600260,0x2600260,0x2600260,0x2600260,0x2600260,0x2600260,0x2600260,0x2600260,0x2600260,0x2600260,0x2600260,0x2600260,0x2600260,0x2600260,0x2600260,0x2600260
.long 0x4240404,0x4640444,0x4060484,0x4460426,0x4180466,0x4580438,0x48a0478,0x43a041a,0x47a045a,0x4040404,0x4040404,0x4040404,0x4040404,0x4040404,0x4040404,0x4040404
.long 0x4040404,0x4040404,0x4040404,0x4040404,0x4040404,0x4040404,0x4040404,0x4040404,0x4040404,0x4040404,0x4040404,0x4040404,0x4040404,0x4040404,0x4040404,0x4040404
.long 0x60b0603,0x6190613,0x621061b,0x6290623,0x6390631,0x4b20641,0x4c204ba,0x68004ca,0x4f70681,0x6030603,0x6030603,0x6030603,0x6030603,0x6030603,0x6030603,0x6030603
.long 0x6030603,0x6030603,0x6030603,0x6030603,0x6030603,0x6030603,0x6030603,0x6030603,0x6030603,0x6030603,0x6030603,0x6030603,0x6030603,0x6030603,0x6030603,0x6030603
.long 0x2210220,0x2230222,0x2250224,0x2270226,0x2290228,0x22b022a,0x22d022c,0x22f022e,0x2200220,0x2200220,0x2200220,0x2200220,0x2200220,0x2200220,0x2200220,0x2200220
.long 0x2200220,0x2200220,0x2200220,0x2200220,0x2200220,0x2200220,0x2200220,0x2200220,0x2200220,0x2200220,0x2200220,0x2200220,0x2200220,0x2200220,0x2200220,0x2200220
.long 0x4340414,0x4740454,0x4160486,0x4560436,0x4080476,0x4480428,0x4880468,0x42a040a,0x46a044a,0x4300410,0x4700450,0x4120482,0x4520432,0x4140472,0x4140414,0x4140414
.long 0x4140414,0x4140414,0x4140414,0x4140414,0x4140414,0x4140414,0x4140414,0x4140414,0x4140414,0x4140414,0x4140414,0x4140414,0x4140414,0x4140414,0x4140414,0x4140414
.long 0x6020600,0x60a0608,0x6120610,0x61a0618,0x6220620,0x62a0628,0x6320630,0x63a0638,0x6420640,0x64a0648,0x6580650,0x4d004b6,0x4d204be,0x4d404c6,0x4d604ce,0x68a0689
.long 0x4f904f8,0x6000600,0x6000600,0x6000600,0x6000600,0x6000600,0x6000600,0x6000600,0x6000600,0x6000600,0x6000600,0x6000600,0x6000600,0x6000600,0x6000600,0x6000600
.long 0x2610260,0x2630262,0x2650264,0x2670266,0x2690268,0x26b026a,0x26d026c,0x26f026e,0x2600260,0x2600260,0x2600260,0x2600260,0x2600260,0x2600260,0x2600260,0x2600260
.long 0x2600260,0x2600260,0x2600260,0x2600260,0x2600260,0x2600260,0x2600260,0x2600260,0x2600260,0x2600260,0x2600260,0x2600260,0x2600260,0x2600260,0x2600260,0x2600260
.long 0x4240404,0x4640444,0x4060484,0x4460426,0x4180466,0x4580438,0x48a0478,0x43a041a,0x47a045a,0x4d904d8,0x4e104e0,0x4e904e8,0x4db04da,0x40404dc,0x4040404,0x4040404
.long 0x4040404,0x4040404,0x4040404,0x4040404,0x4040404,0x4040404,0x4040404,0x4040404,0x4040404,0x4040404,0x4040404,0x4040404,0x4040404,0x4040404,0x4040404,0x4040404
.long 0x60b0603,0x6190613,0x621061b,0x6290623,0x6390631,0x4b60641,0x4be04d0,0x4c604d2,0x4ce04d4,0x68904d6,0x4f8068a,0x60304f9,0x6030603,0x6030603,0x6030603,0x6030603
.long 0x6030603,0x6030603,0x6030603,0x6030603,0x6030603,0x6030603,0x6030603,0x6030603,0x6030603,0x6030603,0x6030603,0x6030603,0x6030603,0x6030603,0x6030603,0x6030603
.long 0x2210220,0x2230222,0x2250224,0x2270226,0x2290228,0x22b022a,0x22d022c,0x22f022e,0x2200220,0x2200220,0x2200220,0x2200220,0x2200220,0x2200220,0x2200220,0x2200220
.long 0x2200220,0x2200220,0x2200220,0x2200220,0x2200220,0x2200220,0x2200220,0x2200220,0x2200220,0x2200220,0x2200220,0x2200220,0x2200220,0x2200220,0x2200220,0x2200220
.long 0x42d040d,0x46d044d,0x40f048d,0x44f042f,0x401046f,0x4410421,0x4810461,0x4230403,0x4630443,0x4290409,0x4690449,0x40b0489,0x44b042b,0x40d046b,0x40d040d,0x40d040d
.long 0x40d040d,0x40d040d,0x40d040d,0x40d040d,0x40d040d,0x40d040d,0x40d040d,0x40d040d,0x40d040d,0x40d040d,0x40d040d,0x40d040d,0x40d040d,0x40d040d,0x40d040d,0x40d040d
.long 0x6060604,0x60e060c,0x6160614,0x61e061c,0x6260624,0x62e062c,0x6360634,0x63e063c,0x6460644,0x64e064c,0x65c0654,0x4bb04b3,0x4cb04c3,0x6810680,0x60404f7,0x6040604
.long 0x6040604,0x6040604,0x6040604,0x6040604,0x6040604,0x6040604,0x6040604,0x6040604,0x6040604,0x6040604,0x6040604,0x6040604,0x6040604,0x6040604,0x6040604,0x6040604
.long 0x2610260,0x2630262,0x2650264,0x2670266,0x2690268,0x26b026a,0x26d026c,0x26f026e,0x2600260,0x2600260,0x2600260,0x2600260,0x2600260,0x2600260,0x2600260,0x2600260
.long 0x2600260,0x2600260,0x2600260,0x2600260,0x2600260,0x2600260,0x2600260,0x2600260,0x2600260,0x2600260,0x2600260,0x2600260,0x2600260,0x2600260,0x2600260,0x2600260
.long 0x4250405,0x4650445,0x4070485,0x4470427,0x4190467,0x4590439,0x48b0479,0x43b041b,0x47b045b,0x4050405,0x4050405,0x4050405,0x4050405,0x4050405,0x4050405,0x4050405
.long 0x4050405,0x4050405,0x4050405,0x4050405,0x4050405,0x4050405,0x4050405,0x4050405,0x4050405,0x4050405,0x4050405,0x4050405,0x4050405,0x4050405,0x4050405,0x4050405
.long 0x60f0607,0x61d0617,0x625061f,0x62d0627,0x63d0635,0x4b30645,0x4c304bb,0x68004cb,0x4f70681,0x6070607,0x6070607,0x6070607,0x6070607,0x6070607,0x6070607,0x6070607
.long 0x6070607,0x6070607,0x6070607,0x6070607,0x6070607,0x6070607,0x6070607,0x6070607,0x6070607,0x6070607,0x6070607,0x6070607,0x6070607,0x6070607,0x6070607,0x6070607
.long 0x2210220,0x2230222,0x2250224,0x2270226,0x2290228,0x22b022a,0x22d022c,0x22f022e,0x2200220,0x2200220,0x2200220,0x2200220,0x2200220,0x2200220,0x2200220,0x2200220
.long 0x2200220,0x2200220,0x2200220,0x2200220,0x2200220,0x2200220,0x2200220,0x2200220,0x2200220,0x2200220,0x2200220,0x2200220,0x2200220,0x2200220,0x2200220,0x2200220
.long 0x4350415,0x4750455,0x4170487,0x4570437,0x4090477,0x4490429,0x4890469,0x42b040b,0x46b044b,0x4310411,0x4710451,0x4130483,0x4530433,0x4150473,0x4150415,0x4150415
.long 0x4150415,0x4150415,0x4150415,0x4150415,0x4150415,0x4150415,0x4150415,0x4150415,0x4150415,0x4150415,0x4150415,0x4150415,0x4150415,0x4150415,0x4150415,0x4150415
.long 0x6060604,0x60e060c,0x6160614,0x61e061c,0x6260624,0x62e062c,0x6360634,0x63e063c,0x6460644,0x64e064c,0x65c0654,0x4d104b7,0x4d304bf,0x4d504c7,0x4d704cf,0x68a0689
.long 0x4f904f8,0x6040604,0x6040604,0x6040604,0x6040604,0x6040604,0x6040604,0x6040604,0x6040604,0x6040604,0x6040604,0x6040604,0x6040604,0x6040604,0x6040604,0x6040604
.long 0x2610260,0x2630262,0x2650264,0x2670266,0x2690268,0x26b026a,0x26d026c,0x26f026e,0x2600260,0x2600260,0x2600260,0x2600260,0x2600260,0x2600260,0x2600260,0x2600260
.long 0x2600260,0x2600260,0x2600260,0x2600260,0x2600260,0x2600260,0x2600260,0x2600260,0x2600260,0x2600260,0x2600260,0x2600260,0x2600260,0x2600260,0x2600260,0x2600260
.long 0x4250405,0x4650445,0x4070485,0x4470427,0x4190467,0x4590439,0x48b0479,0x43b041b,0x47b045b,0x4d904d8,0x4e104e0,0x4e904e8,0x4db04da,0x40504dc,0x4050405,0x4050405
.long 0x4050405,0x4050405,0x4050405,0x4050405,0x4050405,0x4050405,0x4050405,0x4050405,0x4050405,0x4050405,0x4050405,0x4050405,0x4050405,0x4050405,0x4050405,0x4050405
.long 0x60f0607,0x61d0617,0x625061f,0x62d0627,0x63d0635,0x4b70645,0x4bf04d1,0x4c704d3,0x4cf04d5,0x68904d7,0x4f8068a,0x60704f9,0x6070607,0x6070607,0x6070607,0x6070607
.long 0x6070607,0x6070607,0x6070607,0x6070607,0x6070607,0x6070607,0x6070607,0x6070607,0x6070607,0x6070607,0x6070607,0x6070607,0x6070607,0x6070607,0x6070607,0x6070607
.long 0x2310230,0x2330232,0x2350234,0x2370236,0x2390238,0x23b023a,0x23d023c,0x23f023e,0x2300230,0x2300230,0x2300230,0x2300230,0x2300230,0x2300230,0x2300230,0x2300230
.long 0x2300230,0x2300230,0x2300230,0x2300230,0x2300230,0x2300230,0x2300230,0x2300230,0x2300230,0x2300230,0x2300230,0x2300230,0x2300230,0x2300230,0x2300230,0x2300230
.long 0x42c040c,0x46c044c,0x40e048c,0x44e042e,0x414046e,0x4540434,0x4860474,0x4360416,0x4760456,0x4200400,0x4600440,0x4020480,0x4420422,0x4080462,0x4480428,0x4880468
.long 0x42a040a,0x46a044a,0x40c040c,0x40c040c,0x40c040c,0x40c040c,0x40c040c,0x40c040c,0x40c040c,0x40c040c,0x40c040c,0x40c040c,0x40c040c,0x40c040c,0x40c040c,0x40c040c
.long 0x6020600,0x60a0608,0x6120610,0x61a0618,0x6220620,0x62a0628,0x6320630,0x63a0638,0x6420640,0x64a0648,0x6580650,0x49404b2,0x49c04ba,0x4a404c2,0x4ac04ca,0x6820681
.long 0x60004f7,0x6000600,0x6000600,0x6000600,0x6000600,0x6000600,0x6000600,0x6000600,0x6000600,0x6000600,0x6000600,0x6000600,0x6000600,0x6000600,0x6000600,0x6000600
.long 0x2710270,0x2730272,0x2750274,0x2770276,0x2790278,0x27b027a,0x27d027c,0x27f027e,0x2700270,0x2700270,0x2700270,0x2700270,0x2700270,0x2700270,0x2700270,0x2700270
.long 0x2700270,0x2700270,0x2700270,0x2700270,0x2700270,0x2700270,0x2700270,0x2700270,0x2700270,0x2700270,0x2700270,0x2700270,0x2700270,0x2700270,0x2700270,0x2700270
.long 0x4240404,0x4640444,0x4060484,0x4460426,0x40c0466,0x44c042c,0x48c046c,0x42e040e,0x46e044e,0x4380418,0x4780458,0x41a048a,0x45a043a,0x404047a,0x4040404,0x4040404
.long 0x4040404,0x4040404,0x4040404,0x4040404,0x4040404,0x4040404,0x4040404,0x4040404,0x4040404,0x4040404,0x4040404,0x4040404,0x4040404,0x4040404,0x4040404,0x4040404
.long 0x60b0603,0x6190613,0x621061b,0x6290623,0x6390631,0x4b20641,0x4ba0494,0x4c2049c,0x4ca04a4,0x68104ac,0x4f70682,0x6030603,0x6030603,0x6030603,0x6030603,0x6030603
.long 0x6030603,0x6030603,0x6030603,0x6030603,0x6030603,0x6030603,0x6030603,0x6030603,0x6030603,0x6030603,0x6030603,0x6030603,0x6030603,0x6030603,0x6030603,0x6030603
.long 0x2310230,0x2330232,0x2350234,0x2370236,0x2390238,0x23b023a,0x23d023c,0x23f023e,0x2300230,0x2300230,0x2300230,0x2300230,0x2300230,0x2300230,0x2300230,0x2300230
.long 0x2300230,0x2300230,0x2300230,0x2300230,0x2300230,0x2300230,0x2300230,0x2300230,0x2300230,0x2300230,0x2300230,0x2300230,0x2300230,0x2300230,0x2300230,0x2300230
.long 0x4340414,0x4740454,0x4160486,0x4560436,0x4080476,0x4480428,0x4880468,0x42a040a,0x46a044a,0x4300410,0x4700450,0x4120482,0x4520432,0x4140472,0x4140414,0x4140414
.long 0x4140414,0x4140414,0x4140414,0x4140414,0x4140414,0x4140414,0x4140414,0x4140414,0x4140414,0x4140414,0x4140414,0x4140414,0x4140414,0x4140414,0x4140414,0x4140414
.long 0x6020600,0x60a0608,0x6120610,0x61a0618,0x6220620,0x62a0628,0x6320630,0x63a0638,0x6420640,0x64a0648,0x6580650,0x4d204d0,0x4d604d4,0x68b068a,0x60004f9,0x6000600
.long 0x6000600,0x6000600,0x6000600,0x6000600,0x6000600,0x6000600,0x6000600,0x6000600,0x6000600,0x6000600,0x6000600,0x6000600,0x6000600,0x6000600,0x6000600,0x6000600
.long 0x2710270,0x2730272,0x2750274,0x2770276,0x2790278,0x27b027a,0x27d027c,0x27f027e,0x2700270,0x2700270,0x2700270,0x2700270,0x2700270,0x2700270,0x2700270,0x2700270
.long 0x2700270,0x2700270,0x2700270,0x2700270,0x2700270,0x2700270,0x2700270,0x2700270,0x2700270,0x2700270,0x2700270,0x2700270,0x2700270,0x2700270,0x2700270,0x2700270
.long 0x4240404,0x4640444,0x4060484,0x4460426,0x40c0466,0x44c042c,0x48c046c,0x42e040e,0x46e044e,0x4380418,0x4780458,0x41a048a,0x45a043a,0x4d8047a,0x4e004d9,0x4e804e1
.long 0x4da04e9,0x4dc04db,0x4040404,0x4040404,0x4040404,0x4040404,0x4040404,0x4040404,0x4040404,0x4040404,0x4040404,0x4040404,0x4040404,0x4040404,0x4040404,0x4040404
.long 0x60b0603,0x6190613,0x621061b,0x6290623,0x6390631,0x4d00641,0x4d404d2,0x68a04d6,0x4f9068b,0x6030603,0x6030603,0x6030603,0x6030603,0x6030603,0x6030603,0x6030603
.long 0x6030603,0x6030603,0x6030603,0x6030603,0x6030603,0x6030603,0x6030603,0x6030603,0x6030603,0x6030603,0x6030603,0x6030603,0x6030603,0x6030603,0x6030603,0x6030603
.long 0x2310230,0x2330232,0x2350234,0x2370236,0x2390238,0x23b023a,0x23d023c,0x23f023e,0x2300230,0x2300230,0x2300230,0x2300230,0x2300230,0x2300230,0x2300230,0x2300230
.long 0x2300230,0x2300230,0x2300230,0x2300230,0x2300230,0x2300230,0x2300230,0x2300230,0x2300230,0x2300230,0x2300230,0x2300230,0x2300230,0x2300230,0x2300230,0x2300230
.long 0x42d040d,0x46d044d,0x40f048d,0x44f042f,0x415046f,0x4550435,0x4870475,0x4370417,0x4770457,0x4210401,0x4610441,0x4030481,0x4430423,0x4090463,0x4490429,0x4890469
.long 0x42b040b,0x46b044b,0x40d040d,0x40d040d,0x40d040d,0x40d040d,0x40d040d,0x40d040d,0x40d040d,0x40d040d,0x40d040d,0x40d040d,0x40d040d,0x40d040d,0x40d040d,0x40d040d
.long 0x6060604,0x60e060c,0x6160614,0x61e061c,0x6260624,0x62e062c,0x6360634,0x63e063c,0x6460644,0x64e064c,0x65c0654,0x49504b3,0x49d04bb,0x4a504c3,0x4ad04cb,0x6820681
.long 0x60404f7,0x6040604,0x6040604,0x6040604,0x6040604,0x6040604,0x6040604,0x6040604,0x6040604,0x6040604,0x6040604,0x6040604,0x6040604,0x6040604,0x6040604,0x6040604
.long 0x2710270,0x2730272,0x2750274,0x2770276,0x2790278,0x27b027a,0x27d027c,0x27f027e,0x2700270,0x2700270,0x2700270,0x2700270,0x2700270,0x2700270,0x2700270,0x2700270
.long 0x2700270,0x2700270,0x2700270,0x2700270,0x2700270,0x2700270,0x2700270,0x2700270,0x2700270,0x2700270,0x2700270,0x2700270,0x2700270,0x2700270,0x2700270,0x2700270
.long 0x4250405,0x4650445,0x4070485,0x4470427,0x40d0467,0x44d042d,0x48d046d,0x42f040f,0x46f044f,0x4390419,0x4790459,0x41b048b,0x45b043b,0x405047b,0x4050405,0x4050405
.long 0x4050405,0x4050405,0x4050405,0x4050405,0x4050405,0x4050405,0x4050405,0x4050405,0x4050405,0x4050405,0x4050405,0x4050405,0x4050405,0x4050405,0x4050405,0x4050405
.long 0x60f0607,0x61d0617,0x625061f,0x62d0627,0x63d0635,0x4b30645,0x4bb0495,0x4c3049d,0x4cb04a5,0x68104ad,0x4f70682,0x6070607,0x6070607,0x6070607,0x6070607,0x6070607
.long 0x6070607,0x6070607,0x6070607,0x6070607,0x6070607,0x6070607,0x6070607,0x6070607,0x6070607,0x6070607,0x6070607,0x6070607,0x6070607,0x6070607,0x6070607,0x6070607
.long 0x2310230,0x2330232,0x2350234,0x2370236,0x2390238,0x23b023a,0x23d023c,0x23f023e,0x2300230,0x2300230,0x2300230,0x2300230,0x2300230,0x2300230,0x2300230,0x2300230
.long 0x2300230,0x2300230,0x2300230,0x2300230,0x2300230,0x2300230,0x2300230,0x2300230,0x2300230,0x2300230,0x2300230,0x2300230,0x2300230,0x2300230,0x2300230,0x2300230
.long 0x4350415,0x4750455,0x4170487,0x4570437,0x4090477,0x4490429,0x4890469,0x42b040b,0x46b044b,0x4310411,0x4710451,0x4130483,0x4530433,0x4150473,0x4150415,0x4150415
.long 0x4150415,0x4150415,0x4150415,0x4150415,0x4150415,0x4150415,0x4150415,0x4150415,0x4150415,0x4150415,0x4150415,0x4150415,0x4150415,0x4150415,0x4150415,0x4150415
.long 0x6060604,0x60e060c,0x6160614,0x61e061c,0x6260624,0x62e062c,0x6360634,0x63e063c,0x6460644,0x64e064c,0x65c0654,0x4d304d1,0x4d704d5,0x68b068a,0x60404f9,0x6040604
.long 0x6040604,0x6040604,0x6040604,0x6040604,0x6040604,0x6040604,0x6040604,0x6040604,0x6040604,0x6040604,0x6040604,0x6040604,0x6040604,0x6040604,0x6040604,0x6040604
.long 0x2710270,0x2730272,0x2750274,0x2770276,0x2790278,0x27b027a,0x27d027c,0x27f027e,0x2700270,0x2700270,0x2700270,0x2700270,0x2700270,0x2700270,0x2700270,0x2700270
.long 0x2700270,0x2700270,0x2700270,0x2700270,0x2700270,0x2700270,0x2700270,0x2700270,0x2700270,0x2700270,0x2700270,0x2700270,0x2700270,0x2700270,0x2700270,0x2700270
.long 0x4250405,0x4650445,0x4070485,0x4470427,0x40d0467,0x44d042d,0x48d046d,0x42f040f,0x46f044f,0x4390419,0x4790459,0x41b048b,0x45b043b,0x4d8047b,0x4e004d9,0x4e804e1
.long 0x4da04e9,0x4dc04db,0x4050405,0x4050405,0x4050405,0x4050405,0x4050405,0x4050405,0x4050405,0x4050405,0x4050405,0x4050405,0x4050405,0x4050405,0x4050405,0x4050405
.long 0x60f0607,0x61d0617,0x625061f,0x62d0627,0x63d0635,0x4d10645,0x4d504d3,0x68a04d7,0x4f9068b,0x6070607,0x6070607,0x6070607,0x6070607,0x6070607,0x6070607,0x6070607
.long 0x6070607,0x6070607,0x6070607,0x6070607,0x6070607,0x6070607,0x6070607,0x6070607,0x6070607,0x6070607,0x6070607,0x6070607,0x6070607,0x6070607,0x6070607,0x6070607
.long 0x2010200,0x2030202,0x2050204,0x2070206,0x2090208,0x20b020a,0x20d020c,0x20f020e,0x2000200,0x2000200,0x2000200,0x2000200,0x2000200,0x2000200,0x2000200,0x2000200
.long 0x2000200,0x2000200,0x2000200,0x2000200,0x2000200,0x2000200,0x2000200,0x2000200,0x2000200,0x2000200,0x2000200,0x2000200,0x2000200,0x2000200,0x2000200,0x2000200
.long 0x4240404,0x4640444,0x4060484,0x4460426,0x4080466,0x4480428,0x4880468,0x42a040a,0x46a044a,0x4300410,0x4700450,0x4120482,0x4520432,0x4040472,0x4040404,0x4040404
.long 0x4040404,0x4040404,0x4040404,0x4040404,0x4040404,0x4040404,0x4040404,0x4040404,0x4040404,0x4040404,0x4040404,0x4040404,0x4040404,0x4040404,0x4040404,0x4040404
.long 0x630062a,0x6380632,0x640063a,0x6480642,0x650064a,0x4900658,0x4a00498,0x67804a8,0x4f50679,0x62a062a,0x62a062a,0x62a062a,0x62a062a,0x62a062a,0x62a062a,0x62a062a
.long 0x62a062a,0x62a062a,0x62a062a,0x62a062a,0x62a062a,0x62a062a,0x62a062a,0x62a062a,0x62a062a,0x62a062a,0x62a062a,0x62a062a,0x62a062a,0x62a062a,0x62a062a,0x62a062a
.long 0x2410240,0x2430242,0x2450244,0x2470246,0x2490248,0x24b024a,0x24d024c,0x24f024e,0x2400240,0x2400240,0x2400240,0x2400240,0x2400240,0x2400240,0x2400240,0x2400240
.long 0x2400240,0x2400240,0x2400240,0x2400240,0x2400240,0x2400240,0x2400240,0x2400240,0x2400240,0x2400240,0x2400240,0x2400240,0x2400240,0x2400240,0x2400240,0x2400240
.long 0x42c040c,0x46c044c,0x40e048c,0x44e042e,0x418046e,0x4580438,0x48a0478,0x43a041a,0x47a045a,0x40c040c,0x40c040c,0x40c040c,0x40c040c,0x40c040c,0x40c040c,0x40c040c
.long 0x40c040c,0x40c040c,0x40c040c,0x40c040c,0x40c040c,0x40c040c,0x40c040c,0x40c040c,0x40c040c,0x40c040c,0x40c040c,0x40c040c,0x40c040c,0x40c040c,0x40c040c,0x40c040c
.long 0x633062b,0x643063b,0x64b0649,0x6590651,0x6690661,0x4900671,0x4a00498,0x67804a8,0x4f50679,0x62b062b,0x62b062b,0x62b062b,0x62b062b,0x62b062b,0x62b062b,0x62b062b
.long 0x62b062b,0x62b062b,0x62b062b,0x62b062b,0x62b062b,0x62b062b,0x62b062b,0x62b062b,0x62b062b,0x62b062b,0x62b062b,0x62b062b,0x62b062b,0x62b062b,0x62b062b,0x62b062b
.long 0x2010200,0x2030202,0x2050204,0x2070206,0x2090208,0x20b020a,0x20d020c,0x20f020e,0x2000200,0x2000200,0x2000200,0x2000200,0x2000200,0x2000200,0x2000200,0x2000200
.long 0x2000200,0x2000200,0x2000200,0x2000200,0x2000200,0x2000200,0x2000200,0x2000200,0x2000200,0x2000200,0x2000200,0x2000200,0x2000200,0x2000200,0x2000200,0x2000200
.long 0x43c041c,0x47c045c,0x41e048e,0x45e043e,0x408047e,0x4480428,0x4880468,0x42a040a,0x46a044a,0x4300410,0x4700450,0x4120482,0x4520432,0x41c0472,0x41c041c,0x41c041c
.long 0x41c041c,0x41c041c,0x41c041c,0x41c041c,0x41c041c,0x41c041c,0x41c041c,0x41c041c,0x41c041c,0x41c041c,0x41c041c,0x41c041c,0x41c041c,0x41c041c,0x41c041c,0x41c041c
.long 0x630062a,0x6380632,0x640063a,0x6480642,0x650064a,0x4940658,0x49c04b4,0x4a404bc,0x4ac04c4,0x68304cc,0x4f00684,0x62a062a,0x62a062a,0x62a062a,0x62a062a,0x62a062a
.long 0x62a062a,0x62a062a,0x62a062a,0x62a062a,0x62a062a,0x62a062a,0x62a062a,0x62a062a,0x62a062a,0x62a062a,0x62a062a,0x62a062a,0x62a062a,0x62a062a,0x62a062a,0x62a062a
.long 0x2410240,0x2430242,0x2450244,0x2470246,0x2490248,0x24b024a,0x24d024c,0x24f024e,0x2400240,0x2400240,0x2400240,0x2400240,0x2400240,0x2400240,0x2400240,0x2400240
.long 0x2400240,0x2400240,0x2400240,0x2400240,0x2400240,0x2400240,0x2400240,0x2400240,0x2400240,0x2400240,0x2400240,0x2400240,0x2400240,0x2400240,0x2400240,0x2400240
.long 0x42c040c,0x46c044c,0x40e048c,0x44e042e,0x414046e,0x4540434,0x4860474,0x4360416,0x4760456,0x4380418,0x4780458,0x41a048a,0x45a043a,0x4d8047a,0x4e004d9,0x4e804e1
.long 0x4da04e9,0x4dc04db,0x40c040c,0x40c040c,0x40c040c,0x40c040c,0x40c040c,0x40c040c,0x40c040c,0x40c040c,0x40c040c,0x40c040c,0x40c040c,0x40c040c,0x40c040c,0x40c040c
.long 0x633062b,0x643063b,0x64b0649,0x6590651,0x6690661,0x4940671,0x49c04b4,0x4a404bc,0x4ac04c4,0x68304cc,0x4f00684,0x62b062b,0x62b062b,0x62b062b,0x62b062b,0x62b062b
.long 0x62b062b,0x62b062b,0x62b062b,0x62b062b,0x62b062b,0x62b062b,0x62b062b,0x62b062b,0x62b062b,0x62b062b,0x62b062b,0x62b062b,0x62b062b,0x62b062b,0x62b062b,0x62b062b
.long 0x2010200,0x2030202,0x2050204,0x2070206,0x2090208,0x20b020a,0x20d020c,0x20f020e,0x2000200,0x2000200,0x2000200,0x2000200,0x2000200,0x2000200,0x2000200,0x2000200
.long 0x2000200,0x2000200,0x2000200,0x2000200,0x2000200,0x2000200,0x2000200,0x2000200,0x2000200,0x2000200,0x2000200,0x2000200,0x2000200,0x2000200,0x2000200,0x2000200
.long 0x4250405,0x4650445,0x4070485,0x4470427,0x4090467,0x4490429,0x4890469,0x42b040b,0x46b044b,0x4310411,0x4710451,0x4130483,0x4530433,0x4050473,0x4050405,0x4050405
.long 0x4050405,0x4050405,0x4050405,0x4050405,0x4050405,0x4050405,0x4050405,0x4050405,0x4050405,0x4050405,0x4050405,0x4050405,0x4050405,0x4050405,0x4050405,0x4050405
.long 0x634062e,0x63c0636,0x644063e,0x64c0646,0x654064e,0x491065c,0x4a10499,0x67804a9,0x4f50679,0x62e062e,0x62e062e,0x62e062e,0x62e062e,0x62e062e,0x62e062e,0x62e062e
.long 0x62e062e,0x62e062e,0x62e062e,0x62e062e,0x62e062e,0x62e062e,0x62e062e,0x62e062e,0x62e062e,0x62e062e,0x62e062e,0x62e062e,0x62e062e,0x62e062e,0x62e062e,0x62e062e
.long 0x2410240,0x2430242,0x2450244,0x2470246,0x2490248,0x24b024a,0x24d024c,0x24f024e,0x2400240,0x2400240,0x2400240,0x2400240,0x2400240,0x2400240,0x2400240,0x2400240
.long 0x2400240,0x2400240,0x2400240,0x2400240,0x2400240,0x2400240,0x2400240,0x2400240,0x2400240,0x2400240,0x2400240,0x2400240,0x2400240,0x2400240,0x2400240,0x2400240
.long 0x42d040d,0x46d044d,0x40f048d,0x44f042f,0x419046f,0x4590439,0x48b0479,0x43b041b,0x47b045b,0x40d040d,0x40d040d,0x40d040d,0x40d040d,0x40d040d,0x40d040d,0x40d040d
.long 0x40d040d,0x40d040d,0x40d040d,0x40d040d,0x40d040d,0x40d040d,0x40d040d,0x40d040d,0x40d040d,0x40d040d,0x40d040d,0x40d040d,0x40d040d,0x40d040d,0x40d040d,0x40d040d
.long 0x637062f,0x647063f,0x64f064d,0x65d0655,0x66d0665,0x4910675,0x4a10499,0x67804a9,0x4f50679,0x62f062f,0x62f062f,0x62f062f,0x62f062f,0x62f062f,0x62f062f,0x62f062f
.long 0x62f062f,0x62f062f,0x62f062f,0x62f062f,0x62f062f,0x62f062f,0x62f062f,0x62f062f,0x62f062f,0x62f062f,0x62f062f,0x62f062f,0x62f062f,0x62f062f,0x62f062f,0x62f062f
.long 0x2010200,0x2030202,0x2050204,0x2070206,0x2090208,0x20b020a,0x20d020c,0x20f020e,0x2000200,0x2000200,0x2000200,0x2000200,0x2000200,0x2000200,0x2000200,0x2000200
.long 0x2000200,0x2000200,0x2000200,0x2000200,0x2000200,0x2000200,0x2000200,0x2000200,0x2000200,0x2000200,0x2000200,0x2000200,0x2000200,0x2000200,0x2000200,0x2000200
.long 0x43d041d,0x47d045d,0x41f048f,0x45f043f,0x409047f,0x4490429,0x4890469,0x42b040b,0x46b044b,0x4310411,0x4710451,0x4130483,0x4530433,0x41d0473,0x41d041d,0x41d041d
.long 0x41d041d,0x41d041d,0x41d041d,0x41d041d,0x41d041d,0x41d041d,0x41d041d,0x41d041d,0x41d041d,0x41d041d,0x41d041d,0x41d041d,0x41d041d,0x41d041d,0x41d041d,0x41d041d
.long 0x634062e,0x63c0636,0x644063e,0x64c0646,0x654064e,0x495065c,0x49d04b5,0x4a504bd,0x4ad04c5,0x68304cd,0x4f00684,0x62e062e,0x62e062e,0x62e062e,0x62e062e,0x62e062e
.long 0x62e062e,0x62e062e,0x62e062e,0x62e062e,0x62e062e,0x62e062e,0x62e062e,0x62e062e,0x62e062e,0x62e062e,0x62e062e,0x62e062e,0x62e062e,0x62e062e,0x62e062e,0x62e062e
.long 0x2410240,0x2430242,0x2450244,0x2470246,0x2490248,0x24b024a,0x24d024c,0x24f024e,0x2400240,0x2400240,0x2400240,0x2400240,0x2400240,0x2400240,0x2400240,0x2400240
.long 0x2400240,0x2400240,0x2400240,0x2400240,0x2400240,0x2400240,0x2400240,0x2400240,0x2400240,0x2400240,0x2400240,0x2400240,0x2400240,0x2400240,0x2400240,0x2400240
.long 0x42d040d,0x46d044d,0x40f048d,0x44f042f,0x415046f,0x4550435,0x4870475,0x4370417,0x4770457,0x4390419,0x4790459,0x41b048b,0x45b043b,0x4d8047b,0x4e004d9,0x4e804e1
.long 0x4da04e9,0x4dc04db,0x40d040d,0x40d040d,0x40d040d,0x40d040d,0x40d040d,0x40d040d,0x40d040d,0x40d040d,0x40d040d,0x40d040d,0x40d040d,0x40d040d,0x40d040d,0x40d040d
.long 0x637062f,0x647063f,0x64f064d,0x65d0655,0x66d0665,0x4950675,0x49d04b5,0x4a504bd,0x4ad04c5,0x68304cd,0x4f00684,0x62f062f,0x62f062f,0x62f062f,0x62f062f,0x62f062f
.long 0x62f062f,0x62f062f,0x62f062f,0x62f062f,0x62f062f,0x62f062f,0x62f062f,0x62f062f,0x62f062f,0x62f062f,0x62f062f,0x62f062f,0x62f062f,0x62f062f,0x62f062f,0x62f062f
.long 0x2110210,0x2130212,0x2150214,0x2170216,0x2190218,0x21b021a,0x21d021c,0x21f021e,0x2100210,0x2100210,0x2100210,0x2100210,0x2100210,0x2100210,0x2100210,0x2100210
.long 0x2100210,0x2100210,0x2100210,0x2100210,0x2100210,0x2100210,0x2100210,0x2100210,0x2100210,0x2100210,0x2100210,0x2100210,0x2100210,0x2100210,0x2100210,0x2100210
.long 0x4240404,0x4640444,0x4060484,0x4460426,0x4080466,0x4480428,0x4880468,0x42a040a,0x46a044a,0x4300410,0x4700450,0x4120482,0x4520432,0x4040472,0x4040404,0x4040404
.long 0x4040404,0x4040404,0x4040404,0x4040404,0x4040404,0x4040404,0x4040404,0x4040404,0x4040404,0x4040404,0x4040404,0x4040404,0x4040404,0x4040404,0x4040404,0x4040404
.long 0x630062a,0x6380632,0x640063a,0x6480642,0x650064a,0x4900658,0x49804b0,0x4a004b8,0x4a804c0,0x67904c8,0x4f5067a,0x62a062a,0x62a062a,0x62a062a,0x62a062a,0x62a062a
.long 0x62a062a,0x62a062a,0x62a062a,0x62a062a,0x62a062a,0x62a062a,0x62a062a,0x62a062a,0x62a062a,0x62a062a,0x62a062a,0x62a062a,0x62a062a,0x62a062a,0x62a062a,0x62a062a
.long 0x2510250,0x2530252,0x2550254,0x2570256,0x2590258,0x25b025a,0x25d025c,0x25f025e,0x2500250,0x2500250,0x2500250,0x2500250,0x2500250,0x2500250,0x2500250,0x2500250
.long 0x2500250,0x2500250,0x2500250,0x2500250,0x2500250,0x2500250,0x2500250,0x2500250,0x2500250,0x2500250,0x2500250,0x2500250,0x2500250,0x2500250,0x2500250,0x2500250
.long 0x42c040c,0x46c044c,0x40e048c,0x44e042e,0x418046e,0x4580438,0x48a0478,0x43a041a,0x47a045a,0x40c040c,0x40c040c,0x40c040c,0x40c040c,0x40c040c,0x40c040c,0x40c040c
.long 0x40c040c,0x40c040c,0x40c040c,0x40c040c,0x40c040c,0x40c040c,0x40c040c,0x40c040c,0x40c040c,0x40c040c,0x40c040c,0x40c040c,0x40c040c,0x40c040c,0x40c040c,0x40c040c
.long 0x633062b,0x643063b,0x64b0649,0x6590651,0x6690661,0x4900671,0x49804b0,0x4a004b8,0x4a804c0,0x67904c8,0x4f5067a,0x62b062b,0x62b062b,0x62b062b,0x62b062b,0x62b062b
.long 0x62b062b,0x62b062b,0x62b062b,0x62b062b,0x62b062b,0x62b062b,0x62b062b,0x62b062b,0x62b062b,0x62b062b,0x62b062b,0x62b062b,0x62b062b,0x62b062b,0x62b062b,0x62b062b
.long 0x2110210,0x2130212,0x2150214,0x2170216,0x2190218,0x21b021a,0x21d021c,0x21f021e,0x2100210,0x2100210,0x2100210,0x2100210,0x2100210,0x2100210,0x2100210,0x2100210
.long 0x2100210,0x2100210,0x2100210,0x2100210,0x2100210,0x2100210,0x2100210,0x2100210,0x2100210,0x2100210,0x2100210,0x2100210,0x2100210,0x2100210,0x2100210,0x2100210
.long 0x43c041c,0x47c045c,0x41e048e,0x45e043e,0x408047e,0x4480428,0x4880468,0x42a040a,0x46a044a,0x4300410,0x4700450,0x4120482,0x4520432,0x41c0472,0x41c041c,0x41c041c
.long 0x41c041c,0x41c041c,0x41c041c,0x41c041c,0x41c041c,0x41c041c,0x41c041c,0x41c041c,0x41c041c,0x41c041c,0x41c041c,0x41c041c,0x41c041c,0x41c041c,0x41c041c,0x41c041c
.long 0x630062a,0x6380632,0x640063a,0x6480642,0x650064a,0x4b40658,0x4c404bc,0x68404cc,0x4f00685,0x62a062a,0x62a062a,0x62a062a,0x62a062a,0x62a062a,0x62a062a,0x62a062a
.long 0x62a062a,0x62a062a,0x62a062a,0x62a062a,0x62a062a,0x62a062a,0x62a062a,0x62a062a,0x62a062a,0x62a062a,0x62a062a,0x62a062a,0x62a062a,0x62a062a,0x62a062a,0x62a062a
.long 0x2510250,0x2530252,0x2550254,0x2570256,0x2590258,0x25b025a,0x25d025c,0x25f025e,0x2500250,0x2500250,0x2500250,0x2500250,0x2500250,0x2500250,0x2500250,0x2500250
.long 0x2500250,0x2500250,0x2500250,0x2500250,0x2500250,0x2500250,0x2500250,0x2500250,0x2500250,0x2500250,0x2500250,0x2500250,0x2500250,0x2500250,0x2500250,0x2500250
.long 0x4340414,0x4740454,0x4160486,0x4560436,0x4180476,0x4580438,0x48a0478,0x43a041a,0x47a045a,0x4d904d8,0x4e104e0,0x4e904e8,0x4db04da,0x41404dc,0x4140414,0x4140414
.long 0x4140414,0x4140414,0x4140414,0x4140414,0x4140414,0x4140414,0x4140414,0x4140414,0x4140414,0x4140414,0x4140414,0x4140414,0x4140414,0x4140414,0x4140414,0x4140414
.long 0x633062b,0x643063b,0x64b0649,0x6590651,0x6690661,0x4b40671,0x4c404bc,0x68404cc,0x4f00685,0x62b062b,0x62b062b,0x62b062b,0x62b062b,0x62b062b,0x62b062b,0x62b062b
.long 0x62b062b,0x62b062b,0x62b062b,0x62b062b,0x62b062b,0x62b062b,0x62b062b,0x62b062b,0x62b062b,0x62b062b,0x62b062b,0x62b062b,0x62b062b,0x62b062b,0x62b062b,0x62b062b
.long 0x2110210,0x2130212,0x2150214,0x2170216,0x2190218,0x21b021a,0x21d021c,0x21f021e,0x2100210,0x2100210,0x2100210,0x2100210,0x2100210,0x2100210,0x2100210,0x2100210
.long 0x2100210,0x2100210,0x2100210,0x2100210,0x2100210,0x2100210,0x2100210,0x2100210,0x2100210,0x2100210,0x2100210,0x2100210,0x2100210,0x2100210,0x2100210,0x2100210
.long 0x4250405,0x4650445,0x4070485,0x4470427,0x4090467,0x4490429,0x4890469,0x42b040b,0x46b044b,0x4310411,0x4710451,0x4130483,0x4530433,0x4050473,0x4050405,0x4050405
.long 0x4050405,0x4050405,0x4050405,0x4050405,0x4050405,0x4050405,0x4050405,0x4050405,0x4050405,0x4050405,0x4050405,0x4050405,0x4050405,0x4050405,0x4050405,0x4050405
.long 0x634062e,0x63c0636,0x644063e,0x64c0646,0x654064e,0x491065c,0x49904b1,0x4a104b9,0x4a904c1,0x67904c9,0x4f5067a,0x62e062e,0x62e062e,0x62e062e,0x62e062e,0x62e062e
.long 0x62e062e,0x62e062e,0x62e062e,0x62e062e,0x62e062e,0x62e062e,0x62e062e,0x62e062e,0x62e062e,0x62e062e,0x62e062e,0x62e062e,0x62e062e,0x62e062e,0x62e062e,0x62e062e
.long 0x2510250,0x2530252,0x2550254,0x2570256,0x2590258,0x25b025a,0x25d025c,0x25f025e,0x2500250,0x2500250,0x2500250,0x2500250,0x2500250,0x2500250,0x2500250,0x2500250
.long 0x2500250,0x2500250,0x2500250,0x2500250,0x2500250,0x2500250,0x2500250,0x2500250,0x2500250,0x2500250,0x2500250,0x2500250,0x2500250,0x2500250,0x2500250,0x2500250
.long 0x42d040d,0x46d044d,0x40f048d,0x44f042f,0x419046f,0x4590439,0x48b0479,0x43b041b,0x47b045b,0x40d040d,0x40d040d,0x40d040d,0x40d040d,0x40d040d,0x40d040d,0x40d040d
.long 0x40d040d,0x40d040d,0x40d040d,0x40d040d,0x40d040d,0x40d040d,0x40d040d,0x40d040d,0x40d040d,0x40d040d,0x40d040d,0x40d040d,0x40d040d,0x40d040d,0x40d040d,0x40d040d
.long 0x637062f,0x647063f,0x64f064d,0x65d0655,0x66d0665,0x4910675,0x49904b1,0x4a104b9,0x4a904c1,0x67904c9,0x4f5067a,0x62f062f,0x62f062f,0x62f062f,0x62f062f,0x62f062f
.long 0x62f062f,0x62f062f,0x62f062f,0x62f062f,0x62f062f,0x62f062f,0x62f062f,0x62f062f,0x62f062f,0x62f062f,0x62f062f,0x62f062f,0x62f062f,0x62f062f,0x62f062f,0x62f062f
.long 0x2110210,0x2130212,0x2150214,0x2170216,0x2190218,0x21b021a,0x21d021c,0x21f021e,0x2100210,0x2100210,0x2100210,0x2100210,0x2100210,0x2100210,0x2100210,0x2100210
.long 0x2100210,0x2100210,0x2100210,0x2100210,0x2100210,0x2100210,0x2100210,0x2100210,0x2100210,0x2100210,0x2100210,0x2100210,0x2100210,0x2100210,0x2100210,0x2100210
.long 0x43d041d,0x47d045d,0x41f048f,0x45f043f,0x409047f,0x4490429,0x4890469,0x42b040b,0x46b044b,0x4310411,0x4710451,0x4130483,0x4530433,0x41d0473,0x41d041d,0x41d041d
.long 0x41d041d,0x41d041d,0x41d041d,0x41d041d,0x41d041d,0x41d041d,0x41d041d,0x41d041d,0x41d041d,0x41d041d,0x41d041d,0x41d041d,0x41d041d,0x41d041d,0x41d041d,0x41d041d
.long 0x634062e,0x63c0636,0x644063e,0x64c0646,0x654064e,0x4b5065c,0x4c504bd,0x68404cd,0x4f00685,0x62e062e,0x62e062e,0x62e062e,0x62e062e,0x62e062e,0x62e062e,0x62e062e
.long 0x62e062e,0x62e062e,0x62e062e,0x62e062e,0x62e062e,0x62e062e,0x62e062e,0x62e062e,0x62e062e,0x62e062e,0x62e062e,0x62e062e,0x62e062e,0x62e062e,0x62e062e,0x62e062e
.long 0x2510250,0x2530252,0x2550254,0x2570256,0x2590258,0x25b025a,0x25d025c,0x25f025e,0x2500250,0x2500250,0x2500250,0x2500250,0x2500250,0x2500250,0x2500250,0x2500250
.long 0x2500250,0x2500250,0x2500250,0x2500250,0x2500250,0x2500250,0x2500250,0x2500250,0x2500250,0x2500250,0x2500250,0x2500250,0x2500250,0x2500250,0x2500250,0x2500250
.long 0x4350415,0x4750455,0x4170487,0x4570437,0x4190477,0x4590439,0x48b0479,0x43b041b,0x47b045b,0x4d904d8,0x4e104e0,0x4e904e8,0x4db04da,0x41504dc,0x4150415,0x4150415
.long 0x4150415,0x4150415,0x4150415,0x4150415,0x4150415,0x4150415,0x4150415,0x4150415,0x4150415,0x4150415,0x4150415,0x4150415,0x4150415,0x4150415,0x4150415,0x4150415
.long 0x637062f,0x647063f,0x64f064d,0x65d0655,0x66d0665,0x4b50675,0x4c504bd,0x68404cd,0x4f00685,0x62f062f,0x62f062f,0x62f062f,0x62f062f,0x62f062f,0x62f062f,0x62f062f
.long 0x62f062f,0x62f062f,0x62f062f,0x62f062f,0x62f062f,0x62f062f,0x62f062f,0x62f062f,0x62f062f,0x62f062f,0x62f062f,0x62f062f,0x62f062f,0x62f062f,0x62f062f,0x62f062f
.long 0x2210220,0x2230222,0x2250224,0x2270226,0x2290228,0x22b022a,0x22d022c,0x22f022e,0x2200220,0x2200220,0x2200220,0x2200220,0x2200220,0x2200220,0x2200220,0x2200220
.long 0x2200220,0x2200220,0x2200220,0x2200220,0x2200220,0x2200220,0x2200220,0x2200220,0x2200220,0x2200220,0x2200220,0x2200220,0x2200220,0x2200220,0x2200220,0x2200220
.long 0x4240404,0x4640444,0x4060484,0x4460426,0x40c0466,0x44c042c,0x48c046c,0x42e040e,0x46e044e,0x4280408,0x4680448,0x40a0488,0x44a042a,0x410046a,0x4500430,0x4820470
.long 0x4320412,0x4720452,0x4040404,0x4040404,0x4040404,0x4040404,0x4040404,0x4040404,0x4040404,0x4040404,0x4040404,0x4040404,0x4040404,0x4040404,0x4040404,0x4040404
.long 0x630062a,0x6380632,0x640063a,0x6480642,0x650064a,0x4b00658,0x4b80492,0x4c0049a,0x4c804a2,0x67c04aa,0x4f6067d,0x62a062a,0x62a062a,0x62a062a,0x62a062a,0x62a062a
.long 0x62a062a,0x62a062a,0x62a062a,0x62a062a,0x62a062a,0x62a062a,0x62a062a,0x62a062a,0x62a062a,0x62a062a,0x62a062a,0x62a062a,0x62a062a,0x62a062a,0x62a062a,0x62a062a
.long 0x2610260,0x2630262,0x2650264,0x2670266,0x2690268,0x26b026a,0x26d026c,0x26f026e,0x2600260,0x2600260,0x2600260,0x2600260,0x2600260,0x2600260,0x2600260,0x2600260
.long 0x2600260,0x2600260,0x2600260,0x2600260,0x2600260,0x2600260,0x2600260,0x2600260,0x2600260,0x2600260,0x2600260,0x2600260,0x2600260,0x2600260,0x2600260,0x2600260
.long 0x42c040c,0x46c044c,0x40e048c,0x44e042e,0x414046e,0x4540434,0x4860474,0x4360416,0x4760456,0x4380418,0x4780458,0x41a048a,0x45a043a,0x40c047a,0x40c040c,0x40c040c
.long 0x40c040c,0x40c040c,0x40c040c,0x40c040c,0x40c040c,0x40c040c,0x40c040c,0x40c040c,0x40c040c,0x40c040c,0x40c040c,0x40c040c,0x40c040c,0x40c040c,0x40c040c,0x40c040c
.long 0x633062b,0x643063b,0x64b0649,0x6590651,0x6690661,0x4b00671,0x4b80492,0x4c0049a,0x4c804a2,0x67c04aa,0x4f6067d,0x62b062b,0x62b062b,0x62b062b,0x62b062b,0x62b062b
.long 0x62b062b,0x62b062b,0x62b062b,0x62b062b,0x62b062b,0x62b062b,0x62b062b,0x62b062b,0x62b062b,0x62b062b,0x62b062b,0x62b062b,0x62b062b,0x62b062b,0x62b062b,0x62b062b
.long 0x2210220,0x2230222,0x2250224,0x2270226,0x2290228,0x22b022a,0x22d022c,0x22f022e,0x2200220,0x2200220,0x2200220,0x2200220,0x2200220,0x2200220,0x2200220,0x2200220
.long 0x2200220,0x2200220,0x2200220,0x2200220,0x2200220,0x2200220,0x2200220,0x2200220,0x2200220,0x2200220,0x2200220,0x2200220,0x2200220,0x2200220,0x2200220,0x2200220
.long 0x43c041c,0x47c045c,0x41e048e,0x45e043e,0x4dd047e,0x4df04de,0x4e304e2,0x4e504e4,0x4e704e6,0x4280408,0x4680448,0x40a0488,0x44a042a,0x410046a,0x4500430,0x4820470
.long 0x4320412,0x4720452,0x41c041c,0x41c041c,0x41c041c,0x41c041c,0x41c041c,0x41c041c,0x41c041c,0x41c041c,0x41c041c,0x41c041c,0x41c041c,0x41c041c,0x41c041c,0x41c041c
.long 0x630062a,0x6380632,0x640063a,0x6480642,0x650064a,0x4960658,0x4a6049e,0x68604ae,0x4f10687,0x62a062a,0x62a062a,0x62a062a,0x62a062a,0x62a062a,0x62a062a,0x62a062a
.long 0x62a062a,0x62a062a,0x62a062a,0x62a062a,0x62a062a,0x62a062a,0x62a062a,0x62a062a,0x62a062a,0x62a062a,0x62a062a,0x62a062a,0x62a062a,0x62a062a,0x62a062a,0x62a062a
.long 0x2610260,0x2630262,0x2650264,0x2670266,0x2690268,0x26b026a,0x26d026c,0x26f026e,0x2600260,0x2600260,0x2600260,0x2600260,0x2600260,0x2600260,0x2600260,0x2600260
.long 0x2600260,0x2600260,0x2600260,0x2600260,0x2600260,0x2600260,0x2600260,0x2600260,0x2600260,0x2600260,0x2600260,0x2600260,0x2600260,0x2600260,0x2600260,0x2600260
.long 0x43c041c,0x47c045c,0x41e048e,0x45e043e,0x418047e,0x4580438,0x48a0478,0x43a041a,0x47a045a,0x4d904d8,0x4e104e0,0x4e904e8,0x4db04da,0x41c04dc,0x41c041c,0x41c041c
.long 0x41c041c,0x41c041c,0x41c041c,0x41c041c,0x41c041c,0x41c041c,0x41c041c,0x41c041c,0x41c041c,0x41c041c,0x41c041c,0x41c041c,0x41c041c,0x41c041c,0x41c041c,0x41c041c
.long 0x633062b,0x643063b,0x64b0649,0x6590651,0x6690661,0x4960671,0x4a6049e,0x68604ae,0x4f10687,0x62b062b,0x62b062b,0x62b062b,0x62b062b,0x62b062b,0x62b062b,0x62b062b
.long 0x62b062b,0x62b062b,0x62b062b,0x62b062b,0x62b062b,0x62b062b,0x62b062b,0x62b062b,0x62b062b,0x62b062b,0x62b062b,0x62b062b,0x62b062b,0x62b062b,0x62b062b,0x62b062b
.long 0x2210220,0x2230222,0x2250224,0x2270226,0x2290228,0x22b022a,0x22d022c,0x22f022e,0x2200220,0x2200220,0x2200220,0x2200220,0x2200220,0x2200220,0x2200220,0x2200220
.long 0x2200220,0x2200220,0x2200220,0x2200220,0x2200220,0x2200220,0x2200220,0x2200220,0x2200220,0x2200220,0x2200220,0x2200220,0x2200220,0x2200220,0x2200220,0x2200220
.long 0x4250405,0x4650445,0x4070485,0x4470427,0x40d0467,0x44d042d,0x48d046d,0x42f040f,0x46f044f,0x4290409,0x4690449,0x40b0489,0x44b042b,0x411046b,0x4510431,0x4830471
.long 0x4330413,0x4730453,0x4050405,0x4050405,0x4050405,0x4050405,0x4050405,0x4050405,0x4050405,0x4050405,0x4050405,0x4050405,0x4050405,0x4050405,0x4050405,0x4050405
.long 0x634062e,0x63c0636,0x644063e,0x64c0646,0x654064e,0x4b1065c,0x4b90493,0x4c1049b,0x4c904a3,0x67c04ab,0x4f6067d,0x62e062e,0x62e062e,0x62e062e,0x62e062e,0x62e062e
.long 0x62e062e,0x62e062e,0x62e062e,0x62e062e,0x62e062e,0x62e062e,0x62e062e,0x62e062e,0x62e062e,0x62e062e,0x62e062e,0x62e062e,0x62e062e,0x62e062e,0x62e062e,0x62e062e
.long 0x2610260,0x2630262,0x2650264,0x2670266,0x2690268,0x26b026a,0x26d026c,0x26f026e,0x2600260,0x2600260,0x2600260,0x2600260,0x2600260,0x2600260,0x2600260,0x2600260
.long 0x2600260,0x2600260,0x2600260,0x2600260,0x2600260,0x2600260,0x2600260,0x2600260,0x2600260,0x2600260,0x2600260,0x2600260,0x2600260,0x2600260,0x2600260,0x2600260
.long 0x42d040d,0x46d044d,0x40f048d,0x44f042f,0x415046f,0x4550435,0x4870475,0x4370417,0x4770457,0x4390419,0x4790459,0x41b048b,0x45b043b,0x40d047b,0x40d040d,0x40d040d
.long 0x40d040d,0x40d040d,0x40d040d,0x40d040d,0x40d040d,0x40d040d,0x40d040d,0x40d040d,0x40d040d,0x40d040d,0x40d040d,0x40d040d,0x40d040d,0x40d040d,0x40d040d,0x40d040d
.long 0x637062f,0x647063f,0x64f064d,0x65d0655,0x66d0665,0x4b10675,0x4b90493,0x4c1049b,0x4c904a3,0x67c04ab,0x4f6067d,0x62f062f,0x62f062f,0x62f062f,0x62f062f,0x62f062f
.long 0x62f062f,0x62f062f,0x62f062f,0x62f062f,0x62f062f,0x62f062f,0x62f062f,0x62f062f,0x62f062f,0x62f062f,0x62f062f,0x62f062f,0x62f062f,0x62f062f,0x62f062f,0x62f062f
.long 0x2210220,0x2230222,0x2250224,0x2270226,0x2290228,0x22b022a,0x22d022c,0x22f022e,0x2200220,0x2200220,0x2200220,0x2200220,0x2200220,0x2200220,0x2200220,0x2200220
.long 0x2200220,0x2200220,0x2200220,0x2200220,0x2200220,0x2200220,0x2200220,0x2200220,0x2200220,0x2200220,0x2200220,0x2200220,0x2200220,0x2200220,0x2200220,0x2200220
.long 0x43d041d,0x47d045d,0x41f048f,0x45f043f,0x4dd047f,0x4df04de,0x4e304e2,0x4e504e4,0x4e704e6,0x4290409,0x4690449,0x40b0489,0x44b042b,0x411046b,0x4510431,0x4830471
.long 0x4330413,0x4730453,0x41d041d,0x41d041d,0x41d041d,0x41d041d,0x41d041d,0x41d041d,0x41d041d,0x41d041d,0x41d041d,0x41d041d,0x41d041d,0x41d041d,0x41d041d,0x41d041d
.long 0x634062e,0x63c0636,0x644063e,0x64c0646,0x654064e,0x497065c,0x4a7049f,0x68604af,0x4f10687,0x62e062e,0x62e062e,0x62e062e,0x62e062e,0x62e062e,0x62e062e,0x62e062e
.long 0x62e062e,0x62e062e,0x62e062e,0x62e062e,0x62e062e,0x62e062e,0x62e062e,0x62e062e,0x62e062e,0x62e062e,0x62e062e,0x62e062e,0x62e062e,0x62e062e,0x62e062e,0x62e062e
.long 0x2610260,0x2630262,0x2650264,0x2670266,0x2690268,0x26b026a,0x26d026c,0x26f026e,0x2600260,0x2600260,0x2600260,0x2600260,0x2600260,0x2600260,0x2600260,0x2600260
.long 0x2600260,0x2600260,0x2600260,0x2600260,0x2600260,0x2600260,0x2600260,0x2600260,0x2600260,0x2600260,0x2600260,0x2600260,0x2600260,0x2600260,0x2600260,0x2600260
.long 0x43d041d,0x47d045d,0x41f048f,0x45f043f,0x419047f,0x4590439,0x48b0479,0x43b041b,0x47b045b,0x4d904d8,0x4e104e0,0x4e904e8,0x4db04da,0x41d04dc,0x41d041d,0x41d041d
.long 0x41d041d,0x41d041d,0x41d041d,0x41d041d,0x41d041d,0x41d041d,0x41d041d,0x41d041d,0x41d041d,0x41d041d,0x41d041d,0x41d041d,0x41d041d,0x41d041d,0x41d041d,0x41d041d
.long 0x637062f,0x647063f,0x64f064d,0x65d0655,0x66d0665,0x4970675,0x4a7049f,0x68604af,0x4f10687,0x62f062f,0x62f062f,0x62f062f,0x62f062f,0x62f062f,0x62f062f,0x62f062f
.long 0x62f062f,0x62f062f,0x62f062f,0x62f062f,0x62f062f,0x62f062f,0x62f062f,0x62f062f,0x62f062f,0x62f062f,0x62f062f,0x62f062f,0x62f062f,0x62f062f,0x62f062f,0x62f062f
.long 0x2310230,0x2330232,0x2350234,0x2370236,0x2390238,0x23b023a,0x23d023c,0x23f023e,0x2300230,0x2300230,0x2300230,0x2300230,0x2300230,0x2300230,0x2300230,0x2300230
.long 0x2300230,0x2300230,0x2300230,0x2300230,0x2300230,0x2300230,0x2300230,0x2300230,0x2300230,0x2300230,0x2300230,0x2300230,0x2300230,0x2300230,0x2300230,0x2300230
.long 0x4eb04ea,0x4ed04ec,0x4ef04ee,0x4f304f2,0x4ea04f4,0x4ea04ea,0x4ea04ea,0x4ea04ea,0x4ea04ea,0x4ea04ea,0x4ea04ea,0x4ea04ea,0x4ea04ea,0x4ea04ea,0x4ea04ea,0x4ea04ea
.long 0x4ea04ea,0x4ea04ea,0x4ea04ea,0x4ea04ea,0x4ea04ea,0x4ea04ea,0x4ea04ea,0x4ea04ea,0x4ea04ea,0x4ea04ea,0x4ea04ea,0x4ea04ea,0x4ea04ea,0x4ea04ea,0x4ea04ea,0x4ea04ea
.long 0x6e206da,0x6f206ea,0x6e306db,0x6f306eb,0x6e406dc,0xcda06ec,0xcdc0cdb,0xcde0cdd,0xce20cdf,0xce40ce3,0xce60ce5,0xcea0ce7,0xcec0ceb,0xcee0ced,0xcf20cef,0xcf40cf3
.long 0xcf60cf5,0xcfe0cf7,0x6da06da,0x6da06da,0x6da06da,0x6da06da,0x6da06da,0x6da06da,0x6da06da,0x6da06da,0x6da06da,0x6da06da,0x6da06da,0x6da06da,0x6da06da,0x6da06da
.long 0x2710270,0x2730272,0x2750274,0x2770276,0x2790278,0x27b027a,0x27d027c,0x27f027e,0x2700270,0x2700270,0x2700270,0x2700270,0x2700270,0x2700270,0x2700270,0x2700270
.long 0x2700270,0x2700270,0x2700270,0x2700270,0x2700270,0x2700270,0x2700270,0x2700270,0x2700270,0x2700270,0x2700270,0x2700270,0x2700270,0x2700270,0x2700270,0x2700270
.long 0x4eb04ea,0x4ed04ec,0x4ef04ee,0x4f304f2,0x4ea04f4,0x4ea04ea,0x4ea04ea,0x4ea04ea,0x4ea04ea,0x4ea04ea,0x4ea04ea,0x4ea04ea,0x4ea04ea,0x4ea04ea,0x4ea04ea,0x4ea04ea
.long 0x4ea04ea,0x4ea04ea,0x4ea04ea,0x4ea04ea,0x4ea04ea,0x4ea04ea,0x4ea04ea,0x4ea04ea,0x4ea04ea,0x4ea04ea,0x4ea04ea,0x4ea04ea,0x4ea04ea,0x4ea04ea,0x4ea04ea,0x4ea04ea
.long 0x68c06f4,0x6e506dd,0x6de06ed,0x6ee06e6,0x6e706df,0xcda06ef,0xcdc0cdb,0xcde0cdd,0xce20cdf,0xce40ce3,0xce60ce5,0xcea0ce7,0xcec0ceb,0xcee0ced,0xcf20cef,0xcf40cf3
.long 0xcf60cf5,0xcff0cf7,0x6f406f4,0x6f406f4,0x6f406f4,0x6f406f4,0x6f406f4,0x6f406f4,0x6f406f4,0x6f406f4,0x6f406f4,0x6f406f4,0x6f406f4,0x6f406f4,0x6f406f4,0x6f406f4
.long 0x2310230,0x2330232,0x2350234,0x2370236,0x2390238,0x23b023a,0x23d023c,0x23f023e,0x2300230,0x2300230,0x2300230,0x2300230,0x2300230,0x2300230,0x2300230,0x2300230
.long 0x2300230,0x2300230,0x2300230,0x2300230,0x2300230,0x2300230,0x2300230,0x2300230,0x2300230,0x2300230,0x2300230,0x2300230,0x2300230,0x2300230,0x2300230,0x2300230
.long 0x4eb04ea,0x4ed04ec,0x4ef04ee,0x4f304f2,0x4ea04f4,0x4ea04ea,0x4ea04ea,0x4ea04ea,0x4ea04ea,0x4ea04ea,0x4ea04ea,0x4ea04ea,0x4ea04ea,0x4ea04ea,0x4ea04ea,0x4ea04ea
.long 0x4ea04ea,0x4ea04ea,0x4ea04ea,0x4ea04ea,0x4ea04ea,0x4ea04ea,0x4ea04ea,0x4ea04ea,0x4ea04ea,0x4ea04ea,0x4ea04ea,0x4ea04ea,0x4ea04ea,0x4ea04ea,0x4ea04ea,0x4ea04ea
.long 0x6e206da,0x6f206ea,0x6e306db,0x6f306eb,0x6e406dc,0xcda06ec,0xcdc0cdb,0xcde0cdd,0xce20cdf,0xce40ce3,0xce60ce5,0xcea0ce7,0xcec0ceb,0xcee0ced,0xcf20cef,0xcf40cf3
.long 0xcf60cf5,0xcff0cf7,0x6da06da,0x6da06da,0x6da06da,0x6da06da,0x6da06da,0x6da06da,0x6da06da,0x6da06da,0x6da06da,0x6da06da,0x6da06da,0x6da06da,0x6da06da,0x6da06da
.long 0x2710270,0x2730272,0x2750274,0x2770276,0x2790278,0x27b027a,0x27d027c,0x27f027e,0x2700270,0x2700270,0x2700270,0x2700270,0x2700270,0x2700270,0x2700270,0x2700270
.long 0x2700270,0x2700270,0x2700270,0x2700270,0x2700270,0x2700270,0x2700270,0x2700270,0x2700270,0x2700270,0x2700270,0x2700270,0x2700270,0x2700270,0x2700270,0x2700270
.long 0x43c041c,0x47c045c,0x41e048e,0x45e043e,0x4dd047e,0x4df04de,0x4e304e2,0x4e504e4,0x4e704e6,0x4380418,0x4780458,0x41a048a,0x45a043a,0x4d8047a,0x4e004d9,0x4e804e1
.long 0x4da04e9,0x4dc04db,0x41c041c,0x41c041c,0x41c041c,0x41c041c,0x41c041c,0x41c041c,0x41c041c,0x41c041c,0x41c041c,0x41c041c,0x41c041c,0x41c041c,0x41c041c,0x41c041c
.long 0x27b027b,0x27b027b,0x27b027b,0x27b027b,0x27b027b,0x27b027b,0x27b027b,0x27b027b,0x27b027b,0x27b027b,0x27b027b,0x27b027b,0x27b027b,0x27b027b,0x27b027b,0x27b027b
.long 0x27b027b,0x27b027b,0x27b027b,0x27b027b,0x27b027b,0x27b027b,0x27b027b,0x27b027b,0x27b027b,0x27b027b,0x27b027b,0x27b027b,0x27b027b,0x27b027b,0x27b027b,0x27b027b
.long 0x2310230,0x2330232,0x2350234,0x2370236,0x2390238,0x23b023a,0x23d023c,0x23f023e,0x2300230,0x2300230,0x2300230,0x2300230,0x2300230,0x2300230,0x2300230,0x2300230
.long 0x2300230,0x2300230,0x2300230,0x2300230,0x2300230,0x2300230,0x2300230,0x2300230,0x2300230,0x2300230,0x2300230,0x2300230,0x2300230,0x2300230,0x2300230,0x2300230
.long 0x4eb04ea,0x4ed04ec,0x4ef04ee,0x4f304f2,0x4ea04f4,0x4ea04ea,0x4ea04ea,0x4ea04ea,0x4ea04ea,0x4ea04ea,0x4ea04ea,0x4ea04ea,0x4ea04ea,0x4ea04ea,0x4ea04ea,0x4ea04ea
.long 0x4ea04ea,0x4ea04ea,0x4ea04ea,0x4ea04ea,0x4ea04ea,0x4ea04ea,0x4ea04ea,0x4ea04ea,0x4ea04ea,0x4ea04ea,0x4ea04ea,0x4ea04ea,0x4ea04ea,0x4ea04ea,0x4ea04ea,0x4ea04ea
.long 0x6e206da,0x6f206ea,0x6e306db,0x6f306eb,0x6e406dc,0xcda06ec,0xcdc0cdb,0xcde0cdd,0xce20cdf,0xce40ce3,0xce60ce5,0xcea0ce7,0xcec0ceb,0xcee0ced,0xcf20cef,0xcf40cf3
.long 0xcf60cf5,0xcff0cf7,0x6da06da,0x6da06da,0x6da06da,0x6da06da,0x6da06da,0x6da06da,0x6da06da,0x6da06da,0x6da06da,0x6da06da,0x6da06da,0x6da06da,0x6da06da,0x6da06da
.long 0x2710270,0x2730272,0x2750274,0x2770276,0x2790278,0x27b027a,0x27d027c,0x27f027e,0x2700270,0x2700270,0x2700270,0x2700270,0x2700270,0x2700270,0x2700270,0x2700270
.long 0x2700270,0x2700270,0x2700270,0x2700270,0x2700270,0x2700270,0x2700270,0x2700270,0x2700270,0x2700270,0x2700270,0x2700270,0x2700270,0x2700270,0x2700270,0x2700270
.long 0x4eb04ea,0x4ed04ec,0x4ef04ee,0x4f304f2,0x4ea04f4,0x4ea04ea,0x4ea04ea,0x4ea04ea,0x4ea04ea,0x4ea04ea,0x4ea04ea,0x4ea04ea,0x4ea04ea,0x4ea04ea,0x4ea04ea,0x4ea04ea
.long 0x4ea04ea,0x4ea04ea,0x4ea04ea,0x4ea04ea,0x4ea04ea,0x4ea04ea,0x4ea04ea,0x4ea04ea,0x4ea04ea,0x4ea04ea,0x4ea04ea,0x4ea04ea,0x4ea04ea,0x4ea04ea,0x4ea04ea,0x4ea04ea
.long 0x68c06f4,0x6e506dd,0x6de06ed,0x6ee06e6,0x6e706df,0xcda06ef,0xcdc0cdb,0xcde0cdd,0xce20cdf,0xce40ce3,0xce60ce5,0xcea0ce7,0xcec0ceb,0xcee0ced,0xcf20cef,0xcf40cf3
.long 0xcf60cf5,0xdd80cf7,0x6f406f4,0x6f406f4,0x6f406f4,0x6f406f4,0x6f406f4,0x6f406f4,0x6f406f4,0x6f406f4,0x6f406f4,0x6f406f4,0x6f406f4,0x6f406f4,0x6f406f4,0x6f406f4
.long 0x2310230,0x2330232,0x2350234,0x2370236,0x2390238,0x23b023a,0x23d023c,0x23f023e,0x2300230,0x2300230,0x2300230,0x2300230,0x2300230,0x2300230,0x2300230,0x2300230
.long 0x2300230,0x2300230,0x2300230,0x2300230,0x2300230,0x2300230,0x2300230,0x2300230,0x2300230,0x2300230,0x2300230,0x2300230,0x2300230,0x2300230,0x2300230,0x2300230
.long 0x4eb04ea,0x4ed04ec,0x4ef04ee,0x4f304f2,0x4ea04f4,0x4ea04ea,0x4ea04ea,0x4ea04ea,0x4ea04ea,0x4ea04ea,0x4ea04ea,0x4ea04ea,0x4ea04ea,0x4ea04ea,0x4ea04ea,0x4ea04ea
.long 0x4ea04ea,0x4ea04ea,0x4ea04ea,0x4ea04ea,0x4ea04ea,0x4ea04ea,0x4ea04ea,0x4ea04ea,0x4ea04ea,0x4ea04ea,0x4ea04ea,0x4ea04ea,0x4ea04ea,0x4ea04ea,0x4ea04ea,0x4ea04ea
.long 0x6e206da,0x6f206ea,0x6e306db,0x6f306eb,0x6e406dc,0xcda06ec,0xcdc0cdb,0xcde0cdd,0xce20cdf,0xce40ce3,0xce60ce5,0xcea0ce7,0xcec0ceb,0xcee0ced,0xcf20cef,0xcf40cf3
.long 0xcf60cf5,0xdd80cf7,0x6da06da,0x6da06da,0x6da06da,0x6da06da,0x6da06da,0x6da06da,0x6da06da,0x6da06da,0x6da06da,0x6da06da,0x6da06da,0x6da06da,0x6da06da,0x6da06da
.long 0x2710270,0x2730272,0x2750274,0x2770276,0x2790278,0x27b027a,0x27d027c,0x27f027e,0x2700270,0x2700270,0x2700270,0x2700270,0x2700270,0x2700270,0x2700270,0x2700270
.long 0x2700270,0x2700270,0x2700270,0x2700270,0x2700270,0x2700270,0x2700270,0x2700270,0x2700270,0x2700270,0x2700270,0x2700270,0x2700270,0x2700270,0x2700270,0x2700270
.long 0x43d041d,0x47d045d,0x41f048f,0x45f043f,0x4dd047f,0x4df04de,0x4e304e2,0x4e504e4,0x4e704e6,0x4390419,0x4790459,0x41b048b,0x45b043b,0x4d8047b,0x4e004d9,0x4e804e1
.long 0x4da04e9,0x4dc04db,0x41d041d,0x41d041d,0x41d041d,0x41d041d,0x41d041d,0x41d041d,0x41d041d,0x41d041d,0x41d041d,0x41d041d,0x41d041d,0x41d041d,0x41d041d,0x41d041d
.long 0x27f027f,0x27f027f,0x27f027f,0x27f027f,0x27f027f,0x27f027f,0x27f027f,0x27f027f,0x27f027f,0x27f027f,0x27f027f,0x27f027f,0x27f027f,0x27f027f,0x27f027f,0x27f027f
.long 0x27f027f,0x27f027f,0x27f027f,0x27f027f,0x27f027f,0x27f027f,0x27f027f,0x27f027f,0x27f027f,0x27f027f,0x27f027f,0x27f027f,0x27f027f,0x27f027f,0x27f027f,0x27f027f
.long 0x2010200,0x2030202,0x2050204,0x2070206,0x2090208,0x20b020a,0x20d020c,0x20f020e,0x2000200,0x2000200,0x2000200,0x2000200,0x2000200,0x2000200,0x2000200,0x2000200
.long 0x2000200,0x2000200,0x2000200,0x2000200,0x2000200,0x2000200,0x2000200,0x2000200,0x2000200,0x2000200,0x2000200,0x2000200,0x2000200,0x2000200,0x2000200,0x2000200
.long 0x4eb04ea,0x4ed04ec,0x4ef04ee,0x4f304f2,0x4ea04f4,0x4ea04ea,0x4ea04ea,0x4ea04ea,0x4ea04ea,0x4ea04ea,0x4ea04ea,0x4ea04ea,0x4ea04ea,0x4ea04ea,0x4ea04ea,0x4ea04ea
.long 0x4ea04ea,0x4ea04ea,0x4ea04ea,0x4ea04ea,0x4ea04ea,0x4ea04ea,0x4ea04ea,0x4ea04ea,0x4ea04ea,0x4ea04ea,0x4ea04ea,0x4ea04ea,0x4ea04ea,0x4ea04ea,0x4ea04ea,0x4ea04ea
.long 0x6e206da,0x6f206ea,0x6e306db,0x6f306eb,0x6e406dc,0xcda06ec,0xcdc0cdb,0xcde0cdd,0xce20cdf,0xce40ce3,0xce60ce5,0xcea0ce7,0xcec0ceb,0xcee0ced,0xcf20cef,0xcf40cf3
.long 0xcf60cf5,0xdd90cf7,0x6da06da,0x6da06da,0x6da06da,0x6da06da,0x6da06da,0x6da06da,0x6da06da,0x6da06da,0x6da06da,0x6da06da,0x6da06da,0x6da06da,0x6da06da,0x6da06da
.long 0x2410240,0x2430242,0x2450244,0x2470246,0x2490248,0x24b024a,0x24d024c,0x24f024e,0x2400240,0x2400240,0x2400240,0x2400240,0x2400240,0x2400240,0x2400240,0x2400240
.long 0x2400240,0x2400240,0x2400240,0x2400240,0x2400240,0x2400240,0x2400240,0x2400240,0x2400240,0x2400240,0x2400240,0x2400240,0x2400240,0x2400240,0x2400240,0x2400240
.long 0x4eb04ea,0x4ed04ec,0x4ef04ee,0x4f304f2,0x4ea04f4,0x4ea04ea,0x4ea04ea,0x4ea04ea,0x4ea04ea,0x4ea04ea,0x4ea04ea,0x4ea04ea,0x4ea04ea,0x4ea04ea,0x4ea04ea,0x4ea04ea
.long 0x4ea04ea,0x4ea04ea,0x4ea04ea,0x4ea04ea,0x4ea04ea,0x4ea04ea,0x4ea04ea,0x4ea04ea,0x4ea04ea,0x4ea04ea,0x4ea04ea,0x4ea04ea,0x4ea04ea,0x4ea04ea,0x4ea04ea,0x4ea04ea
.long 0x68c06f4,0x6e506dd,0x6de06ed,0x6ee06e6,0x6e706df,0xcda06ef,0xcdc0cdb,0xcde0cdd,0xce20cdf,0xce40ce3,0xce60ce5,0xcea0ce7,0xcec0ceb,0xcee0ced,0xcf20cef,0xcf40cf3
.long 0xcf60cf5,0xdd90cf7,0x6f406f4,0x6f406f4,0x6f406f4,0x6f406f4,0x6f406f4,0x6f406f4,0x6f406f4,0x6f406f4,0x6f406f4,0x6f406f4,0x6f406f4,0x6f406f4,0x6f406f4,0x6f406f4
.long 0x2210220,0x2230222,0x2250224,0x2270226,0x2290228,0x22b022a,0x22d022c,0x22f022e,0x2200220,0x2200220,0x2200220,0x2200220,0x2200220,0x2200220,0x2200220,0x2200220
.long 0x2200220,0x2200220,0x2200220,0x2200220,0x2200220,0x2200220,0x2200220,0x2200220,0x2200220,0x2200220,0x2200220,0x2200220,0x2200220,0x2200220,0x2200220,0x2200220
.long 0x4eb04ea,0x4ed04ec,0x4ef04ee,0x4f304f2,0x4ea04f4,0x4ea04ea,0x4ea04ea,0x4ea04ea,0x4ea04ea,0x4ea04ea,0x4ea04ea,0x4ea04ea,0x4ea04ea,0x4ea04ea,0x4ea04ea,0x4ea04ea
.long 0x4ea04ea,0x4ea04ea,0x4ea04ea,0x4ea04ea,0x4ea04ea,0x4ea04ea,0x4ea04ea,0x4ea04ea,0x4ea04ea,0x4ea04ea,0x4ea04ea,0x4ea04ea,0x4ea04ea,0x4ea04ea,0x4ea04ea,0x4ea04ea
.long 0x6e206da,0x6f206ea,0x6e306db,0x6f306eb,0x6e406dc,0xcda06ec,0xcdc0cdb,0xcde0cdd,0xce20cdf,0xce40ce3,0xce60ce5,0xcea0ce7,0xcec0ceb,0xcee0ced,0xcf20cef,0xcf40cf3
.long 0xcf60cf5,0xde00cf7,0x6da06da,0x6da06da,0x6da06da,0x6da06da,0x6da06da,0x6da06da,0x6da06da,0x6da06da,0x6da06da,0x6da06da,0x6da06da,0x6da06da,0x6da06da,0x6da06da
.long 0x2610260,0x2630262,0x2650264,0x2670266,0x2690268,0x26b026a,0x26d026c,0x26f026e,0x2600260,0x2600260,0x2600260,0x2600260,0x2600260,0x2600260,0x2600260,0x2600260
.long 0x2600260,0x2600260,0x2600260,0x2600260,0x2600260,0x2600260,0x2600260,0x2600260,0x2600260,0x2600260,0x2600260,0x2600260,0x2600260,0x2600260,0x2600260,0x2600260
.long 0x4eb04ea,0x4ed04ec,0x4ef04ee,0x4f304f2,0x4ea04f4,0x4ea04ea,0x4ea04ea,0x4ea04ea,0x4ea04ea,0x4ea04ea,0x4ea04ea,0x4ea04ea,0x4ea04ea,0x4ea04ea,0x4ea04ea,0x4ea04ea
.long 0x4ea04ea,0x4ea04ea,0x4ea04ea,0x4ea04ea,0x4ea04ea,0x4ea04ea,0x4ea04ea,0x4ea04ea,0x4ea04ea,0x4ea04ea,0x4ea04ea,0x4ea04ea,0x4ea04ea,0x4ea04ea,0x4ea04ea,0x4ea04ea
.long 0x68c06f4,0x6e506dd,0x6de06ed,0x6ee06e6,0x6e706df,0xcda06ef,0xcdc0cdb,0xcde0cdd,0xce20cdf,0xce40ce3,0xce60ce5,0xcea0ce7,0xcec0ceb,0xcee0ced,0xcf20cef,0xcf40cf3
.long 0xcf60cf5,0xde00cf7,0x6f406f4,0x6f406f4,0x6f406f4,0x6f406f4,0x6f406f4,0x6f406f4,0x6f406f4,0x6f406f4,0x6f406f4,0x6f406f4,0x6f406f4,0x6f406f4,0x6f406f4,0x6f406f4
.long 0x2010200,0x2030202,0x2050204,0x2070206,0x2090208,0x20b020a,0x20d020c,0x20f020e,0x2000200,0x2000200,0x2000200,0x2000200,0x2000200,0x2000200,0x2000200,0x2000200
.long 0x2000200,0x2000200,0x2000200,0x2000200,0x2000200,0x2000200,0x2000200,0x2000200,0x2000200,0x2000200,0x2000200,0x2000200,0x2000200,0x2000200,0x2000200,0x2000200
.long 0x4eb04ea,0x4ed04ec,0x4ef04ee,0x4f304f2,0x4ea04f4,0x4ea04ea,0x4ea04ea,0x4ea04ea,0x4ea04ea,0x4ea04ea,0x4ea04ea,0x4ea04ea,0x4ea04ea,0x4ea04ea,0x4ea04ea,0x4ea04ea
.long 0x4ea04ea,0x4ea04ea,0x4ea04ea,0x4ea04ea,0x4ea04ea,0x4ea04ea,0x4ea04ea,0x4ea04ea,0x4ea04ea,0x4ea04ea,0x4ea04ea,0x4ea04ea,0x4ea04ea,0x4ea04ea,0x4ea04ea,0x4ea04ea
.long 0x6e206da,0x6f206ea,0x6e306db,0x6f306eb,0x6e406dc,0xcda06ec,0xcdc0cdb,0xcde0cdd,0xce20cdf,0xce40ce3,0xce60ce5,0xcea0ce7,0xcec0ceb,0xcee0ced,0xcf20cef,0xcf40cf3
.long 0xcf60cf5,0xde10cf7,0x6da06da,0x6da06da,0x6da06da,0x6da06da,0x6da06da,0x6da06da,0x6da06da,0x6da06da,0x6da06da,0x6da06da,0x6da06da,0x6da06da,0x6da06da,0x6da06da
.long 0x2410240,0x2430242,0x2450244,0x2470246,0x2490248,0x24b024a,0x24d024c,0x24f024e,0x2400240,0x2400240,0x2400240,0x2400240,0x2400240,0x2400240,0x2400240,0x2400240
.long 0x2400240,0x2400240,0x2400240,0x2400240,0x2400240,0x2400240,0x2400240,0x2400240,0x2400240,0x2400240,0x2400240,0x2400240,0x2400240,0x2400240,0x2400240,0x2400240
.long 0x4eb04ea,0x4ed04ec,0x4ef04ee,0x4f304f2,0x4ea04f4,0x4ea04ea,0x4ea04ea,0x4ea04ea,0x4ea04ea,0x4ea04ea,0x4ea04ea,0x4ea04ea,0x4ea04ea,0x4ea04ea,0x4ea04ea,0x4ea04ea
.long 0x4ea04ea,0x4ea04ea,0x4ea04ea,0x4ea04ea,0x4ea04ea,0x4ea04ea,0x4ea04ea,0x4ea04ea,0x4ea04ea,0x4ea04ea,0x4ea04ea,0x4ea04ea,0x4ea04ea,0x4ea04ea,0x4ea04ea,0x4ea04ea
.long 0x68c06f4,0x6e506dd,0x6de06ed,0x6ee06e6,0x6e706df,0xcda06ef,0xcdc0cdb,0xcde0cdd,0xce20cdf,0xce40ce3,0xce60ce5,0xcea0ce7,0xcec0ceb,0xcee0ced,0xcf20cef,0xcf40cf3
.long 0xcf60cf5,0xde10cf7,0x6f406f4,0x6f406f4,0x6f406f4,0x6f406f4,0x6f406f4,0x6f406f4,0x6f406f4,0x6f406f4,0x6f406f4,0x6f406f4,0x6f406f4,0x6f406f4,0x6f406f4,0x6f406f4
.long 0x2210220,0x2230222,0x2250224,0x2270226,0x2290228,0x22b022a,0x22d022c,0x22f022e,0x2200220,0x2200220,0x2200220,0x2200220,0x2200220,0x2200220,0x2200220,0x2200220
.long 0x2200220,0x2200220,0x2200220,0x2200220,0x2200220,0x2200220,0x2200220,0x2200220,0x2200220,0x2200220,0x2200220,0x2200220,0x2200220,0x2200220,0x2200220,0x2200220
.long 0x4eb04ea,0x4ed04ec,0x4ef04ee,0x4f304f2,0x4ea04f4,0x4ea04ea,0x4ea04ea,0x4ea04ea,0x4ea04ea,0x4ea04ea,0x4ea04ea,0x4ea04ea,0x4ea04ea,0x4ea04ea,0x4ea04ea,0x4ea04ea
.long 0x4ea04ea,0x4ea04ea,0x4ea04ea,0x4ea04ea,0x4ea04ea,0x4ea04ea,0x4ea04ea,0x4ea04ea,0x4ea04ea,0x4ea04ea,0x4ea04ea,0x4ea04ea,0x4ea04ea,0x4ea04ea,0x4ea04ea,0x4ea04ea
.long 0x6e206da,0x6f206ea,0x6e306db,0x6f306eb,0x6e406dc,0xcda06ec,0xcdc0cdb,0xcde0cdd,0xce20cdf,0xce40ce3,0xce60ce5,0xcea0ce7,0xcec0ceb,0xcee0ced,0xcf20cef,0xcf40cf3
.long 0xcf60cf5,0xde80cf7,0x6da06da,0x6da06da,0x6da06da,0x6da06da,0x6da06da,0x6da06da,0x6da06da,0x6da06da,0x6da06da,0x6da06da,0x6da06da,0x6da06da,0x6da06da,0x6da06da
.long 0x2610260,0x2630262,0x2650264,0x2670266,0x2690268,0x26b026a,0x26d026c,0x26f026e,0x2600260,0x2600260,0x2600260,0x2600260,0x2600260,0x2600260,0x2600260,0x2600260
.long 0x2600260,0x2600260,0x2600260,0x2600260,0x2600260,0x2600260,0x2600260,0x2600260,0x2600260,0x2600260,0x2600260,0x2600260,0x2600260,0x2600260,0x2600260,0x2600260
.long 0x4eb04ea,0x4ed04ec,0x4ef04ee,0x4f304f2,0x4ea04f4,0x4ea04ea,0x4ea04ea,0x4ea04ea,0x4ea04ea,0x4ea04ea,0x4ea04ea,0x4ea04ea,0x4ea04ea,0x4ea04ea,0x4ea04ea,0x4ea04ea
.long 0x4ea04ea,0x4ea04ea,0x4ea04ea,0x4ea04ea,0x4ea04ea,0x4ea04ea,0x4ea04ea,0x4ea04ea,0x4ea04ea,0x4ea04ea,0x4ea04ea,0x4ea04ea,0x4ea04ea,0x4ea04ea,0x4ea04ea,0x4ea04ea
.long 0x68c06f4,0x6e506dd,0x6de06ed,0x6ee06e6,0x6e706df,0xcda06ef,0xcdc0cdb,0xcde0cdd,0xce20cdf,0xce40ce3,0xce60ce5,0xcea0ce7,0xcec0ceb,0xcee0ced,0xcf20cef,0xcf40cf3
.long 0xcf60cf5,0xde80cf7,0x6f406f4,0x6f406f4,0x6f406f4,0x6f406f4,0x6f406f4,0x6f406f4,0x6f406f4,0x6f406f4,0x6f406f4,0x6f406f4,0x6f406f4,0x6f406f4,0x6f406f4,0x6f406f4
.long 0x2110210,0x2130212,0x2150214,0x2170216,0x2190218,0x21b021a,0x21d021c,0x21f021e,0x2100210,0x2100210,0x2100210,0x2100210,0x2100210,0x2100210,0x2100210,0x2100210
.long 0x2100210,0x2100210,0x2100210,0x2100210,0x2100210,0x2100210,0x2100210,0x2100210,0x2100210,0x2100210,0x2100210,0x2100210,0x2100210,0x2100210,0x2100210,0x2100210
.long 0x4eb04ea,0x4ed04ec,0x4ef04ee,0x4f304f2,0x4ea04f4,0x4ea04ea,0x4ea04ea,0x4ea04ea,0x4ea04ea,0x4ea04ea,0x4ea04ea,0x4ea04ea,0x4ea04ea,0x4ea04ea,0x4ea04ea,0x4ea04ea
.long 0x4ea04ea,0x4ea04ea,0x4ea04ea,0x4ea04ea,0x4ea04ea,0x4ea04ea,0x4ea04ea,0x4ea04ea,0x4ea04ea,0x4ea04ea,0x4ea04ea,0x4ea04ea,0x4ea04ea,0x4ea04ea,0x4ea04ea,0x4ea04ea
.long 0x6e206da,0x6f206ea,0x6e306db,0x6f306eb,0x6e406dc,0xcda06ec,0xcdc0cdb,0xcde0cdd,0xce20cdf,0xce40ce3,0xce60ce5,0xcea0ce7,0xcec0ceb,0xcee0ced,0xcf20cef,0xcf40cf3
.long 0xcf60cf5,0xde90cf7,0x6da06da,0x6da06da,0x6da06da,0x6da06da,0x6da06da,0x6da06da,0x6da06da,0x6da06da,0x6da06da,0x6da06da,0x6da06da,0x6da06da,0x6da06da,0x6da06da
.long 0x2510250,0x2530252,0x2550254,0x2570256,0x2590258,0x25b025a,0x25d025c,0x25f025e,0x2500250,0x2500250,0x2500250,0x2500250,0x2500250,0x2500250,0x2500250,0x2500250
.long 0x2500250,0x2500250,0x2500250,0x2500250,0x2500250,0x2500250,0x2500250,0x2500250,0x2500250,0x2500250,0x2500250,0x2500250,0x2500250,0x2500250,0x2500250,0x2500250
.long 0x4eb04ea,0x4ed04ec,0x4ef04ee,0x4f304f2,0x4ea04f4,0x4ea04ea,0x4ea04ea,0x4ea04ea,0x4ea04ea,0x4ea04ea,0x4ea04ea,0x4ea04ea,0x4ea04ea,0x4ea04ea,0x4ea04ea,0x4ea04ea
.long 0x4ea04ea,0x4ea04ea,0x4ea04ea,0x4ea04ea,0x4ea04ea,0x4ea04ea,0x4ea04ea,0x4ea04ea,0x4ea04ea,0x4ea04ea,0x4ea04ea,0x4ea04ea,0x4ea04ea,0x4ea04ea,0x4ea04ea,0x4ea04ea
.long 0x68c06f4,0x6e506dd,0x6de06ed,0x6ee06e6,0x6e706df,0xcda06ef,0xcdc0cdb,0xcde0cdd,0xce20cdf,0xce40ce3,0xce60ce5,0xcea0ce7,0xcec0ceb,0xcee0ced,0xcf20cef,0xcf40cf3
.long 0xcf60cf5,0xde90cf7,0x6f406f4,0x6f406f4,0x6f406f4,0x6f406f4,0x6f406f4,0x6f406f4,0x6f406f4,0x6f406f4,0x6f406f4,0x6f406f4,0x6f406f4,0x6f406f4,0x6f406f4,0x6f406f4
.long 0x2310230,0x2330232,0x2350234,0x2370236,0x2390238,0x23b023a,0x23d023c,0x23f023e,0x2300230,0x2300230,0x2300230,0x2300230,0x2300230,0x2300230,0x2300230,0x2300230
.long 0x2300230,0x2300230,0x2300230,0x2300230,0x2300230,0x2300230,0x2300230,0x2300230,0x2300230,0x2300230,0x2300230,0x2300230,0x2300230,0x2300230,0x2300230,0x2300230
.long 0x4eb04ea,0x4ed04ec,0x4ef04ee,0x4f304f2,0x4ea04f4,0x4ea04ea,0x4ea04ea,0x4ea04ea,0x4ea04ea,0x4ea04ea,0x4ea04ea,0x4ea04ea,0x4ea04ea,0x4ea04ea,0x4ea04ea,0x4ea04ea
.long 0x4ea04ea,0x4ea04ea,0x4ea04ea,0x4ea04ea,0x4ea04ea,0x4ea04ea,0x4ea04ea,0x4ea04ea,0x4ea04ea,0x4ea04ea,0x4ea04ea,0x4ea04ea,0x4ea04ea,0x4ea04ea,0x4ea04ea,0x4ea04ea
.long 0x68c06f4,0x6e506dd,0x6de06ed,0x6ee06e6,0x6e706df,0xcda06ef,0xcdc0cdb,0xcde0cdd,0xce20cdf,0xce40ce3,0xce60ce5,0xcea0ce7,0xcec0ceb,0xcee0ced,0xcf20cef,0xcf40cf3
.long 0xcf60cf5,0xcfa0cf7,0x6f406f4,0x6f406f4,0x6f406f4,0x6f406f4,0x6f406f4,0x6f406f4,0x6f406f4,0x6f406f4,0x6f406f4,0x6f406f4,0x6f406f4,0x6f406f4,0x6f406f4,0x6f406f4
.long 0x2710270,0x2730272,0x2750274,0x2770276,0x2790278,0x27b027a,0x27d027c,0x27f027e,0x2700270,0x2700270,0x2700270,0x2700270,0x2700270,0x2700270,0x2700270,0x2700270
.long 0x2700270,0x2700270,0x2700270,0x2700270,0x2700270,0x2700270,0x2700270,0x2700270,0x2700270,0x2700270,0x2700270,0x2700270,0x2700270,0x2700270,0x2700270,0x2700270
.long 0x4eb04ea,0x4ed04ec,0x4ef04ee,0x4f304f2,0x4ea04f4,0x4ea04ea,0x4ea04ea,0x4ea04ea,0x4ea04ea,0x4ea04ea,0x4ea04ea,0x4ea04ea,0x4ea04ea,0x4ea04ea,0x4ea04ea,0x4ea04ea
.long 0x4ea04ea,0x4ea04ea,0x4ea04ea,0x4ea04ea,0x4ea04ea,0x4ea04ea,0x4ea04ea,0x4ea04ea,0x4ea04ea,0x4ea04ea,0x4ea04ea,0x4ea04ea,0x4ea04ea,0x4ea04ea,0x4ea04ea,0x4ea04ea
.long 0x28b028b,0x28b028b,0x28b028b,0x28b028b,0x28b028b,0x28b028b,0x28b028b,0x28b028b,0x28b028b,0x28b028b,0x28b028b,0x28b028b,0x28b028b,0x28b028b,0x28b028b,0x28b028b
.long 0x28b028b,0x28b028b,0x28b028b,0x28b028b,0x28b028b,0x28b028b,0x28b028b,0x28b028b,0x28b028b,0x28b028b,0x28b028b,0x28b028b,0x28b028b,0x28b028b,0x28b028b,0x28b028b
.long 0x2110210,0x2130212,0x2150214,0x2170216,0x2190218,0x21b021a,0x21d021c,0x21f021e,0x2100210,0x2100210,0x2100210,0x2100210,0x2100210,0x2100210,0x2100210,0x2100210
.long 0x2100210,0x2100210,0x2100210,0x2100210,0x2100210,0x2100210,0x2100210,0x2100210,0x2100210,0x2100210,0x2100210,0x2100210,0x2100210,0x2100210,0x2100210,0x2100210
.long 0x4250405,0x4650445,0x4070485,0x4470427,0x4d80467,0x4e004d9,0x4e804e1,0x4da04e9,0x4dc04db,0x4050405,0x4050405,0x4050405,0x4050405,0x4050405,0x4050405,0x4050405
.long 0x4050405,0x4050405,0x4050405,0x4050405,0x4050405,0x4050405,0x4050405,0x4050405,0x4050405,0x4050405,0x4050405,0x4050405,0x4050405,0x4050405,0x4050405,0x4050405
.long 0x28c028c,0x28c028c,0x28c028c,0x28c028c,0x28c028c,0x28c028c,0x28c028c,0x28c028c,0x28c028c,0x28c028c,0x28c028c,0x28c028c,0x28c028c,0x28c028c,0x28c028c,0x28c028c
.long 0x28c028c,0x28c028c,0x28c028c,0x28c028c,0x28c028c,0x28c028c,0x28c028c,0x28c028c,0x28c028c,0x28c028c,0x28c028c,0x28c028c,0x28c028c,0x28c028c,0x28c028c,0x28c028c
.long 0x2510250,0x2530252,0x2550254,0x2570256,0x2590258,0x25b025a,0x25d025c,0x25f025e,0x2500250,0x2500250,0x2500250,0x2500250,0x2500250,0x2500250,0x2500250,0x2500250
.long 0x2500250,0x2500250,0x2500250,0x2500250,0x2500250,0x2500250,0x2500250,0x2500250,0x2500250,0x2500250,0x2500250,0x2500250,0x2500250,0x2500250,0x2500250,0x2500250
.long 0x28d028d,0x28d028d,0x28d028d,0x28d028d,0x28d028d,0x28d028d,0x28d028d,0x28d028d,0x28d028d,0x28d028d,0x28d028d,0x28d028d,0x28d028d,0x28d028d,0x28d028d,0x28d028d
.long 0x28d028d,0x28d028d,0x28d028d,0x28d028d,0x28d028d,0x28d028d,0x28d028d,0x28d028d,0x28d028d,0x28d028d,0x28d028d,0x28d028d,0x28d028d,0x28d028d,0x28d028d,0x28d028d
.long 0x68c06f4,0x6e506dd,0x6de06ed,0x6ee06e6,0x6e706df,0xcda06ef,0xcdc0cdb,0xcde0cdd,0xce20cdf,0xce40ce3,0xce60ce5,0xcea0ce7,0xcec0ceb,0xcee0ced,0xcf20cef,0xcf40cf3
.long 0xcf60cf5,0xcfe0cf7,0x6f406f4,0x6f406f4,0x6f406f4,0x6f406f4,0x6f406f4,0x6f406f4,0x6f406f4,0x6f406f4,0x6f406f4,0x6f406f4,0x6f406f4,0x6f406f4,0x6f406f4,0x6f406f4
.long 0x2310230,0x2330232,0x2350234,0x2370236,0x2390238,0x23b023a,0x23d023c,0x23f023e,0x2300230,0x2300230,0x2300230,0x2300230,0x2300230,0x2300230,0x2300230,0x2300230
.long 0x2300230,0x2300230,0x2300230,0x2300230,0x2300230,0x2300230,0x2300230,0x2300230,0x2300230,0x2300230,0x2300230,0x2300230,0x2300230,0x2300230,0x2300230,0x2300230
.long 0x28e028e,0x28e028e,0x28e028e,0x28e028e,0x28e028e,0x28e028e,0x28e028e,0x28e028e,0x28e028e,0x28e028e,0x28e028e,0x28e028e,0x28e028e,0x28e028e,0x28e028e,0x28e028e
.long 0x28e028e,0x28e028e,0x28e028e,0x28e028e,0x28e028e,0x28e028e,0x28e028e,0x28e028e,0x28e028e,0x28e028e,0x28e028e,0x28e028e,0x28e028e,0x28e028e,0x28e028e,0x28e028e
.long 0x6e206da,0x6f206ea,0x6e306db,0x6f306eb,0x6e406dc,0xcda06ec,0xcdc0cdb,0xcde0cdd,0xce20cdf,0xce40ce3,0xce60ce5,0xcea0ce7,0xcec0ceb,0xcee0ced,0xcf20cef,0xcf40cf3
.long 0xcf60cf5,0xcfe0cf7,0x6da06da,0x6da06da,0x6da06da,0x6da06da,0x6da06da,0x6da06da,0x6da06da,0x6da06da,0x6da06da,0x6da06da,0x6da06da,0x6da06da,0x6da06da,0x6da06da
.long 0x2710270,0x2730272,0x2750274,0x2770276,0x2790278,0x27b027a,0x27d027c,0x27f027e,0x2700270,0x2700270,0x2700270,0x2700270,0x2700270,0x2700270,0x2700270,0x2700270
.long 0x2700270,0x2700270,0x2700270,0x2700270,0x2700270,0x2700270,0x2700270,0x2700270,0x2700270,0x2700270,0x2700270,0x2700270,0x2700270,0x2700270,0x2700270,0x2700270
.long 0x28f028f,0x28f028f,0x28f028f,0x28f028f,0x28f028f,0x28f028f,0x28f028f,0x28f028f,0x28f028f,0x28f028f,0x28f028f,0x28f028f,0x28f028f,0x28f028f,0x28f028f,0x28f028f
.long 0x28f028f,0x28f028f,0x28f028f,0x28f028f,0x28f028f,0x28f028f,0x28f028f,0x28f028f,0x28f028f,0x28f028f,0x28f028f,0x28f028f,0x28f028f,0x28f028f,0x28f028f,0x28f028f
.long 0x68c06f4,0x6e506dd,0x6de06ed,0x6ee06e6,0x6e706df,0xcda06ef,0xcdc0cdb,0xcde0cdd,0xce20cdf,0xce40ce3,0xce60ce5,0xcea0ce7,0xcec0ceb,0xcee0ced,0xcf20cef,0xcf40cf3
.long 0xcf60cf5,0xcff0cf7,0x6f406f4,0x6f406f4,0x6f406f4,0x6f406f4,0x6f406f4,0x6f406f4,0x6f406f4,0x6f406f4,0x6f406f4,0x6f406f4,0x6f406f4,0x6f406f4,0x6f406f4,0x6f406f4
.long 0x2010200,0x2030202,0x2050204,0x2070206,0x2090208,0x20b020a,0x20d020c,0x20f020e,0x3a80390,0x39303c0,0x3c303ab,0x3ae0396,0x20003c6,0x2000200,0x2000200,0x2000200
.long 0x2000200,0x2000200,0x2000200,0x2000200,0x2000200,0x2000200,0x2000200,0x2000200,0x2000200,0x2000200,0x2000200,0x2000200,0x2000200,0x2000200,0x2000200,0x2000200
.long 0x2900290,0x2900290,0x2900290,0x2900290,0x2900290,0x2900290,0x2900290,0x2900290,0x2900290,0x2900290,0x2900290,0x2900290,0x2900290,0x2900290,0x2900290,0x2900290
.long 0x2900290,0x2900290,0x2900290,0x2900290,0x2900290,0x2900290,0x2900290,0x2900290,0x2900290,0x2900290,0x2900290,0x2900290,0x2900290,0x2900290,0x2900290,0x2900290
.long 0x630062a,0x6380632,0x640063a,0x6480642,0x650064a,0x4920658,0x4a2049a,0x67d04aa,0x4f6067e,0x62a062a,0x62a062a,0x62a062a,0x62a062a,0x62a062a,0x62a062a,0x62a062a
.long 0x62a062a,0x62a062a,0x62a062a,0x62a062a,0x62a062a,0x62a062a,0x62a062a,0x62a062a,0x62a062a,0x62a062a,0x62a062a,0x62a062a,0x62a062a,0x62a062a,0x62a062a,0x62a062a
.long 0x2410240,0x2430242,0x2450244,0x2470246,0x2490248,0x24b024a,0x24d024c,0x24f024e,0x3a80390,0x39303c0,0x3c303ab,0x3ae0396,0x24003c6,0x2400240,0x2400240,0x2400240
.long 0x2400240,0x2400240,0x2400240,0x2400240,0x2400240,0x2400240,0x2400240,0x2400240,0x2400240,0x2400240,0x2400240,0x2400240,0x2400240,0x2400240,0x2400240,0x2400240
.long 0x2910291,0x2910291,0x2910291,0x2910291,0x2910291,0x2910291,0x2910291,0x2910291,0x2910291,0x2910291,0x2910291,0x2910291,0x2910291,0x2910291,0x2910291,0x2910291
.long 0x2910291,0x2910291,0x2910291,0x2910291,0x2910291,0x2910291,0x2910291,0x2910291,0x2910291,0x2910291,0x2910291,0x2910291,0x2910291,0x2910291,0x2910291,0x2910291
.long 0x633062b,0x643063b,0x64b0649,0x6590651,0x6690661,0x4920671,0x4a2049a,0x67d04aa,0x4f6067e,0x62b062b,0x62b062b,0x62b062b,0x62b062b,0x62b062b,0x62b062b,0x62b062b
.long 0x62b062b,0x62b062b,0x62b062b,0x62b062b,0x62b062b,0x62b062b,0x62b062b,0x62b062b,0x62b062b,0x62b062b,0x62b062b,0x62b062b,0x62b062b,0x62b062b,0x62b062b,0x62b062b
.long 0x2010200,0x2030202,0x2050204,0x2070206,0x2090208,0x20b020a,0x20d020c,0x20f020e,0x3b803a0,0x3a303d0,0x3d303bb,0x3be03a6,0x20003d6,0x2000200,0x2000200,0x2000200
.long 0x2000200,0x2000200,0x2000200,0x2000200,0x2000200,0x2000200,0x2000200,0x2000200,0x2000200,0x2000200,0x2000200,0x2000200,0x2000200,0x2000200,0x2000200,0x2000200
.long 0x2920292,0x2920292,0x2920292,0x2920292,0x2920292,0x2920292,0x2920292,0x2920292,0x2920292,0x2920292,0x2920292,0x2920292,0x2920292,0x2920292,0x2920292,0x2920292
.long 0x2920292,0x2920292,0x2920292,0x2920292,0x2920292,0x2920292,0x2920292,0x2920292,0x2920292,0x2920292,0x2920292,0x2920292,0x2920292,0x2920292,0x2920292,0x2920292
.long 0x630062a,0x6380632,0x640063a,0x6480642,0x650064a,0x4960658,0x49e04b6,0x4a604be,0x4ae04c6,0x68704ce,0x4f10688,0x62a04f8,0x62a062a,0x62a062a,0x62a062a,0x62a062a
.long 0x62a062a,0x62a062a,0x62a062a,0x62a062a,0x62a062a,0x62a062a,0x62a062a,0x62a062a,0x62a062a,0x62a062a,0x62a062a,0x62a062a,0x62a062a,0x62a062a,0x62a062a,0x62a062a
.long 0x2410240,0x2430242,0x2450244,0x2470246,0x2490248,0x24b024a,0x24d024c,0x24f024e,0x3b803a0,0x3a303d0,0x3d303bb,0x3be03a6,0x24003d6,0x2400240,0x2400240,0x2400240
.long 0x2400240,0x2400240,0x2400240,0x2400240,0x2400240,0x2400240,0x2400240,0x2400240,0x2400240,0x2400240,0x2400240,0x2400240,0x2400240,0x2400240,0x2400240,0x2400240
.long 0x2930293,0x2930293,0x2930293,0x2930293,0x2930293,0x2930293,0x2930293,0x2930293,0x2930293,0x2930293,0x2930293,0x2930293,0x2930293,0x2930293,0x2930293,0x2930293
.long 0x2930293,0x2930293,0x2930293,0x2930293,0x2930293,0x2930293,0x2930293,0x2930293,0x2930293,0x2930293,0x2930293,0x2930293,0x2930293,0x2930293,0x2930293,0x2930293
.long 0x633062b,0x643063b,0x64b0649,0x6590651,0x6690661,0x4960671,0x49e04b6,0x4a604be,0x4ae04c6,0x68704ce,0x4f10688,0x62b04f8,0x62b062b,0x62b062b,0x62b062b,0x62b062b
.long 0x62b062b,0x62b062b,0x62b062b,0x62b062b,0x62b062b,0x62b062b,0x62b062b,0x62b062b,0x62b062b,0x62b062b,0x62b062b,0x62b062b,0x62b062b,0x62b062b,0x62b062b,0x62b062b
.long 0x2010200,0x2030202,0x2050204,0x2070206,0x2090208,0x20b020a,0x20d020c,0x20f020e,0x3b10399,0x39c03c9,0x3cc03b4,0x3b7039f,0x20003cf,0x2000200,0x2000200,0x2000200
.long 0x2000200,0x2000200,0x2000200,0x2000200,0x2000200,0x2000200,0x2000200,0x2000200,0x2000200,0x2000200,0x2000200,0x2000200,0x2000200,0x2000200,0x2000200,0x2000200
.long 0x2940294,0x2940294,0x2940294,0x2940294,0x2940294,0x2940294,0x2940294,0x2940294,0x2940294,0x2940294,0x2940294,0x2940294,0x2940294,0x2940294,0x2940294,0x2940294
.long 0x2940294,0x2940294,0x2940294,0x2940294,0x2940294,0x2940294,0x2940294,0x2940294,0x2940294,0x2940294,0x2940294,0x2940294,0x2940294,0x2940294,0x2940294,0x2940294
.long 0x634062e,0x63c0636,0x644063e,0x64c0646,0x654064e,0x493065c,0x4a3049b,0x67d04ab,0x4f6067e,0x62e062e,0x62e062e,0x62e062e,0x62e062e,0x62e062e,0x62e062e,0x62e062e
.long 0x62e062e,0x62e062e,0x62e062e,0x62e062e,0x62e062e,0x62e062e,0x62e062e,0x62e062e,0x62e062e,0x62e062e,0x62e062e,0x62e062e,0x62e062e,0x62e062e,0x62e062e,0x62e062e
.long 0x2410240,0x2430242,0x2450244,0x2470246,0x2490248,0x24b024a,0x24d024c,0x24f024e,0x3b10399,0x39c03c9,0x3cc03b4,0x3b7039f,0x24003cf,0x2400240,0x2400240,0x2400240
.long 0x2400240,0x2400240,0x2400240,0x2400240,0x2400240,0x2400240,0x2400240,0x2400240,0x2400240,0x2400240,0x2400240,0x2400240,0x2400240,0x2400240,0x2400240,0x2400240
.long 0x2950295,0x2950295,0x2950295,0x2950295,0x2950295,0x2950295,0x2950295,0x2950295,0x2950295,0x2950295,0x2950295,0x2950295,0x2950295,0x2950295,0x2950295,0x2950295
.long 0x2950295,0x2950295,0x2950295,0x2950295,0x2950295,0x2950295,0x2950295,0x2950295,0x2950295,0x2950295,0x2950295,0x2950295,0x2950295,0x2950295,0x2950295,0x2950295
.long 0x637062f,0x647063f,0x64f064d,0x65d0655,0x66d0665,0x4930675,0x4a3049b,0x67d04ab,0x4f6067e,0x62f062f,0x62f062f,0x62f062f,0x62f062f,0x62f062f,0x62f062f,0x62f062f
.long 0x62f062f,0x62f062f,0x62f062f,0x62f062f,0x62f062f,0x62f062f,0x62f062f,0x62f062f,0x62f062f,0x62f062f,0x62f062f,0x62f062f,0x62f062f,0x62f062f,0x62f062f,0x62f062f
.long 0x2010200,0x2030202,0x2050204,0x2070206,0x2090208,0x20b020a,0x20d020c,0x20f020e,0x3aa0392,0x39503c2,0x3c503ad,0x3fa03f1,0x20003fd,0x2000200,0x2000200,0x2000200
.long 0x2000200,0x2000200,0x2000200,0x2000200,0x2000200,0x2000200,0x2000200,0x2000200,0x2000200,0x2000200,0x2000200,0x2000200,0x2000200,0x2000200,0x2000200,0x2000200
.long 0x2960296,0x2960296,0x2960296,0x2960296,0x2960296,0x2960296,0x2960296,0x2960296,0x2960296,0x2960296,0x2960296,0x2960296,0x2960296,0x2960296,0x2960296,0x2960296
.long 0x2960296,0x2960296,0x2960296,0x2960296,0x2960296,0x2960296,0x2960296,0x2960296,0x2960296,0x2960296,0x2960296,0x2960296,0x2960296,0x2960296,0x2960296,0x2960296
.long 0x634062e,0x63c0636,0x644063e,0x64c0646,0x654064e,0x497065c,0x49f04b7,0x4a704bf,0x4af04c7,0x68704cf,0x4f10688,0x62e04f8,0x62e062e,0x62e062e,0x62e062e,0x62e062e
.long 0x62e062e,0x62e062e,0x62e062e,0x62e062e,0x62e062e,0x62e062e,0x62e062e,0x62e062e,0x62e062e,0x62e062e,0x62e062e,0x62e062e,0x62e062e,0x62e062e,0x62e062e,0x62e062e
.long 0x2410240,0x2430242,0x2450244,0x2470246,0x2490248,0x24b024a,0x24d024c,0x24f024e,0x3aa0392,0x39503c2,0x3c503ad,0x3fa03f1,0x24003fd,0x2400240,0x2400240,0x2400240
.long 0x2400240,0x2400240,0x2400240,0x2400240,0x2400240,0x2400240,0x2400240,0x2400240,0x2400240,0x2400240,0x2400240,0x2400240,0x2400240,0x2400240,0x2400240,0x2400240
.long 0x2970297,0x2970297,0x2970297,0x2970297,0x2970297,0x2970297,0x2970297,0x2970297,0x2970297,0x2970297,0x2970297,0x2970297,0x2970297,0x2970297,0x2970297,0x2970297
.long 0x2970297,0x2970297,0x2970297,0x2970297,0x2970297,0x2970297,0x2970297,0x2970297,0x2970297,0x2970297,0x2970297,0x2970297,0x2970297,0x2970297,0x2970297,0x2970297
.long 0x637062f,0x647063f,0x64f064d,0x65d0655,0x66d0665,0x4970675,0x49f04b7,0x4a704bf,0x4af04c7,0x68704cf,0x4f10688,0x62f04f8,0x62f062f,0x62f062f,0x62f062f,0x62f062f
.long 0x62f062f,0x62f062f,0x62f062f,0x62f062f,0x62f062f,0x62f062f,0x62f062f,0x62f062f,0x62f062f,0x62f062f,0x62f062f,0x62f062f,0x62f062f,0x62f062f,0x62f062f,0x62f062f
.long 0x2110210,0x2130212,0x2150214,0x2170216,0x2190218,0x21b021a,0x21d021c,0x21f021e,0x3a80390,0x39303c0,0x3c303ab,0x3ae0396,0x21003c6,0x2100210,0x2100210,0x2100210
.long 0x2100210,0x2100210,0x2100210,0x2100210,0x2100210,0x2100210,0x2100210,0x2100210,0x2100210,0x2100210,0x2100210,0x2100210,0x2100210,0x2100210,0x2100210,0x2100210
.long 0x2980298,0x2980298,0x2980298,0x2980298,0x2980298,0x2980298,0x2980298,0x2980298,0x2980298,0x2980298,0x2980298,0x2980298,0x2980298,0x2980298,0x2980298,0x2980298
.long 0x2980298,0x2980298,0x2980298,0x2980298,0x2980298,0x2980298,0x2980298,0x2980298,0x2980298,0x2980298,0x2980298,0x2980298,0x2980298,0x2980298,0x2980298,0x2980298
.long 0x630062a,0x6380632,0x640063a,0x6480642,0x650064a,0x4b20658,0x4c204ba,0x68004ca,0x4f70681,0x62a062a,0x62a062a,0x62a062a,0x62a062a,0x62a062a,0x62a062a,0x62a062a
.long 0x62a062a,0x62a062a,0x62a062a,0x62a062a,0x62a062a,0x62a062a,0x62a062a,0x62a062a,0x62a062a,0x62a062a,0x62a062a,0x62a062a,0x62a062a,0x62a062a,0x62a062a,0x62a062a
.long 0x2510250,0x2530252,0x2550254,0x2570256,0x2590258,0x25b025a,0x25d025c,0x25f025e,0x3a80390,0x39303c0,0x3c303ab,0x3ae0396,0x25003c6,0x2500250,0x2500250,0x2500250
.long 0x2500250,0x2500250,0x2500250,0x2500250,0x2500250,0x2500250,0x2500250,0x2500250,0x2500250,0x2500250,0x2500250,0x2500250,0x2500250,0x2500250,0x2500250,0x2500250
.long 0x2990299,0x2990299,0x2990299,0x2990299,0x2990299,0x2990299,0x2990299,0x2990299,0x2990299,0x2990299,0x2990299,0x2990299,0x2990299,0x2990299,0x2990299,0x2990299
.long 0x2990299,0x2990299,0x2990299,0x2990299,0x2990299,0x2990299,0x2990299,0x2990299,0x2990299,0x2990299,0x2990299,0x2990299,0x2990299,0x2990299,0x2990299,0x2990299
.long 0x633062b,0x643063b,0x64b0649,0x6590651,0x6690661,0x4b20671,0x4c204ba,0x68004ca,0x4f70681,0x62b062b,0x62b062b,0x62b062b,0x62b062b,0x62b062b,0x62b062b,0x62b062b
.long 0x62b062b,0x62b062b,0x62b062b,0x62b062b,0x62b062b,0x62b062b,0x62b062b,0x62b062b,0x62b062b,0x62b062b,0x62b062b,0x62b062b,0x62b062b,0x62b062b,0x62b062b,0x62b062b
.long 0x2110210,0x2130212,0x2150214,0x2170216,0x2190218,0x21b021a,0x21d021c,0x21f021e,0x3b803a0,0x3a303d0,0x3d303bb,0x3be03a6,0x21003d6,0x2100210,0x2100210,0x2100210
.long 0x2100210,0x2100210,0x2100210,0x2100210,0x2100210,0x2100210,0x2100210,0x2100210,0x2100210,0x2100210,0x2100210,0x2100210,0x2100210,0x2100210,0x2100210,0x2100210
.long 0x29a029a,0x29a029a,0x29a029a,0x29a029a,0x29a029a,0x29a029a,0x29a029a,0x29a029a,0x29a029a,0x29a029a,0x29a029a,0x29a029a,0x29a029a,0x29a029a,0x29a029a,0x29a029a
.long 0x29a029a,0x29a029a,0x29a029a,0x29a029a,0x29a029a,0x29a029a,0x29a029a,0x29a029a,0x29a029a,0x29a029a,0x29a029a,0x29a029a,0x29a029a,0x29a029a,0x29a029a,0x29a029a
.long 0x630062a,0x6380632,0x640063a,0x6480642,0x650064a,0x4b60658,0x4be04d0,0x4c604d2,0x4ce04d4,0x68904d6,0x4f8068a,0x62a04f9,0x62a062a,0x62a062a,0x62a062a,0x62a062a
.long 0x62a062a,0x62a062a,0x62a062a,0x62a062a,0x62a062a,0x62a062a,0x62a062a,0x62a062a,0x62a062a,0x62a062a,0x62a062a,0x62a062a,0x62a062a,0x62a062a,0x62a062a,0x62a062a
.long 0x2510250,0x2530252,0x2550254,0x2570256,0x2590258,0x25b025a,0x25d025c,0x25f025e,0x3b803a0,0x3a303d0,0x3d303bb,0x3be03a6,0x25003d6,0x2500250,0x2500250,0x2500250
.long 0x2500250,0x2500250,0x2500250,0x2500250,0x2500250,0x2500250,0x2500250,0x2500250,0x2500250,0x2500250,0x2500250,0x2500250,0x2500250,0x2500250,0x2500250,0x2500250
.long 0x29b029b,0x29b029b,0x29b029b,0x29b029b,0x29b029b,0x29b029b,0x29b029b,0x29b029b,0x29b029b,0x29b029b,0x29b029b,0x29b029b,0x29b029b,0x29b029b,0x29b029b,0x29b029b
.long 0x29b029b,0x29b029b,0x29b029b,0x29b029b,0x29b029b,0x29b029b,0x29b029b,0x29b029b,0x29b029b,0x29b029b,0x29b029b,0x29b029b,0x29b029b,0x29b029b,0x29b029b,0x29b029b
.long 0x633062b,0x643063b,0x64b0649,0x6590651,0x6690661,0x4b60671,0x4be04d0,0x4c604d2,0x4ce04d4,0x68904d6,0x4f8068a,0x62b04f9,0x62b062b,0x62b062b,0x62b062b,0x62b062b
.long 0x62b062b,0x62b062b,0x62b062b,0x62b062b,0x62b062b,0x62b062b,0x62b062b,0x62b062b,0x62b062b,0x62b062b,0x62b062b,0x62b062b,0x62b062b,0x62b062b,0x62b062b,0x62b062b
.long 0x2110210,0x2130212,0x2150214,0x2170216,0x2190218,0x21b021a,0x21d021c,0x21f021e,0x3b10399,0x39c03c9,0x3cc03b4,0x3b7039f,0x21003cf,0x2100210,0x2100210,0x2100210
.long 0x2100210,0x2100210,0x2100210,0x2100210,0x2100210,0x2100210,0x2100210,0x2100210,0x2100210,0x2100210,0x2100210,0x2100210,0x2100210,0x2100210,0x2100210,0x2100210
.long 0x29c029c,0x29c029c,0x29c029c,0x29c029c,0x29c029c,0x29c029c,0x29c029c,0x29c029c,0x29c029c,0x29c029c,0x29c029c,0x29c029c,0x29c029c,0x29c029c,0x29c029c,0x29c029c
.long 0x29c029c,0x29c029c,0x29c029c,0x29c029c,0x29c029c,0x29c029c,0x29c029c,0x29c029c,0x29c029c,0x29c029c,0x29c029c,0x29c029c,0x29c029c,0x29c029c,0x29c029c,0x29c029c
.long 0x634062e,0x63c0636,0x644063e,0x64c0646,0x654064e,0x4b3065c,0x4c304bb,0x68004cb,0x4f70681,0x62e062e,0x62e062e,0x62e062e,0x62e062e,0x62e062e,0x62e062e,0x62e062e
.long 0x62e062e,0x62e062e,0x62e062e,0x62e062e,0x62e062e,0x62e062e,0x62e062e,0x62e062e,0x62e062e,0x62e062e,0x62e062e,0x62e062e,0x62e062e,0x62e062e,0x62e062e,0x62e062e
.long 0x2510250,0x2530252,0x2550254,0x2570256,0x2590258,0x25b025a,0x25d025c,0x25f025e,0x3b10399,0x39c03c9,0x3cc03b4,0x3b7039f,0x25003cf,0x2500250,0x2500250,0x2500250
.long 0x2500250,0x2500250,0x2500250,0x2500250,0x2500250,0x2500250,0x2500250,0x2500250,0x2500250,0x2500250,0x2500250,0x2500250,0x2500250,0x2500250,0x2500250,0x2500250
.long 0x29d029d,0x29d029d,0x29d029d,0x29d029d,0x29d029d,0x29d029d,0x29d029d,0x29d029d,0x29d029d,0x29d029d,0x29d029d,0x29d029d,0x29d029d,0x29d029d,0x29d029d,0x29d029d
.long 0x29d029d,0x29d029d,0x29d029d,0x29d029d,0x29d029d,0x29d029d,0x29d029d,0x29d029d,0x29d029d,0x29d029d,0x29d029d,0x29d029d,0x29d029d,0x29d029d,0x29d029d,0x29d029d
.long 0x637062f,0x647063f,0x64f064d,0x65d0655,0x66d0665,0x4b30675,0x4c304bb,0x68004cb,0x4f70681,0x62f062f,0x62f062f,0x62f062f,0x62f062f,0x62f062f,0x62f062f,0x62f062f
.long 0x62f062f,0x62f062f,0x62f062f,0x62f062f,0x62f062f,0x62f062f,0x62f062f,0x62f062f,0x62f062f,0x62f062f,0x62f062f,0x62f062f,0x62f062f,0x62f062f,0x62f062f,0x62f062f
.long 0x2110210,0x2130212,0x2150214,0x2170216,0x2190218,0x21b021a,0x21d021c,0x21f021e,0x3aa0392,0x39503c2,0x3c503ad,0x3fa03f1,0x21003fd,0x2100210,0x2100210,0x2100210
.long 0x2100210,0x2100210,0x2100210,0x2100210,0x2100210,0x2100210,0x2100210,0x2100210,0x2100210,0x2100210,0x2100210,0x2100210,0x2100210,0x2100210,0x2100210,0x2100210
.long 0x29e029e,0x29e029e,0x29e029e,0x29e029e,0x29e029e,0x29e029e,0x29e029e,0x29e029e,0x29e029e,0x29e029e,0x29e029e,0x29e029e,0x29e029e,0x29e029e,0x29e029e,0x29e029e
.long 0x29e029e,0x29e029e,0x29e029e,0x29e029e,0x29e029e,0x29e029e,0x29e029e,0x29e029e,0x29e029e,0x29e029e,0x29e029e,0x29e029e,0x29e029e,0x29e029e,0x29e029e,0x29e029e
.long 0x634062e,0x63c0636,0x644063e,0x64c0646,0x654064e,0x4b7065c,0x4bf04d1,0x4c704d3,0x4cf04d5,0x68904d7,0x4f8068a,0x62e04f9,0x62e062e,0x62e062e,0x62e062e,0x62e062e
.long 0x62e062e,0x62e062e,0x62e062e,0x62e062e,0x62e062e,0x62e062e,0x62e062e,0x62e062e,0x62e062e,0x62e062e,0x62e062e,0x62e062e,0x62e062e,0x62e062e,0x62e062e,0x62e062e
.long 0x2510250,0x2530252,0x2550254,0x2570256,0x2590258,0x25b025a,0x25d025c,0x25f025e,0x3aa0392,0x39503c2,0x3c503ad,0x3fa03f1,0x25003fd,0x2500250,0x2500250,0x2500250
.long 0x2500250,0x2500250,0x2500250,0x2500250,0x2500250,0x2500250,0x2500250,0x2500250,0x2500250,0x2500250,0x2500250,0x2500250,0x2500250,0x2500250,0x2500250,0x2500250
.long 0x29f029f,0x29f029f,0x29f029f,0x29f029f,0x29f029f,0x29f029f,0x29f029f,0x29f029f,0x29f029f,0x29f029f,0x29f029f,0x29f029f,0x29f029f,0x29f029f,0x29f029f,0x29f029f
.long 0x29f029f,0x29f029f,0x29f029f,0x29f029f,0x29f029f,0x29f029f,0x29f029f,0x29f029f,0x29f029f,0x29f029f,0x29f029f,0x29f029f,0x29f029f,0x29f029f,0x29f029f,0x29f029f
.long 0x637062f,0x647063f,0x64f064d,0x65d0655,0x66d0665,0x4b70675,0x4bf04d1,0x4c704d3,0x4cf04d5,0x68904d7,0x4f8068a,0x62f04f9,0x62f062f,0x62f062f,0x62f062f,0x62f062f
.long 0x62f062f,0x62f062f,0x62f062f,0x62f062f,0x62f062f,0x62f062f,0x62f062f,0x62f062f,0x62f062f,0x62f062f,0x62f062f,0x62f062f,0x62f062f,0x62f062f,0x62f062f,0x62f062f
.long 0x2210220,0x2230222,0x2250224,0x2270226,0x2290228,0x22b022a,0x22d022c,0x22f022e,0x3a80390,0x39303c0,0x3c303ab,0x3ae0396,0x22003c6,0x2200220,0x2200220,0x2200220
.long 0x2200220,0x2200220,0x2200220,0x2200220,0x2200220,0x2200220,0x2200220,0x2200220,0x2200220,0x2200220,0x2200220,0x2200220,0x2200220,0x2200220,0x2200220,0x2200220
.long 0x2a002a0,0x2a002a0,0x2a002a0,0x2a002a0,0x2a002a0,0x2a002a0,0x2a002a0,0x2a002a0,0x2a002a0,0x2a002a0,0x2a002a0,0x2a002a0,0x2a002a0,0x2a002a0,0x2a002a0,0x2a002a0
.long 0x2a002a0,0x2a002a0,0x2a002a0,0x2a002a0,0x2a002a0,0x2a002a0,0x2a002a0,0x2a002a0,0x2a002a0,0x2a002a0,0x2a002a0,0x2a002a0,0x2a002a0,0x2a002a0,0x2a002a0,0x2a002a0
.long 0x630062a,0x6380632,0x640063a,0x6480642,0x650064a,0x4b20658,0x4ba0494,0x4c2049c,0x4ca04a4,0x68104ac,0x4f70682,0x62a062a,0x62a062a,0x62a062a,0x62a062a,0x62a062a
.long 0x62a062a,0x62a062a,0x62a062a,0x62a062a,0x62a062a,0x62a062a,0x62a062a,0x62a062a,0x62a062a,0x62a062a,0x62a062a,0x62a062a,0x62a062a,0x62a062a,0x62a062a,0x62a062a
.long 0x2610260,0x2630262,0x2650264,0x2670266,0x2690268,0x26b026a,0x26d026c,0x26f026e,0x3a80390,0x39303c0,0x3c303ab,0x3ae0396,0x26003c6,0x2600260,0x2600260,0x2600260
.long 0x2600260,0x2600260,0x2600260,0x2600260,0x2600260,0x2600260,0x2600260,0x2600260,0x2600260,0x2600260,0x2600260,0x2600260,0x2600260,0x2600260,0x2600260,0x2600260
.long 0x2a102a1,0x2a102a1,0x2a102a1,0x2a102a1,0x2a102a1,0x2a102a1,0x2a102a1,0x2a102a1,0x2a102a1,0x2a102a1,0x2a102a1,0x2a102a1,0x2a102a1,0x2a102a1,0x2a102a1,0x2a102a1
.long 0x2a102a1,0x2a102a1,0x2a102a1,0x2a102a1,0x2a102a1,0x2a102a1,0x2a102a1,0x2a102a1,0x2a102a1,0x2a102a1,0x2a102a1,0x2a102a1,0x2a102a1,0x2a102a1,0x2a102a1,0x2a102a1
.long 0x633062b,0x643063b,0x64b0649,0x6590651,0x6690661,0x4b20671,0x4ba0494,0x4c2049c,0x4ca04a4,0x68104ac,0x4f70682,0x62b062b,0x62b062b,0x62b062b,0x62b062b,0x62b062b
.long 0x62b062b,0x62b062b,0x62b062b,0x62b062b,0x62b062b,0x62b062b,0x62b062b,0x62b062b,0x62b062b,0x62b062b,0x62b062b,0x62b062b,0x62b062b,0x62b062b,0x62b062b,0x62b062b
.long 0x2210220,0x2230222,0x2250224,0x2270226,0x2290228,0x22b022a,0x22d022c,0x22f022e,0x3b803a0,0x3a303d0,0x3d303bb,0x3be03a6,0x22003d6,0x2200220,0x2200220,0x2200220
.long 0x2200220,0x2200220,0x2200220,0x2200220,0x2200220,0x2200220,0x2200220,0x2200220,0x2200220,0x2200220,0x2200220,0x2200220,0x2200220,0x2200220,0x2200220,0x2200220
.long 0x2a202a2,0x2a202a2,0x2a202a2,0x2a202a2,0x2a202a2,0x2a202a2,0x2a202a2,0x2a202a2,0x2a202a2,0x2a202a2,0x2a202a2,0x2a202a2,0x2a202a2,0x2a202a2,0x2a202a2,0x2a202a2
.long 0x2a202a2,0x2a202a2,0x2a202a2,0x2a202a2,0x2a202a2,0x2a202a2,0x2a202a2,0x2a202a2,0x2a202a2,0x2a202a2,0x2a202a2,0x2a202a2,0x2a202a2,0x2a202a2,0x2a202a2,0x2a202a2
.long 0x630062a,0x6380632,0x640063a,0x6480642,0x650064a,0x4d00658,0x4d404d2,0x68a04d6,0x4f9068b,0x62a062a,0x62a062a,0x62a062a,0x62a062a,0x62a062a,0x62a062a,0x62a062a
.long 0x62a062a,0x62a062a,0x62a062a,0x62a062a,0x62a062a,0x62a062a,0x62a062a,0x62a062a,0x62a062a,0x62a062a,0x62a062a,0x62a062a,0x62a062a,0x62a062a,0x62a062a,0x62a062a
.long 0x2610260,0x2630262,0x2650264,0x2670266,0x2690268,0x26b026a,0x26d026c,0x26f026e,0x3b803a0,0x3a303d0,0x3d303bb,0x3be03a6,0x26003d6,0x2600260,0x2600260,0x2600260
.long 0x2600260,0x2600260,0x2600260,0x2600260,0x2600260,0x2600260,0x2600260,0x2600260,0x2600260,0x2600260,0x2600260,0x2600260,0x2600260,0x2600260,0x2600260,0x2600260
.long 0x2a302a3,0x2a302a3,0x2a302a3,0x2a302a3,0x2a302a3,0x2a302a3,0x2a302a3,0x2a302a3,0x2a302a3,0x2a302a3,0x2a302a3,0x2a302a3,0x2a302a3,0x2a302a3,0x2a302a3,0x2a302a3
.long 0x2a302a3,0x2a302a3,0x2a302a3,0x2a302a3,0x2a302a3,0x2a302a3,0x2a302a3,0x2a302a3,0x2a302a3,0x2a302a3,0x2a302a3,0x2a302a3,0x2a302a3,0x2a302a3,0x2a302a3,0x2a302a3
.long 0x633062b,0x643063b,0x64b0649,0x6590651,0x6690661,0x4d00671,0x4d404d2,0x68a04d6,0x4f9068b,0x62b062b,0x62b062b,0x62b062b,0x62b062b,0x62b062b,0x62b062b,0x62b062b
.long 0x62b062b,0x62b062b,0x62b062b,0x62b062b,0x62b062b,0x62b062b,0x62b062b,0x62b062b,0x62b062b,0x62b062b,0x62b062b,0x62b062b,0x62b062b,0x62b062b,0x62b062b,0x62b062b
.long 0x2210220,0x2230222,0x2250224,0x2270226,0x2290228,0x22b022a,0x22d022c,0x22f022e,0x3b10399,0x39c03c9,0x3cc03b4,0x3b7039f,0x22003cf,0x2200220,0x2200220,0x2200220
.long 0x2200220,0x2200220,0x2200220,0x2200220,0x2200220,0x2200220,0x2200220,0x2200220,0x2200220,0x2200220,0x2200220,0x2200220,0x2200220,0x2200220,0x2200220,0x2200220
.long 0x2a402a4,0x2a402a4,0x2a402a4,0x2a402a4,0x2a402a4,0x2a402a4,0x2a402a4,0x2a402a4,0x2a402a4,0x2a402a4,0x2a402a4,0x2a402a4,0x2a402a4,0x2a402a4,0x2a402a4,0x2a402a4
.long 0x2a402a4,0x2a402a4,0x2a402a4,0x2a402a4,0x2a402a4,0x2a402a4,0x2a402a4,0x2a402a4,0x2a402a4,0x2a402a4,0x2a402a4,0x2a402a4,0x2a402a4,0x2a402a4,0x2a402a4,0x2a402a4
.long 0x634062e,0x63c0636,0x644063e,0x64c0646,0x654064e,0x4b3065c,0x4bb0495,0x4c3049d,0x4cb04a5,0x68104ad,0x4f70682,0x62e062e,0x62e062e,0x62e062e,0x62e062e,0x62e062e
.long 0x62e062e,0x62e062e,0x62e062e,0x62e062e,0x62e062e,0x62e062e,0x62e062e,0x62e062e,0x62e062e,0x62e062e,0x62e062e,0x62e062e,0x62e062e,0x62e062e,0x62e062e,0x62e062e
.long 0x2610260,0x2630262,0x2650264,0x2670266,0x2690268,0x26b026a,0x26d026c,0x26f026e,0x3b10399,0x39c03c9,0x3cc03b4,0x3b7039f,0x26003cf,0x2600260,0x2600260,0x2600260
.long 0x2600260,0x2600260,0x2600260,0x2600260,0x2600260,0x2600260,0x2600260,0x2600260,0x2600260,0x2600260,0x2600260,0x2600260,0x2600260,0x2600260,0x2600260,0x2600260
.long 0x2a502a5,0x2a502a5,0x2a502a5,0x2a502a5,0x2a502a5,0x2a502a5,0x2a502a5,0x2a502a5,0x2a502a5,0x2a502a5,0x2a502a5,0x2a502a5,0x2a502a5,0x2a502a5,0x2a502a5,0x2a502a5
.long 0x2a502a5,0x2a502a5,0x2a502a5,0x2a502a5,0x2a502a5,0x2a502a5,0x2a502a5,0x2a502a5,0x2a502a5,0x2a502a5,0x2a502a5,0x2a502a5,0x2a502a5,0x2a502a5,0x2a502a5,0x2a502a5
.long 0x637062f,0x647063f,0x64f064d,0x65d0655,0x66d0665,0x4b30675,0x4bb0495,0x4c3049d,0x4cb04a5,0x68104ad,0x4f70682,0x62f062f,0x62f062f,0x62f062f,0x62f062f,0x62f062f
.long 0x62f062f,0x62f062f,0x62f062f,0x62f062f,0x62f062f,0x62f062f,0x62f062f,0x62f062f,0x62f062f,0x62f062f,0x62f062f,0x62f062f,0x62f062f,0x62f062f,0x62f062f,0x62f062f
.long 0x2210220,0x2230222,0x2250224,0x2270226,0x2290228,0x22b022a,0x22d022c,0x22f022e,0x3aa0392,0x39503c2,0x3c503ad,0x3fa03f1,0x22003fd,0x2200220,0x2200220,0x2200220
.long 0x2200220,0x2200220,0x2200220,0x2200220,0x2200220,0x2200220,0x2200220,0x2200220,0x2200220,0x2200220,0x2200220,0x2200220,0x2200220,0x2200220,0x2200220,0x2200220
.long 0x2a602a6,0x2a602a6,0x2a602a6,0x2a602a6,0x2a602a6,0x2a602a6,0x2a602a6,0x2a602a6,0x2a602a6,0x2a602a6,0x2a602a6,0x2a602a6,0x2a602a6,0x2a602a6,0x2a602a6,0x2a602a6
.long 0x2a602a6,0x2a602a6,0x2a602a6,0x2a602a6,0x2a602a6,0x2a602a6,0x2a602a6,0x2a602a6,0x2a602a6,0x2a602a6,0x2a602a6,0x2a602a6,0x2a602a6,0x2a602a6,0x2a602a6,0x2a602a6
.long 0x634062e,0x63c0636,0x644063e,0x64c0646,0x654064e,0x4d1065c,0x4d504d3,0x68a04d7,0x4f9068b,0x62e062e,0x62e062e,0x62e062e,0x62e062e,0x62e062e,0x62e062e,0x62e062e
.long 0x62e062e,0x62e062e,0x62e062e,0x62e062e,0x62e062e,0x62e062e,0x62e062e,0x62e062e,0x62e062e,0x62e062e,0x62e062e,0x62e062e,0x62e062e,0x62e062e,0x62e062e,0x62e062e
.long 0x2610260,0x2630262,0x2650264,0x2670266,0x2690268,0x26b026a,0x26d026c,0x26f026e,0x3aa0392,0x39503c2,0x3c503ad,0x3fa03f1,0x26003fd,0x2600260,0x2600260,0x2600260
.long 0x2600260,0x2600260,0x2600260,0x2600260,0x2600260,0x2600260,0x2600260,0x2600260,0x2600260,0x2600260,0x2600260,0x2600260,0x2600260,0x2600260,0x2600260,0x2600260
.long 0x2a702a7,0x2a702a7,0x2a702a7,0x2a702a7,0x2a702a7,0x2a702a7,0x2a702a7,0x2a702a7,0x2a702a7,0x2a702a7,0x2a702a7,0x2a702a7,0x2a702a7,0x2a702a7,0x2a702a7,0x2a702a7
.long 0x2a702a7,0x2a702a7,0x2a702a7,0x2a702a7,0x2a702a7,0x2a702a7,0x2a702a7,0x2a702a7,0x2a702a7,0x2a702a7,0x2a702a7,0x2a702a7,0x2a702a7,0x2a702a7,0x2a702a7,0x2a702a7
.long 0x637062f,0x647063f,0x64f064d,0x65d0655,0x66d0665,0x4d10675,0x4d504d3,0x68a04d7,0x4f9068b,0x62f062f,0x62f062f,0x62f062f,0x62f062f,0x62f062f,0x62f062f,0x62f062f
.long 0x62f062f,0x62f062f,0x62f062f,0x62f062f,0x62f062f,0x62f062f,0x62f062f,0x62f062f,0x62f062f,0x62f062f,0x62f062f,0x62f062f,0x62f062f,0x62f062f,0x62f062f,0x62f062f
.long 0x2310230,0x2330232,0x2350234,0x2370236,0x2390238,0x23b023a,0x23d023c,0x23f023e,0x3a80390,0x39303c0,0x3c303ab,0x3ae0396,0x23003c6,0x2300230,0x2300230,0x2300230
.long 0x2300230,0x2300230,0x2300230,0x2300230,0x2300230,0x2300230,0x2300230,0x2300230,0x2300230,0x2300230,0x2300230,0x2300230,0x2300230,0x2300230,0x2300230,0x2300230
.long 0x2a802a8,0x2a802a8,0x2a802a8,0x2a802a8,0x2a802a8,0x2a802a8,0x2a802a8,0x2a802a8,0x2a802a8,0x2a802a8,0x2a802a8,0x2a802a8,0x2a802a8,0x2a802a8,0x2a802a8,0x2a802a8
.long 0x2a802a8,0x2a802a8,0x2a802a8,0x2a802a8,0x2a802a8,0x2a802a8,0x2a802a8,0x2a802a8,0x2a802a8,0x2a802a8,0x2a802a8,0x2a802a8,0x2a802a8,0x2a802a8,0x2a802a8,0x2a802a8
.long 0x6090601,0x6520611,0x660065a,0x6680662,0x670066a,0x4900672,0x4a00498,0x67804a8,0x4f50679,0x6010601,0x6010601,0x6010601,0x6010601,0x6010601,0x6010601,0x6010601
.long 0x6010601,0x6010601,0x6010601,0x6010601,0x6010601,0x6010601,0x6010601,0x6010601,0x6010601,0x6010601,0x6010601,0x6010601,0x6010601,0x6010601,0x6010601,0x6010601
.long 0x2710270,0x2730272,0x2750274,0x2770276,0x2790278,0x27b027a,0x27d027c,0x27f027e,0x3a80390,0x39303c0,0x3c303ab,0x3ae0396,0x27003c6,0x2700270,0x2700270,0x2700270
.long 0x2700270,0x2700270,0x2700270,0x2700270,0x2700270,0x2700270,0x2700270,0x2700270,0x2700270,0x2700270,0x2700270,0x2700270,0x2700270,0x2700270,0x2700270,0x2700270
.long 0x2a902a9,0x2a902a9,0x2a902a9,0x2a902a9,0x2a902a9,0x2a902a9,0x2a902a9,0x2a902a9,0x2a902a9,0x2a902a9,0x2a902a9,0x2a902a9,0x2a902a9,0x2a902a9,0x2a902a9,0x2a902a9
.long 0x2a902a9,0x2a902a9,0x2a902a9,0x2a902a9,0x2a902a9,0x2a902a9,0x2a902a9,0x2a902a9,0x2a902a9,0x2a902a9,0x2a902a9,0x2a902a9,0x2a902a9,0x2a902a9,0x2a902a9,0x2a902a9
.long 0x633062b,0x643063b,0x64b0649,0x6530651,0x65b0659,0x6630661,0x66b0669,0x6730671,0x490067b,0x4a00498,0x67804a8,0x4f50679,0x62b062b,0x62b062b,0x62b062b,0x62b062b
.long 0x62b062b,0x62b062b,0x62b062b,0x62b062b,0x62b062b,0x62b062b,0x62b062b,0x62b062b,0x62b062b,0x62b062b,0x62b062b,0x62b062b,0x62b062b,0x62b062b,0x62b062b,0x62b062b
.long 0x2310230,0x2330232,0x2350234,0x2370236,0x2390238,0x23b023a,0x23d023c,0x23f023e,0x3b803a0,0x3a303d0,0x3d303bb,0x3be03a6,0x23003d6,0x2300230,0x2300230,0x2300230
.long 0x2300230,0x2300230,0x2300230,0x2300230,0x2300230,0x2300230,0x2300230,0x2300230,0x2300230,0x2300230,0x2300230,0x2300230,0x2300230,0x2300230,0x2300230,0x2300230
.long 0x2aa02aa,0x2aa02aa,0x2aa02aa,0x2aa02aa,0x2aa02aa,0x2aa02aa,0x2aa02aa,0x2aa02aa,0x2aa02aa,0x2aa02aa,0x2aa02aa,0x2aa02aa,0x2aa02aa,0x2aa02aa,0x2aa02aa,0x2aa02aa
.long 0x2aa02aa,0x2aa02aa,0x2aa02aa,0x2aa02aa,0x2aa02aa,0x2aa02aa,0x2aa02aa,0x2aa02aa,0x2aa02aa,0x2aa02aa,0x2aa02aa,0x2aa02aa,0x2aa02aa,0x2aa02aa,0x2aa02aa,0x2aa02aa
.long 0x6090601,0x6520611,0x660065a,0x6680662,0x670066a,0x4940672,0x49c04b4,0x4a404bc,0x4ac04c4,0x68304cc,0x4f00684,0x6010601,0x6010601,0x6010601,0x6010601,0x6010601
.long 0x6010601,0x6010601,0x6010601,0x6010601,0x6010601,0x6010601,0x6010601,0x6010601,0x6010601,0x6010601,0x6010601,0x6010601,0x6010601,0x6010601,0x6010601,0x6010601
.long 0x2710270,0x2730272,0x2750274,0x2770276,0x2790278,0x27b027a,0x27d027c,0x27f027e,0x3b803a0,0x3a303d0,0x3d303bb,0x3be03a6,0x27003d6,0x2700270,0x2700270,0x2700270
.long 0x2700270,0x2700270,0x2700270,0x2700270,0x2700270,0x2700270,0x2700270,0x2700270,0x2700270,0x2700270,0x2700270,0x2700270,0x2700270,0x2700270,0x2700270,0x2700270
.long 0x2ab02ab,0x2ab02ab,0x2ab02ab,0x2ab02ab,0x2ab02ab,0x2ab02ab,0x2ab02ab,0x2ab02ab,0x2ab02ab,0x2ab02ab,0x2ab02ab,0x2ab02ab,0x2ab02ab,0x2ab02ab,0x2ab02ab,0x2ab02ab
.long 0x2ab02ab,0x2ab02ab,0x2ab02ab,0x2ab02ab,0x2ab02ab,0x2ab02ab,0x2ab02ab,0x2ab02ab,0x2ab02ab,0x2ab02ab,0x2ab02ab,0x2ab02ab,0x2ab02ab,0x2ab02ab,0x2ab02ab,0x2ab02ab
.long 0x633062b,0x643063b,0x64b0649,0x6530651,0x65b0659,0x6630661,0x66b0669,0x6730671,0x494067b,0x49c04b4,0x4a404bc,0x4ac04c4,0x68304cc,0x4f00684,0x62b062b,0x62b062b
.long 0x62b062b,0x62b062b,0x62b062b,0x62b062b,0x62b062b,0x62b062b,0x62b062b,0x62b062b,0x62b062b,0x62b062b,0x62b062b,0x62b062b,0x62b062b,0x62b062b,0x62b062b,0x62b062b
.long 0x2310230,0x2330232,0x2350234,0x2370236,0x2390238,0x23b023a,0x23d023c,0x23f023e,0x3b10399,0x39c03c9,0x3cc03b4,0x3b7039f,0x23003cf,0x2300230,0x2300230,0x2300230
.long 0x2300230,0x2300230,0x2300230,0x2300230,0x2300230,0x2300230,0x2300230,0x2300230,0x2300230,0x2300230,0x2300230,0x2300230,0x2300230,0x2300230,0x2300230,0x2300230
.long 0x2ac02ac,0x2ac02ac,0x2ac02ac,0x2ac02ac,0x2ac02ac,0x2ac02ac,0x2ac02ac,0x2ac02ac,0x2ac02ac,0x2ac02ac,0x2ac02ac,0x2ac02ac,0x2ac02ac,0x2ac02ac,0x2ac02ac,0x2ac02ac
.long 0x2ac02ac,0x2ac02ac,0x2ac02ac,0x2ac02ac,0x2ac02ac,0x2ac02ac,0x2ac02ac,0x2ac02ac,0x2ac02ac,0x2ac02ac,0x2ac02ac,0x2ac02ac,0x2ac02ac,0x2ac02ac,0x2ac02ac,0x2ac02ac
.long 0x60d0605,0x6560615,0x664065e,0x66c0666,0x674066e,0x4910676,0x4a10499,0x67804a9,0x4f50679,0x6050605,0x6050605,0x6050605,0x6050605,0x6050605,0x6050605,0x6050605
.long 0x6050605,0x6050605,0x6050605,0x6050605,0x6050605,0x6050605,0x6050605,0x6050605,0x6050605,0x6050605,0x6050605,0x6050605,0x6050605,0x6050605,0x6050605,0x6050605
.long 0x2710270,0x2730272,0x2750274,0x2770276,0x2790278,0x27b027a,0x27d027c,0x27f027e,0x3b10399,0x39c03c9,0x3cc03b4,0x3b7039f,0x27003cf,0x2700270,0x2700270,0x2700270
.long 0x2700270,0x2700270,0x2700270,0x2700270,0x2700270,0x2700270,0x2700270,0x2700270,0x2700270,0x2700270,0x2700270,0x2700270,0x2700270,0x2700270,0x2700270,0x2700270
.long 0x2ad02ad,0x2ad02ad,0x2ad02ad,0x2ad02ad,0x2ad02ad,0x2ad02ad,0x2ad02ad,0x2ad02ad,0x2ad02ad,0x2ad02ad,0x2ad02ad,0x2ad02ad,0x2ad02ad,0x2ad02ad,0x2ad02ad,0x2ad02ad
.long 0x2ad02ad,0x2ad02ad,0x2ad02ad,0x2ad02ad,0x2ad02ad,0x2ad02ad,0x2ad02ad,0x2ad02ad,0x2ad02ad,0x2ad02ad,0x2ad02ad,0x2ad02ad,0x2ad02ad,0x2ad02ad,0x2ad02ad,0x2ad02ad
.long 0x637062f,0x647063f,0x64f064d,0x6570655,0x65f065d,0x6670665,0x66f066d,0x6770675,0x491067f,0x4a10499,0x67804a9,0x4f50679,0x62f062f,0x62f062f,0x62f062f,0x62f062f
.long 0x62f062f,0x62f062f,0x62f062f,0x62f062f,0x62f062f,0x62f062f,0x62f062f,0x62f062f,0x62f062f,0x62f062f,0x62f062f,0x62f062f,0x62f062f,0x62f062f,0x62f062f,0x62f062f
.long 0x2310230,0x2330232,0x2350234,0x2370236,0x2390238,0x23b023a,0x23d023c,0x23f023e,0x3aa0392,0x39503c2,0x3c503ad,0x3fa03f1,0x23003fd,0x2300230,0x2300230,0x2300230
.long 0x2300230,0x2300230,0x2300230,0x2300230,0x2300230,0x2300230,0x2300230,0x2300230,0x2300230,0x2300230,0x2300230,0x2300230,0x2300230,0x2300230,0x2300230,0x2300230
.long 0x2ae02ae,0x2ae02ae,0x2ae02ae,0x2ae02ae,0x2ae02ae,0x2ae02ae,0x2ae02ae,0x2ae02ae,0x2ae02ae,0x2ae02ae,0x2ae02ae,0x2ae02ae,0x2ae02ae,0x2ae02ae,0x2ae02ae,0x2ae02ae
.long 0x2ae02ae,0x2ae02ae,0x2ae02ae,0x2ae02ae,0x2ae02ae,0x2ae02ae,0x2ae02ae,0x2ae02ae,0x2ae02ae,0x2ae02ae,0x2ae02ae,0x2ae02ae,0x2ae02ae,0x2ae02ae,0x2ae02ae,0x2ae02ae
.long 0x60d0605,0x6560615,0x664065e,0x66c0666,0x674066e,0x4950676,0x49d04b5,0x4a504bd,0x4ad04c5,0x68304cd,0x4f00684,0x6050605,0x6050605,0x6050605,0x6050605,0x6050605
.long 0x6050605,0x6050605,0x6050605,0x6050605,0x6050605,0x6050605,0x6050605,0x6050605,0x6050605,0x6050605,0x6050605,0x6050605,0x6050605,0x6050605,0x6050605,0x6050605
.long 0x2710270,0x2730272,0x2750274,0x2770276,0x2790278,0x27b027a,0x27d027c,0x27f027e,0x3aa0392,0x39503c2,0x3c503ad,0x3fa03f1,0x27003fd,0x2700270,0x2700270,0x2700270
.long 0x2700270,0x2700270,0x2700270,0x2700270,0x2700270,0x2700270,0x2700270,0x2700270,0x2700270,0x2700270,0x2700270,0x2700270,0x2700270,0x2700270,0x2700270,0x2700270
.long 0x2af02af,0x2af02af,0x2af02af,0x2af02af,0x2af02af,0x2af02af,0x2af02af,0x2af02af,0x2af02af,0x2af02af,0x2af02af,0x2af02af,0x2af02af,0x2af02af,0x2af02af,0x2af02af
.long 0x2af02af,0x2af02af,0x2af02af,0x2af02af,0x2af02af,0x2af02af,0x2af02af,0x2af02af,0x2af02af,0x2af02af,0x2af02af,0x2af02af,0x2af02af,0x2af02af,0x2af02af,0x2af02af
.long 0x637062f,0x647063f,0x64f064d,0x6570655,0x65f065d,0x6670665,0x66f066d,0x6770675,0x495067f,0x49d04b5,0x4a504bd,0x4ad04c5,0x68304cd,0x4f00684,0x62f062f,0x62f062f
.long 0x62f062f,0x62f062f,0x62f062f,0x62f062f,0x62f062f,0x62f062f,0x62f062f,0x62f062f,0x62f062f,0x62f062f,0x62f062f,0x62f062f,0x62f062f,0x62f062f,0x62f062f,0x62f062f
.long 0x2010200,0x2030202,0x2050204,0x2070206,0x2090208,0x20b020a,0x20d020c,0x20f020e,0x3b00398,0x39b03c8,0x3cb03b3,0x3b6039e,0x20003ce,0x2000200,0x2000200,0x2000200
.long 0x2000200,0x2000200,0x2000200,0x2000200,0x2000200,0x2000200,0x2000200,0x2000200,0x2000200,0x2000200,0x2000200,0x2000200,0x2000200,0x2000200,0x2000200,0x2000200
.long 0x2b002b0,0x2b002b0,0x2b002b0,0x2b002b0,0x2b002b0,0x2b002b0,0x2b002b0,0x2b002b0,0x2b002b0,0x2b002b0,0x2b002b0,0x2b002b0,0x2b002b0,0x2b002b0,0x2b002b0,0x2b002b0
.long 0x2b002b0,0x2b002b0,0x2b002b0,0x2b002b0,0x2b002b0,0x2b002b0,0x2b002b0,0x2b002b0,0x2b002b0,0x2b002b0,0x2b002b0,0x2b002b0,0x2b002b0,0x2b002b0,0x2b002b0,0x2b002b0
.long 0x6090601,0x6520611,0x660065a,0x6680662,0x670066a,0x4900672,0x49804b0,0x4a004b8,0x4a804c0,0x67904c8,0x4f5067a,0x6010601,0x6010601,0x6010601,0x6010601,0x6010601
.long 0x6010601,0x6010601,0x6010601,0x6010601,0x6010601,0x6010601,0x6010601,0x6010601,0x6010601,0x6010601,0x6010601,0x6010601,0x6010601,0x6010601,0x6010601,0x6010601
.long 0x2410240,0x2430242,0x2450244,0x2470246,0x2490248,0x24b024a,0x24d024c,0x24f024e,0x3b00398,0x39b03c8,0x3cb03b3,0x3b6039e,0x24003ce,0x2400240,0x2400240,0x2400240
.long 0x2400240,0x2400240,0x2400240,0x2400240,0x2400240,0x2400240,0x2400240,0x2400240,0x2400240,0x2400240,0x2400240,0x2400240,0x2400240,0x2400240,0x2400240,0x2400240
.long 0x2b102b1,0x2b102b1,0x2b102b1,0x2b102b1,0x2b102b1,0x2b102b1,0x2b102b1,0x2b102b1,0x2b102b1,0x2b102b1,0x2b102b1,0x2b102b1,0x2b102b1,0x2b102b1,0x2b102b1,0x2b102b1
.long 0x2b102b1,0x2b102b1,0x2b102b1,0x2b102b1,0x2b102b1,0x2b102b1,0x2b102b1,0x2b102b1,0x2b102b1,0x2b102b1,0x2b102b1,0x2b102b1,0x2b102b1,0x2b102b1,0x2b102b1,0x2b102b1
.long 0x633062b,0x643063b,0x64b0649,0x6530651,0x65b0659,0x6630661,0x66b0669,0x6730671,0x490067b,0x49804b0,0x4a004b8,0x4a804c0,0x67904c8,0x4f5067a,0x62b062b,0x62b062b
.long 0x62b062b,0x62b062b,0x62b062b,0x62b062b,0x62b062b,0x62b062b,0x62b062b,0x62b062b,0x62b062b,0x62b062b,0x62b062b,0x62b062b,0x62b062b,0x62b062b,0x62b062b,0x62b062b
.long 0x2010200,0x2030202,0x2050204,0x2070206,0x2090208,0x20b020a,0x20d020c,0x20f020e,0x3a90391,0x39403c1,0x3c403ac,0x3af0397,0x20003c7,0x2000200,0x2000200,0x2000200
.long 0x2000200,0x2000200,0x2000200,0x2000200,0x2000200,0x2000200,0x2000200,0x2000200,0x2000200,0x2000200,0x2000200,0x2000200,0x2000200,0x2000200,0x2000200,0x2000200
.long 0x2b202b2,0x2b202b2,0x2b202b2,0x2b202b2,0x2b202b2,0x2b202b2,0x2b202b2,0x2b202b2,0x2b202b2,0x2b202b2,0x2b202b2,0x2b202b2,0x2b202b2,0x2b202b2,0x2b202b2,0x2b202b2
.long 0x2b202b2,0x2b202b2,0x2b202b2,0x2b202b2,0x2b202b2,0x2b202b2,0x2b202b2,0x2b202b2,0x2b202b2,0x2b202b2,0x2b202b2,0x2b202b2,0x2b202b2,0x2b202b2,0x2b202b2,0x2b202b2
.long 0x6090601,0x6520611,0x660065a,0x6680662,0x670066a,0x4b40672,0x4c404bc,0x68404cc,0x4f00685,0x6010601,0x6010601,0x6010601,0x6010601,0x6010601,0x6010601,0x6010601
.long 0x6010601,0x6010601,0x6010601,0x6010601,0x6010601,0x6010601,0x6010601,0x6010601,0x6010601,0x6010601,0x6010601,0x6010601,0x6010601,0x6010601,0x6010601,0x6010601
.long 0x2410240,0x2430242,0x2450244,0x2470246,0x2490248,0x24b024a,0x24d024c,0x24f024e,0x3a90391,0x39403c1,0x3c403ac,0x3af0397,0x24003c7,0x2400240,0x2400240,0x2400240
.long 0x2400240,0x2400240,0x2400240,0x2400240,0x2400240,0x2400240,0x2400240,0x2400240,0x2400240,0x2400240,0x2400240,0x2400240,0x2400240,0x2400240,0x2400240,0x2400240
.long 0x2b302b3,0x2b302b3,0x2b302b3,0x2b302b3,0x2b302b3,0x2b302b3,0x2b302b3,0x2b302b3,0x2b302b3,0x2b302b3,0x2b302b3,0x2b302b3,0x2b302b3,0x2b302b3,0x2b302b3,0x2b302b3
.long 0x2b302b3,0x2b302b3,0x2b302b3,0x2b302b3,0x2b302b3,0x2b302b3,0x2b302b3,0x2b302b3,0x2b302b3,0x2b302b3,0x2b302b3,0x2b302b3,0x2b302b3,0x2b302b3,0x2b302b3,0x2b302b3
.long 0x633062b,0x643063b,0x64b0649,0x6530651,0x65b0659,0x6630661,0x66b0669,0x6730671,0x4b4067b,0x4c404bc,0x68404cc,0x4f00685,0x62b062b,0x62b062b,0x62b062b,0x62b062b
.long 0x62b062b,0x62b062b,0x62b062b,0x62b062b,0x62b062b,0x62b062b,0x62b062b,0x62b062b,0x62b062b,0x62b062b,0x62b062b,0x62b062b,0x62b062b,0x62b062b,0x62b062b,0x62b062b
.long 0x2010200,0x2030202,0x2050204,0x2070206,0x2090208,0x20b020a,0x20d020c,0x20f020e,0x3b903a1,0x3a403d1,0x3d403bc,0x3bf03a7,0x20003d7,0x2000200,0x2000200,0x2000200
.long 0x2000200,0x2000200,0x2000200,0x2000200,0x2000200,0x2000200,0x2000200,0x2000200,0x2000200,0x2000200,0x2000200,0x2000200,0x2000200,0x2000200,0x2000200,0x2000200
.long 0x2b402b4,0x2b402b4,0x2b402b4,0x2b402b4,0x2b402b4,0x2b402b4,0x2b402b4,0x2b402b4,0x2b402b4,0x2b402b4,0x2b402b4,0x2b402b4,0x2b402b4,0x2b402b4,0x2b402b4,0x2b402b4
.long 0x2b402b4,0x2b402b4,0x2b402b4,0x2b402b4,0x2b402b4,0x2b402b4,0x2b402b4,0x2b402b4,0x2b402b4,0x2b402b4,0x2b402b4,0x2b402b4,0x2b402b4,0x2b402b4,0x2b402b4,0x2b402b4
.long 0x60d0605,0x6560615,0x664065e,0x66c0666,0x674066e,0x4910676,0x49904b1,0x4a104b9,0x4a904c1,0x67904c9,0x4f5067a,0x6050605,0x6050605,0x6050605,0x6050605,0x6050605
.long 0x6050605,0x6050605,0x6050605,0x6050605,0x6050605,0x6050605,0x6050605,0x6050605,0x6050605,0x6050605,0x6050605,0x6050605,0x6050605,0x6050605,0x6050605,0x6050605
.long 0x2410240,0x2430242,0x2450244,0x2470246,0x2490248,0x24b024a,0x24d024c,0x24f024e,0x3b903a1,0x3a403d1,0x3d403bc,0x3bf03a7,0x24003d7,0x2400240,0x2400240,0x2400240
.long 0x2400240,0x2400240,0x2400240,0x2400240,0x2400240,0x2400240,0x2400240,0x2400240,0x2400240,0x2400240,0x2400240,0x2400240,0x2400240,0x2400240,0x2400240,0x2400240
.long 0x2b502b5,0x2b502b5,0x2b502b5,0x2b502b5,0x2b502b5,0x2b502b5,0x2b502b5,0x2b502b5,0x2b502b5,0x2b502b5,0x2b502b5,0x2b502b5,0x2b502b5,0x2b502b5,0x2b502b5,0x2b502b5
.long 0x2b502b5,0x2b502b5,0x2b502b5,0x2b502b5,0x2b502b5,0x2b502b5,0x2b502b5,0x2b502b5,0x2b502b5,0x2b502b5,0x2b502b5,0x2b502b5,0x2b502b5,0x2b502b5,0x2b502b5,0x2b502b5
.long 0x637062f,0x647063f,0x64f064d,0x6570655,0x65f065d,0x6670665,0x66f066d,0x6770675,0x491067f,0x49904b1,0x4a104b9,0x4a904c1,0x67904c9,0x4f5067a,0x62f062f,0x62f062f
.long 0x62f062f,0x62f062f,0x62f062f,0x62f062f,0x62f062f,0x62f062f,0x62f062f,0x62f062f,0x62f062f,0x62f062f,0x62f062f,0x62f062f,0x62f062f,0x62f062f,0x62f062f,0x62f062f
.long 0x2010200,0x2030202,0x2050204,0x2070206,0x2090208,0x20b020a,0x20d020c,0x20f020e,0x3b2039a,0x39d03ca,0x3cd03b5,0x3fb03f8,0x20003fe,0x2000200,0x2000200,0x2000200
.long 0x2000200,0x2000200,0x2000200,0x2000200,0x2000200,0x2000200,0x2000200,0x2000200,0x2000200,0x2000200,0x2000200,0x2000200,0x2000200,0x2000200,0x2000200,0x2000200
.long 0x2b602b6,0x2b602b6,0x2b602b6,0x2b602b6,0x2b602b6,0x2b602b6,0x2b602b6,0x2b602b6,0x2b602b6,0x2b602b6,0x2b602b6,0x2b602b6,0x2b602b6,0x2b602b6,0x2b602b6,0x2b602b6
.long 0x2b602b6,0x2b602b6,0x2b602b6,0x2b602b6,0x2b602b6,0x2b602b6,0x2b602b6,0x2b602b6,0x2b602b6,0x2b602b6,0x2b602b6,0x2b602b6,0x2b602b6,0x2b602b6,0x2b602b6,0x2b602b6
.long 0x60d0605,0x6560615,0x664065e,0x66c0666,0x674066e,0x4b50676,0x4c504bd,0x68404cd,0x4f00685,0x6050605,0x6050605,0x6050605,0x6050605,0x6050605,0x6050605,0x6050605
.long 0x6050605,0x6050605,0x6050605,0x6050605,0x6050605,0x6050605,0x6050605,0x6050605,0x6050605,0x6050605,0x6050605,0x6050605,0x6050605,0x6050605,0x6050605,0x6050605
.long 0x2410240,0x2430242,0x2450244,0x2470246,0x2490248,0x24b024a,0x24d024c,0x24f024e,0x3b2039a,0x39d03ca,0x3cd03b5,0x3fb03f8,0x24003fe,0x2400240,0x2400240,0x2400240
.long 0x2400240,0x2400240,0x2400240,0x2400240,0x2400240,0x2400240,0x2400240,0x2400240,0x2400240,0x2400240,0x2400240,0x2400240,0x2400240,0x2400240,0x2400240,0x2400240
.long 0x2b702b7,0x2b702b7,0x2b702b7,0x2b702b7,0x2b702b7,0x2b702b7,0x2b702b7,0x2b702b7,0x2b702b7,0x2b702b7,0x2b702b7,0x2b702b7,0x2b702b7,0x2b702b7,0x2b702b7,0x2b702b7
.long 0x2b702b7,0x2b702b7,0x2b702b7,0x2b702b7,0x2b702b7,0x2b702b7,0x2b702b7,0x2b702b7,0x2b702b7,0x2b702b7,0x2b702b7,0x2b702b7,0x2b702b7,0x2b702b7,0x2b702b7,0x2b702b7
.long 0x637062f,0x647063f,0x64f064d,0x6570655,0x65f065d,0x6670665,0x66f066d,0x6770675,0x4b5067f,0x4c504bd,0x68404cd,0x4f00685,0x62f062f,0x62f062f,0x62f062f,0x62f062f
.long 0x62f062f,0x62f062f,0x62f062f,0x62f062f,0x62f062f,0x62f062f,0x62f062f,0x62f062f,0x62f062f,0x62f062f,0x62f062f,0x62f062f,0x62f062f,0x62f062f,0x62f062f,0x62f062f
.long 0x2110210,0x2130212,0x2150214,0x2170216,0x2190218,0x21b021a,0x21d021c,0x21f021e,0x3b00398,0x39b03c8,0x3cb03b3,0x3b6039e,0x21003ce,0x2100210,0x2100210,0x2100210
.long 0x2100210,0x2100210,0x2100210,0x2100210,0x2100210,0x2100210,0x2100210,0x2100210,0x2100210,0x2100210,0x2100210,0x2100210,0x2100210,0x2100210,0x2100210,0x2100210
.long 0x2b802b8,0x2b802b8,0x2b802b8,0x2b802b8,0x2b802b8,0x2b802b8,0x2b802b8,0x2b802b8,0x2b802b8,0x2b802b8,0x2b802b8,0x2b802b8,0x2b802b8,0x2b802b8,0x2b802b8,0x2b802b8
.long 0x2b802b8,0x2b802b8,0x2b802b8,0x2b802b8,0x2b802b8,0x2b802b8,0x2b802b8,0x2b802b8,0x2b802b8,0x2b802b8,0x2b802b8,0x2b802b8,0x2b802b8,0x2b802b8,0x2b802b8,0x2b802b8
.long 0x6090601,0x6520611,0x660065a,0x6680662,0x670066a,0x4b00672,0x4b80492,0x4c0049a,0x4c804a2,0x67c04aa,0x4f6067d,0x6010601,0x6010601,0x6010601,0x6010601,0x6010601
.long 0x6010601,0x6010601,0x6010601,0x6010601,0x6010601,0x6010601,0x6010601,0x6010601,0x6010601,0x6010601,0x6010601,0x6010601,0x6010601,0x6010601,0x6010601,0x6010601
.long 0x2510250,0x2530252,0x2550254,0x2570256,0x2590258,0x25b025a,0x25d025c,0x25f025e,0x3b00398,0x39b03c8,0x3cb03b3,0x3b6039e,0x25003ce,0x2500250,0x2500250,0x2500250
.long 0x2500250,0x2500250,0x2500250,0x2500250,0x2500250,0x2500250,0x2500250,0x2500250,0x2500250,0x2500250,0x2500250,0x2500250,0x2500250,0x2500250,0x2500250,0x2500250
.long 0x2b902b9,0x2b902b9,0x2b902b9,0x2b902b9,0x2b902b9,0x2b902b9,0x2b902b9,0x2b902b9,0x2b902b9,0x2b902b9,0x2b902b9,0x2b902b9,0x2b902b9,0x2b902b9,0x2b902b9,0x2b902b9
.long 0x2b902b9,0x2b902b9,0x2b902b9,0x2b902b9,0x2b902b9,0x2b902b9,0x2b902b9,0x2b902b9,0x2b902b9,0x2b902b9,0x2b902b9,0x2b902b9,0x2b902b9,0x2b902b9,0x2b902b9,0x2b902b9
.long 0x633062b,0x643063b,0x64b0649,0x6530651,0x65b0659,0x6630661,0x66b0669,0x6730671,0x4b0067b,0x4b80492,0x4c0049a,0x4c804a2,0x67c04aa,0x4f6067d,0x62b062b,0x62b062b
.long 0x62b062b,0x62b062b,0x62b062b,0x62b062b,0x62b062b,0x62b062b,0x62b062b,0x62b062b,0x62b062b,0x62b062b,0x62b062b,0x62b062b,0x62b062b,0x62b062b,0x62b062b,0x62b062b
.long 0x2110210,0x2130212,0x2150214,0x2170216,0x2190218,0x21b021a,0x21d021c,0x21f021e,0x3a90391,0x39403c1,0x3c403ac,0x3af0397,0x21003c7,0x2100210,0x2100210,0x2100210
.long 0x2100210,0x2100210,0x2100210,0x2100210,0x2100210,0x2100210,0x2100210,0x2100210,0x2100210,0x2100210,0x2100210,0x2100210,0x2100210,0x2100210,0x2100210,0x2100210
.long 0x2ba02ba,0x2ba02ba,0x2ba02ba,0x2ba02ba,0x2ba02ba,0x2ba02ba,0x2ba02ba,0x2ba02ba,0x2ba02ba,0x2ba02ba,0x2ba02ba,0x2ba02ba,0x2ba02ba,0x2ba02ba,0x2ba02ba,0x2ba02ba
.long 0x2ba02ba,0x2ba02ba,0x2ba02ba,0x2ba02ba,0x2ba02ba,0x2ba02ba,0x2ba02ba,0x2ba02ba,0x2ba02ba,0x2ba02ba,0x2ba02ba,0x2ba02ba,0x2ba02ba,0x2ba02ba,0x2ba02ba,0x2ba02ba
.long 0x6090601,0x6520611,0x660065a,0x6680662,0x670066a,0x4960672,0x4a6049e,0x68604ae,0x4f10687,0x6010601,0x6010601,0x6010601,0x6010601,0x6010601,0x6010601,0x6010601
.long 0x6010601,0x6010601,0x6010601,0x6010601,0x6010601,0x6010601,0x6010601,0x6010601,0x6010601,0x6010601,0x6010601,0x6010601,0x6010601,0x6010601,0x6010601,0x6010601
.long 0x2510250,0x2530252,0x2550254,0x2570256,0x2590258,0x25b025a,0x25d025c,0x25f025e,0x3a90391,0x39403c1,0x3c403ac,0x3af0397,0x25003c7,0x2500250,0x2500250,0x2500250
.long 0x2500250,0x2500250,0x2500250,0x2500250,0x2500250,0x2500250,0x2500250,0x2500250,0x2500250,0x2500250,0x2500250,0x2500250,0x2500250,0x2500250,0x2500250,0x2500250
.long 0x2bb02bb,0x2bb02bb,0x2bb02bb,0x2bb02bb,0x2bb02bb,0x2bb02bb,0x2bb02bb,0x2bb02bb,0x2bb02bb,0x2bb02bb,0x2bb02bb,0x2bb02bb,0x2bb02bb,0x2bb02bb,0x2bb02bb,0x2bb02bb
.long 0x2bb02bb,0x2bb02bb,0x2bb02bb,0x2bb02bb,0x2bb02bb,0x2bb02bb,0x2bb02bb,0x2bb02bb,0x2bb02bb,0x2bb02bb,0x2bb02bb,0x2bb02bb,0x2bb02bb,0x2bb02bb,0x2bb02bb,0x2bb02bb
.long 0x633062b,0x643063b,0x64b0649,0x6530651,0x65b0659,0x6630661,0x66b0669,0x6730671,0x496067b,0x4a6049e,0x68604ae,0x4f10687,0x62b062b,0x62b062b,0x62b062b,0x62b062b
.long 0x62b062b,0x62b062b,0x62b062b,0x62b062b,0x62b062b,0x62b062b,0x62b062b,0x62b062b,0x62b062b,0x62b062b,0x62b062b,0x62b062b,0x62b062b,0x62b062b,0x62b062b,0x62b062b
.long 0x2110210,0x2130212,0x2150214,0x2170216,0x2190218,0x21b021a,0x21d021c,0x21f021e,0x3b903a1,0x3a403d1,0x3d403bc,0x3bf03a7,0x21003d7,0x2100210,0x2100210,0x2100210
.long 0x2100210,0x2100210,0x2100210,0x2100210,0x2100210,0x2100210,0x2100210,0x2100210,0x2100210,0x2100210,0x2100210,0x2100210,0x2100210,0x2100210,0x2100210,0x2100210
.long 0x2bc02bc,0x2bc02bc,0x2bc02bc,0x2bc02bc,0x2bc02bc,0x2bc02bc,0x2bc02bc,0x2bc02bc,0x2bc02bc,0x2bc02bc,0x2bc02bc,0x2bc02bc,0x2bc02bc,0x2bc02bc,0x2bc02bc,0x2bc02bc
.long 0x2bc02bc,0x2bc02bc,0x2bc02bc,0x2bc02bc,0x2bc02bc,0x2bc02bc,0x2bc02bc,0x2bc02bc,0x2bc02bc,0x2bc02bc,0x2bc02bc,0x2bc02bc,0x2bc02bc,0x2bc02bc,0x2bc02bc,0x2bc02bc
.long 0x60d0605,0x6560615,0x664065e,0x66c0666,0x674066e,0x4b10676,0x4b90493,0x4c1049b,0x4c904a3,0x67c04ab,0x4f6067d,0x6050605,0x6050605,0x6050605,0x6050605,0x6050605
.long 0x6050605,0x6050605,0x6050605,0x6050605,0x6050605,0x6050605,0x6050605,0x6050605,0x6050605,0x6050605,0x6050605,0x6050605,0x6050605,0x6050605,0x6050605,0x6050605
.long 0x2510250,0x2530252,0x2550254,0x2570256,0x2590258,0x25b025a,0x25d025c,0x25f025e,0x3b903a1,0x3a403d1,0x3d403bc,0x3bf03a7,0x25003d7,0x2500250,0x2500250,0x2500250
.long 0x2500250,0x2500250,0x2500250,0x2500250,0x2500250,0x2500250,0x2500250,0x2500250,0x2500250,0x2500250,0x2500250,0x2500250,0x2500250,0x2500250,0x2500250,0x2500250
.long 0x2bd02bd,0x2bd02bd,0x2bd02bd,0x2bd02bd,0x2bd02bd,0x2bd02bd,0x2bd02bd,0x2bd02bd,0x2bd02bd,0x2bd02bd,0x2bd02bd,0x2bd02bd,0x2bd02bd,0x2bd02bd,0x2bd02bd,0x2bd02bd
.long 0x2bd02bd,0x2bd02bd,0x2bd02bd,0x2bd02bd,0x2bd02bd,0x2bd02bd,0x2bd02bd,0x2bd02bd,0x2bd02bd,0x2bd02bd,0x2bd02bd,0x2bd02bd,0x2bd02bd,0x2bd02bd,0x2bd02bd,0x2bd02bd
.long 0x637062f,0x647063f,0x64f064d,0x6570655,0x65f065d,0x6670665,0x66f066d,0x6770675,0x4b1067f,0x4b90493,0x4c1049b,0x4c904a3,0x67c04ab,0x4f6067d,0x62f062f,0x62f062f
.long 0x62f062f,0x62f062f,0x62f062f,0x62f062f,0x62f062f,0x62f062f,0x62f062f,0x62f062f,0x62f062f,0x62f062f,0x62f062f,0x62f062f,0x62f062f,0x62f062f,0x62f062f,0x62f062f
.long 0x2110210,0x2130212,0x2150214,0x2170216,0x2190218,0x21b021a,0x21d021c,0x21f021e,0x3b2039a,0x39d03ca,0x3cd03b5,0x3fb03f8,0x21003fe,0x2100210,0x2100210,0x2100210
.long 0x2100210,0x2100210,0x2100210,0x2100210,0x2100210,0x2100210,0x2100210,0x2100210,0x2100210,0x2100210,0x2100210,0x2100210,0x2100210,0x2100210,0x2100210,0x2100210
.long 0x2be02be,0x2be02be,0x2be02be,0x2be02be,0x2be02be,0x2be02be,0x2be02be,0x2be02be,0x2be02be,0x2be02be,0x2be02be,0x2be02be,0x2be02be,0x2be02be,0x2be02be,0x2be02be
.long 0x2be02be,0x2be02be,0x2be02be,0x2be02be,0x2be02be,0x2be02be,0x2be02be,0x2be02be,0x2be02be,0x2be02be,0x2be02be,0x2be02be,0x2be02be,0x2be02be,0x2be02be,0x2be02be
.long 0x60d0605,0x6560615,0x664065e,0x66c0666,0x674066e,0x4970676,0x4a7049f,0x68604af,0x4f10687,0x6050605,0x6050605,0x6050605,0x6050605,0x6050605,0x6050605,0x6050605
.long 0x6050605,0x6050605,0x6050605,0x6050605,0x6050605,0x6050605,0x6050605,0x6050605,0x6050605,0x6050605,0x6050605,0x6050605,0x6050605,0x6050605,0x6050605,0x6050605
.long 0x2510250,0x2530252,0x2550254,0x2570256,0x2590258,0x25b025a,0x25d025c,0x25f025e,0x3b2039a,0x39d03ca,0x3cd03b5,0x3fb03f8,0x25003fe,0x2500250,0x2500250,0x2500250
.long 0x2500250,0x2500250,0x2500250,0x2500250,0x2500250,0x2500250,0x2500250,0x2500250,0x2500250,0x2500250,0x2500250,0x2500250,0x2500250,0x2500250,0x2500250,0x2500250
.long 0x2bf02bf,0x2bf02bf,0x2bf02bf,0x2bf02bf,0x2bf02bf,0x2bf02bf,0x2bf02bf,0x2bf02bf,0x2bf02bf,0x2bf02bf,0x2bf02bf,0x2bf02bf,0x2bf02bf,0x2bf02bf,0x2bf02bf,0x2bf02bf
.long 0x2bf02bf,0x2bf02bf,0x2bf02bf,0x2bf02bf,0x2bf02bf,0x2bf02bf,0x2bf02bf,0x2bf02bf,0x2bf02bf,0x2bf02bf,0x2bf02bf,0x2bf02bf,0x2bf02bf,0x2bf02bf,0x2bf02bf,0x2bf02bf
.long 0x637062f,0x647063f,0x64f064d,0x6570655,0x65f065d,0x6670665,0x66f066d,0x6770675,0x497067f,0x4a7049f,0x68604af,0x4f10687,0x62f062f,0x62f062f,0x62f062f,0x62f062f
.long 0x62f062f,0x62f062f,0x62f062f,0x62f062f,0x62f062f,0x62f062f,0x62f062f,0x62f062f,0x62f062f,0x62f062f,0x62f062f,0x62f062f,0x62f062f,0x62f062f,0x62f062f,0x62f062f
.long 0x2210220,0x2230222,0x2250224,0x2270226,0x2290228,0x22b022a,0x22d022c,0x22f022e,0x3b00398,0x39b03c8,0x3cb03b3,0x3b6039e,0x22003ce,0x2200220,0x2200220,0x2200220
.long 0x2200220,0x2200220,0x2200220,0x2200220,0x2200220,0x2200220,0x2200220,0x2200220,0x2200220,0x2200220,0x2200220,0x2200220,0x2200220,0x2200220,0x2200220,0x2200220
.long 0x2c002c0,0x2c002c0,0x2c002c0,0x2c002c0,0x2c002c0,0x2c002c0,0x2c002c0,0x2c002c0,0x2c002c0,0x2c002c0,0x2c002c0,0x2c002c0,0x2c002c0,0x2c002c0,0x2c002c0,0x2c002c0
.long 0x2c002c0,0x2c002c0,0x2c002c0,0x2c002c0,0x2c002c0,0x2c002c0,0x2c002c0,0x2c002c0,0x2c002c0,0x2c002c0,0x2c002c0,0x2c002c0,0x2c002c0,0x2c002c0,0x2c002c0,0x2c002c0
.long 0x6090601,0x6520611,0x660065a,0x6680662,0x670066a,0x4920672,0x4a2049a,0x67d04aa,0x4f6067e,0x6010601,0x6010601,0x6010601,0x6010601,0x6010601,0x6010601,0x6010601
.long 0x6010601,0x6010601,0x6010601,0x6010601,0x6010601,0x6010601,0x6010601,0x6010601,0x6010601,0x6010601,0x6010601,0x6010601,0x6010601,0x6010601,0x6010601,0x6010601
.long 0x2610260,0x2630262,0x2650264,0x2670266,0x2690268,0x26b026a,0x26d026c,0x26f026e,0x3b00398,0x39b03c8,0x3cb03b3,0x3b6039e,0x26003ce,0x2600260,0x2600260,0x2600260
.long 0x2600260,0x2600260,0x2600260,0x2600260,0x2600260,0x2600260,0x2600260,0x2600260,0x2600260,0x2600260,0x2600260,0x2600260,0x2600260,0x2600260,0x2600260,0x2600260
.long 0x2c102c1,0x2c102c1,0x2c102c1,0x2c102c1,0x2c102c1,0x2c102c1,0x2c102c1,0x2c102c1,0x2c102c1,0x2c102c1,0x2c102c1,0x2c102c1,0x2c102c1,0x2c102c1,0x2c102c1,0x2c102c1
.long 0x2c102c1,0x2c102c1,0x2c102c1,0x2c102c1,0x2c102c1,0x2c102c1,0x2c102c1,0x2c102c1,0x2c102c1,0x2c102c1,0x2c102c1,0x2c102c1,0x2c102c1,0x2c102c1,0x2c102c1,0x2c102c1
.long 0x633062b,0x643063b,0x64b0649,0x6530651,0x65b0659,0x6630661,0x66b0669,0x6730671,0x492067b,0x4a2049a,0x67d04aa,0x4f6067e,0x62b062b,0x62b062b,0x62b062b,0x62b062b
.long 0x62b062b,0x62b062b,0x62b062b,0x62b062b,0x62b062b,0x62b062b,0x62b062b,0x62b062b,0x62b062b,0x62b062b,0x62b062b,0x62b062b,0x62b062b,0x62b062b,0x62b062b,0x62b062b
.long 0x2210220,0x2230222,0x2250224,0x2270226,0x2290228,0x22b022a,0x22d022c,0x22f022e,0x3a90391,0x39403c1,0x3c403ac,0x3af0397,0x22003c7,0x2200220,0x2200220,0x2200220
.long 0x2200220,0x2200220,0x2200220,0x2200220,0x2200220,0x2200220,0x2200220,0x2200220,0x2200220,0x2200220,0x2200220,0x2200220,0x2200220,0x2200220,0x2200220,0x2200220
.long 0x2c202c2,0x2c202c2,0x2c202c2,0x2c202c2,0x2c202c2,0x2c202c2,0x2c202c2,0x2c202c2,0x2c202c2,0x2c202c2,0x2c202c2,0x2c202c2,0x2c202c2,0x2c202c2,0x2c202c2,0x2c202c2
.long 0x2c202c2,0x2c202c2,0x2c202c2,0x2c202c2,0x2c202c2,0x2c202c2,0x2c202c2,0x2c202c2,0x2c202c2,0x2c202c2,0x2c202c2,0x2c202c2,0x2c202c2,0x2c202c2,0x2c202c2,0x2c202c2
.long 0x6090601,0x6520611,0x660065a,0x6680662,0x670066a,0x4960672,0x49e04b6,0x4a604be,0x4ae04c6,0x68704ce,0x4f10688,0x60104f8,0x6010601,0x6010601,0x6010601,0x6010601
.long 0x6010601,0x6010601,0x6010601,0x6010601,0x6010601,0x6010601,0x6010601,0x6010601,0x6010601,0x6010601,0x6010601,0x6010601,0x6010601,0x6010601,0x6010601,0x6010601
.long 0x2610260,0x2630262,0x2650264,0x2670266,0x2690268,0x26b026a,0x26d026c,0x26f026e,0x3a90391,0x39403c1,0x3c403ac,0x3af0397,0x26003c7,0x2600260,0x2600260,0x2600260
.long 0x2600260,0x2600260,0x2600260,0x2600260,0x2600260,0x2600260,0x2600260,0x2600260,0x2600260,0x2600260,0x2600260,0x2600260,0x2600260,0x2600260,0x2600260,0x2600260
.long 0x2c302c3,0x2c302c3,0x2c302c3,0x2c302c3,0x2c302c3,0x2c302c3,0x2c302c3,0x2c302c3,0x2c302c3,0x2c302c3,0x2c302c3,0x2c302c3,0x2c302c3,0x2c302c3,0x2c302c3,0x2c302c3
.long 0x2c302c3,0x2c302c3,0x2c302c3,0x2c302c3,0x2c302c3,0x2c302c3,0x2c302c3,0x2c302c3,0x2c302c3,0x2c302c3,0x2c302c3,0x2c302c3,0x2c302c3,0x2c302c3,0x2c302c3,0x2c302c3
.long 0x633062b,0x643063b,0x64b0649,0x6530651,0x65b0659,0x6630661,0x66b0669,0x6730671,0x496067b,0x49e04b6,0x4a604be,0x4ae04c6,0x68704ce,0x4f10688,0x62b04f8,0x62b062b
.long 0x62b062b,0x62b062b,0x62b062b,0x62b062b,0x62b062b,0x62b062b,0x62b062b,0x62b062b,0x62b062b,0x62b062b,0x62b062b,0x62b062b,0x62b062b,0x62b062b,0x62b062b,0x62b062b
.long 0x2210220,0x2230222,0x2250224,0x2270226,0x2290228,0x22b022a,0x22d022c,0x22f022e,0x3b903a1,0x3a403d1,0x3d403bc,0x3bf03a7,0x22003d7,0x2200220,0x2200220,0x2200220
.long 0x2200220,0x2200220,0x2200220,0x2200220,0x2200220,0x2200220,0x2200220,0x2200220,0x2200220,0x2200220,0x2200220,0x2200220,0x2200220,0x2200220,0x2200220,0x2200220
.long 0x2c402c4,0x2c402c4,0x2c402c4,0x2c402c4,0x2c402c4,0x2c402c4,0x2c402c4,0x2c402c4,0x2c402c4,0x2c402c4,0x2c402c4,0x2c402c4,0x2c402c4,0x2c402c4,0x2c402c4,0x2c402c4
.long 0x2c402c4,0x2c402c4,0x2c402c4,0x2c402c4,0x2c402c4,0x2c402c4,0x2c402c4,0x2c402c4,0x2c402c4,0x2c402c4,0x2c402c4,0x2c402c4,0x2c402c4,0x2c402c4,0x2c402c4,0x2c402c4
.long 0x60d0605,0x6560615,0x664065e,0x66c0666,0x674066e,0x4930676,0x4a3049b,0x67d04ab,0x4f6067e,0x6050605,0x6050605,0x6050605,0x6050605,0x6050605,0x6050605,0x6050605
.long 0x6050605,0x6050605,0x6050605,0x6050605,0x6050605,0x6050605,0x6050605,0x6050605,0x6050605,0x6050605,0x6050605,0x6050605,0x6050605,0x6050605,0x6050605,0x6050605
.long 0x2610260,0x2630262,0x2650264,0x2670266,0x2690268,0x26b026a,0x26d026c,0x26f026e,0x3b903a1,0x3a403d1,0x3d403bc,0x3bf03a7,0x26003d7,0x2600260,0x2600260,0x2600260
.long 0x2600260,0x2600260,0x2600260,0x2600260,0x2600260,0x2600260,0x2600260,0x2600260,0x2600260,0x2600260,0x2600260,0x2600260,0x2600260,0x2600260,0x2600260,0x2600260
.long 0x2c502c5,0x2c502c5,0x2c502c5,0x2c502c5,0x2c502c5,0x2c502c5,0x2c502c5,0x2c502c5,0x2c502c5,0x2c502c5,0x2c502c5,0x2c502c5,0x2c502c5,0x2c502c5,0x2c502c5,0x2c502c5
.long 0x2c502c5,0x2c502c5,0x2c502c5,0x2c502c5,0x2c502c5,0x2c502c5,0x2c502c5,0x2c502c5,0x2c502c5,0x2c502c5,0x2c502c5,0x2c502c5,0x2c502c5,0x2c502c5,0x2c502c5,0x2c502c5
.long 0x637062f,0x647063f,0x64f064d,0x6570655,0x65f065d,0x6670665,0x66f066d,0x6770675,0x493067f,0x4a3049b,0x67d04ab,0x4f6067e,0x62f062f,0x62f062f,0x62f062f,0x62f062f
.long 0x62f062f,0x62f062f,0x62f062f,0x62f062f,0x62f062f,0x62f062f,0x62f062f,0x62f062f,0x62f062f,0x62f062f,0x62f062f,0x62f062f,0x62f062f,0x62f062f,0x62f062f,0x62f062f
.long 0x2210220,0x2230222,0x2250224,0x2270226,0x2290228,0x22b022a,0x22d022c,0x22f022e,0x3b2039a,0x39d03ca,0x3cd03b5,0x3fb03f8,0x22003fe,0x2200220,0x2200220,0x2200220
.long 0x2200220,0x2200220,0x2200220,0x2200220,0x2200220,0x2200220,0x2200220,0x2200220,0x2200220,0x2200220,0x2200220,0x2200220,0x2200220,0x2200220,0x2200220,0x2200220
.long 0x2c602c6,0x2c602c6,0x2c602c6,0x2c602c6,0x2c602c6,0x2c602c6,0x2c602c6,0x2c602c6,0x2c602c6,0x2c602c6,0x2c602c6,0x2c602c6,0x2c602c6,0x2c602c6,0x2c602c6,0x2c602c6
.long 0x2c602c6,0x2c602c6,0x2c602c6,0x2c602c6,0x2c602c6,0x2c602c6,0x2c602c6,0x2c602c6,0x2c602c6,0x2c602c6,0x2c602c6,0x2c602c6,0x2c602c6,0x2c602c6,0x2c602c6,0x2c602c6
.long 0x60d0605,0x6560615,0x664065e,0x66c0666,0x674066e,0x4970676,0x49f04b7,0x4a704bf,0x4af04c7,0x68704cf,0x4f10688,0x60504f8,0x6050605,0x6050605,0x6050605,0x6050605
.long 0x6050605,0x6050605,0x6050605,0x6050605,0x6050605,0x6050605,0x6050605,0x6050605,0x6050605,0x6050605,0x6050605,0x6050605,0x6050605,0x6050605,0x6050605,0x6050605
.long 0x2610260,0x2630262,0x2650264,0x2670266,0x2690268,0x26b026a,0x26d026c,0x26f026e,0x3b2039a,0x39d03ca,0x3cd03b5,0x3fb03f8,0x26003fe,0x2600260,0x2600260,0x2600260
.long 0x2600260,0x2600260,0x2600260,0x2600260,0x2600260,0x2600260,0x2600260,0x2600260,0x2600260,0x2600260,0x2600260,0x2600260,0x2600260,0x2600260,0x2600260,0x2600260
.long 0x2c702c7,0x2c702c7,0x2c702c7,0x2c702c7,0x2c702c7,0x2c702c7,0x2c702c7,0x2c702c7,0x2c702c7,0x2c702c7,0x2c702c7,0x2c702c7,0x2c702c7,0x2c702c7,0x2c702c7,0x2c702c7
.long 0x2c702c7,0x2c702c7,0x2c702c7,0x2c702c7,0x2c702c7,0x2c702c7,0x2c702c7,0x2c702c7,0x2c702c7,0x2c702c7,0x2c702c7,0x2c702c7,0x2c702c7,0x2c702c7,0x2c702c7,0x2c702c7
.long 0x637062f,0x647063f,0x64f064d,0x6570655,0x65f065d,0x6670665,0x66f066d,0x6770675,0x497067f,0x49f04b7,0x4a704bf,0x4af04c7,0x68704cf,0x4f10688,0x62f04f8,0x62f062f
.long 0x62f062f,0x62f062f,0x62f062f,0x62f062f,0x62f062f,0x62f062f,0x62f062f,0x62f062f,0x62f062f,0x62f062f,0x62f062f,0x62f062f,0x62f062f,0x62f062f,0x62f062f,0x62f062f
.long 0x2310230,0x2330232,0x2350234,0x2370236,0x2390238,0x23b023a,0x23d023c,0x23f023e,0x3b00398,0x39b03c8,0x3cb03b3,0x3b6039e,0x23003ce,0x2300230,0x2300230,0x2300230
.long 0x2300230,0x2300230,0x2300230,0x2300230,0x2300230,0x2300230,0x2300230,0x2300230,0x2300230,0x2300230,0x2300230,0x2300230,0x2300230,0x2300230,0x2300230,0x2300230
.long 0x2c802c8,0x2c802c8,0x2c802c8,0x2c802c8,0x2c802c8,0x2c802c8,0x2c802c8,0x2c802c8,0x2c802c8,0x2c802c8,0x2c802c8,0x2c802c8,0x2c802c8,0x2c802c8,0x2c802c8,0x2c802c8
.long 0x2c802c8,0x2c802c8,0x2c802c8,0x2c802c8,0x2c802c8,0x2c802c8,0x2c802c8,0x2c802c8,0x2c802c8,0x2c802c8,0x2c802c8,0x2c802c8,0x2c802c8,0x2c802c8,0x2c802c8,0x2c802c8
.long 0x6090601,0x6520611,0x660065a,0x6680662,0x670066a,0x4b20672,0x4c204ba,0x68004ca,0x4f70681,0x6010601,0x6010601,0x6010601,0x6010601,0x6010601,0x6010601,0x6010601
.long 0x6010601,0x6010601,0x6010601,0x6010601,0x6010601,0x6010601,0x6010601,0x6010601,0x6010601,0x6010601,0x6010601,0x6010601,0x6010601,0x6010601,0x6010601,0x6010601
.long 0x2710270,0x2730272,0x2750274,0x2770276,0x2790278,0x27b027a,0x27d027c,0x27f027e,0x3b00398,0x39b03c8,0x3cb03b3,0x3b6039e,0x27003ce,0x2700270,0x2700270,0x2700270
.long 0x2700270,0x2700270,0x2700270,0x2700270,0x2700270,0x2700270,0x2700270,0x2700270,0x2700270,0x2700270,0x2700270,0x2700270,0x2700270,0x2700270,0x2700270,0x2700270
.long 0x2c902c9,0x2c902c9,0x2c902c9,0x2c902c9,0x2c902c9,0x2c902c9,0x2c902c9,0x2c902c9,0x2c902c9,0x2c902c9,0x2c902c9,0x2c902c9,0x2c902c9,0x2c902c9,0x2c902c9,0x2c902c9
.long 0x2c902c9,0x2c902c9,0x2c902c9,0x2c902c9,0x2c902c9,0x2c902c9,0x2c902c9,0x2c902c9,0x2c902c9,0x2c902c9,0x2c902c9,0x2c902c9,0x2c902c9,0x2c902c9,0x2c902c9,0x2c902c9
.long 0x633062b,0x643063b,0x64b0649,0x6530651,0x65b0659,0x6630661,0x66b0669,0x6730671,0x4b2067b,0x4c204ba,0x68004ca,0x4f70681,0x62b062b,0x62b062b,0x62b062b,0x62b062b
.long 0x62b062b,0x62b062b,0x62b062b,0x62b062b,0x62b062b,0x62b062b,0x62b062b,0x62b062b,0x62b062b,0x62b062b,0x62b062b,0x62b062b,0x62b062b,0x62b062b,0x62b062b,0x62b062b
.long 0x2310230,0x2330232,0x2350234,0x2370236,0x2390238,0x23b023a,0x23d023c,0x23f023e,0x3a90391,0x39403c1,0x3c403ac,0x3af0397,0x23003c7,0x2300230,0x2300230,0x2300230
.long 0x2300230,0x2300230,0x2300230,0x2300230,0x2300230,0x2300230,0x2300230,0x2300230,0x2300230,0x2300230,0x2300230,0x2300230,0x2300230,0x2300230,0x2300230,0x2300230
.long 0x2ca02ca,0x2ca02ca,0x2ca02ca,0x2ca02ca,0x2ca02ca,0x2ca02ca,0x2ca02ca,0x2ca02ca,0x2ca02ca,0x2ca02ca,0x2ca02ca,0x2ca02ca,0x2ca02ca,0x2ca02ca,0x2ca02ca,0x2ca02ca
.long 0x2ca02ca,0x2ca02ca,0x2ca02ca,0x2ca02ca,0x2ca02ca,0x2ca02ca,0x2ca02ca,0x2ca02ca,0x2ca02ca,0x2ca02ca,0x2ca02ca,0x2ca02ca,0x2ca02ca,0x2ca02ca,0x2ca02ca,0x2ca02ca
.long 0x6090601,0x6520611,0x660065a,0x6680662,0x670066a,0x4b60672,0x4be04d0,0x4c604d2,0x4ce04d4,0x68904d6,0x4f8068a,0x60104f9,0x6010601,0x6010601,0x6010601,0x6010601
.long 0x6010601,0x6010601,0x6010601,0x6010601,0x6010601,0x6010601,0x6010601,0x6010601,0x6010601,0x6010601,0x6010601,0x6010601,0x6010601,0x6010601,0x6010601,0x6010601
.long 0x2710270,0x2730272,0x2750274,0x2770276,0x2790278,0x27b027a,0x27d027c,0x27f027e,0x3a90391,0x39403c1,0x3c403ac,0x3af0397,0x27003c7,0x2700270,0x2700270,0x2700270
.long 0x2700270,0x2700270,0x2700270,0x2700270,0x2700270,0x2700270,0x2700270,0x2700270,0x2700270,0x2700270,0x2700270,0x2700270,0x2700270,0x2700270,0x2700270,0x2700270
.long 0x2cb02cb,0x2cb02cb,0x2cb02cb,0x2cb02cb,0x2cb02cb,0x2cb02cb,0x2cb02cb,0x2cb02cb,0x2cb02cb,0x2cb02cb,0x2cb02cb,0x2cb02cb,0x2cb02cb,0x2cb02cb,0x2cb02cb,0x2cb02cb
.long 0x2cb02cb,0x2cb02cb,0x2cb02cb,0x2cb02cb,0x2cb02cb,0x2cb02cb,0x2cb02cb,0x2cb02cb,0x2cb02cb,0x2cb02cb,0x2cb02cb,0x2cb02cb,0x2cb02cb,0x2cb02cb,0x2cb02cb,0x2cb02cb
.long 0x633062b,0x643063b,0x64b0649,0x6530651,0x65b0659,0x6630661,0x66b0669,0x6730671,0x4b6067b,0x4be04d0,0x4c604d2,0x4ce04d4,0x68904d6,0x4f8068a,0x62b04f9,0x62b062b
.long 0x62b062b,0x62b062b,0x62b062b,0x62b062b,0x62b062b,0x62b062b,0x62b062b,0x62b062b,0x62b062b,0x62b062b,0x62b062b,0x62b062b,0x62b062b,0x62b062b,0x62b062b,0x62b062b
.long 0x2310230,0x2330232,0x2350234,0x2370236,0x2390238,0x23b023a,0x23d023c,0x23f023e,0x3b903a1,0x3a403d1,0x3d403bc,0x3bf03a7,0x23003d7,0x2300230,0x2300230,0x2300230
.long 0x2300230,0x2300230,0x2300230,0x2300230,0x2300230,0x2300230,0x2300230,0x2300230,0x2300230,0x2300230,0x2300230,0x2300230,0x2300230,0x2300230,0x2300230,0x2300230
.long 0x2cc02cc,0x2cc02cc,0x2cc02cc,0x2cc02cc,0x2cc02cc,0x2cc02cc,0x2cc02cc,0x2cc02cc,0x2cc02cc,0x2cc02cc,0x2cc02cc,0x2cc02cc,0x2cc02cc,0x2cc02cc,0x2cc02cc,0x2cc02cc
.long 0x2cc02cc,0x2cc02cc,0x2cc02cc,0x2cc02cc,0x2cc02cc,0x2cc02cc,0x2cc02cc,0x2cc02cc,0x2cc02cc,0x2cc02cc,0x2cc02cc,0x2cc02cc,0x2cc02cc,0x2cc02cc,0x2cc02cc,0x2cc02cc
.long 0x60d0605,0x6560615,0x664065e,0x66c0666,0x674066e,0x4b30676,0x4c304bb,0x68004cb,0x4f70681,0x6050605,0x6050605,0x6050605,0x6050605,0x6050605,0x6050605,0x6050605
.long 0x6050605,0x6050605,0x6050605,0x6050605,0x6050605,0x6050605,0x6050605,0x6050605,0x6050605,0x6050605,0x6050605,0x6050605,0x6050605,0x6050605,0x6050605,0x6050605
.long 0x2710270,0x2730272,0x2750274,0x2770276,0x2790278,0x27b027a,0x27d027c,0x27f027e,0x3b903a1,0x3a403d1,0x3d403bc,0x3bf03a7,0x27003d7,0x2700270,0x2700270,0x2700270
.long 0x2700270,0x2700270,0x2700270,0x2700270,0x2700270,0x2700270,0x2700270,0x2700270,0x2700270,0x2700270,0x2700270,0x2700270,0x2700270,0x2700270,0x2700270,0x2700270
.long 0x2cd02cd,0x2cd02cd,0x2cd02cd,0x2cd02cd,0x2cd02cd,0x2cd02cd,0x2cd02cd,0x2cd02cd,0x2cd02cd,0x2cd02cd,0x2cd02cd,0x2cd02cd,0x2cd02cd,0x2cd02cd,0x2cd02cd,0x2cd02cd
.long 0x2cd02cd,0x2cd02cd,0x2cd02cd,0x2cd02cd,0x2cd02cd,0x2cd02cd,0x2cd02cd,0x2cd02cd,0x2cd02cd,0x2cd02cd,0x2cd02cd,0x2cd02cd,0x2cd02cd,0x2cd02cd,0x2cd02cd,0x2cd02cd
.long 0x637062f,0x647063f,0x64f064d,0x6570655,0x65f065d,0x6670665,0x66f066d,0x6770675,0x4b3067f,0x4c304bb,0x68004cb,0x4f70681,0x62f062f,0x62f062f,0x62f062f,0x62f062f
.long 0x62f062f,0x62f062f,0x62f062f,0x62f062f,0x62f062f,0x62f062f,0x62f062f,0x62f062f,0x62f062f,0x62f062f,0x62f062f,0x62f062f,0x62f062f,0x62f062f,0x62f062f,0x62f062f
.long 0x2310230,0x2330232,0x2350234,0x2370236,0x2390238,0x23b023a,0x23d023c,0x23f023e,0x3b2039a,0x39d03ca,0x3cd03b5,0x3fb03f8,0x23003fe,0x2300230,0x2300230,0x2300230
.long 0x2300230,0x2300230,0x2300230,0x2300230,0x2300230,0x2300230,0x2300230,0x2300230,0x2300230,0x2300230,0x2300230,0x2300230,0x2300230,0x2300230,0x2300230,0x2300230
.long 0x2ce02ce,0x2ce02ce,0x2ce02ce,0x2ce02ce,0x2ce02ce,0x2ce02ce,0x2ce02ce,0x2ce02ce,0x2ce02ce,0x2ce02ce,0x2ce02ce,0x2ce02ce,0x2ce02ce,0x2ce02ce,0x2ce02ce,0x2ce02ce
.long 0x2ce02ce,0x2ce02ce,0x2ce02ce,0x2ce02ce,0x2ce02ce,0x2ce02ce,0x2ce02ce,0x2ce02ce,0x2ce02ce,0x2ce02ce,0x2ce02ce,0x2ce02ce,0x2ce02ce,0x2ce02ce,0x2ce02ce,0x2ce02ce
.long 0x60d0605,0x6560615,0x664065e,0x66c0666,0x674066e,0x4b70676,0x4bf04d1,0x4c704d3,0x4cf04d5,0x68904d7,0x4f8068a,0x60504f9,0x6050605,0x6050605,0x6050605,0x6050605
.long 0x6050605,0x6050605,0x6050605,0x6050605,0x6050605,0x6050605,0x6050605,0x6050605,0x6050605,0x6050605,0x6050605,0x6050605,0x6050605,0x6050605,0x6050605,0x6050605
.long 0x2710270,0x2730272,0x2750274,0x2770276,0x2790278,0x27b027a,0x27d027c,0x27f027e,0x3b2039a,0x39d03ca,0x3cd03b5,0x3fb03f8,0x27003fe,0x2700270,0x2700270,0x2700270
.long 0x2700270,0x2700270,0x2700270,0x2700270,0x2700270,0x2700270,0x2700270,0x2700270,0x2700270,0x2700270,0x2700270,0x2700270,0x2700270,0x2700270,0x2700270,0x2700270
.long 0x2cf02cf,0x2cf02cf,0x2cf02cf,0x2cf02cf,0x2cf02cf,0x2cf02cf,0x2cf02cf,0x2cf02cf,0x2cf02cf,0x2cf02cf,0x2cf02cf,0x2cf02cf,0x2cf02cf,0x2cf02cf,0x2cf02cf,0x2cf02cf
.long 0x2cf02cf,0x2cf02cf,0x2cf02cf,0x2cf02cf,0x2cf02cf,0x2cf02cf,0x2cf02cf,0x2cf02cf,0x2cf02cf,0x2cf02cf,0x2cf02cf,0x2cf02cf,0x2cf02cf,0x2cf02cf,0x2cf02cf,0x2cf02cf
.long 0x637062f,0x647063f,0x64f064d,0x6570655,0x65f065d,0x6670665,0x66f066d,0x6770675,0x4b7067f,0x4bf04d1,0x4c704d3,0x4cf04d5,0x68904d7,0x4f8068a,0x62f04f9,0x62f062f
.long 0x62f062f,0x62f062f,0x62f062f,0x62f062f,0x62f062f,0x62f062f,0x62f062f,0x62f062f,0x62f062f,0x62f062f,0x62f062f,0x62f062f,0x62f062f,0x62f062f,0x62f062f,0x62f062f
.long 0x2010200,0x2030202,0x2050204,0x2070206,0x2090208,0x20b020a,0x20d020c,0x20f020e,0x3ba03a2,0x3a503d2,0x3d503bd,0x3fc03f9,0x20003ff,0x2000200,0x2000200,0x2000200
.long 0x2000200,0x2000200,0x2000200,0x2000200,0x2000200,0x2000200,0x2000200,0x2000200,0x2000200,0x2000200,0x2000200,0x2000200,0x2000200,0x2000200,0x2000200,0x2000200
.long 0x2d002d0,0x2d002d0,0x2d002d0,0x2d002d0,0x2d002d0,0x2d002d0,0x2d002d0,0x2d002d0,0x2d002d0,0x2d002d0,0x2d002d0,0x2d002d0,0x2d002d0,0x2d002d0,0x2d002d0,0x2d002d0
.long 0x2d002d0,0x2d002d0,0x2d002d0,0x2d002d0,0x2d002d0,0x2d002d0,0x2d002d0,0x2d002d0,0x2d002d0,0x2d002d0,0x2d002d0,0x2d002d0,0x2d002d0,0x2d002d0,0x2d002d0,0x2d002d0
.long 0x6090601,0x6520611,0x660065a,0x6680662,0x670066a,0x4b20672,0x4ba0494,0x4c2049c,0x4ca04a4,0x68104ac,0x4f70682,0x6010601,0x6010601,0x6010601,0x6010601,0x6010601
.long 0x6010601,0x6010601,0x6010601,0x6010601,0x6010601,0x6010601,0x6010601,0x6010601,0x6010601,0x6010601,0x6010601,0x6010601,0x6010601,0x6010601,0x6010601,0x6010601
.long 0x2410240,0x2430242,0x2450244,0x2470246,0x2490248,0x24b024a,0x24d024c,0x24f024e,0x3ba03a2,0x3a503d2,0x3d503bd,0x3fc03f9,0x24003ff,0x2400240,0x2400240,0x2400240
.long 0x2400240,0x2400240,0x2400240,0x2400240,0x2400240,0x2400240,0x2400240,0x2400240,0x2400240,0x2400240,0x2400240,0x2400240,0x2400240,0x2400240,0x2400240,0x2400240
.long 0x2d102d1,0x2d102d1,0x2d102d1,0x2d102d1,0x2d102d1,0x2d102d1,0x2d102d1,0x2d102d1,0x2d102d1,0x2d102d1,0x2d102d1,0x2d102d1,0x2d102d1,0x2d102d1,0x2d102d1,0x2d102d1
.long 0x2d102d1,0x2d102d1,0x2d102d1,0x2d102d1,0x2d102d1,0x2d102d1,0x2d102d1,0x2d102d1,0x2d102d1,0x2d102d1,0x2d102d1,0x2d102d1,0x2d102d1,0x2d102d1,0x2d102d1,0x2d102d1
.long 0x633062b,0x643063b,0x64b0649,0x6530651,0x65b0659,0x6630661,0x66b0669,0x6730671,0x4b2067b,0x4ba0494,0x4c2049c,0x4ca04a4,0x68104ac,0x4f70682,0x62b062b,0x62b062b
.long 0x62b062b,0x62b062b,0x62b062b,0x62b062b,0x62b062b,0x62b062b,0x62b062b,0x62b062b,0x62b062b,0x62b062b,0x62b062b,0x62b062b,0x62b062b,0x62b062b,0x62b062b,0x62b062b
.long 0x2110210,0x2130212,0x2150214,0x2170216,0x2190218,0x21b021a,0x21d021c,0x21f021e,0x3ba03a2,0x3a503d2,0x3d503bd,0x3fc03f9,0x21003ff,0x2100210,0x2100210,0x2100210
.long 0x2100210,0x2100210,0x2100210,0x2100210,0x2100210,0x2100210,0x2100210,0x2100210,0x2100210,0x2100210,0x2100210,0x2100210,0x2100210,0x2100210,0x2100210,0x2100210
.long 0x2d202d2,0x2d202d2,0x2d202d2,0x2d202d2,0x2d202d2,0x2d202d2,0x2d202d2,0x2d202d2,0x2d202d2,0x2d202d2,0x2d202d2,0x2d202d2,0x2d202d2,0x2d202d2,0x2d202d2,0x2d202d2
.long 0x2d202d2,0x2d202d2,0x2d202d2,0x2d202d2,0x2d202d2,0x2d202d2,0x2d202d2,0x2d202d2,0x2d202d2,0x2d202d2,0x2d202d2,0x2d202d2,0x2d202d2,0x2d202d2,0x2d202d2,0x2d202d2
.long 0x6090601,0x6520611,0x660065a,0x6680662,0x670066a,0x4d00672,0x4d404d2,0x68a04d6,0x4f9068b,0x6010601,0x6010601,0x6010601,0x6010601,0x6010601,0x6010601,0x6010601
.long 0x6010601,0x6010601,0x6010601,0x6010601,0x6010601,0x6010601,0x6010601,0x6010601,0x6010601,0x6010601,0x6010601,0x6010601,0x6010601,0x6010601,0x6010601,0x6010601
.long 0x2510250,0x2530252,0x2550254,0x2570256,0x2590258,0x25b025a,0x25d025c,0x25f025e,0x3ba03a2,0x3a503d2,0x3d503bd,0x3fc03f9,0x25003ff,0x2500250,0x2500250,0x2500250
.long 0x2500250,0x2500250,0x2500250,0x2500250,0x2500250,0x2500250,0x2500250,0x2500250,0x2500250,0x2500250,0x2500250,0x2500250,0x2500250,0x2500250,0x2500250,0x2500250
.long 0x2d302d3,0x2d302d3,0x2d302d3,0x2d302d3,0x2d302d3,0x2d302d3,0x2d302d3,0x2d302d3,0x2d302d3,0x2d302d3,0x2d302d3,0x2d302d3,0x2d302d3,0x2d302d3,0x2d302d3,0x2d302d3
.long 0x2d302d3,0x2d302d3,0x2d302d3,0x2d302d3,0x2d302d3,0x2d302d3,0x2d302d3,0x2d302d3,0x2d302d3,0x2d302d3,0x2d302d3,0x2d302d3,0x2d302d3,0x2d302d3,0x2d302d3,0x2d302d3
.long 0x633062b,0x643063b,0x64b0649,0x6530651,0x65b0659,0x6630661,0x66b0669,0x6730671,0x4d0067b,0x4d404d2,0x68a04d6,0x4f9068b,0x62b062b,0x62b062b,0x62b062b,0x62b062b
.long 0x62b062b,0x62b062b,0x62b062b,0x62b062b,0x62b062b,0x62b062b,0x62b062b,0x62b062b,0x62b062b,0x62b062b,0x62b062b,0x62b062b,0x62b062b,0x62b062b,0x62b062b,0x62b062b
.long 0x2210220,0x2230222,0x2250224,0x2270226,0x2290228,0x22b022a,0x22d022c,0x22f022e,0x3ba03a2,0x3a503d2,0x3d503bd,0x3fc03f9,0x22003ff,0x2200220,0x2200220,0x2200220
.long 0x2200220,0x2200220,0x2200220,0x2200220,0x2200220,0x2200220,0x2200220,0x2200220,0x2200220,0x2200220,0x2200220,0x2200220,0x2200220,0x2200220,0x2200220,0x2200220
.long 0x2d402d4,0x2d402d4,0x2d402d4,0x2d402d4,0x2d402d4,0x2d402d4,0x2d402d4,0x2d402d4,0x2d402d4,0x2d402d4,0x2d402d4,0x2d402d4,0x2d402d4,0x2d402d4,0x2d402d4,0x2d402d4
.long 0x2d402d4,0x2d402d4,0x2d402d4,0x2d402d4,0x2d402d4,0x2d402d4,0x2d402d4,0x2d402d4,0x2d402d4,0x2d402d4,0x2d402d4,0x2d402d4,0x2d402d4,0x2d402d4,0x2d402d4,0x2d402d4
.long 0x60d0605,0x6560615,0x664065e,0x66c0666,0x674066e,0x4b30676,0x4bb0495,0x4c3049d,0x4cb04a5,0x68104ad,0x4f70682,0x6050605,0x6050605,0x6050605,0x6050605,0x6050605
.long 0x6050605,0x6050605,0x6050605,0x6050605,0x6050605,0x6050605,0x6050605,0x6050605,0x6050605,0x6050605,0x6050605,0x6050605,0x6050605,0x6050605,0x6050605,0x6050605
.long 0x2610260,0x2630262,0x2650264,0x2670266,0x2690268,0x26b026a,0x26d026c,0x26f026e,0x3ba03a2,0x3a503d2,0x3d503bd,0x3fc03f9,0x26003ff,0x2600260,0x2600260,0x2600260
.long 0x2600260,0x2600260,0x2600260,0x2600260,0x2600260,0x2600260,0x2600260,0x2600260,0x2600260,0x2600260,0x2600260,0x2600260,0x2600260,0x2600260,0x2600260,0x2600260
.long 0x2d502d5,0x2d502d5,0x2d502d5,0x2d502d5,0x2d502d5,0x2d502d5,0x2d502d5,0x2d502d5,0x2d502d5,0x2d502d5,0x2d502d5,0x2d502d5,0x2d502d5,0x2d502d5,0x2d502d5,0x2d502d5
.long 0x2d502d5,0x2d502d5,0x2d502d5,0x2d502d5,0x2d502d5,0x2d502d5,0x2d502d5,0x2d502d5,0x2d502d5,0x2d502d5,0x2d502d5,0x2d502d5,0x2d502d5,0x2d502d5,0x2d502d5,0x2d502d5
.long 0x637062f,0x647063f,0x64f064d,0x6570655,0x65f065d,0x6670665,0x66f066d,0x6770675,0x4b3067f,0x4bb0495,0x4c3049d,0x4cb04a5,0x68104ad,0x4f70682,0x62f062f,0x62f062f
.long 0x62f062f,0x62f062f,0x62f062f,0x62f062f,0x62f062f,0x62f062f,0x62f062f,0x62f062f,0x62f062f,0x62f062f,0x62f062f,0x62f062f,0x62f062f,0x62f062f,0x62f062f,0x62f062f
.long 0x2310230,0x2330232,0x2350234,0x2370236,0x2390238,0x23b023a,0x23d023c,0x23f023e,0x3ba03a2,0x3a503d2,0x3d503bd,0x3fc03f9,0x23003ff,0x2300230,0x2300230,0x2300230
.long 0x2300230,0x2300230,0x2300230,0x2300230,0x2300230,0x2300230,0x2300230,0x2300230,0x2300230,0x2300230,0x2300230,0x2300230,0x2300230,0x2300230,0x2300230,0x2300230
.long 0x2d602d6,0x2d602d6,0x2d602d6,0x2d602d6,0x2d602d6,0x2d602d6,0x2d602d6,0x2d602d6,0x2d602d6,0x2d602d6,0x2d602d6,0x2d602d6,0x2d602d6,0x2d602d6,0x2d602d6,0x2d602d6
.long 0x2d602d6,0x2d602d6,0x2d602d6,0x2d602d6,0x2d602d6,0x2d602d6,0x2d602d6,0x2d602d6,0x2d602d6,0x2d602d6,0x2d602d6,0x2d602d6,0x2d602d6,0x2d602d6,0x2d602d6,0x2d602d6
.long 0x60d0605,0x6560615,0x664065e,0x66c0666,0x674066e,0x4d10676,0x4d504d3,0x68a04d7,0x4f9068b,0x6050605,0x6050605,0x6050605,0x6050605,0x6050605,0x6050605,0x6050605
.long 0x6050605,0x6050605,0x6050605,0x6050605,0x6050605,0x6050605,0x6050605,0x6050605,0x6050605,0x6050605,0x6050605,0x6050605,0x6050605,0x6050605,0x6050605,0x6050605
.long 0x2710270,0x2730272,0x2750274,0x2770276,0x2790278,0x27b027a,0x27d027c,0x27f027e,0x3ba03a2,0x3a503d2,0x3d503bd,0x3fc03f9,0x27003ff,0x2700270,0x2700270,0x2700270
.long 0x2700270,0x2700270,0x2700270,0x2700270,0x2700270,0x2700270,0x2700270,0x2700270,0x2700270,0x2700270,0x2700270,0x2700270,0x2700270,0x2700270,0x2700270,0x2700270
.long 0x2d702d7,0x2d702d7,0x2d702d7,0x2d702d7,0x2d702d7,0x2d702d7,0x2d702d7,0x2d702d7,0x2d702d7,0x2d702d7,0x2d702d7,0x2d702d7,0x2d702d7,0x2d702d7,0x2d702d7,0x2d702d7
.long 0x2d702d7,0x2d702d7,0x2d702d7,0x2d702d7,0x2d702d7,0x2d702d7,0x2d702d7,0x2d702d7,0x2d702d7,0x2d702d7,0x2d702d7,0x2d702d7,0x2d702d7,0x2d702d7,0x2d702d7,0x2d702d7
.long 0x637062f,0x647063f,0x64f064d,0x6570655,0x65f065d,0x6670665,0x66f066d,0x6770675,0x4d1067f,0x4d504d3,0x68a04d7,0x4f9068b,0x62f062f,0x62f062f,0x62f062f,0x62f062f
.long 0x62f062f,0x62f062f,0x62f062f,0x62f062f,0x62f062f,0x62f062f,0x62f062f,0x62f062f,0x62f062f,0x62f062f,0x62f062f,0x62f062f,0x62f062f,0x62f062f,0x62f062f,0x62f062f
.long 0x2f602f5,0x2f002f7,0xa010a00,0x2f50a02,0x2f502f5,0x2f502f5,0x2f502f5,0x2f502f5,0x2f502f5,0x2f502f5,0x2f502f5,0x2f502f5,0x2f502f5,0x2f502f5,0x2f502f5,0x2f502f5
.long 0x2f502f5,0x2f502f5,0x2f502f5,0x2f502f5,0x2f502f5,0x2f502f5,0x2f502f5,0x2f502f5,0x2f502f5,0x2f502f5,0x2f502f5,0x2f502f5,0x2f502f5,0x2f502f5,0x2f502f5,0x2f502f5
.long 0x2d802d8,0x2d802d8,0x2d802d8,0x2d802d8,0x2d802d8,0x2d802d8,0x2d802d8,0x2d802d8,0x2d802d8,0x2d802d8,0x2d802d8,0x2d802d8,0x2d802d8,0x2d802d8,0x2d802d8,0x2d802d8
.long 0x2d802d8,0x2d802d8,0x2d802d8,0x2d802d8,0x2d802d8,0x2d802d8,0x2d802d8,0x2d802d8,0x2d802d8,0x2d802d8,0x2d802d8,0x2d802d8,0x2d802d8,0x2d802d8,0x2d802d8,0x2d802d8
.long 0x6e206da,0x6f206ea,0x6e306db,0x6f306eb,0x6e406dc,0xcda06ec,0xcdc0cdb,0xcde0cdd,0xce20cdf,0xce40ce3,0xce60ce5,0xcea0ce7,0xcec0ceb,0xcee0ced,0xcf20cef,0xcf40cf3
.long 0xcf60cf5,0xcfa0cf7,0x6da06da,0x6da06da,0x6da06da,0x6da06da,0x6da06da,0x6da06da,0x6da06da,0x6da06da,0x6da06da,0x6da06da,0x6da06da,0x6da06da,0x6da06da,0x6da06da
.long 0x2f602f5,0x2f002f7,0xa010a00,0x2f50a02,0x2f502f5,0x2f502f5,0x2f502f5,0x2f502f5,0x2f502f5,0x2f502f5,0x2f502f5,0x2f502f5,0x2f502f5,0x2f502f5,0x2f502f5,0x2f502f5
.long 0x2f502f5,0x2f502f5,0x2f502f5,0x2f502f5,0x2f502f5,0x2f502f5,0x2f502f5,0x2f502f5,0x2f502f5,0x2f502f5,0x2f502f5,0x2f502f5,0x2f502f5,0x2f502f5,0x2f502f5,0x2f502f5
.long 0x2d902d9,0x2d902d9,0x2d902d9,0x2d902d9,0x2d902d9,0x2d902d9,0x2d902d9,0x2d902d9,0x2d902d9,0x2d902d9,0x2d902d9,0x2d902d9,0x2d902d9,0x2d902d9,0x2d902d9,0x2d902d9
.long 0x2d902d9,0x2d902d9,0x2d902d9,0x2d902d9,0x2d902d9,0x2d902d9,0x2d902d9,0x2d902d9,0x2d902d9,0x2d902d9,0x2d902d9,0x2d902d9,0x2d902d9,0x2d902d9,0x2d902d9,0x2d902d9
.long 0x68c06f4,0x6e506dd,0x6de06ed,0x6ee06e6,0x6e706df,0xcda06ef,0xcdc0cdb,0xcde0cdd,0xce20cdf,0xce40ce3,0xce60ce5,0xcea0ce7,0xcec0ceb,0xcee0ced,0xcf20cef,0xcf40cf3
.long 0xcf60cf5,0xcfa0cf7,0x6f406f4,0x6f406f4,0x6f406f4,0x6f406f4,0x6f406f4,0x6f406f4,0x6f406f4,0x6f406f4,0x6f406f4,0x6f406f4,0x6f406f4,0x6f406f4,0x6f406f4,0x6f406f4
.long 0x2f602f5,0x2f002f7,0xa010a00,0x2f50a02,0x2f502f5,0x2f502f5,0x2f502f5,0x2f502f5,0x2f502f5,0x2f502f5,0x2f502f5,0x2f502f5,0x2f502f5,0x2f502f5,0x2f502f5,0x2f502f5
.long 0x2f502f5,0x2f502f5,0x2f502f5,0x2f502f5,0x2f502f5,0x2f502f5,0x2f502f5,0x2f502f5,0x2f502f5,0x2f502f5,0x2f502f5,0x2f502f5,0x2f502f5,0x2f502f5,0x2f502f5,0x2f502f5
.long 0x4240404,0x4640444,0x4060484,0x4460426,0x4d80466,0x4e004d9,0x4e804e1,0x4da04e9,0x4dc04db,0x4040404,0x4040404,0x4040404,0x4040404,0x4040404,0x4040404,0x4040404
.long 0x4040404,0x4040404,0x4040404,0x4040404,0x4040404,0x4040404,0x4040404,0x4040404,0x4040404,0x4040404,0x4040404,0x4040404,0x4040404,0x4040404,0x4040404,0x4040404
.long 0xc7805ea,0xc7a0c79,0xc7d0c7c,0xc800c7e,0xc820c81,0xc840c83,0xc860c85,0xc880c87,0xc8a0c89,0xc8e0c8d,0xcd80c8f,0xce00cd9,0xce80ce1,0xcf00ce9,0xcf80cf1,0xcfa0cf9
.long 0xcfc0cfb,0xcfe0cfd,0x5ea0cff,0x5ea05ea,0x5ea05ea,0x5ea05ea,0x5ea05ea,0x5ea05ea,0x5ea05ea,0x5ea05ea,0x5ea05ea,0x5ea05ea,0x5ea05ea,0x5ea05ea,0x5ea05ea,0x5ea05ea
.long 0x2f602f5,0x2f002f7,0xa010a00,0x2f50a02,0x2f502f5,0x2f502f5,0x2f502f5,0x2f502f5,0x2f502f5,0x2f502f5,0x2f502f5,0x2f502f5,0x2f502f5,0x2f502f5,0x2f502f5,0x2f502f5
.long 0x2f502f5,0x2f502f5,0x2f502f5,0x2f502f5,0x2f502f5,0x2f502f5,0x2f502f5,0x2f502f5,0x2f502f5,0x2f502f5,0x2f502f5,0x2f502f5,0x2f502f5,0x2f502f5,0x2f502f5,0x2f502f5
.long 0x42c040c,0x46c044c,0x40e048c,0x44e042e,0x4d8046e,0x4e004d9,0x4e804e1,0x4da04e9,0x4dc04db,0x40c040c,0x40c040c,0x40c040c,0x40c040c,0x40c040c,0x40c040c,0x40c040c
.long 0x40c040c,0x40c040c,0x40c040c,0x40c040c,0x40c040c,0x40c040c,0x40c040c,0x40c040c,0x40c040c,0x40c040c,0x40c040c,0x40c040c,0x40c040c,0x40c040c,0x40c040c,0x40c040c
.long 0x5ec05eb,0xc790c78,0xc7c0c7a,0xc7e0c7d,0xc810c80,0xc830c82,0xc850c84,0xc870c86,0xc890c88,0xc8d0c8a,0xc8f0c8e,0xcd90cd8,0xce10ce0,0xce90ce8,0xcf10cf0,0xcf90cf8
.long 0xcfb0cfa,0xcfd0cfc,0xcff0cfe,0x5eb05eb,0x5eb05eb,0x5eb05eb,0x5eb05eb,0x5eb05eb,0x5eb05eb,0x5eb05eb,0x5eb05eb,0x5eb05eb,0x5eb05eb,0x5eb05eb,0x5eb05eb,0x5eb05eb
.long 0x2f602f5,0x2f002f7,0xa010a00,0x2f50a02,0x2f502f5,0x2f502f5,0x2f502f5,0x2f502f5,0x2f502f5,0x2f502f5,0x2f502f5,0x2f502f5,0x2f502f5,0x2f502f5,0x2f502f5,0x2f502f5
.long 0x2f502f5,0x2f502f5,0x2f502f5,0x2f502f5,0x2f502f5,0x2f502f5,0x2f502f5,0x2f502f5,0x2f502f5,0x2f502f5,0x2f502f5,0x2f502f5,0x2f502f5,0x2f502f5,0x2f502f5,0x2f502f5
.long 0x43c041c,0x47c045c,0x41e048e,0x45e043e,0x4d8047e,0x4e004d9,0x4e804e1,0x4da04e9,0x4dc04db,0x41c041c,0x41c041c,0x41c041c,0x41c041c,0x41c041c,0x41c041c,0x41c041c
.long 0x41c041c,0x41c041c,0x41c041c,0x41c041c,0x41c041c,0x41c041c,0x41c041c,0x41c041c,0x41c041c,0x41c041c,0x41c041c,0x41c041c,0x41c041c,0x41c041c,0x41c041c,0x41c041c
.long 0xc7805ed,0xc7a0c79,0xc7d0c7c,0xc800c7e,0xc820c81,0xc840c83,0xc860c85,0xc880c87,0xc8a0c89,0xc8e0c8d,0xcd80c8f,0xce00cd9,0xce80ce1,0xcf00ce9,0xcf80cf1,0xcfa0cf9
.long 0xcfc0cfb,0xcfe0cfd,0x5ed0cff,0x5ed05ed,0x5ed05ed,0x5ed05ed,0x5ed05ed,0x5ed05ed,0x5ed05ed,0x5ed05ed,0x5ed05ed,0x5ed05ed,0x5ed05ed,0x5ed05ed,0x5ed05ed,0x5ed05ed
.long 0x2f602f5,0x2f002f7,0xa010a00,0x2f50a02,0x2f502f5,0x2f502f5,0x2f502f5,0x2f502f5,0x2f502f5,0x2f502f5,0x2f502f5,0x2f502f5,0x2f502f5,0x2f502f5,0x2f502f5,0x2f502f5
.long 0x2f502f5,0x2f502f5,0x2f502f5,0x2f502f5,0x2f502f5,0x2f502f5,0x2f502f5,0x2f502f5,0x2f502f5,0x2f502f5,0x2f502f5,0x2f502f5,0x2f502f5,0x2f502f5,0x2f502f5,0x2f502f5
.long 0x4250405,0x4650445,0x4070485,0x4470427,0x40d0467,0x44d042d,0x48d046d,0x42f040f,0x46f044f,0x4d904d8,0x4e104e0,0x4e904e8,0x4db04da,0x40504dc,0x4050405,0x4050405
.long 0x4050405,0x4050405,0x4050405,0x4050405,0x4050405,0x4050405,0x4050405,0x4050405,0x4050405,0x4050405,0x4050405,0x4050405,0x4050405,0x4050405,0x4050405,0x4050405
.long 0x5ef05ee,0xc790c78,0xc7c0c7a,0xc7e0c7d,0xc810c80,0xc830c82,0xc850c84,0xc870c86,0xc890c88,0xc8d0c8a,0xc8f0c8e,0xcd90cd8,0xce10ce0,0xce90ce8,0xcf10cf0,0xcf90cf8
.long 0xcfb0cfa,0xcfd0cfc,0xcff0cfe,0x5ee05ee,0x5ee05ee,0x5ee05ee,0x5ee05ee,0x5ee05ee,0x5ee05ee,0x5ee05ee,0x5ee05ee,0x5ee05ee,0x5ee05ee,0x5ee05ee,0x5ee05ee,0x5ee05ee
.long 0x2f602f5,0x2f002f7,0xa010a00,0x2f50a02,0x2f502f5,0x2f502f5,0x2f502f5,0x2f502f5,0x2f502f5,0x2f502f5,0x2f502f5,0x2f502f5,0x2f502f5,0x2f502f5,0x2f502f5,0x2f502f5
.long 0x2f502f5,0x2f502f5,0x2f502f5,0x2f502f5,0x2f502f5,0x2f502f5,0x2f502f5,0x2f502f5,0x2f502f5,0x2f502f5,0x2f502f5,0x2f502f5,0x2f502f5,0x2f502f5,0x2f502f5,0x2f502f5
.long 0x42d040d,0x46d044d,0x40f048d,0x44f042f,0x415046f,0x4550435,0x4870475,0x4370417,0x4770457,0x4d904d8,0x4e104e0,0x4e904e8,0x4db04da,0x40d04dc,0x40d040d,0x40d040d
.long 0x40d040d,0x40d040d,0x40d040d,0x40d040d,0x40d040d,0x40d040d,0x40d040d,0x40d040d,0x40d040d,0x40d040d,0x40d040d,0x40d040d,0x40d040d,0x40d040d,0x40d040d,0x40d040d
.long 0xc7805f2,0xc7a0c79,0xc7d0c7c,0xc800c7e,0xc820c81,0xc840c83,0xc860c85,0xc880c87,0xc8a0c89,0xc8e0c8d,0xcd80c8f,0xce00cd9,0xce80ce1,0xcf00ce9,0xcf80cf1,0xcfa0cf9
.long 0xcfc0cfb,0xcfe0cfd,0x5f20cff,0x5f205f2,0x5f205f2,0x5f205f2,0x5f205f2,0x5f205f2,0x5f205f2,0x5f205f2,0x5f205f2,0x5f205f2,0x5f205f2,0x5f205f2,0x5f205f2,0x5f205f2
.long 0x2f602f5,0x2f002f7,0xa010a00,0x2f50a02,0x2f502f5,0x2f502f5,0x2f502f5,0x2f502f5,0x2f502f5,0x2f502f5,0x2f502f5,0x2f502f5,0x2f502f5,0x2f502f5,0x2f502f5,0x2f502f5
.long 0x2f502f5,0x2f502f5,0x2f502f5,0x2f502f5,0x2f502f5,0x2f502f5,0x2f502f5,0x2f502f5,0x2f502f5,0x2f502f5,0x2f502f5,0x2f502f5,0x2f502f5,0x2f502f5,0x2f502f5,0x2f502f5
.long 0x43d041d,0x47d045d,0x41f048f,0x45f043f,0x4d8047f,0x4e004d9,0x4e804e1,0x4da04e9,0x4dc04db,0x41d041d,0x41d041d,0x41d041d,0x41d041d,0x41d041d,0x41d041d,0x41d041d
.long 0x41d041d,0x41d041d,0x41d041d,0x41d041d,0x41d041d,0x41d041d,0x41d041d,0x41d041d,0x41d041d,0x41d041d,0x41d041d,0x41d041d,0x41d041d,0x41d041d,0x41d041d,0x41d041d
.long 0x5f405f3,0xc790c78,0xc7c0c7a,0xc7e0c7d,0xc810c80,0xc830c82,0xc850c84,0xc870c86,0xc890c88,0xc8d0c8a,0xc8f0c8e,0xcd90cd8,0xce10ce0,0xce90ce8,0xcf10cf0,0xcf90cf8
.long 0xcfb0cfa,0xcfd0cfc,0xcff0cfe,0x5f305f3,0x5f305f3,0x5f305f3,0x5f305f3,0x5f305f3,0x5f305f3,0x5f305f3,0x5f305f3,0x5f305f3,0x5f305f3,0x5f305f3,0x5f305f3,0x5f305f3
.long 0x2f602f5,0x2f002f7,0xa010a00,0x2f50a02,0x2f502f5,0x2f502f5,0x2f502f5,0x2f502f5,0x2f502f5,0x2f502f5,0x2f502f5,0x2f502f5,0x2f502f5,0x2f502f5,0x2f502f5,0x2f502f5
.long 0x2f502f5,0x2f502f5,0x2f502f5,0x2f502f5,0x2f502f5,0x2f502f5,0x2f502f5,0x2f502f5,0x2f502f5,0x2f502f5,0x2f502f5,0x2f502f5,0x2f502f5,0x2f502f5,0x2f502f5,0x2f502f5
.long 0x2e002e0,0x2e002e0,0x2e002e0,0x2e002e0,0x2e002e0,0x2e002e0,0x2e002e0,0x2e002e0,0x2e002e0,0x2e002e0,0x2e002e0,0x2e002e0,0x2e002e0,0x2e002e0,0x2e002e0,0x2e002e0
.long 0x2e002e0,0x2e002e0,0x2e002e0,0x2e002e0,0x2e002e0,0x2e002e0,0x2e002e0,0x2e002e0,0x2e002e0,0x2e002e0,0x2e002e0,0x2e002e0,0x2e002e0,0x2e002e0,0x2e002e0,0x2e002e0
.long 0x6e206da,0x6f206ea,0x6e306db,0x6f306eb,0x6e406dc,0xcda06ec,0xcdc0cdb,0xcde0cdd,0xce20cdf,0xce40ce3,0xce60ce5,0xcea0ce7,0xcec0ceb,0xcee0ced,0xcf20cef,0xcf40cf3
.long 0xcf60cf5,0xcfa0cf7,0x6da06da,0x6da06da,0x6da06da,0x6da06da,0x6da06da,0x6da06da,0x6da06da,0x6da06da,0x6da06da,0x6da06da,0x6da06da,0x6da06da,0x6da06da,0x6da06da
.long 0x2f602f5,0x2f002f7,0xa010a00,0x2f50a02,0x2f502f5,0x2f502f5,0x2f502f5,0x2f502f5,0x2f502f5,0x2f502f5,0x2f502f5,0x2f502f5,0x2f502f5,0x2f502f5,0x2f502f5,0x2f502f5
.long 0x2f502f5,0x2f502f5,0x2f502f5,0x2f502f5,0x2f502f5,0x2f502f5,0x2f502f5,0x2f502f5,0x2f502f5,0x2f502f5,0x2f502f5,0x2f502f5,0x2f502f5,0x2f502f5,0x2f502f5,0x2f502f5
.long 0x2e102e1,0x2e102e1,0x2e102e1,0x2e102e1,0x2e102e1,0x2e102e1,0x2e102e1,0x2e102e1,0x2e102e1,0x2e102e1,0x2e102e1,0x2e102e1,0x2e102e1,0x2e102e1,0x2e102e1,0x2e102e1
.long 0x2e102e1,0x2e102e1,0x2e102e1,0x2e102e1,0x2e102e1,0x2e102e1,0x2e102e1,0x2e102e1,0x2e102e1,0x2e102e1,0x2e102e1,0x2e102e1,0x2e102e1,0x2e102e1,0x2e102e1,0x2e102e1
.long 0x68c06f4,0x6e506dd,0x6de06ed,0x6ee06e6,0x6e706df,0xcda06ef,0xcdc0cdb,0xcde0cdd,0xce20cdf,0xce40ce3,0xce60ce5,0xcea0ce7,0xcec0ceb,0xcee0ced,0xcf20cef,0xcf40cf3
.long 0xcf60cf5,0xcfb0cf7,0x6f406f4,0x6f406f4,0x6f406f4,0x6f406f4,0x6f406f4,0x6f406f4,0x6f406f4,0x6f406f4,0x6f406f4,0x6f406f4,0x6f406f4,0x6f406f4,0x6f406f4,0x6f406f4
.long 0x2f602f5,0x2f002f7,0xa010a00,0x2f50a02,0x2f502f5,0x2f502f5,0x2f502f5,0x2f502f5,0x2f502f5,0x2f502f5,0x2f502f5,0x2f502f5,0x2f502f5,0x2f502f5,0x2f502f5,0x2f502f5
.long 0x2f502f5,0x2f502f5,0x2f502f5,0x2f502f5,0x2f502f5,0x2f502f5,0x2f502f5,0x2f502f5,0x2f502f5,0x2f502f5,0x2f502f5,0x2f502f5,0x2f502f5,0x2f502f5,0x2f502f5,0x2f502f5
.long 0x4240404,0x4640444,0x4060484,0x4460426,0x4d80466,0x4e004d9,0x4e804e1,0x4da04e9,0x4dc04db,0x4040404,0x4040404,0x4040404,0x4040404,0x4040404,0x4040404,0x4040404
.long 0x4040404,0x4040404,0x4040404,0x4040404,0x4040404,0x4040404,0x4040404,0x4040404,0x4040404,0x4040404,0x4040404,0x4040404,0x4040404,0x4040404,0x4040404,0x4040404
.long 0xc7805ea,0xc7a0c79,0xc7d0c7c,0xc800c7e,0xc820c81,0xc840c83,0xc860c85,0xc880c87,0xc8a0c89,0xc8e0c8d,0xcd80c8f,0xce00cd9,0xce80ce1,0xcf00ce9,0xcf80cf1,0xcfa0cf9
.long 0xcfc0cfb,0xcfe0cfd,0x5ea0cff,0x5ea05ea,0x5ea05ea,0x5ea05ea,0x5ea05ea,0x5ea05ea,0x5ea05ea,0x5ea05ea,0x5ea05ea,0x5ea05ea,0x5ea05ea,0x5ea05ea,0x5ea05ea,0x5ea05ea
.long 0x2f602f5,0x2f002f7,0xa010a00,0x2f50a02,0x2f502f5,0x2f502f5,0x2f502f5,0x2f502f5,0x2f502f5,0x2f502f5,0x2f502f5,0x2f502f5,0x2f502f5,0x2f502f5,0x2f502f5,0x2f502f5
.long 0x2f502f5,0x2f502f5,0x2f502f5,0x2f502f5,0x2f502f5,0x2f502f5,0x2f502f5,0x2f502f5,0x2f502f5,0x2f502f5,0x2f502f5,0x2f502f5,0x2f502f5,0x2f502f5,0x2f502f5,0x2f502f5
.long 0x42c040c,0x46c044c,0x40e048c,0x44e042e,0x414046e,0x4540434,0x4860474,0x4360416,0x4760456,0x4d904d8,0x4e104e0,0x4e904e8,0x4db04da,0x40c04dc,0x40c040c,0x40c040c
.long 0x40c040c,0x40c040c,0x40c040c,0x40c040c,0x40c040c,0x40c040c,0x40c040c,0x40c040c,0x40c040c,0x40c040c,0x40c040c,0x40c040c,0x40c040c,0x40c040c,0x40c040c,0x40c040c
.long 0xc7805eb,0xc7a0c79,0xc7d0c7c,0xc800c7e,0xc820c81,0xc840c83,0xc860c85,0xc880c87,0xc8a0c89,0xc8e0c8d,0xcd80c8f,0xce00cd9,0xce80ce1,0xcf00ce9,0xcf80cf1,0xcfa0cf9
.long 0xcfc0cfb,0xcfe0cfd,0x5eb0cff,0x5eb05eb,0x5eb05eb,0x5eb05eb,0x5eb05eb,0x5eb05eb,0x5eb05eb,0x5eb05eb,0x5eb05eb,0x5eb05eb,0x5eb05eb,0x5eb05eb,0x5eb05eb,0x5eb05eb
.long 0x2f602f5,0x2f002f7,0xa010a00,0x2f50a02,0x2f502f5,0x2f502f5,0x2f502f5,0x2f502f5,0x2f502f5,0x2f502f5,0x2f502f5,0x2f502f5,0x2f502f5,0x2f502f5,0x2f502f5,0x2f502f5
.long 0x2f502f5,0x2f502f5,0x2f502f5,0x2f502f5,0x2f502f5,0x2f502f5,0x2f502f5,0x2f502f5,0x2f502f5,0x2f502f5,0x2f502f5,0x2f502f5,0x2f502f5,0x2f502f5,0x2f502f5,0x2f502f5
.long 0x43c041c,0x47c045c,0x41e048e,0x45e043e,0x4d8047e,0x4e004d9,0x4e804e1,0x4da04e9,0x4dc04db,0x41c041c,0x41c041c,0x41c041c,0x41c041c,0x41c041c,0x41c041c,0x41c041c
.long 0x41c041c,0x41c041c,0x41c041c,0x41c041c,0x41c041c,0x41c041c,0x41c041c,0x41c041c,0x41c041c,0x41c041c,0x41c041c,0x41c041c,0x41c041c,0x41c041c,0x41c041c,0x41c041c
.long 0xc7805ed,0xc7a0c79,0xc7d0c7c,0xc800c7e,0xc820c81,0xc840c83,0xc860c85,0xc880c87,0xc8a0c89,0xc8e0c8d,0xcd80c8f,0xce00cd9,0xce80ce1,0xcf00ce9,0xcf80cf1,0xcfa0cf9
.long 0xcfc0cfb,0xcfe0cfd,0x5ed0cff,0x5ed05ed,0x5ed05ed,0x5ed05ed,0x5ed05ed,0x5ed05ed,0x5ed05ed,0x5ed05ed,0x5ed05ed,0x5ed05ed,0x5ed05ed,0x5ed05ed,0x5ed05ed,0x5ed05ed
.long 0x2f602f5,0x2f002f7,0xa010a00,0x2f50a02,0x2f502f5,0x2f502f5,0x2f502f5,0x2f502f5,0x2f502f5,0x2f502f5,0x2f502f5,0x2f502f5,0x2f502f5,0x2f502f5,0x2f502f5,0x2f502f5
.long 0x2f502f5,0x2f502f5,0x2f502f5,0x2f502f5,0x2f502f5,0x2f502f5,0x2f502f5,0x2f502f5,0x2f502f5,0x2f502f5,0x2f502f5,0x2f502f5,0x2f502f5,0x2f502f5,0x2f502f5,0x2f502f5
.long 0x42d040d,0x46d044d,0x40f048d,0x44f042f,0x4d8046f,0x4e004d9,0x4e804e1,0x4da04e9,0x4dc04db,0x40d040d,0x40d040d,0x40d040d,0x40d040d,0x40d040d,0x40d040d,0x40d040d
.long 0x40d040d,0x40d040d,0x40d040d,0x40d040d,0x40d040d,0x40d040d,0x40d040d,0x40d040d,0x40d040d,0x40d040d,0x40d040d,0x40d040d,0x40d040d,0x40d040d,0x40d040d,0x40d040d
.long 0xc7805ee,0xc7a0c79,0xc7d0c7c,0xc800c7e,0xc820c81,0xc840c83,0xc860c85,0xc880c87,0xc8a0c89,0xc8e0c8d,0xcd80c8f,0xce00cd9,0xce80ce1,0xcf00ce9,0xcf80cf1,0xcfa0cf9
.long 0xcfc0cfb,0xcfe0cfd,0x5ee0cff,0x5ee05ee,0x5ee05ee,0x5ee05ee,0x5ee05ee,0x5ee05ee,0x5ee05ee,0x5ee05ee,0x5ee05ee,0x5ee05ee,0x5ee05ee,0x5ee05ee,0x5ee05ee,0x5ee05ee
.long 0x2f602f5,0x2f002f7,0xa010a00,0x2f50a02,0x2f502f5,0x2f502f5,0x2f502f5,0x2f502f5,0x2f502f5,0x2f502f5,0x2f502f5,0x2f502f5,0x2f502f5,0x2f502f5,0x2f502f5,0x2f502f5
.long 0x2f502f5,0x2f502f5,0x2f502f5,0x2f502f5,0x2f502f5,0x2f502f5,0x2f502f5,0x2f502f5,0x2f502f5,0x2f502f5,0x2f502f5,0x2f502f5,0x2f502f5,0x2f502f5,0x2f502f5,0x2f502f5
.long 0x4350415,0x4750455,0x4170487,0x4570437,0x4d80477,0x4e004d9,0x4e804e1,0x4da04e9,0x4dc04db,0x4150415,0x4150415,0x4150415,0x4150415,0x4150415,0x4150415,0x4150415
.long 0x4150415,0x4150415,0x4150415,0x4150415,0x4150415,0x4150415,0x4150415,0x4150415,0x4150415,0x4150415,0x4150415,0x4150415,0x4150415,0x4150415,0x4150415,0x4150415
.long 0xc7805f2,0xc7a0c79,0xc7d0c7c,0xc800c7e,0xc820c81,0xc840c83,0xc860c85,0xc880c87,0xc8a0c89,0xc8e0c8d,0xcd80c8f,0xce00cd9,0xce80ce1,0xcf00ce9,0xcf80cf1,0xcfa0cf9
.long 0xcfc0cfb,0xcfe0cfd,0x5f20cff,0x5f205f2,0x5f205f2,0x5f205f2,0x5f205f2,0x5f205f2,0x5f205f2,0x5f205f2,0x5f205f2,0x5f205f2,0x5f205f2,0x5f205f2,0x5f205f2,0x5f205f2
.long 0x2f602f5,0x2f002f7,0xa010a00,0x2f50a02,0x2f502f5,0x2f502f5,0x2f502f5,0x2f502f5,0x2f502f5,0x2f502f5,0x2f502f5,0x2f502f5,0x2f502f5,0x2f502f5,0x2f502f5,0x2f502f5
.long 0x2f502f5,0x2f502f5,0x2f502f5,0x2f502f5,0x2f502f5,0x2f502f5,0x2f502f5,0x2f502f5,0x2f502f5,0x2f502f5,0x2f502f5,0x2f502f5,0x2f502f5,0x2f502f5,0x2f502f5,0x2f502f5
.long 0x43d041d,0x47d045d,0x41f048f,0x45f043f,0x4d8047f,0x4e004d9,0x4e804e1,0x4da04e9,0x4dc04db,0x41d041d,0x41d041d,0x41d041d,0x41d041d,0x41d041d,0x41d041d,0x41d041d
.long 0x41d041d,0x41d041d,0x41d041d,0x41d041d,0x41d041d,0x41d041d,0x41d041d,0x41d041d,0x41d041d,0x41d041d,0x41d041d,0x41d041d,0x41d041d,0x41d041d,0x41d041d,0x41d041d
.long 0xc7805f3,0xc7a0c79,0xc7d0c7c,0xc800c7e,0xc820c81,0xc840c83,0xc860c85,0xc880c87,0xc8a0c89,0xc8e0c8d,0xcd80c8f,0xce00cd9,0xce80ce1,0xcf00ce9,0xcf80cf1,0xcfa0cf9
.long 0xcfc0cfb,0xcfe0cfd,0x5f30cff,0x5f305f3,0x5f305f3,0x5f305f3,0x5f305f3,0x5f305f3,0x5f305f3,0x5f305f3,0x5f305f3,0x5f305f3,0x5f305f3,0x5f305f3,0x5f305f3,0x5f305f3
.long 0x2f602f5,0x2f002f7,0xa010a00,0x2f50a02,0x2f502f5,0x2f502f5,0x2f502f5,0x2f502f5,0x2f502f5,0x2f502f5,0x2f502f5,0x2f502f5,0x2f502f5,0x2f502f5,0x2f502f5,0x2f502f5
.long 0x2f502f5,0x2f502f5,0x2f502f5,0x2f502f5,0x2f502f5,0x2f502f5,0x2f502f5,0x2f502f5,0x2f502f5,0x2f502f5,0x2f502f5,0x2f502f5,0x2f502f5,0x2f502f5,0x2f502f5,0x2f502f5
.long 0x2e802e8,0x2e802e8,0x2e802e8,0x2e802e8,0x2e802e8,0x2e802e8,0x2e802e8,0x2e802e8,0x2e802e8,0x2e802e8,0x2e802e8,0x2e802e8,0x2e802e8,0x2e802e8,0x2e802e8,0x2e802e8
.long 0x2e802e8,0x2e802e8,0x2e802e8,0x2e802e8,0x2e802e8,0x2e802e8,0x2e802e8,0x2e802e8,0x2e802e8,0x2e802e8,0x2e802e8,0x2e802e8,0x2e802e8,0x2e802e8,0x2e802e8,0x2e802e8
.long 0x6e206da,0x6f206ea,0x6e306db,0x6f306eb,0x6e406dc,0xcda06ec,0xcdc0cdb,0xcde0cdd,0xce20cdf,0xce40ce3,0xce60ce5,0xcea0ce7,0xcec0ceb,0xcee0ced,0xcf20cef,0xcf40cf3
.long 0xcf60cf5,0xcfb0cf7,0x6da06da,0x6da06da,0x6da06da,0x6da06da,0x6da06da,0x6da06da,0x6da06da,0x6da06da,0x6da06da,0x6da06da,0x6da06da,0x6da06da,0x6da06da,0x6da06da
.long 0x2f602f5,0x2f002f7,0xa010a00,0x2f50a02,0x2f502f5,0x2f502f5,0x2f502f5,0x2f502f5,0x2f502f5,0x2f502f5,0x2f502f5,0x2f502f5,0x2f502f5,0x2f502f5,0x2f502f5,0x2f502f5
.long 0x2f502f5,0x2f502f5,0x2f502f5,0x2f502f5,0x2f502f5,0x2f502f5,0x2f502f5,0x2f502f5,0x2f502f5,0x2f502f5,0x2f502f5,0x2f502f5,0x2f502f5,0x2f502f5,0x2f502f5,0x2f502f5
.long 0x2e902e9,0x2e902e9,0x2e902e9,0x2e902e9,0x2e902e9,0x2e902e9,0x2e902e9,0x2e902e9,0x2e902e9,0x2e902e9,0x2e902e9,0x2e902e9,0x2e902e9,0x2e902e9,0x2e902e9,0x2e902e9
.long 0x2e902e9,0x2e902e9,0x2e902e9,0x2e902e9,0x2e902e9,0x2e902e9,0x2e902e9,0x2e902e9,0x2e902e9,0x2e902e9,0x2e902e9,0x2e902e9,0x2e902e9,0x2e902e9,0x2e902e9,0x2e902e9
.long 0x68c06f4,0x6e506dd,0x6de06ed,0x6ee06e6,0x6e706df,0xcda06ef,0xcdc0cdb,0xcde0cdd,0xce20cdf,0xce40ce3,0xce60ce5,0xcea0ce7,0xcec0ceb,0xcee0ced,0xcf20cef,0xcf40cf3
.long 0xcf60cf5,0xcfb0cf7,0x6f406f4,0x6f406f4,0x6f406f4,0x6f406f4,0x6f406f4,0x6f406f4,0x6f406f4,0x6f406f4,0x6f406f4,0x6f406f4,0x6f406f4,0x6f406f4,0x6f406f4,0x6f406f4
.long 0x2f602f5,0x2f002f7,0xa010a00,0x2f50a02,0x2f502f5,0x2f502f5,0x2f502f5,0x2f502f5,0x2f502f5,0x2f502f5,0x2f502f5,0x2f502f5,0x2f502f5,0x2f502f5,0x2f502f5,0x2f502f5
.long 0x2f502f5,0x2f502f5,0x2f502f5,0x2f502f5,0x2f502f5,0x2f502f5,0x2f502f5,0x2f502f5,0x2f502f5,0x2f502f5,0x2f502f5,0x2f502f5,0x2f502f5,0x2f502f5,0x2f502f5,0x2f502f5
.long 0x4240404,0x4640444,0x4060484,0x4460426,0x40c0466,0x44c042c,0x48c046c,0x42e040e,0x46e044e,0x4d904d8,0x4e104e0,0x4e904e8,0x4db04da,0x40404dc,0x4040404,0x4040404
.long 0x4040404,0x4040404,0x4040404,0x4040404,0x4040404,0x4040404,0x4040404,0x4040404,0x4040404,0x4040404,0x4040404,0x4040404,0x4040404,0x4040404,0x4040404,0x4040404
.long 0xc7805eb,0xc7a0c79,0xc7d0c7c,0xc800c7e,0xc820c81,0xc840c83,0xc860c85,0xc880c87,0xc8a0c89,0xc8e0c8d,0xcd80c8f,0xce00cd9,0xce80ce1,0xcf00ce9,0xcf80cf1,0xcfa0cf9
.long 0xcfc0cfb,0xcfe0cfd,0x5eb0cff,0x5eb05eb,0x5eb05eb,0x5eb05eb,0x5eb05eb,0x5eb05eb,0x5eb05eb,0x5eb05eb,0x5eb05eb,0x5eb05eb,0x5eb05eb,0x5eb05eb,0x5eb05eb,0x5eb05eb
.long 0x2f602f5,0x2f002f7,0xa010a00,0x2f50a02,0x2f502f5,0x2f502f5,0x2f502f5,0x2f502f5,0x2f502f5,0x2f502f5,0x2f502f5,0x2f502f5,0x2f502f5,0x2f502f5,0x2f502f5,0x2f502f5
.long 0x2f502f5,0x2f502f5,0x2f502f5,0x2f502f5,0x2f502f5,0x2f502f5,0x2f502f5,0x2f502f5,0x2f502f5,0x2f502f5,0x2f502f5,0x2f502f5,0x2f502f5,0x2f502f5,0x2f502f5,0x2f502f5
.long 0x4340414,0x4740454,0x4160486,0x4560436,0x4d80476,0x4e004d9,0x4e804e1,0x4da04e9,0x4dc04db,0x4140414,0x4140414,0x4140414,0x4140414,0x4140414,0x4140414,0x4140414
.long 0x4140414,0x4140414,0x4140414,0x4140414,0x4140414,0x4140414,0x4140414,0x4140414,0x4140414,0x4140414,0x4140414,0x4140414,0x4140414,0x4140414,0x4140414,0x4140414
.long 0xc7805ec,0xc7a0c79,0xc7d0c7c,0xc800c7e,0xc820c81,0xc840c83,0xc860c85,0xc880c87,0xc8a0c89,0xc8e0c8d,0xcd80c8f,0xce00cd9,0xce80ce1,0xcf00ce9,0xcf80cf1,0xcfa0cf9
.long 0xcfc0cfb,0xcfe0cfd,0x5ec0cff,0x5ec05ec,0x5ec05ec,0x5ec05ec,0x5ec05ec,0x5ec05ec,0x5ec05ec,0x5ec05ec,0x5ec05ec,0x5ec05ec,0x5ec05ec,0x5ec05ec,0x5ec05ec,0x5ec05ec
.long 0x2f602f5,0x2f002f7,0xa010a00,0x2f50a02,0x2f502f5,0x2f502f5,0x2f502f5,0x2f502f5,0x2f502f5,0x2f502f5,0x2f502f5,0x2f502f5,0x2f502f5,0x2f502f5,0x2f502f5,0x2f502f5
.long 0x2f502f5,0x2f502f5,0x2f502f5,0x2f502f5,0x2f502f5,0x2f502f5,0x2f502f5,0x2f502f5,0x2f502f5,0x2f502f5,0x2f502f5,0x2f502f5,0x2f502f5,0x2f502f5,0x2f502f5,0x2f502f5
.long 0x43c041c,0x47c045c,0x41e048e,0x45e043e,0x4dd047e,0x4df04de,0x4e304e2,0x4e504e4,0x4e704e6,0x4d904d8,0x4e104e0,0x4e904e8,0x4db04da,0x41c04dc,0x41c041c,0x41c041c
.long 0x41c041c,0x41c041c,0x41c041c,0x41c041c,0x41c041c,0x41c041c,0x41c041c,0x41c041c,0x41c041c,0x41c041c,0x41c041c,0x41c041c,0x41c041c,0x41c041c,0x41c041c,0x41c041c
.long 0xc7805ee,0xc7a0c79,0xc7d0c7c,0xc800c7e,0xc820c81,0xc840c83,0xc860c85,0xc880c87,0xc8a0c89,0xc8e0c8d,0xcd80c8f,0xce00cd9,0xce80ce1,0xcf00ce9,0xcf80cf1,0xcfa0cf9
.long 0xcfc0cfb,0xcfe0cfd,0x5ee0cff,0x5ee05ee,0x5ee05ee,0x5ee05ee,0x5ee05ee,0x5ee05ee,0x5ee05ee,0x5ee05ee,0x5ee05ee,0x5ee05ee,0x5ee05ee,0x5ee05ee,0x5ee05ee,0x5ee05ee
.long 0x2f602f5,0x2f002f7,0xa010a00,0x2f50a02,0x2f502f5,0x2f502f5,0x2f502f5,0x2f502f5,0x2f502f5,0x2f502f5,0x2f502f5,0x2f502f5,0x2f502f5,0x2f502f5,0x2f502f5,0x2f502f5
.long 0x2f502f5,0x2f502f5,0x2f502f5,0x2f502f5,0x2f502f5,0x2f502f5,0x2f502f5,0x2f502f5,0x2f502f5,0x2f502f5,0x2f502f5,0x2f502f5,0x2f502f5,0x2f502f5,0x2f502f5,0x2f502f5
.long 0x42d040d,0x46d044d,0x40f048d,0x44f042f,0x4d8046f,0x4e004d9,0x4e804e1,0x4da04e9,0x4dc04db,0x40d040d,0x40d040d,0x40d040d,0x40d040d,0x40d040d,0x40d040d,0x40d040d
.long 0x40d040d,0x40d040d,0x40d040d,0x40d040d,0x40d040d,0x40d040d,0x40d040d,0x40d040d,0x40d040d,0x40d040d,0x40d040d,0x40d040d,0x40d040d,0x40d040d,0x40d040d,0x40d040d
.long 0xc7805ef,0xc7a0c79,0xc7d0c7c,0xc800c7e,0xc820c81,0xc840c83,0xc860c85,0xc880c87,0xc8a0c89,0xc8e0c8d,0xcd80c8f,0xce00cd9,0xce80ce1,0xcf00ce9,0xcf80cf1,0xcfa0cf9
.long 0xcfc0cfb,0xcfe0cfd,0x5ef0cff,0x5ef05ef,0x5ef05ef,0x5ef05ef,0x5ef05ef,0x5ef05ef,0x5ef05ef,0x5ef05ef,0x5ef05ef,0x5ef05ef,0x5ef05ef,0x5ef05ef,0x5ef05ef,0x5ef05ef
.long 0x2f602f5,0x2f002f7,0xa010a00,0x2f50a02,0x2f502f5,0x2f502f5,0x2f502f5,0x2f502f5,0x2f502f5,0x2f502f5,0x2f502f5,0x2f502f5,0x2f502f5,0x2f502f5,0x2f502f5,0x2f502f5
.long 0x2f502f5,0x2f502f5,0x2f502f5,0x2f502f5,0x2f502f5,0x2f502f5,0x2f502f5,0x2f502f5,0x2f502f5,0x2f502f5,0x2f502f5,0x2f502f5,0x2f502f5,0x2f502f5,0x2f502f5,0x2f502f5
.long 0x4350415,0x4750455,0x4170487,0x4570437,0x4d80477,0x4e004d9,0x4e804e1,0x4da04e9,0x4dc04db,0x4150415,0x4150415,0x4150415,0x4150415,0x4150415,0x4150415,0x4150415
.long 0x4150415,0x4150415,0x4150415,0x4150415,0x4150415,0x4150415,0x4150415,0x4150415,0x4150415,0x4150415,0x4150415,0x4150415,0x4150415,0x4150415,0x4150415,0x4150415
.long 0xc7805f3,0xc7a0c79,0xc7d0c7c,0xc800c7e,0xc820c81,0xc840c83,0xc860c85,0xc880c87,0xc8a0c89,0xc8e0c8d,0xcd80c8f,0xce00cd9,0xce80ce1,0xcf00ce9,0xcf80cf1,0xcfa0cf9
.long 0xcfc0cfb,0xcfe0cfd,0x5f30cff,0x5f305f3,0x5f305f3,0x5f305f3,0x5f305f3,0x5f305f3,0x5f305f3,0x5f305f3,0x5f305f3,0x5f305f3,0x5f305f3,0x5f305f3,0x5f305f3,0x5f305f3
.long 0x2f602f5,0x2f002f7,0xa010a00,0x2f50a02,0x2f502f5,0x2f502f5,0x2f502f5,0x2f502f5,0x2f502f5,0x2f502f5,0x2f502f5,0x2f502f5,0x2f502f5,0x2f502f5,0x2f502f5,0x2f502f5
.long 0x2f502f5,0x2f502f5,0x2f502f5,0x2f502f5,0x2f502f5,0x2f502f5,0x2f502f5,0x2f502f5,0x2f502f5,0x2f502f5,0x2f502f5,0x2f502f5,0x2f502f5,0x2f502f5,0x2f502f5,0x2f502f5
.long 0x43d041d,0x47d045d,0x41f048f,0x45f043f,0x4dd047f,0x4df04de,0x4e304e2,0x4e504e4,0x4e704e6,0x4d904d8,0x4e104e0,0x4e904e8,0x4db04da,0x41d04dc,0x41d041d,0x41d041d
.long 0x41d041d,0x41d041d,0x41d041d,0x41d041d,0x41d041d,0x41d041d,0x41d041d,0x41d041d,0x41d041d,0x41d041d,0x41d041d,0x41d041d,0x41d041d,0x41d041d,0x41d041d,0x41d041d
.long 0xc7805f4,0xc7a0c79,0xc7d0c7c,0xc800c7e,0xc820c81,0xc840c83,0xc860c85,0xc880c87,0xc8a0c89,0xc8e0c8d,0xcd80c8f,0xce00cd9,0xce80ce1,0xcf00ce9,0xcf80cf1,0xcfa0cf9
.long 0xcfc0cfb,0xcfe0cfd,0x5f40cff,0x5f405f4,0x5f405f4,0x5f405f4,0x5f405f4,0x5f405f4,0x5f405f4,0x5f405f4,0x5f405f4,0x5f405f4,0x5f405f4,0x5f405f4,0x5f405f4,0x5f405f4
.long 0x2010200,0x2000202,0x2000200,0x2000200,0x2000200,0x2000200,0x2000200,0x2000200,0x2000200,0x2000200,0x2000200,0x2000200,0x2000200,0x2000200,0x2000200,0x2000200
.long 0x2000200,0x2000200,0x2000200,0x2000200,0x2000200,0x2000200,0x2000200,0x2000200,0x2000200,0x2000200,0x2000200,0x2000200,0x2000200,0x2000200,0x2000200,0x2000200
.long 0x2f002f0,0x2f002f0,0x2f002f0,0x2f002f0,0x2f002f0,0x2f002f0,0x2f002f0,0x2f002f0,0x2f002f0,0x2f002f0,0x2f002f0,0x2f002f0,0x2f002f0,0x2f002f0,0x2f002f0,0x2f002f0
.long 0x2f002f0,0x2f002f0,0x2f002f0,0x2f002f0,0x2f002f0,0x2f002f0,0x2f002f0,0x2f002f0,0x2f002f0,0x2f002f0,0x2f002f0,0x2f002f0,0x2f002f0,0x2f002f0,0x2f002f0,0x2f002f0
.long 0x6e206da,0x6f206ea,0x6e306db,0x6f306eb,0x6e406dc,0xcda06ec,0xcdc0cdb,0xcde0cdd,0xce20cdf,0xce40ce3,0xce60ce5,0xcea0ce7,0xcec0ceb,0xcee0ced,0xcf20cef,0xcf40cf3
.long 0xcf60cf5,0xcfb0cf7,0x6da06da,0x6da06da,0x6da06da,0x6da06da,0x6da06da,0x6da06da,0x6da06da,0x6da06da,0x6da06da,0x6da06da,0x6da06da,0x6da06da,0x6da06da,0x6da06da
.long 0x2010200,0x2000202,0x2000200,0x2000200,0x2000200,0x2000200,0x2000200,0x2000200,0x2000200,0x2000200,0x2000200,0x2000200,0x2000200,0x2000200,0x2000200,0x2000200
.long 0x2000200,0x2000200,0x2000200,0x2000200,0x2000200,0x2000200,0x2000200,0x2000200,0x2000200,0x2000200,0x2000200,0x2000200,0x2000200,0x2000200,0x2000200,0x2000200
.long 0x2f102f1,0x2f102f1,0x2f102f1,0x2f102f1,0x2f102f1,0x2f102f1,0x2f102f1,0x2f102f1,0x2f102f1,0x2f102f1,0x2f102f1,0x2f102f1,0x2f102f1,0x2f102f1,0x2f102f1,0x2f102f1
.long 0x2f102f1,0x2f102f1,0x2f102f1,0x2f102f1,0x2f102f1,0x2f102f1,0x2f102f1,0x2f102f1,0x2f102f1,0x2f102f1,0x2f102f1,0x2f102f1,0x2f102f1,0x2f102f1,0x2f102f1,0x2f102f1
.long 0x68c06f4,0x6e506dd,0x6de06ed,0x6ee06e6,0x6e706df,0xcda06ef,0xcdc0cdb,0xcde0cdd,0xce20cdf,0xce40ce3,0xce60ce5,0xcea0ce7,0xcec0ceb,0xcee0ced,0xcf20cef,0xcf40cf3
.long 0xcf60cf5,0xcfc0cf7,0x6f406f4,0x6f406f4,0x6f406f4,0x6f406f4,0x6f406f4,0x6f406f4,0x6f406f4,0x6f406f4,0x6f406f4,0x6f406f4,0x6f406f4,0x6f406f4,0x6f406f4,0x6f406f4
.long 0x2f602f5,0x2f002f7,0xa010a00,0x2f50a02,0x2f502f5,0x2f502f5,0x2f502f5,0x2f502f5,0x2f502f5,0x2f502f5,0x2f502f5,0x2f502f5,0x2f502f5,0x2f502f5,0x2f502f5,0x2f502f5
.long 0x2f502f5,0x2f502f5,0x2f502f5,0x2f502f5,0x2f502f5,0x2f502f5,0x2f502f5,0x2f502f5,0x2f502f5,0x2f502f5,0x2f502f5,0x2f502f5,0x2f502f5,0x2f502f5,0x2f502f5,0x2f502f5
.long 0x42c040c,0x46c044c,0x40e048c,0x44e042e,0x4d8046e,0x4e004d9,0x4e804e1,0x4da04e9,0x4dc04db,0x40c040c,0x40c040c,0x40c040c,0x40c040c,0x40c040c,0x40c040c,0x40c040c
.long 0x40c040c,0x40c040c,0x40c040c,0x40c040c,0x40c040c,0x40c040c,0x40c040c,0x40c040c,0x40c040c,0x40c040c,0x40c040c,0x40c040c,0x40c040c,0x40c040c,0x40c040c,0x40c040c
.long 0x5eb05ea,0xc790c78,0xc7c0c7a,0xc7e0c7d,0xc810c80,0xc830c82,0xc850c84,0xc870c86,0xc890c88,0xc8d0c8a,0xc8f0c8e,0xcd90cd8,0xce10ce0,0xce90ce8,0xcf10cf0,0xcf90cf8
.long 0xcfb0cfa,0xcfd0cfc,0xcff0cfe,0x5ea05ea,0x5ea05ea,0x5ea05ea,0x5ea05ea,0x5ea05ea,0x5ea05ea,0x5ea05ea,0x5ea05ea,0x5ea05ea,0x5ea05ea,0x5ea05ea,0x5ea05ea,0x5ea05ea
.long 0x2f602f5,0x2f002f7,0xa010a00,0x2f50a02,0x2f502f5,0x2f502f5,0x2f502f5,0x2f502f5,0x2f502f5,0x2f502f5,0x2f502f5,0x2f502f5,0x2f502f5,0x2f502f5,0x2f502f5,0x2f502f5
.long 0x2f502f5,0x2f502f5,0x2f502f5,0x2f502f5,0x2f502f5,0x2f502f5,0x2f502f5,0x2f502f5,0x2f502f5,0x2f502f5,0x2f502f5,0x2f502f5,0x2f502f5,0x2f502f5,0x2f502f5,0x2f502f5
.long 0x4340414,0x4740454,0x4160486,0x4560436,0x4d80476,0x4e004d9,0x4e804e1,0x4da04e9,0x4dc04db,0x4140414,0x4140414,0x4140414,0x4140414,0x4140414,0x4140414,0x4140414
.long 0x4140414,0x4140414,0x4140414,0x4140414,0x4140414,0x4140414,0x4140414,0x4140414,0x4140414,0x4140414,0x4140414,0x4140414,0x4140414,0x4140414,0x4140414,0x4140414
.long 0xc7805ec,0xc7a0c79,0xc7d0c7c,0xc800c7e,0xc820c81,0xc840c83,0xc860c85,0xc880c87,0xc8a0c89,0xc8e0c8d,0xcd80c8f,0xce00cd9,0xce80ce1,0xcf00ce9,0xcf80cf1,0xcfa0cf9
.long 0xcfc0cfb,0xcfe0cfd,0x5ec0cff,0x5ec05ec,0x5ec05ec,0x5ec05ec,0x5ec05ec,0x5ec05ec,0x5ec05ec,0x5ec05ec,0x5ec05ec,0x5ec05ec,0x5ec05ec,0x5ec05ec,0x5ec05ec,0x5ec05ec
.long 0x2f602f5,0x2f002f7,0xa010a00,0x2f50a02,0x2f502f5,0x2f502f5,0x2f502f5,0x2f502f5,0x2f502f5,0x2f502f5,0x2f502f5,0x2f502f5,0x2f502f5,0x2f502f5,0x2f502f5,0x2f502f5
.long 0x2f502f5,0x2f502f5,0x2f502f5,0x2f502f5,0x2f502f5,0x2f502f5,0x2f502f5,0x2f502f5,0x2f502f5,0x2f502f5,0x2f502f5,0x2f502f5,0x2f502f5,0x2f502f5,0x2f502f5,0x2f502f5
.long 0x4250405,0x4650445,0x4070485,0x4470427,0x4d80467,0x4e004d9,0x4e804e1,0x4da04e9,0x4dc04db,0x4050405,0x4050405,0x4050405,0x4050405,0x4050405,0x4050405,0x4050405
.long 0x4050405,0x4050405,0x4050405,0x4050405,0x4050405,0x4050405,0x4050405,0x4050405,0x4050405,0x4050405,0x4050405,0x4050405,0x4050405,0x4050405,0x4050405,0x4050405
.long 0x5ee05ed,0xc790c78,0xc7c0c7a,0xc7e0c7d,0xc810c80,0xc830c82,0xc850c84,0xc870c86,0xc890c88,0xc8d0c8a,0xc8f0c8e,0xcd90cd8,0xce10ce0,0xce90ce8,0xcf10cf0,0xcf90cf8
.long 0xcfb0cfa,0xcfd0cfc,0xcff0cfe,0x5ed05ed,0x5ed05ed,0x5ed05ed,0x5ed05ed,0x5ed05ed,0x5ed05ed,0x5ed05ed,0x5ed05ed,0x5ed05ed,0x5ed05ed,0x5ed05ed,0x5ed05ed,0x5ed05ed
.long 0x2010200,0x2000202,0x2000200,0x2000200,0x2000200,0x2000200,0x2000200,0x2000200,0x2000200,0x2000200,0x2000200,0x2000200,0x2000200,0x2000200,0x2000200,0x2000200
.long 0x2000200,0x2000200,0x2000200,0x2000200,0x2000200,0x2000200,0x2000200,0x2000200,0x2000200,0x2000200,0x2000200,0x2000200,0x2000200,0x2000200,0x2000200,0x2000200
.long 0x2f502f5,0x2f502f5,0x2f502f5,0x2f502f5,0x2f502f5,0x2f502f5,0x2f502f5,0x2f502f5,0x2f502f5,0x2f502f5,0x2f502f5,0x2f502f5,0x2f502f5,0x2f502f5,0x2f502f5,0x2f502f5
.long 0x2f502f5,0x2f502f5,0x2f502f5,0x2f502f5,0x2f502f5,0x2f502f5,0x2f502f5,0x2f502f5,0x2f502f5,0x2f502f5,0x2f502f5,0x2f502f5,0x2f502f5,0x2f502f5,0x2f502f5,0x2f502f5
.long 0xc7805ef,0xc7a0c79,0xc7d0c7c,0xc800c7e,0xc820c81,0xc840c83,0xc860c85,0xc880c87,0xc8a0c89,0xc8e0c8d,0xcd80c8f,0xce00cd9,0xce80ce1,0xcf00ce9,0xcf80cf1,0xcfa0cf9
.long 0xcfc0cfb,0xcfe0cfd,0x5ef0cff,0x5ef05ef,0x5ef05ef,0x5ef05ef,0x5ef05ef,0x5ef05ef,0x5ef05ef,0x5ef05ef,0x5ef05ef,0x5ef05ef,0x5ef05ef,0x5ef05ef,0x5ef05ef,0x5ef05ef
.long 0x2010200,0x2000202,0x2000200,0x2000200,0x2000200,0x2000200,0x2000200,0x2000200,0x2000200,0x2000200,0x2000200,0x2000200,0x2000200,0x2000200,0x2000200,0x2000200
.long 0x2000200,0x2000200,0x2000200,0x2000200,0x2000200,0x2000200,0x2000200,0x2000200,0x2000200,0x2000200,0x2000200,0x2000200,0x2000200,0x2000200,0x2000200,0x2000200
.long 0x2f602f6,0x2f602f6,0x2f602f6,0x2f602f6,0x2f602f6,0x2f602f6,0x2f602f6,0x2f602f6,0x2f602f6,0x2f602f6,0x2f602f6,0x2f602f6,0x2f602f6,0x2f602f6,0x2f602f6,0x2f602f6
.long 0x2f602f6,0x2f602f6,0x2f602f6,0x2f602f6,0x2f602f6,0x2f602f6,0x2f602f6,0x2f602f6,0x2f602f6,0x2f602f6,0x2f602f6,0x2f602f6,0x2f602f6,0x2f602f6,0x2f602f6,0x2f602f6
.long 0x5f305f2,0xc790c78,0xc7c0c7a,0xc7e0c7d,0xc810c80,0xc830c82,0xc850c84,0xc870c86,0xc890c88,0xc8d0c8a,0xc8f0c8e,0xcd90cd8,0xce10ce0,0xce90ce8,0xcf10cf0,0xcf90cf8
.long 0xcfb0cfa,0xcfd0cfc,0xcff0cfe,0x5f205f2,0x5f205f2,0x5f205f2,0x5f205f2,0x5f205f2,0x5f205f2,0x5f205f2,0x5f205f2,0x5f205f2,0x5f205f2,0x5f205f2,0x5f205f2,0x5f205f2
.long 0x2010200,0x2000202,0x2000200,0x2000200,0x2000200,0x2000200,0x2000200,0x2000200,0x2000200,0x2000200,0x2000200,0x2000200,0x2000200,0x2000200,0x2000200,0x2000200
.long 0x2000200,0x2000200,0x2000200,0x2000200,0x2000200,0x2000200,0x2000200,0x2000200,0x2000200,0x2000200,0x2000200,0x2000200,0x2000200,0x2000200,0x2000200,0x2000200
.long 0x2f702f7,0x2f702f7,0x2f702f7,0x2f702f7,0x2f702f7,0x2f702f7,0x2f702f7,0x2f702f7,0x2f702f7,0x2f702f7,0x2f702f7,0x2f702f7,0x2f702f7,0x2f702f7,0x2f702f7,0x2f702f7
.long 0x2f702f7,0x2f702f7,0x2f702f7,0x2f702f7,0x2f702f7,0x2f702f7,0x2f702f7,0x2f702f7,0x2f702f7,0x2f702f7,0x2f702f7,0x2f702f7,0x2f702f7,0x2f702f7,0x2f702f7,0x2f702f7
.long 0xc7805f4,0xc7a0c79,0xc7d0c7c,0xc800c7e,0xc820c81,0xc840c83,0xc860c85,0xc880c87,0xc8a0c89,0xc8e0c8d,0xcd80c8f,0xce00cd9,0xce80ce1,0xcf00ce9,0xcf80cf1,0xcfa0cf9
.long 0xcfc0cfb,0xcfe0cfd,0x5f40cff,0x5f405f4,0x5f405f4,0x5f405f4,0x5f405f4,0x5f405f4,0x5f405f4,0x5f405f4,0x5f405f4,0x5f405f4,0x5f405f4,0x5f405f4,0x5f405f4,0x5f405f4
.long 0x2010200,0x2000202,0x2000200,0x2000200,0x2000200,0x2000200,0x2000200,0x2000200,0x2000200,0x2000200,0x2000200,0x2000200,0x2000200,0x2000200,0x2000200,0x2000200
.long 0x2000200,0x2000200,0x2000200,0x2000200,0x2000200,0x2000200,0x2000200,0x2000200,0x2000200,0x2000200,0x2000200,0x2000200,0x2000200,0x2000200,0x2000200,0x2000200
.long 0x2f802f8,0x2f802f8,0x2f802f8,0x2f802f8,0x2f802f8,0x2f802f8,0x2f802f8,0x2f802f8,0x2f802f8,0x2f802f8,0x2f802f8,0x2f802f8,0x2f802f8,0x2f802f8,0x2f802f8,0x2f802f8
.long 0x2f802f8,0x2f802f8,0x2f802f8,0x2f802f8,0x2f802f8,0x2f802f8,0x2f802f8,0x2f802f8,0x2f802f8,0x2f802f8,0x2f802f8,0x2f802f8,0x2f802f8,0x2f802f8,0x2f802f8,0x2f802f8
.long 0x6e206da,0x6f206ea,0x6e306db,0x6f306eb,0x6e406dc,0xcda06ec,0xcdc0cdb,0xcde0cdd,0xce20cdf,0xce40ce3,0xce60ce5,0xcea0ce7,0xcec0ceb,0xcee0ced,0xcf20cef,0xcf40cf3
.long 0xcf60cf5,0xcfc0cf7,0x6da06da,0x6da06da,0x6da06da,0x6da06da,0x6da06da,0x6da06da,0x6da06da,0x6da06da,0x6da06da,0x6da06da,0x6da06da,0x6da06da,0x6da06da,0x6da06da
.long 0x2010200,0x2000202,0x2000200,0x2000200,0x2000200,0x2000200,0x2000200,0x2000200,0x2000200,0x2000200,0x2000200,0x2000200,0x2000200,0x2000200,0x2000200,0x2000200
.long 0x2000200,0x2000200,0x2000200,0x2000200,0x2000200,0x2000200,0x2000200,0x2000200,0x2000200,0x2000200,0x2000200,0x2000200,0x2000200,0x2000200,0x2000200,0x2000200
.long 0x2f902f9,0x2f902f9,0x2f902f9,0x2f902f9,0x2f902f9,0x2f902f9,0x2f902f9,0x2f902f9,0x2f902f9,0x2f902f9,0x2f902f9,0x2f902f9,0x2f902f9,0x2f902f9,0x2f902f9,0x2f902f9
.long 0x2f902f9,0x2f902f9,0x2f902f9,0x2f902f9,0x2f902f9,0x2f902f9,0x2f902f9,0x2f902f9,0x2f902f9,0x2f902f9,0x2f902f9,0x2f902f9,0x2f902f9,0x2f902f9,0x2f902f9,0x2f902f9
.long 0x68c06f4,0x6e506dd,0x6de06ed,0x6ee06e6,0x6e706df,0xcda06ef,0xcdc0cdb,0xcde0cdd,0xce20cdf,0xce40ce3,0xce60ce5,0xcea0ce7,0xcec0ceb,0xcee0ced,0xcf20cef,0xcf40cf3
.long 0xcf60cf5,0xcfc0cf7,0x6f406f4,0x6f406f4,0x6f406f4,0x6f406f4,0x6f406f4,0x6f406f4,0x6f406f4,0x6f406f4,0x6f406f4,0x6f406f4,0x6f406f4,0x6f406f4,0x6f406f4,0x6f406f4
.long 0x2010200,0x2000202,0x2000200,0x2000200,0x2000200,0x2000200,0x2000200,0x2000200,0x2000200,0x2000200,0x2000200,0x2000200,0x2000200,0x2000200,0x2000200,0x2000200
.long 0x2000200,0x2000200,0x2000200,0x2000200,0x2000200,0x2000200,0x2000200,0x2000200,0x2000200,0x2000200,0x2000200,0x2000200,0x2000200,0x2000200,0x2000200,0x2000200
.long 0x2fa02fa,0x2fa02fa,0x2fa02fa,0x2fa02fa,0x2fa02fa,0x2fa02fa,0x2fa02fa,0x2fa02fa,0x2fa02fa,0x2fa02fa,0x2fa02fa,0x2fa02fa,0x2fa02fa,0x2fa02fa,0x2fa02fa,0x2fa02fa
.long 0x2fa02fa,0x2fa02fa,0x2fa02fa,0x2fa02fa,0x2fa02fa,0x2fa02fa,0x2fa02fa,0x2fa02fa,0x2fa02fa,0x2fa02fa,0x2fa02fa,0x2fa02fa,0x2fa02fa,0x2fa02fa,0x2fa02fa,0x2fa02fa
.long 0x6e206da,0x6f206ea,0x6e306db,0x6f306eb,0x6e406dc,0xcda06ec,0xcdc0cdb,0xcde0cdd,0xce20cdf,0xce40ce3,0xce60ce5,0xcea0ce7,0xcec0ceb,0xcee0ced,0xcf20cef,0xcf40cf3
.long 0xcf60cf5,0xcfc0cf7,0x6da06da,0x6da06da,0x6da06da,0x6da06da,0x6da06da,0x6da06da,0x6da06da,0x6da06da,0x6da06da,0x6da06da,0x6da06da,0x6da06da,0x6da06da,0x6da06da
.long 0x2010200,0x2000202,0x2000200,0x2000200,0x2000200,0x2000200,0x2000200,0x2000200,0x2000200,0x2000200,0x2000200,0x2000200,0x2000200,0x2000200,0x2000200,0x2000200
.long 0x2000200,0x2000200,0x2000200,0x2000200,0x2000200,0x2000200,0x2000200,0x2000200,0x2000200,0x2000200,0x2000200,0x2000200,0x2000200,0x2000200,0x2000200,0x2000200
.long 0x2fb02fb,0x2fb02fb,0x2fb02fb,0x2fb02fb,0x2fb02fb,0x2fb02fb,0x2fb02fb,0x2fb02fb,0x2fb02fb,0x2fb02fb,0x2fb02fb,0x2fb02fb,0x2fb02fb,0x2fb02fb,0x2fb02fb,0x2fb02fb
.long 0x2fb02fb,0x2fb02fb,0x2fb02fb,0x2fb02fb,0x2fb02fb,0x2fb02fb,0x2fb02fb,0x2fb02fb,0x2fb02fb,0x2fb02fb,0x2fb02fb,0x2fb02fb,0x2fb02fb,0x2fb02fb,0x2fb02fb,0x2fb02fb
.long 0x68c06f4,0x6e506dd,0x6de06ed,0x6ee06e6,0x6e706df,0xcda06ef,0xcdc0cdb,0xcde0cdd,0xce20cdf,0xce40ce3,0xce60ce5,0xcea0ce7,0xcec0ceb,0xcee0ced,0xcf20cef,0xcf40cf3
.long 0xcf60cf5,0xcfd0cf7,0x6f406f4,0x6f406f4,0x6f406f4,0x6f406f4,0x6f406f4,0x6f406f4,0x6f406f4,0x6f406f4,0x6f406f4,0x6f406f4,0x6f406f4,0x6f406f4,0x6f406f4,0x6f406f4
.long 0x2010200,0x2000202,0x2000200,0x2000200,0x2000200,0x2000200,0x2000200,0x2000200,0x2000200,0x2000200,0x2000200,0x2000200,0x2000200,0x2000200,0x2000200,0x2000200
.long 0x2000200,0x2000200,0x2000200,0x2000200,0x2000200,0x2000200,0x2000200,0x2000200,0x2000200,0x2000200,0x2000200,0x2000200,0x2000200,0x2000200,0x2000200,0x2000200
.long 0x2fc02fc,0x2fc02fc,0x2fc02fc,0x2fc02fc,0x2fc02fc,0x2fc02fc,0x2fc02fc,0x2fc02fc,0x2fc02fc,0x2fc02fc,0x2fc02fc,0x2fc02fc,0x2fc02fc,0x2fc02fc,0x2fc02fc,0x2fc02fc
.long 0x2fc02fc,0x2fc02fc,0x2fc02fc,0x2fc02fc,0x2fc02fc,0x2fc02fc,0x2fc02fc,0x2fc02fc,0x2fc02fc,0x2fc02fc,0x2fc02fc,0x2fc02fc,0x2fc02fc,0x2fc02fc,0x2fc02fc,0x2fc02fc
.long 0x6e206da,0x6f206ea,0x6e306db,0x6f306eb,0x6e406dc,0xcda06ec,0xcdc0cdb,0xcde0cdd,0xce20cdf,0xce40ce3,0xce60ce5,0xcea0ce7,0xcec0ceb,0xcee0ced,0xcf20cef,0xcf40cf3
.long 0xcf60cf5,0xcfd0cf7,0x6da06da,0x6da06da,0x6da06da,0x6da06da,0x6da06da,0x6da06da,0x6da06da,0x6da06da,0x6da06da,0x6da06da,0x6da06da,0x6da06da,0x6da06da,0x6da06da
.long 0x2010200,0x2000202,0x2000200,0x2000200,0x2000200,0x2000200,0x2000200,0x2000200,0x2000200,0x2000200,0x2000200,0x2000200,0x2000200,0x2000200,0x2000200,0x2000200
.long 0x2000200,0x2000200,0x2000200,0x2000200,0x2000200,0x2000200,0x2000200,0x2000200,0x2000200,0x2000200,0x2000200,0x2000200,0x2000200,0x2000200,0x2000200,0x2000200
.long 0x2fd02fd,0x2fd02fd,0x2fd02fd,0x2fd02fd,0x2fd02fd,0x2fd02fd,0x2fd02fd,0x2fd02fd,0x2fd02fd,0x2fd02fd,0x2fd02fd,0x2fd02fd,0x2fd02fd,0x2fd02fd,0x2fd02fd,0x2fd02fd
.long 0x2fd02fd,0x2fd02fd,0x2fd02fd,0x2fd02fd,0x2fd02fd,0x2fd02fd,0x2fd02fd,0x2fd02fd,0x2fd02fd,0x2fd02fd,0x2fd02fd,0x2fd02fd,0x2fd02fd,0x2fd02fd,0x2fd02fd,0x2fd02fd
.long 0x68c06f4,0x6e506dd,0x6de06ed,0x6ee06e6,0x6e706df,0xcda06ef,0xcdc0cdb,0xcde0cdd,0xce20cdf,0xce40ce3,0xce60ce5,0xcea0ce7,0xcec0ceb,0xcee0ced,0xcf20cef,0xcf40cf3
.long 0xcf60cf5,0xcfd0cf7,0x6f406f4,0x6f406f4,0x6f406f4,0x6f406f4,0x6f406f4,0x6f406f4,0x6f406f4,0x6f406f4,0x6f406f4,0x6f406f4,0x6f406f4,0x6f406f4,0x6f406f4,0x6f406f4
.long 0x2010200,0x2000202,0x2000200,0x2000200,0x2000200,0x2000200,0x2000200,0x2000200,0x2000200,0x2000200,0x2000200,0x2000200,0x2000200,0x2000200,0x2000200,0x2000200
.long 0x2000200,0x2000200,0x2000200,0x2000200,0x2000200,0x2000200,0x2000200,0x2000200,0x2000200,0x2000200,0x2000200,0x2000200,0x2000200,0x2000200,0x2000200,0x2000200
.long 0x2fe02fe,0x2fe02fe,0x2fe02fe,0x2fe02fe,0x2fe02fe,0x2fe02fe,0x2fe02fe,0x2fe02fe,0x2fe02fe,0x2fe02fe,0x2fe02fe,0x2fe02fe,0x2fe02fe,0x2fe02fe,0x2fe02fe,0x2fe02fe
.long 0x2fe02fe,0x2fe02fe,0x2fe02fe,0x2fe02fe,0x2fe02fe,0x2fe02fe,0x2fe02fe,0x2fe02fe,0x2fe02fe,0x2fe02fe,0x2fe02fe,0x2fe02fe,0x2fe02fe,0x2fe02fe,0x2fe02fe,0x2fe02fe
.long 0x6e206da,0x6f206ea,0x6e306db,0x6f306eb,0x6e406dc,0xcda06ec,0xcdc0cdb,0xcde0cdd,0xce20cdf,0xce40ce3,0xce60ce5,0xcea0ce7,0xcec0ceb,0xcee0ced,0xcf20cef,0xcf40cf3
.long 0xcf60cf5,0xcfd0cf7,0x6da06da,0x6da06da,0x6da06da,0x6da06da,0x6da06da,0x6da06da,0x6da06da,0x6da06da,0x6da06da,0x6da06da,0x6da06da,0x6da06da,0x6da06da,0x6da06da
.long 0x2010200,0x2000202,0x2000200,0x2000200,0x2000200,0x2000200,0x2000200,0x2000200,0x2000200,0x2000200,0x2000200,0x2000200,0x2000200,0x2000200,0x2000200,0x2000200
.long 0x2000200,0x2000200,0x2000200,0x2000200,0x2000200,0x2000200,0x2000200,0x2000200,0x2000200,0x2000200,0x2000200,0x2000200,0x2000200,0x2000200,0x2000200,0x2000200
.long 0x2ff02ff,0x2ff02ff,0x2ff02ff,0x2ff02ff,0x2ff02ff,0x2ff02ff,0x2ff02ff,0x2ff02ff,0x2ff02ff,0x2ff02ff,0x2ff02ff,0x2ff02ff,0x2ff02ff,0x2ff02ff,0x2ff02ff,0x2ff02ff
.long 0x2ff02ff,0x2ff02ff,0x2ff02ff,0x2ff02ff,0x2ff02ff,0x2ff02ff,0x2ff02ff,0x2ff02ff,0x2ff02ff,0x2ff02ff,0x2ff02ff,0x2ff02ff,0x2ff02ff,0x2ff02ff,0x2ff02ff,0x2ff02ff
.long 0x68c06f4,0x6e506dd,0x6de06ed,0x6ee06e6,0x6e706df,0xcda06ef,0xcdc0cdb,0xcde0cdd,0xce20cdf,0xce40ce3,0xce60ce5,0xcea0ce7,0xcec0ceb,0xcee0ced,0xcf20cef,0xcf40cf3
.long 0xcf60cf5,0xcfe0cf7,0x6f406f4,0x6f406f4,0x6f406f4,0x6f406f4,0x6f406f4,0x6f406f4,0x6f406f4,0x6f406f4,0x6f406f4,0x6f406f4,0x6f406f4,0x6f406f4,0x6f406f4,0x6f406f4
.p2align 6
.amdhsa_kernel standalone__mm_dit__diffusion_kernel
  .amdhsa_next_free_vgpr 256
  .amdhsa_next_free_sgpr 102
  .amdhsa_accum_offset 256
  .amdhsa_group_segment_fixed_size 0
  .amdhsa_kernarg_size 96
  .amdhsa_user_sgpr_count 2
  .amdhsa_user_sgpr_kernarg_segment_ptr 1
  .amdhsa_system_sgpr_workgroup_id_x 1
.end_amdhsa_kernel
```
